```python
import torch

def _softmax(x, axis=-1):
    return torch.softmax(x, dim=axis)
def _gelu(x):
    return torch.nn.functional.gelu(x, approximate="tanh")
def _silu(x):
    return torch.nn.functional.silu(x)
def _sigmoid(x):
    return torch.sigmoid(x)
def _layernorm(x, axis=-1, eps=1e-5):
    m = x.mean(dim=axis, keepdim=True)
    v = x.var(dim=axis, keepdim=True, unbiased=False)
    return (x - m) / torch.sqrt(v + eps)
def _scatter_add(tgt, idx, src, axis=0):
    return tgt.clone().index_add_(axis, idx, src)
def _segment_sum(src, seg, n):
    out = torch.zeros((n,) + src.shape[1:], dtype=src.dtype)
    return out.index_add_(0, seg, src)
def _pad(x, pw):
    flat = tuple(v for pair in reversed(pw) for v in pair)
    return torch.nn.functional.pad(x, flat)

kernel_name = 'interleave_layers__mha_block__mixer_s_mlp__prompt'

def setup_inputs():

    _w = (lambda a: (lambda t: t.to(torch.bfloat16) if t.is_floating_point() else t)(torch.as_tensor(a)))
    def _A_setup():
        B, S, D, H = 1, 2048, 448, 16
        return {
            "x": _w((lambda *s: torch.randn(*s, dtype=torch.bfloat16) * 0.05)(B, S, D)),
            "wqkv": _w((lambda *s: torch.randn(*s, dtype=torch.bfloat16) * 0.05)(D, 3 * D)),
            "wo": _w((lambda *s: torch.randn(*s, dtype=torch.bfloat16) * 0.05)(D, D)),
        }
    _A_in = _A_setup()

    def _B_setup():
        B, S, D, F = 1, 2048, 448, 1792
        return {
            "x":  _w((lambda *s: torch.randn(*s, dtype=torch.bfloat16) * 0.05)(B, S, D)),
            "w1": _w((lambda *s: torch.randn(*s, dtype=torch.bfloat16) * 0.8)(D, D) * (D ** -0.5)),
            "w2": _w((lambda *s: torch.randn(*s, dtype=torch.bfloat16) * 0.8)(D, D) * (D ** -0.5)),
            "w3": _w((lambda *s: torch.randn(*s, dtype=torch.bfloat16) * 0.8)(D, F) * (D ** -0.5)),
            "w4": _w((lambda *s: torch.randn(*s, dtype=torch.bfloat16) * 0.8)(F, D) * (F ** -0.5)),
        }
    _B_in = _B_setup()

    return {
        "A_x": _A_in["x"],
        "A_wqkv": _A_in["wqkv"],
        "A_wo": _A_in["wo"],
        "B_x": _B_in["x"],
        "B_w1": _B_in["w1"],
        "B_w2": _B_in["w2"],
        "B_w3": _B_in["w3"],
        "B_w4": _B_in["w4"],
    }

def reference(A_x, A_wqkv, A_wo, B_x, B_w1, B_w2, B_w3, B_w4):
    def _A_ref(x, wqkv, wo):
        B, S, D = x.shape
        H = 16
        Dh = D // H
        qkv = (lambda x, *d: x.permute(*d))((x @ wqkv).reshape(B, S, 3, H, Dh), 2, 0, 3, 1, 4)
        q, k, v = qkv[0], qkv[1], qkv[2]
        scores = torch.einsum("bhqd,bhkd->bhqk", q, k) * (Dh ** -0.5)
        p = _softmax(scores, axis=-1)
        o = torch.einsum("bhqk,bhkd->bhqd", p, v)
        return (lambda x, *d: x.permute(*d))(o, 0, 2, 1, 3).reshape(B, S, D) @ wo

    def _B_ref(x, w1, w2, w3, w4):
        B, S, D = x.shape
        h = _gelu(_layernorm(x, axis=-1) @ w1)
        c = D // 4
        g0 = _pad(h[:, :, 0*c:1*c], ((0, 0), (1, 0), (0, 0)))[:, :S, :]
        g1 = _pad(h[:, :, 1*c:2*c], ((0, 0), (0, 1), (0, 0)))[:, 1:, :]
        g2 = _pad(h[:, :, 2*c:3*c], ((0, 0), (2, 0), (0, 0)))[:, :S, :]
        g3 = _pad(h[:, :, 3*c:   ], ((0, 0), (0, 2), (0, 0)))[:, 2:, :]
        hs = torch.concatenate([g0, g1, g2, g3], axis=-1) @ w2
        x1 = x + hs
        h2 = _gelu(_layernorm(x1, axis=-1) @ w3) @ w4
        return x1 + h2

    x = A_x
    x = x + _A_ref(_layernorm(x, axis=-1), A_wqkv, A_wo)
    x = x + _B_ref(_layernorm(x, axis=-1), B_w1, B_w2, B_w3, B_w4)
    x = x + _A_ref(_layernorm(x, axis=-1), A_wqkv, A_wo)
    x = x + _B_ref(_layernorm(x, axis=-1), B_w1, B_w2, B_w3, B_w4)
    return x
```

```asm
; @launch grid=(256,1,1) block=(256,1,1) lds=163840
.amdgcn_target "amdgcn-amd-amdhsa--gfx950"
.text
.globl interleave_layers__mha_block__mixer_s_mlp__prompt_kernel
.p2align 8
.type interleave_layers__mha_block__mixer_s_mlp__prompt_kernel,@function
interleave_layers__mha_block__mixer_s_mlp__prompt_kernel:
  s_cmp_ge_u32 s2, 256
  s_cbranch_scc1 L_exit
  s_load_dwordx2 s[28:29], s[0:1], 0
  s_load_dwordx2 s[32:33], s[0:1], 8
  s_getpc_b64 s[26:27]
L_pc:
  v_lshrrev_b32 v1, 6, v0
  v_and_b32 v0, 63, v0
  v_readfirstlane_b32 s72, v1
  s_lshr_b32 s69, s2, 3
  v_and_b32 v2, 7, v0
  v_lshlrev_b32 v2, 7, v2
  v_lshl_add_u32 v2, v1, 15, v2
  s_lshl_b32 s3, s69, 10
  v_add_u32 v2, s3, v2
  v_min_u32 v2, L_last-L_pc, v2
  global_load_dword v15, v2, s[26:27]
  s_and_b32 s69, s69, 15
  s_mov_b32 s30, 0x1c0000
  s_mov_b32 s31, 0x20000
  s_mov_b32 s34, 0x126000
  s_mov_b32 s35, 0x20000
  s_and_b32 s3, s2, 7
  s_lshr_b32 s68, s2, 7
  s_lshl1_add_u32 s68, s3, s68
  s_lshl2_add_u32 s7, s2, s72
  s_mulk_i32 s7, 1280
  s_lshl4_add_u32 s8, s68, s69
  s_lshl2_add_u32 s8, s8, s72
  s_mulk_i32 s8, 1792
  v_min_u32 v16, 9, v0
  v_lshlrev_b32 v16, 7, v16
  v_min_u32 v17, 13, v0
  v_lshlrev_b32 v17, 7, v17
  s_waitcnt lgkmcnt(0)
  s_and_b32 s29, s29, 0xffff
  s_and_b32 s33, s33, 0xffff
  buffer_load_dword v15, v17, s[28:31], s8 offen sc1
  buffer_load_dword v15, v16, s[32:35], s7 offen sc1
  v_lshrrev_b32 v16, 2, v0
  v_mul_u32_u24 v16, 2688, v16
  v_and_b32 v12, 3, v0
  v_lshl_add_u32 v12, v12, 4, v16
  s_mul_i32 s88, s69, 56
  s_and_b32 s88, s88, -16
  s_mul_i32 s89, s72, 43008
  s_add_u32 s89, s89, s88
  v_add_u32 v12, s89, v12
  s_lshl_b32 s88, s72, 10
  s_add_u32 m0, s88, 0
  s_mov_b32 s6, 896
  buffer_load_dwordx4 v12, s[32:35], s6 offen lds
  s_add_u32 m0, s88, 28672
  s_mov_b32 s6, 1792
  buffer_load_dwordx4 v12, s[32:35], s6 offen lds
  s_load_dwordx2 s[64:65], s[0:1], 80
  s_load_dwordx2 s[36:37], s[0:1], 16
  s_load_dwordx8 s[12:19], s[0:1], 32
  s_load_dwordx4 s[20:23], s[0:1], 64
  v_lshrrev_b32 v16, 3, v0
  v_mul_u32_u24 v17, 896, v16
  v_lshrrev_b32 v16, 1, v16
  v_and_b32 v18, 7, v0
  v_xor_b32 v16, v16, v18
  v_lshl_add_u32 v10, v16, 4, v17
  v_xor_b32 v11, 64, v10
  s_lshl_b32 s89, s72, 12
  s_mul_i32 s87, s68, 114688
  s_mul_i32 s3, s72, 28672
  s_add_u32 s87, s87, s3
  s_add_u32 m0, s89, 90112
  s_add_u32 s6, s87, 0
  buffer_load_dwordx4 v10, s[28:31], s6 offen lds
  s_add_u32 m0, s89, 91136
  s_add_u32 s6, s87, 7168
  buffer_load_dwordx4 v11, s[28:31], s6 offen lds
  s_add_u32 m0, s89, 92160
  s_add_u32 s6, s87, 14336
  buffer_load_dwordx4 v10, s[28:31], s6 offen lds
  s_add_u32 m0, s89, 93184
  s_add_u32 s6, s87, 21504
  buffer_load_dwordx4 v11, s[28:31], s6 offen lds
  v_lshlrev_b32 v1, 4, v0
  v_lshlrev_b32 v2, 2, v0
  s_mov_b32 s94, 0x3f803f80
  s_mov_b32 s38, 0x62000
  s_mov_b32 s39, 0x20000
  s_mov_b32 s42, 0x62000
  s_mov_b32 s43, 0x20000
  s_mov_b32 s46, 0x62000
  s_mov_b32 s47, 0x20000
  s_mov_b32 s50, 0x188000
  s_mov_b32 s51, 0x20000
  s_mov_b32 s54, 0x188000
  s_mov_b32 s55, 0x20000
  s_mov_b32 s58, 0x1c0000
  s_mov_b32 s59, 0x20000
  s_mov_b32 s62, 0x100
  s_mov_b32 s63, 0x20000
  s_mov_b32 s66, 0x10000000
  s_mov_b32 s67, 0x20000
  s_waitcnt lgkmcnt(0)
  s_and_b32 s37, s37, 0xffff
  s_mov_b32 s40, s12
  s_and_b32 s41, s13, 0xffff
  s_mov_b32 s44, s14
  s_and_b32 s45, s15, 0xffff
  s_mov_b32 s48, s16
  s_and_b32 s49, s17, 0xffff
  s_mov_b32 s52, s18
  s_and_b32 s53, s19, 0xffff
  s_mov_b32 s56, s20
  s_and_b32 s57, s21, 0xffff
  s_mov_b32 s60, s22
  s_and_b32 s61, s23, 0xffff
  s_and_b32 s65, s65, 0xffff
  s_lshl_b32 s17, s72, 8
  s_add_u32 s17, s17, 0x27000
  v_mov_b32 v228, 0
  v_mov_b32 v229, 0
  v_mov_b32 v230, 0
  v_mov_b32 v231, 0
  s_cmp_eq_u32 s69, 15
  s_cbranch_scc0 L1
  s_lshl_b32 s5, s68, 13
  s_lshl_b32 s3, s72, 11
  s_add_u32 s5, s5, s3
  s_add_u32 s5, s5, 0x1800000
  s_lshl_b32 s10, s72, 10
  s_lshl_b32 s3, s68, 20
  s_add_u32 s10, s10, s3
  s_add_u32 s10, s10, 0xc0000
  s_add_u32 s7, s5, 0x0
  buffer_store_dwordx4 v[228:231], v1, s[64:67], s7 offen offset:0 sc1
  buffer_store_dwordx4 v[228:231], v1, s[64:67], s7 offen offset:1024 sc1
  s_add_u32 s7, s5, 0x80000
  buffer_store_dwordx4 v[228:231], v1, s[64:67], s7 offen offset:0 sc1
  buffer_store_dwordx4 v[228:231], v1, s[64:67], s7 offen offset:1024 sc1
  s_add_u32 s7, s5, 0x180000
  buffer_store_dwordx4 v[228:231], v1, s[64:67], s7 offen offset:0 sc1
  buffer_store_dwordx4 v[228:231], v1, s[64:67], s7 offen offset:1024 sc1
  buffer_store_dwordx4 v[228:231], v1, s[64:67], s10 offen sc1
L1:
  s_mov_b32 s4, 0x48372e10
  s_mov_b32 s5, 0xd6ac95fb
  s_lshl_b32 s3, s69, 2
  s_lshr_b64 s[4:5], s[4:5], s3
  s_and_b32 s0, s4, 15
  s_cmp_ge_u32 s0, 7
  s_cselect_b32 s70, 1, 0
  s_cselect_b32 s3, 7, 0
  s_sub_u32 s71, s0, s3
  s_cmp_ge_u32 s71, 7
  s_cselect_b32 s3, 7, 0
  s_sub_u32 s71, s71, s3
  s_lshl_b32 s73, s68, 20
  s_mov_b32 s90, 0
  s_mov_b32 s91, -1
  s_mov_b32 s92, 0xf0000000
  s_mov_b32 s93, 0xf0000000
  s_mov_b32 s74, 0
  s_lshr_b32 s80, s72, 1
  s_and_b32 s81, s72, 1
  s_mul_i32 s76, s72, 14336
  s_add_u32 s77, s76, 0xe000
  s_mul_i32 s78, s72, 100352
  s_lshl_b32 s3, s71, 7
  s_add_u32 s78, s78, s3
  s_lshl_b32 s1, s68, 8
  s_add_u32 s1, s1, s78
  s_lshl_b32 s4, s68, 1
  s_add_u32 s4, s4, s71
  s_cmp_lt_u32 s4, 7
  s_cselect_b32 s1, s1, 0x7f000000
  s_cmp_lt_u32 s0, 14
  s_cselect_b32 s1, s78, s1
  s_cselect_b32 s78, s78, 0x7f000000
  s_lshl_b32 s79, s70, 16
  s_lshl_b32 s3, s80, 15
  s_add_u32 s79, s79, s3
  s_add_u32 s79, s79, s73
  s_lshl_b32 s82, s70, 5
  s_lshl_b32 s3, s71, 2
  s_add_u32 m0, s88, 4096
  s_mov_b32 s6, 172928
  buffer_load_dwordx4 v12, s[32:35], s6 offen lds
  s_add_u32 s82, s82, s3
  s_lshl_b32 s4, s71, 5
  s_add_u32 s4, s4, 0x1c
  s_cmp_lt_u32 s0, 14
  s_cselect_b32 s82, s82, s4
  s_add_u32 s82, s82, s73
  s_add_u32 s82, s82, 786432
  s_cmp_eq_u32 s72, 0
  s_cselect_b32 s82, s82, 0x7f000000
  s_mul_i32 s83, s72, 12288
  s_add_u32 s83, s83, 0x1c000
  s_lshl_b32 s84, s71, 12
  s_lshl_b32 s3, s81, 11
  s_add_u32 s84, s84, s3
  s_lshl_b32 s85, s68, 1
  s_add_u32 s85, s85, s70
  s_lshl_b32 s75, s69, 19
  s_lshl_b32 s3, s72, 12
  s_add_u32 s75, s75, s3
  s_add_u32 s75, s75, 0x1000000
  v_bfe_u32 v232, v0, 4, 1
  v_lshlrev_b32 v232, 5, v232
  v_and_b32 v16, 3, v0
  s_add_u32 m0, s88, 32768
  s_mov_b32 s6, 173824
  buffer_load_dwordx4 v12, s[32:35], s6 offen lds
  v_lshl_add_u32 v232, v16, 3, v232
  v_bfe_u32 v16, v0, 2, 2
  v_lshl_add_u32 v232, v16, 6, v232
  v_lshrrev_b32 v16, 5, v0
  v_lshl_add_u32 v232, v16, 9, v232
  s_and_b32 s4, s69, 1
  s_lshl_b32 s4, s4, 3
  v_add_u32 v232, s4, v232
  v_add_u32 v233, s88, v232
  v_and_b32 v16, 31, v0
  v_lshrrev_b32 v17, 5, v0
  v_bfe_u32 v18, v0, 1, 3
  v_xor_b32 v17, v17, v18
  v_lshlrev_b32 v17, 4, v17
  v_lshl_add_u32 v17, v16, 7, v17
  v_add_u32 v17, s89, v17
  v_add_u32 v224, 90112, v17
  v_xor_b32 v225, 32, v224
  v_xor_b32 v226, 64, v224
  v_xor_b32 v227, 96, v224
  v_mov_b32 v234, 0
  v_mov_b32 v235, 0
  v_mov_b32 v236, 0
  s_add_u32 m0, s89, 106496
  s_add_u32 s6, s87, 128
  buffer_load_dwordx4 v10, s[28:31], s6 offen lds
  v_mov_b32 v237, 0
  v_mov_b32 v238, 0
  s_lshl_b32 s4, s72, 2
  s_add_u32 s4, s4, 0x26000
  v_add_u32 v13, s4, v1
  v_bfe_u32 v18, v0, 3, 1
  v_xor_b32 v18, s81, v18
  v_bfe_u32 v16, v0, 4, 1
  v_lshl_add_u32 v16, v18, 1, v16
  v_and_b32 v18, 3, v0
  v_lshl_add_u32 v16, v16, 2, v18
  v_bfe_u32 v18, v0, 2, 2
  v_lshl_add_u32 v16, v18, 4, v16
  v_lshrrev_b32 v18, 5, v0
  v_lshl_add_u32 v16, v18, 6, v16
  v_lshlrev_b32 v16, 3, v16
  v_xor_b32 v17, 64, v16
  v_accvgpr_write_b32 a224, v16
  v_bfe_u32 v18, v0, 3, 1
  v_bfe_u32 v16, v0, 4, 1
  v_lshl_add_u32 v16, v18, 1, v16
  v_and_b32 v18, 3, v0
  v_lshl_add_u32 v16, v16, 2, v18
  s_add_u32 m0, s89, 107520
  s_add_u32 s6, s87, 7296
  buffer_load_dwordx4 v11, s[28:31], s6 offen lds
  v_bfe_u32 v18, v0, 2, 2
  v_lshl_add_u32 v16, v18, 4, v16
  v_lshrrev_b32 v18, 5, v0
  v_lshl_add_u32 v16, v18, 6, v16
  v_lshlrev_b32 v16, 3, v16
  v_xor_b32 v17, 64, v16
  v_accvgpr_write_b32 a225, v16
  v_bfe_u32 v20, v0, 4, 1
  v_lshlrev_b32 v20, 2, v20
  v_and_b32 v16, 7, v0
  v_xor_b32 v16, v20, v16
  v_lshrrev_b32 v20, 3, v0
  v_mul_u32_u24 v20, 3584, v20
  v_lshl_add_u32 v16, v16, 4, v20
  v_add_u32 v17, 27648, v16
  v_add_u32 v18, 55296, v16
  v_add_u32 v19, 82944, v16
  v_accvgpr_write_b32 a226, v16
  v_accvgpr_write_b32 a227, v17
  v_accvgpr_write_b32 a228, v18
  v_accvgpr_write_b32 a229, v19
  v_and_b32 v20, 31, v0
  v_lshrrev_b32 v21, 5, v0
  s_add_u32 m0, s89, 108544
  s_add_u32 s6, s87, 14464
  buffer_load_dwordx4 v10, s[28:31], s6 offen lds
  v_mov_b32 v22, 0x7f000000
  s_lshl_b32 s10, s80, 5
  v_add_u32 v23, s10, v20
  s_add_u32 s5, s84, 0x0
  s_mov_b32 s7, 1
  s_cmp_ge_u32 s5, 7168
  s_cselect_b32 s7, -1, s7
  s_cmp_ge_u32 s5, 14336
  s_cselect_b32 s7, 2, s7
  s_cmp_ge_u32 s5, 21504
  s_cselect_b32 s7, -2, s7
  s_cmp_gt_i32 s7, 0
  s_cselect_b32 s4, 1, -1
  s_add_u32 s4, s4, s85
  s_lshr_b32 s8, s4, 3
  s_and_b32 s10, s4, 7
  s_lshl_b32 s8, s8, 15
  s_lshl_b32 s3, s10, 7
  s_add_u32 s8, s8, s3
  s_add_u32 s8, s8, s5
  s_add_u32 s8, s8, 0x1840000
  s_cmp_lt_u32 s4, 32
  s_cselect_b32 s8, s8, 0x7f000000
  s_add_u32 m0, s89, 109568
  s_add_u32 s6, s87, 21632
  buffer_load_dwordx4 v11, s[28:31], s6 offen lds
  v_add_u32 v16, s7, v23
  v_lshrrev_b32 v17, 5, v16
  v_lshlrev_b32 v17, 15, v17
  v_and_b32 v18, 31, v16
  v_lshl_add_u32 v18, v21, 5, v18
  v_lshl_add_u32 v17, v18, 4, v17
  v_cmp_gt_u32 vcc, 64, v16
  v_and_b32 v16, 1, v16
  v_lshl_add_u32 v16, v21, 1, v16
  v_lshl_add_u32 v16, v16, 4, s8
  v_cndmask_b32 v17, v22, v17, vcc
  v_cndmask_b32 v16, v16, v22, vcc
  v_accvgpr_write_b32 a230, v17
  v_accvgpr_write_b32 a232, v16
  s_add_u32 s5, s84, 0x400
  s_mov_b32 s7, 1
  s_cmp_ge_u32 s5, 7168
  s_cselect_b32 s7, -1, s7
  s_cmp_ge_u32 s5, 14336
  s_cselect_b32 s7, 2, s7
  s_cmp_ge_u32 s5, 21504
  s_cselect_b32 s7, -2, s7
  s_cmp_gt_i32 s7, 0
  s_cselect_b32 s4, 1, -1
  s_add_u32 m0, s88, 8192
  s_mov_b32 s6, 344960
  buffer_load_dwordx4 v12, s[32:35], s6 offen lds
  s_add_u32 s4, s4, s85
  s_lshr_b32 s8, s4, 3
  s_and_b32 s10, s4, 7
  s_lshl_b32 s8, s8, 15
  s_lshl_b32 s3, s10, 7
  s_add_u32 s8, s8, s3
  s_add_u32 s8, s8, s5
  s_add_u32 s8, s8, 0x1840000
  s_cmp_lt_u32 s4, 32
  s_cselect_b32 s8, s8, 0x7f000000
  v_add_u32 v16, s7, v23
  v_lshrrev_b32 v17, 5, v16
  v_lshlrev_b32 v17, 15, v17
  v_and_b32 v18, 31, v16
  v_lshl_add_u32 v18, v21, 5, v18
  v_lshl_add_u32 v17, v18, 4, v17
  v_cmp_gt_u32 vcc, 64, v16
  v_and_b32 v16, 1, v16
  v_lshl_add_u32 v16, v21, 1, v16
  v_lshl_add_u32 v16, v16, 4, s8
  v_cndmask_b32 v17, v22, v17, vcc
  v_cndmask_b32 v16, v16, v22, vcc
  s_add_u32 m0, s88, 36864
  s_mov_b32 s6, 345856
  buffer_load_dwordx4 v12, s[32:35], s6 offen lds
  v_accvgpr_write_b32 a231, v17
  v_accvgpr_write_b32 a233, v16
  s_mul_i32 s7, s80, 31
  v_xor_b32 v17, s7, v20
  v_cmp_ge_u32 vcc, s81, v17
  v_and_b32 v16, 1, v20
  v_lshl_add_u32 v16, v21, 1, v16
  s_lshr_b32 s8, s85, 3
  s_and_b32 s10, s85, 7
  s_lshl_b32 s8, s8, 15
  s_lshl_b32 s3, s10, 7
  s_add_u32 s8, s8, s3
  s_add_u32 s8, s8, 0x1840000
  s_sub_u32 s8, s8, s79
  s_cmp_eq_u32 s85, s7
  s_cselect_b32 s8, 0x7f000000, s8
  v_lshl_add_u32 v17, v16, 4, s8
  v_cndmask_b32 v17, v1, v17, vcc
  v_accvgpr_write_b32 a234, v17
  s_lshr_b32 s8, s85, 3
  s_and_b32 s10, s85, 7
  s_lshl_b32 s8, s8, 15
  s_lshl_b32 s3, s10, 7
  s_add_u32 m0, s89, 122880
  s_add_u32 s6, s87, 256
  buffer_load_dwordx4 v10, s[28:31], s6 offen lds
  s_add_u32 s8, s8, s3
  s_add_u32 s8, s8, 0x1860000
  s_sub_u32 s8, s8, s79
  s_cmp_eq_u32 s85, s7
  s_cselect_b32 s8, 0x7f000000, s8
  v_lshl_add_u32 v17, v16, 4, s8
  v_cndmask_b32 v17, v1, v17, vcc
  v_accvgpr_write_b32 a235, v17
  v_and_b32 v16, 7, v0
  v_min_u32 v17, 6, v16
  v_lshlrev_b32 v16, 2, v16
  v_lshlrev_b32 v17, 2, v17
  s_lshl_b32 s4, s70, 5
  v_add_u32 v18, s4, v17
  v_accvgpr_write_b32 a236, v18
  s_lshl_b32 s4, s80, 5
  v_add_u32 v18, s4, v17
  v_accvgpr_write_b32 a237, v18
  v_bfe_u32 v18, v0, 3, 1
  v_lshl_add_u32 v17, v18, 5, v17
  v_accvgpr_write_b32 a238, v17
  v_lshl_add_u32 v16, v18, 5, v16
  v_accvgpr_write_b32 a239, v16
  s_waitcnt vmcnt(9)
  s_barrier
  ds_read_b64_tr_b16 v[160:161], v233 offset:0
  ds_read_b64_tr_b16 v[162:163], v233 offset:256
  ds_read_b64_tr_b16 v[164:165], v233 offset:28672
  ds_read_b64_tr_b16 v[166:167], v233 offset:28928
  ds_read_b128 v[16:19], v224 offset:0
  ds_read_b128 v[20:23], v225 offset:0
  ds_read_b128 v[24:27], v226 offset:0
  ds_read_b128 v[28:31], v227 offset:0
  ds_read_b64_tr_b16 v[176:177], v232 offset:0
  ds_read_b64_tr_b16 v[178:179], v232 offset:256
  ds_read_b64_tr_b16 v[180:181], v232 offset:28672
  ds_read_b64_tr_b16 v[182:183], v232 offset:28928
  ds_read_b64_tr_b16 v[184:185], v232 offset:1024
  ds_read_b64_tr_b16 v[186:187], v232 offset:1280
  ds_read_b64_tr_b16 v[188:189], v232 offset:29696
  ds_read_b64_tr_b16 v[190:191], v232 offset:29952
  ds_read_b64_tr_b16 v[192:193], v232 offset:2048
  ds_read_b64_tr_b16 v[194:195], v232 offset:2304
  ds_read_b64_tr_b16 v[196:197], v232 offset:30720
  ds_read_b64_tr_b16 v[198:199], v232 offset:30976
  ds_read_b64_tr_b16 v[200:201], v232 offset:3072
  ds_read_b64_tr_b16 v[202:203], v232 offset:3328
  ds_read_b64_tr_b16 v[204:205], v232 offset:31744
  ds_read_b64_tr_b16 v[206:207], v232 offset:32000
  s_waitcnt lgkmcnt(15)
  v_dot2c_f32_bf16 v236, s94, v160
  v_dot2c_f32_bf16 v237, s94, v164
  v_dot2c_f32_bf16 v236, s94, v161
  v_dot2c_f32_bf16 v237, s94, v165
  v_dot2c_f32_bf16 v236, s94, v162
  v_dot2c_f32_bf16 v237, s94, v166
  v_dot2c_f32_bf16 v236, s94, v163
  v_dot2c_f32_bf16 v237, s94, v167
  s_add_u32 m0, s89, 123904
  s_add_u32 s6, s87, 7424
  buffer_load_dwordx4 v11, s[28:31], s6 offen lds
  v_dot2c_f32_bf16 v234, s94, v16
  v_dot2c_f32_bf16 v235, v16, v16
  v_dot2c_f32_bf16 v234, s94, v17
  v_dot2c_f32_bf16 v235, v17, v17
  v_dot2c_f32_bf16 v234, s94, v18
  v_dot2c_f32_bf16 v235, v18, v18
  v_dot2c_f32_bf16 v234, s94, v19
  v_dot2c_f32_bf16 v235, v19, v19
  s_add_u32 m0, s89, 124928
  s_add_u32 s6, s87, 14592
  buffer_load_dwordx4 v10, s[28:31], s6 offen lds
  v_dot2c_f32_bf16 v234, s94, v20
  v_dot2c_f32_bf16 v235, v20, v20
  v_dot2c_f32_bf16 v234, s94, v21
  v_dot2c_f32_bf16 v235, v21, v21
  v_dot2c_f32_bf16 v234, s94, v22
  v_dot2c_f32_bf16 v235, v22, v22
  v_dot2c_f32_bf16 v234, s94, v23
  v_dot2c_f32_bf16 v235, v23, v23
  s_add_u32 m0, s89, 125952
  s_add_u32 s6, s87, 21760
  buffer_load_dwordx4 v11, s[28:31], s6 offen lds
  v_dot2c_f32_bf16 v234, s94, v24
  v_dot2c_f32_bf16 v235, v24, v24
  v_dot2c_f32_bf16 v234, s94, v25
  v_dot2c_f32_bf16 v235, v25, v25
  v_dot2c_f32_bf16 v234, s94, v26
  v_dot2c_f32_bf16 v235, v26, v26
  v_dot2c_f32_bf16 v234, s94, v27
  v_dot2c_f32_bf16 v235, v27, v27
  v_dot2c_f32_bf16 v234, s94, v28
  v_dot2c_f32_bf16 v235, v28, v28
  v_dot2c_f32_bf16 v234, s94, v29
  v_dot2c_f32_bf16 v235, v29, v29
  v_dot2c_f32_bf16 v234, s94, v30
  v_dot2c_f32_bf16 v235, v30, v30
  v_dot2c_f32_bf16 v234, s94, v31
  v_dot2c_f32_bf16 v235, v31, v31
  s_waitcnt vmcnt(6)
  s_waitcnt lgkmcnt(0)
  s_barrier
  v_mov_b32 v239, 1
  s_lshl_b32 s4, s72, 4
  s_add_u32 s4, s4, s69
  s_lshl_b32 s5, s68, 4
  s_cmp_eq_u32 s4, 15
  s_cselect_b32 s5, s5, 0x7f000000
  s_mov_b64 exec, 1
  buffer_store_dword v239, off, s[60:63], s5 sc1
  s_mov_b64 exec, -1
  v_mfma_f32_32x32x16_bf16 v[128:143], v[176:179], v[16:19], 0
  s_add_u32 m0, s88, 12288
  s_mov_b32 s6, 516992
  buffer_load_dwordx4 v12, s[32:35], s6 offen lds
  ds_read_b64_tr_b16 v[168:169], v233 offset:4096
  ds_read_b64_tr_b16 v[170:171], v233 offset:4352
  ds_read_b64_tr_b16 v[172:173], v233 offset:32768
  v_mfma_f32_32x32x16_bf16 v[144:159], v[16:19], v[180:183], 0
  s_add_u32 m0, s88, 40960
  s_mov_b32 s6, 517888
  buffer_load_dwordx4 v12, s[32:35], s6 offen lds
  ds_read_b64_tr_b16 v[174:175], v233 offset:33024
  ds_read_b128 v[32:35], v224 offset:16384
  ds_read_b128 v[36:39], v225 offset:16384
  v_mfma_f32_32x32x16_bf16 v[128:143], v[184:187], v[20:23], v[128:143]
  s_add_u32 m0, s89, 90112
  s_add_u32 s6, s87, 384
  buffer_load_dwordx4 v10, s[28:31], s6 offen lds
  ds_read_b128 v[40:43], v226 offset:16384
  ds_read_b128 v[44:47], v227 offset:16384
  ds_read_b64_tr_b16 v[208:209], v232 offset:4096
  v_mfma_f32_32x32x16_bf16 v[144:159], v[20:23], v[188:191], v[144:159]
  ds_read_b64_tr_b16 v[210:211], v232 offset:4352
  ds_read_b64_tr_b16 v[212:213], v232 offset:32768
  ds_read_b64_tr_b16 v[214:215], v232 offset:33024
  v_mfma_f32_32x32x16_bf16 v[128:143], v[192:195], v[24:27], v[128:143]
  s_add_u32 m0, s89, 91136
  s_add_u32 s6, s87, 7552
  buffer_load_dwordx4 v11, s[28:31], s6 offen lds
  ds_read_b64_tr_b16 v[216:217], v232 offset:5120
  ds_read_b64_tr_b16 v[218:219], v232 offset:5376
  ds_read_b64_tr_b16 v[220:221], v232 offset:33792
  v_mfma_f32_32x32x16_bf16 v[144:159], v[24:27], v[196:199], v[144:159]
  s_add_u32 m0, s89, 92160
  s_add_u32 s6, s87, 14720
  buffer_load_dwordx4 v10, s[28:31], s6 offen lds
  ds_read_b64_tr_b16 v[222:223], v232 offset:34048
  ds_read_b64_tr_b16 v[240:241], v232 offset:6144
  ds_read_b64_tr_b16 v[242:243], v232 offset:6400
  v_mfma_f32_32x32x16_bf16 v[128:143], v[200:203], v[28:31], v[128:143]
  s_add_u32 m0, s89, 93184
  s_add_u32 s6, s87, 21888
  buffer_load_dwordx4 v11, s[28:31], s6 offen lds
  ds_read_b64_tr_b16 v[244:245], v232 offset:34816
  ds_read_b64_tr_b16 v[246:247], v232 offset:35072
  ds_read_b64_tr_b16 v[248:249], v232 offset:7168
  v_mfma_f32_32x32x16_bf16 v[144:159], v[28:31], v[204:207], v[144:159]
  ds_read_b64_tr_b16 v[250:251], v232 offset:7424
  ds_read_b64_tr_b16 v[252:253], v232 offset:35840
  ds_read_b64_tr_b16 v[254:255], v232 offset:36096
  s_waitcnt lgkmcnt(15)
  v_dot2c_f32_bf16 v236, s94, v168
  v_dot2c_f32_bf16 v237, s94, v172
  v_dot2c_f32_bf16 v236, s94, v169
  v_dot2c_f32_bf16 v237, s94, v173
  v_dot2c_f32_bf16 v236, s94, v170
  v_dot2c_f32_bf16 v237, s94, v174
  v_dot2c_f32_bf16 v236, s94, v171
  v_dot2c_f32_bf16 v237, s94, v175
  s_add_u32 m0, s88, 16384
  s_mov_b32 s6, 689024
  buffer_load_dwordx4 v12, s[32:35], s6 offen lds
  v_dot2c_f32_bf16 v234, s94, v32
  v_dot2c_f32_bf16 v235, v32, v32
  v_dot2c_f32_bf16 v234, s94, v33
  v_dot2c_f32_bf16 v235, v33, v33
  v_dot2c_f32_bf16 v234, s94, v34
  v_dot2c_f32_bf16 v235, v34, v34
  v_dot2c_f32_bf16 v234, s94, v35
  v_dot2c_f32_bf16 v235, v35, v35
  v_dot2c_f32_bf16 v234, s94, v36
  v_dot2c_f32_bf16 v235, v36, v36
  v_dot2c_f32_bf16 v234, s94, v37
  v_dot2c_f32_bf16 v235, v37, v37
  v_dot2c_f32_bf16 v234, s94, v38
  v_dot2c_f32_bf16 v235, v38, v38
  v_dot2c_f32_bf16 v234, s94, v39
  v_dot2c_f32_bf16 v235, v39, v39
  s_add_u32 m0, s88, 45056
  s_mov_b32 s6, 689920
  buffer_load_dwordx4 v12, s[32:35], s6 offen lds
  v_dot2c_f32_bf16 v234, s94, v40
  v_dot2c_f32_bf16 v235, v40, v40
  v_dot2c_f32_bf16 v234, s94, v41
  v_dot2c_f32_bf16 v235, v41, v41
  v_dot2c_f32_bf16 v234, s94, v42
  v_dot2c_f32_bf16 v235, v42, v42
  v_dot2c_f32_bf16 v234, s94, v43
  v_dot2c_f32_bf16 v235, v43, v43
  v_dot2c_f32_bf16 v234, s94, v44
  v_dot2c_f32_bf16 v235, v44, v44
  v_dot2c_f32_bf16 v234, s94, v45
  v_dot2c_f32_bf16 v235, v45, v45
  v_dot2c_f32_bf16 v234, s94, v46
  v_dot2c_f32_bf16 v235, v46, v46
  v_dot2c_f32_bf16 v234, s94, v47
  v_dot2c_f32_bf16 v235, v47, v47
  s_waitcnt vmcnt(9)
  s_waitcnt lgkmcnt(0)
  s_barrier
  v_mfma_f32_32x32x16_bf16 v[128:143], v[208:211], v[32:35], v[128:143]
  s_add_u32 m0, s89, 106496
  s_add_u32 s6, s87, 512
  buffer_load_dwordx4 v10, s[28:31], s6 offen lds
  ds_read_b64_tr_b16 v[160:161], v233 offset:8192
  ds_read_b64_tr_b16 v[162:163], v233 offset:8448
  ds_read_b64_tr_b16 v[164:165], v233 offset:36864
  v_mfma_f32_32x32x16_bf16 v[144:159], v[32:35], v[212:215], v[144:159]
  ds_read_b64_tr_b16 v[166:167], v233 offset:37120
  ds_read_b128 v[48:51], v224 offset:32768
  ds_read_b128 v[52:55], v225 offset:32768
  v_mfma_f32_32x32x16_bf16 v[128:143], v[216:219], v[36:39], v[128:143]
  s_add_u32 m0, s89, 107520
  s_add_u32 s6, s87, 7680
  buffer_load_dwordx4 v11, s[28:31], s6 offen lds
  ds_read_b128 v[56:59], v226 offset:32768
  ds_read_b128 v[60:63], v227 offset:32768
  ds_read_b64_tr_b16 v[176:177], v232 offset:8192
  v_mfma_f32_32x32x16_bf16 v[144:159], v[36:39], v[220:223], v[144:159]
  ds_read_b64_tr_b16 v[178:179], v232 offset:8448
  ds_read_b64_tr_b16 v[180:181], v232 offset:36864
  ds_read_b64_tr_b16 v[182:183], v232 offset:37120
  v_mfma_f32_32x32x16_bf16 v[128:143], v[240:243], v[40:43], v[128:143]
  s_add_u32 m0, s89, 108544
  s_add_u32 s6, s87, 14848
  buffer_load_dwordx4 v10, s[28:31], s6 offen lds
  ds_read_b64_tr_b16 v[184:185], v232 offset:9216
  ds_read_b64_tr_b16 v[186:187], v232 offset:9472
  ds_read_b64_tr_b16 v[188:189], v232 offset:37888
  v_mfma_f32_32x32x16_bf16 v[144:159], v[40:43], v[244:247], v[144:159]
  ds_read_b64_tr_b16 v[190:191], v232 offset:38144
  ds_read_b64_tr_b16 v[192:193], v232 offset:10240
  ds_read_b64_tr_b16 v[194:195], v232 offset:10496
  v_mfma_f32_32x32x16_bf16 v[128:143], v[248:251], v[44:47], v[128:143]
  s_add_u32 m0, s89, 109568
  s_add_u32 s6, s87, 22016
  buffer_load_dwordx4 v11, s[28:31], s6 offen lds
  ds_read_b64_tr_b16 v[196:197], v232 offset:38912
  ds_read_b64_tr_b16 v[198:199], v232 offset:39168
  ds_read_b64_tr_b16 v[200:201], v232 offset:11264
  v_mfma_f32_32x32x16_bf16 v[144:159], v[44:47], v[252:255], v[144:159]
  ds_read_b64_tr_b16 v[202:203], v232 offset:11520
  ds_read_b64_tr_b16 v[204:205], v232 offset:39936
  ds_read_b64_tr_b16 v[206:207], v232 offset:40192
  s_waitcnt lgkmcnt(15)
  v_dot2c_f32_bf16 v236, s94, v160
  v_dot2c_f32_bf16 v237, s94, v164
  v_dot2c_f32_bf16 v236, s94, v161
  v_dot2c_f32_bf16 v237, s94, v165
  v_dot2c_f32_bf16 v236, s94, v162
  v_dot2c_f32_bf16 v237, s94, v166
  v_dot2c_f32_bf16 v236, s94, v163
  v_dot2c_f32_bf16 v237, s94, v167
  s_add_u32 m0, s88, 20480
  s_mov_b32 s6, 861056
  buffer_load_dwordx4 v12, s[32:35], s6 offen lds
  v_dot2c_f32_bf16 v234, s94, v48
  v_dot2c_f32_bf16 v235, v48, v48
  v_dot2c_f32_bf16 v234, s94, v49
  v_dot2c_f32_bf16 v235, v49, v49
  v_dot2c_f32_bf16 v234, s94, v50
  v_dot2c_f32_bf16 v235, v50, v50
  v_dot2c_f32_bf16 v234, s94, v51
  v_dot2c_f32_bf16 v235, v51, v51
  v_dot2c_f32_bf16 v234, s94, v52
  v_dot2c_f32_bf16 v235, v52, v52
  v_dot2c_f32_bf16 v234, s94, v53
  v_dot2c_f32_bf16 v235, v53, v53
  v_dot2c_f32_bf16 v234, s94, v54
  v_dot2c_f32_bf16 v235, v54, v54
  v_dot2c_f32_bf16 v234, s94, v55
  v_dot2c_f32_bf16 v235, v55, v55
  s_add_u32 m0, s88, 49152
  s_mov_b32 s6, 861952
  buffer_load_dwordx4 v12, s[32:35], s6 offen lds
  v_dot2c_f32_bf16 v234, s94, v56
  v_dot2c_f32_bf16 v235, v56, v56
  v_dot2c_f32_bf16 v234, s94, v57
  v_dot2c_f32_bf16 v235, v57, v57
  v_dot2c_f32_bf16 v234, s94, v58
  v_dot2c_f32_bf16 v235, v58, v58
  v_dot2c_f32_bf16 v234, s94, v59
  v_dot2c_f32_bf16 v235, v59, v59
  v_dot2c_f32_bf16 v234, s94, v60
  v_dot2c_f32_bf16 v235, v60, v60
  v_dot2c_f32_bf16 v234, s94, v61
  v_dot2c_f32_bf16 v235, v61, v61
  v_dot2c_f32_bf16 v234, s94, v62
  v_dot2c_f32_bf16 v235, v62, v62
  v_dot2c_f32_bf16 v234, s94, v63
  v_dot2c_f32_bf16 v235, v63, v63
  s_waitcnt vmcnt(8)
  s_waitcnt lgkmcnt(0)
  s_barrier
  v_mfma_f32_32x32x16_bf16 v[128:143], v[176:179], v[48:51], v[128:143]
  s_add_u32 m0, s89, 122880
  s_add_u32 s6, s87, 640
  buffer_load_dwordx4 v10, s[28:31], s6 offen lds
  ds_read_b64_tr_b16 v[168:169], v233 offset:12288
  ds_read_b64_tr_b16 v[170:171], v233 offset:12544
  ds_read_b64_tr_b16 v[172:173], v233 offset:40960
  v_mfma_f32_32x32x16_bf16 v[144:159], v[48:51], v[180:183], v[144:159]
  ds_read_b64_tr_b16 v[174:175], v233 offset:41216
  ds_read_b128 v[64:67], v224 offset:0
  ds_read_b128 v[68:71], v225 offset:0
  v_mfma_f32_32x32x16_bf16 v[128:143], v[184:187], v[52:55], v[128:143]
  s_add_u32 m0, s89, 123904
  s_add_u32 s6, s87, 7808
  buffer_load_dwordx4 v11, s[28:31], s6 offen lds
  ds_read_b128 v[72:75], v226 offset:0
  ds_read_b128 v[76:79], v227 offset:0
  ds_read_b64_tr_b16 v[208:209], v232 offset:12288
  v_mfma_f32_32x32x16_bf16 v[144:159], v[52:55], v[188:191], v[144:159]
  ds_read_b64_tr_b16 v[210:211], v232 offset:12544
  ds_read_b64_tr_b16 v[212:213], v232 offset:40960
  ds_read_b64_tr_b16 v[214:215], v232 offset:41216
  v_mfma_f32_32x32x16_bf16 v[128:143], v[192:195], v[56:59], v[128:143]
  s_add_u32 m0, s89, 124928
  s_add_u32 s6, s87, 14976
  buffer_load_dwordx4 v10, s[28:31], s6 offen lds
  ds_read_b64_tr_b16 v[216:217], v232 offset:13312
  ds_read_b64_tr_b16 v[218:219], v232 offset:13568
  ds_read_b64_tr_b16 v[220:221], v232 offset:41984
  v_mfma_f32_32x32x16_bf16 v[144:159], v[56:59], v[196:199], v[144:159]
  ds_read_b64_tr_b16 v[222:223], v232 offset:42240
  ds_read_b64_tr_b16 v[240:241], v232 offset:14336
  ds_read_b64_tr_b16 v[242:243], v232 offset:14592
  v_mfma_f32_32x32x16_bf16 v[128:143], v[200:203], v[60:63], v[128:143]
  s_add_u32 m0, s89, 125952
  s_add_u32 s6, s87, 22144
  buffer_load_dwordx4 v11, s[28:31], s6 offen lds
  ds_read_b64_tr_b16 v[244:245], v232 offset:43008
  ds_read_b64_tr_b16 v[246:247], v232 offset:43264
  ds_read_b64_tr_b16 v[248:249], v232 offset:15360
  v_mfma_f32_32x32x16_bf16 v[144:159], v[60:63], v[204:207], v[144:159]
  ds_read_b64_tr_b16 v[250:251], v232 offset:15616
  ds_read_b64_tr_b16 v[252:253], v232 offset:44032
  ds_read_b64_tr_b16 v[254:255], v232 offset:44288
  s_waitcnt lgkmcnt(15)
  v_dot2c_f32_bf16 v236, s94, v168
  v_dot2c_f32_bf16 v237, s94, v172
  v_dot2c_f32_bf16 v236, s94, v169
  v_dot2c_f32_bf16 v237, s94, v173
  v_dot2c_f32_bf16 v236, s94, v170
  v_dot2c_f32_bf16 v237, s94, v174
  v_dot2c_f32_bf16 v236, s94, v171
  v_dot2c_f32_bf16 v237, s94, v175
  s_add_u32 m0, s88, 24576
  s_mov_b32 s6, 1033088
  buffer_load_dwordx4 v12, s[32:35], s6 offen lds
  v_dot2c_f32_bf16 v234, s94, v64
  v_dot2c_f32_bf16 v235, v64, v64
  v_dot2c_f32_bf16 v234, s94, v65
  v_dot2c_f32_bf16 v235, v65, v65
  v_dot2c_f32_bf16 v234, s94, v66
  v_dot2c_f32_bf16 v235, v66, v66
  v_dot2c_f32_bf16 v234, s94, v67
  v_dot2c_f32_bf16 v235, v67, v67
  v_dot2c_f32_bf16 v234, s94, v68
  v_dot2c_f32_bf16 v235, v68, v68
  v_dot2c_f32_bf16 v234, s94, v69
  v_dot2c_f32_bf16 v235, v69, v69
  v_dot2c_f32_bf16 v234, s94, v70
  v_dot2c_f32_bf16 v235, v70, v70
  v_dot2c_f32_bf16 v234, s94, v71
  v_dot2c_f32_bf16 v235, v71, v71
  s_add_u32 m0, s88, 53248
  s_mov_b32 s6, 1033984
  buffer_load_dwordx4 v12, s[32:35], s6 offen lds
  v_dot2c_f32_bf16 v234, s94, v72
  v_dot2c_f32_bf16 v235, v72, v72
  v_dot2c_f32_bf16 v234, s94, v73
  v_dot2c_f32_bf16 v235, v73, v73
  v_dot2c_f32_bf16 v234, s94, v74
  v_dot2c_f32_bf16 v235, v74, v74
  v_dot2c_f32_bf16 v234, s94, v75
  v_dot2c_f32_bf16 v235, v75, v75
  v_dot2c_f32_bf16 v234, s94, v76
  v_dot2c_f32_bf16 v235, v76, v76
  v_dot2c_f32_bf16 v234, s94, v77
  v_dot2c_f32_bf16 v235, v77, v77
  v_dot2c_f32_bf16 v234, s94, v78
  v_dot2c_f32_bf16 v235, v78, v78
  v_dot2c_f32_bf16 v234, s94, v79
  v_dot2c_f32_bf16 v235, v79, v79
  s_waitcnt vmcnt(8)
  s_waitcnt lgkmcnt(0)
  s_barrier
  v_mfma_f32_32x32x16_bf16 v[128:143], v[208:211], v[64:67], v[128:143]
  s_add_u32 m0, s89, 90112
  s_add_u32 s6, s87, 768
  buffer_load_dwordx4 v10, s[28:31], s6 offen lds
  ds_read_b64_tr_b16 v[160:161], v233 offset:16384
  ds_read_b64_tr_b16 v[162:163], v233 offset:16640
  ds_read_b64_tr_b16 v[164:165], v233 offset:45056
  v_mfma_f32_32x32x16_bf16 v[144:159], v[64:67], v[212:215], v[144:159]
  ds_read_b64_tr_b16 v[166:167], v233 offset:45312
  ds_read_b128 v[80:83], v224 offset:16384
  ds_read_b128 v[84:87], v225 offset:16384
  v_mfma_f32_32x32x16_bf16 v[128:143], v[216:219], v[68:71], v[128:143]
  s_add_u32 m0, s89, 91136
  s_add_u32 s6, s87, 7936
  buffer_load_dwordx4 v11, s[28:31], s6 offen lds
  ds_read_b128 v[88:91], v226 offset:16384
  ds_read_b128 v[92:95], v227 offset:16384
  ds_read_b64_tr_b16 v[176:177], v232 offset:16384
  v_mfma_f32_32x32x16_bf16 v[144:159], v[68:71], v[220:223], v[144:159]
  ds_read_b64_tr_b16 v[178:179], v232 offset:16640
  ds_read_b64_tr_b16 v[180:181], v232 offset:45056
  ds_read_b64_tr_b16 v[182:183], v232 offset:45312
  v_mfma_f32_32x32x16_bf16 v[128:143], v[240:243], v[72:75], v[128:143]
  s_add_u32 m0, s89, 92160
  s_add_u32 s6, s87, 15104
  buffer_load_dwordx4 v10, s[28:31], s6 offen lds
  ds_read_b64_tr_b16 v[184:185], v232 offset:17408
  ds_read_b64_tr_b16 v[186:187], v232 offset:17664
  ds_read_b64_tr_b16 v[188:189], v232 offset:46080
  v_mfma_f32_32x32x16_bf16 v[144:159], v[72:75], v[244:247], v[144:159]
  ds_read_b64_tr_b16 v[190:191], v232 offset:46336
  ds_read_b64_tr_b16 v[192:193], v232 offset:18432
  ds_read_b64_tr_b16 v[194:195], v232 offset:18688
  v_mfma_f32_32x32x16_bf16 v[128:143], v[248:251], v[76:79], v[128:143]
  s_add_u32 m0, s89, 93184
  s_add_u32 s6, s87, 22272
  buffer_load_dwordx4 v11, s[28:31], s6 offen lds
  ds_read_b64_tr_b16 v[196:197], v232 offset:47104
  ds_read_b64_tr_b16 v[198:199], v232 offset:47360
  ds_read_b64_tr_b16 v[200:201], v232 offset:19456
  v_mfma_f32_32x32x16_bf16 v[144:159], v[76:79], v[252:255], v[144:159]
  ds_read_b64_tr_b16 v[202:203], v232 offset:19712
  ds_read_b64_tr_b16 v[204:205], v232 offset:48128
  ds_read_b64_tr_b16 v[206:207], v232 offset:48384
  s_waitcnt lgkmcnt(15)
  v_dot2c_f32_bf16 v236, s94, v160
  v_dot2c_f32_bf16 v237, s94, v164
  v_dot2c_f32_bf16 v236, s94, v161
  v_dot2c_f32_bf16 v237, s94, v165
  v_dot2c_f32_bf16 v236, s94, v162
  v_dot2c_f32_bf16 v237, s94, v166
  v_dot2c_f32_bf16 v236, s94, v163
  v_dot2c_f32_bf16 v237, s94, v167
  v_bfe_u32 v239, v0, 4, 1
  v_lshlrev_b32 v239, 2, v239
  v_and_b32 v4, 7, v0
  v_xor_b32 v4, v239, v4
  v_lshrrev_b32 v239, 3, v0
  v_mul_u32_u24 v239, 896, v239
  v_lshl_add_u32 v4, v4, 4, v239
  v_add_u32 v5, 6144, v4
  v_add_u32 v6, 12288, v4
  v_add_u32 v7, 18432, v4
  s_cmp_ge_u32 s68, 7
  s_cselect_b32 s5, 602112, 0
  s_mul_i32 s11, s68, 28672
  s_mul_i32 s3, s72, 200704
  s_add_u32 s11, s11, s3
  s_lshl_b32 s3, s71, 7
  s_add_u32 s11, s11, s3
  s_add_u32 s11, s11, s5
  s_cmp_lt_u32 s68, 14
  s_cselect_b32 s11, s11, 0x7f000000
  s_cmp_lt_u32 s0, 7
  s_cselect_b32 s11, s11, 0x7f000000
  s_add_u32 m0, s89, 139264
  s_nop 0
  buffer_load_dwordx4 v4, s[52:55], s11 offen offset:0 lds
  buffer_load_dwordx4 v5, s[52:55], s11 offen offset:1024 lds
  buffer_load_dwordx4 v6, s[52:55], s11 offen offset:2048 lds
  buffer_load_dwordx4 v7, s[52:55], s11 offen offset:3072 lds
  v_dot2c_f32_bf16 v234, s94, v80
  v_dot2c_f32_bf16 v235, v80, v80
  v_dot2c_f32_bf16 v234, s94, v81
  v_dot2c_f32_bf16 v235, v81, v81
  v_dot2c_f32_bf16 v234, s94, v82
  v_dot2c_f32_bf16 v235, v82, v82
  v_dot2c_f32_bf16 v234, s94, v83
  v_dot2c_f32_bf16 v235, v83, v83
  s_lshl_b32 s7, s71, 6
  s_lshl_b32 s3, s68, 2
  s_add_u32 s7, s7, s3
  s_add_u32 s7, s7, s72
  s_cmp_lt_u32 s0, 7
  s_cselect_b32 s8, 0, 0x7f000000
  v_dot2c_f32_bf16 v234, s94, v84
  v_dot2c_f32_bf16 v235, v84, v84
  v_dot2c_f32_bf16 v234, s94, v85
  v_dot2c_f32_bf16 v235, v85, v85
  v_dot2c_f32_bf16 v234, s94, v86
  v_dot2c_f32_bf16 v235, v86, v86
  v_dot2c_f32_bf16 v234, s94, v87
  v_dot2c_f32_bf16 v235, v87, v87
  v_dot2c_f32_bf16 v234, s94, v88
  v_dot2c_f32_bf16 v235, v88, v88
  v_dot2c_f32_bf16 v234, s94, v89
  v_dot2c_f32_bf16 v235, v89, v89
  v_dot2c_f32_bf16 v234, s94, v90
  v_dot2c_f32_bf16 v235, v90, v90
  v_dot2c_f32_bf16 v234, s94, v91
  v_dot2c_f32_bf16 v235, v91, v91
  s_mul_i32 s4, s7, 896
  s_add_u32 s4, s4, s8
  v_min_u32 v14, 6, v0
  v_lshlrev_b32 v14, 7, v14
  buffer_load_dword v15, v14, s[36:39], s4 offen sc1
  v_dot2c_f32_bf16 v234, s94, v92
  v_dot2c_f32_bf16 v235, v92, v92
  v_dot2c_f32_bf16 v234, s94, v93
  v_dot2c_f32_bf16 v235, v93, v93
  v_dot2c_f32_bf16 v234, s94, v94
  v_dot2c_f32_bf16 v235, v94, v94
  v_dot2c_f32_bf16 v234, s94, v95
  v_dot2c_f32_bf16 v235, v95, v95
  s_waitcnt vmcnt(11)
  s_waitcnt lgkmcnt(0)
  s_barrier
  v_mfma_f32_32x32x16_bf16 v[128:143], v[176:179], v[80:83], v[128:143]
  ds_read_b64_tr_b16 v[168:169], v233 offset:20480
  ds_read_b64_tr_b16 v[170:171], v233 offset:20736
  ds_read_b64_tr_b16 v[172:173], v233 offset:49152
  v_mfma_f32_32x32x16_bf16 v[144:159], v[80:83], v[180:183], v[144:159]
  s_mul_i32 s4, s7, 896
  s_add_u32 s4, s4, s8
  v_min_u32 v14, 6, v0
  v_lshlrev_b32 v14, 7, v14
  buffer_load_dword v15, v14, s[40:43], s4 offen sc1
  ds_read_b64_tr_b16 v[174:175], v233 offset:49408
  ds_read_b128 v[96:99], v224 offset:32768
  ds_read_b128 v[100:103], v225 offset:32768
  v_mfma_f32_32x32x16_bf16 v[128:143], v[184:187], v[84:87], v[128:143]
  s_add_u32 m0, s88, 57344
  s_mov_b32 s6, 0
  buffer_load_dwordx4 v12, s[32:35], s6 offen lds
  ds_read_b128 v[104:107], v226 offset:32768
  ds_read_b128 v[108:111], v227 offset:32768
  ds_read_b64_tr_b16 v[208:209], v232 offset:20480
  v_mfma_f32_32x32x16_bf16 v[144:159], v[84:87], v[188:191], v[144:159]
  ds_read_b64_tr_b16 v[210:211], v232 offset:20736
  ds_read_b64_tr_b16 v[212:213], v232 offset:49152
  ds_read_b64_tr_b16 v[214:215], v232 offset:49408
  v_mfma_f32_32x32x16_bf16 v[128:143], v[192:195], v[88:91], v[128:143]
  s_add_u32 m0, s88, 61440
  s_mov_b32 s6, 172032
  buffer_load_dwordx4 v12, s[32:35], s6 offen lds
  ds_read_b64_tr_b16 v[216:217], v232 offset:21504
  ds_read_b64_tr_b16 v[218:219], v232 offset:21760
  ds_read_b64_tr_b16 v[220:221], v232 offset:50176
  v_mfma_f32_32x32x16_bf16 v[144:159], v[88:91], v[196:199], v[144:159]
  ds_read_b64_tr_b16 v[222:223], v232 offset:50432
  ds_read_b64_tr_b16 v[240:241], v232 offset:22528
  ds_read_b64_tr_b16 v[242:243], v232 offset:22784
  v_mfma_f32_32x32x16_bf16 v[128:143], v[200:203], v[92:95], v[128:143]
  s_add_u32 m0, s88, 65536
  s_mov_b32 s6, 344064
  buffer_load_dwordx4 v12, s[32:35], s6 offen lds
  ds_read_b64_tr_b16 v[244:245], v232 offset:51200
  ds_read_b64_tr_b16 v[246:247], v232 offset:51456
  ds_read_b64_tr_b16 v[248:249], v232 offset:23552
  v_mfma_f32_32x32x16_bf16 v[144:159], v[92:95], v[204:207], v[144:159]
  ds_read_b64_tr_b16 v[250:251], v232 offset:23808
  ds_read_b64_tr_b16 v[252:253], v232 offset:52224
  ds_read_b64_tr_b16 v[254:255], v232 offset:52480
  s_waitcnt lgkmcnt(15)
  v_dot2c_f32_bf16 v236, s94, v168
  v_dot2c_f32_bf16 v237, s94, v172
  v_dot2c_f32_bf16 v236, s94, v169
  v_dot2c_f32_bf16 v237, s94, v173
  v_dot2c_f32_bf16 v236, s94, v170
  v_dot2c_f32_bf16 v237, s94, v174
  v_dot2c_f32_bf16 v236, s94, v171
  v_dot2c_f32_bf16 v237, s94, v175
  s_add_u32 m0, s88, 69632
  s_mov_b32 s6, 516096
  buffer_load_dwordx4 v12, s[32:35], s6 offen lds
  v_dot2c_f32_bf16 v234, s94, v96
  v_dot2c_f32_bf16 v235, v96, v96
  v_dot2c_f32_bf16 v234, s94, v97
  v_dot2c_f32_bf16 v235, v97, v97
  v_dot2c_f32_bf16 v234, s94, v98
  v_dot2c_f32_bf16 v235, v98, v98
  v_dot2c_f32_bf16 v234, s94, v99
  v_dot2c_f32_bf16 v235, v99, v99
  v_dot2c_f32_bf16 v234, s94, v100
  v_dot2c_f32_bf16 v235, v100, v100
  v_dot2c_f32_bf16 v234, s94, v101
  v_dot2c_f32_bf16 v235, v101, v101
  v_dot2c_f32_bf16 v234, s94, v102
  v_dot2c_f32_bf16 v235, v102, v102
  v_dot2c_f32_bf16 v234, s94, v103
  v_dot2c_f32_bf16 v235, v103, v103
  v_dot2c_f32_bf16 v234, s94, v104
  v_dot2c_f32_bf16 v235, v104, v104
  v_dot2c_f32_bf16 v234, s94, v105
  v_dot2c_f32_bf16 v235, v105, v105
  v_dot2c_f32_bf16 v234, s94, v106
  v_dot2c_f32_bf16 v235, v106, v106
  v_dot2c_f32_bf16 v234, s94, v107
  v_dot2c_f32_bf16 v235, v107, v107
  v_dot2c_f32_bf16 v234, s94, v108
  v_dot2c_f32_bf16 v235, v108, v108
  v_dot2c_f32_bf16 v234, s94, v109
  v_dot2c_f32_bf16 v235, v109, v109
  v_dot2c_f32_bf16 v234, s94, v110
  v_dot2c_f32_bf16 v235, v110, v110
  v_dot2c_f32_bf16 v234, s94, v111
  v_dot2c_f32_bf16 v235, v111, v111
  s_waitcnt vmcnt(10)
  s_waitcnt lgkmcnt(0)
  s_barrier
  v_mfma_f32_32x32x16_bf16 v[128:143], v[208:211], v[96:99], v[128:143]
  s_add_u32 m0, s88, 73728
  s_mov_b32 s6, 688128
  buffer_load_dwordx4 v12, s[32:35], s6 offen lds
  ds_read_b64_tr_b16 v[160:161], v233 offset:24576
  ds_read_b64_tr_b16 v[162:163], v233 offset:24832
  ds_read_b64_tr_b16 v[164:165], v233 offset:53248
  v_mfma_f32_32x32x16_bf16 v[144:159], v[96:99], v[212:215], v[144:159]
  ds_read_b64_tr_b16 v[166:167], v233 offset:53504
  ds_read_b128 v[112:115], v224 offset:0
  ds_read_b128 v[116:119], v225 offset:0
  v_mfma_f32_32x32x16_bf16 v[128:143], v[216:219], v[100:103], v[128:143]
  ds_read_b128 v[120:123], v226 offset:0
  ds_read_b128 v[124:127], v227 offset:0
  ds_read_b64_tr_b16 v[176:177], v232 offset:24576
  v_mfma_f32_32x32x16_bf16 v[144:159], v[100:103], v[220:223], v[144:159]
  ds_read_b64_tr_b16 v[178:179], v232 offset:24832
  ds_read_b64_tr_b16 v[180:181], v232 offset:53248
  ds_read_b64_tr_b16 v[182:183], v232 offset:53504
  v_mfma_f32_32x32x16_bf16 v[128:143], v[240:243], v[104:107], v[128:143]
  s_add_u32 m0, s88, 77824
  s_mov_b32 s6, 860160
  buffer_load_dwordx4 v12, s[32:35], s6 offen lds
  ds_read_b64_tr_b16 v[184:185], v232 offset:25600
  ds_read_b64_tr_b16 v[186:187], v232 offset:25856
  ds_read_b64_tr_b16 v[188:189], v232 offset:54272
  v_mfma_f32_32x32x16_bf16 v[144:159], v[104:107], v[244:247], v[144:159]
  ds_read_b64_tr_b16 v[190:191], v232 offset:54528
  ds_read_b64_tr_b16 v[192:193], v232 offset:26624
  ds_read_b64_tr_b16 v[194:195], v232 offset:26880
  v_mfma_f32_32x32x16_bf16 v[128:143], v[248:251], v[108:111], v[128:143]
  ds_read_b64_tr_b16 v[196:197], v232 offset:55296
  ds_read_b64_tr_b16 v[198:199], v232 offset:55552
  ds_read_b64_tr_b16 v[200:201], v232 offset:27648
  v_mfma_f32_32x32x16_bf16 v[144:159], v[108:111], v[252:255], v[144:159]
  ds_read_b64_tr_b16 v[202:203], v232 offset:27904
  ds_read_b64_tr_b16 v[204:205], v232 offset:56320
  ds_read_b64_tr_b16 v[206:207], v232 offset:56576
  s_waitcnt lgkmcnt(15)
  v_dot2c_f32_bf16 v236, s94, v160
  v_dot2c_f32_bf16 v237, s94, v164
  v_dot2c_f32_bf16 v236, s94, v161
  v_dot2c_f32_bf16 v237, s94, v165
  v_dot2c_f32_bf16 v236, s94, v162
  v_dot2c_f32_bf16 v237, s94, v166
  v_dot2c_f32_bf16 v236, s94, v163
  v_dot2c_f32_bf16 v237, s94, v167
  s_nop 1
  ds_write_b32 v13, v236
  ds_write_b32 v13, v237 offset:1024
  v_mov_b32 v11, v13
  s_add_u32 m0, s88, 81920
  s_mov_b32 s6, 1032192
  buffer_load_dwordx4 v12, s[32:35], s6 offen lds
  v_dot2c_f32_bf16 v234, s94, v112
  v_dot2c_f32_bf16 v235, v112, v112
  v_dot2c_f32_bf16 v234, s94, v113
  v_dot2c_f32_bf16 v235, v113, v113
  v_dot2c_f32_bf16 v234, s94, v114
  v_dot2c_f32_bf16 v235, v114, v114
  v_dot2c_f32_bf16 v234, s94, v115
  v_dot2c_f32_bf16 v235, v115, v115
  v_dot2c_f32_bf16 v234, s94, v116
  v_dot2c_f32_bf16 v235, v116, v116
  v_dot2c_f32_bf16 v234, s94, v117
  v_dot2c_f32_bf16 v235, v117, v117
  v_dot2c_f32_bf16 v234, s94, v118
  v_dot2c_f32_bf16 v235, v118, v118
  v_dot2c_f32_bf16 v234, s94, v119
  v_dot2c_f32_bf16 v235, v119, v119
  v_dot2c_f32_bf16 v234, s94, v120
  v_dot2c_f32_bf16 v235, v120, v120
  v_dot2c_f32_bf16 v234, s94, v121
  v_dot2c_f32_bf16 v235, v121, v121
  v_dot2c_f32_bf16 v234, s94, v122
  v_dot2c_f32_bf16 v235, v122, v122
  v_dot2c_f32_bf16 v234, s94, v123
  v_dot2c_f32_bf16 v235, v123, v123
  v_dot2c_f32_bf16 v234, s94, v124
  v_dot2c_f32_bf16 v235, v124, v124
  v_dot2c_f32_bf16 v234, s94, v125
  v_dot2c_f32_bf16 v235, v125, v125
  v_dot2c_f32_bf16 v234, s94, v126
  v_dot2c_f32_bf16 v235, v126, v126
  v_dot2c_f32_bf16 v234, s94, v127
  v_dot2c_f32_bf16 v235, v127, v127
  s_waitcnt lgkmcnt(0)
  s_barrier
  v_mfma_f32_32x32x16_bf16 v[128:143], v[176:179], v[112:115], v[128:143]
  v_add_u32 v239, 155648, v1
  ds_read_b128 v[208:211], v239
  ds_read_b128 v[212:215], v239 offset:1024
  v_mov_b32 v230, v234
  v_mov_b32 v231, v235
  s_nop 0
  v_permlane32_swap_b32 v230, v234
  v_permlane32_swap_b32 v231, v235
  v_mfma_f32_32x32x16_bf16 v[144:159], v[112:115], v[180:183], v[144:159]
  v_add_f32 v234, v230, v234
  v_add_f32 v235, v231, v235
  v_mul_f32 v230, 0x3b124925, v234
  v_mul_f32 v235, 0x3b124925, v235
  v_fma_f32 v234, -v230, v230, v235
  v_max_f32 v234, 0, v234
  v_mfma_f32_32x32x16_bf16 v[128:143], v[184:187], v[116:119], v[128:143]
  v_add_f32 v234, 0x3727c5ac, v234
  v_rsq_f32 v234, v234
  v_add_u32 v235, s17, v2
  v_cvt_pk_bf16_f32 v226, -v230, -v230
  v_mov_b32 v224, 0
  v_mov_b32 v225, 0
  v_mfma_f32_32x32x16_bf16 v[144:159], v[116:119], v[188:191], v[144:159]
  v_lshlrev_b32 v231, 16, v226
  v_mov_b32 v228, 0
  v_add_f32 v231, v230, v231
  v_mov_b32 v229, 0
  v_cvt_pk_bf16_f32 v227, -v231, 0
  ds_write_b32 v235, v234
  v_mfma_f32_32x32x16_bf16 v[128:143], v[192:195], v[120:123], v[128:143]
  v_lshrrev_b32 v231, 5, v0
  v_lshlrev_b32 v231, 4, v231
  v_add_u32 v231, s17, v231
  s_waitcnt lgkmcnt(0)
  ds_read_b128 v[160:163], v231 offset:0
  ds_read_b128 v[164:167], v231 offset:32
  ds_read_b128 v[168:171], v231 offset:64
  v_mfma_f32_32x32x16_bf16 v[144:159], v[120:123], v[196:199], v[144:159]
  ds_read_b128 v[172:175], v231 offset:96
  v_mov_b32 v230, 0
  v_and_b32 v235, 31, v0
  v_cmp_eq_u32 vcc, 28, v235
  v_mov_b32 v231, s94
  s_nop 0
  v_cndmask_b32 v231, v230, v231, vcc
  v_add_f32 v208, v208, v209
  v_add_f32 v210, v210, v211
  v_mfma_f32_32x32x16_bf16 v[128:143], v[200:203], v[124:127], v[128:143]
  v_add_f32 v208, v208, v210
  v_cvt_pk_bf16_f32 v5, v208, 0
  v_lshlrev_b32 v209, 16, v5
  v_sub_f32 v209, v208, v209
  v_cvt_pk_bf16_f32 v4, v208, v209
  v_add_f32 v212, v212, v213
  v_mfma_f32_32x32x16_bf16 v[144:159], v[124:127], v[204:207], v[144:159]
  v_add_f32 v214, v214, v215
  v_add_f32 v212, v212, v214
  v_cvt_pk_bf16_f32 v7, v212, 0
  v_lshlrev_b32 v213, 16, v7
  v_sub_f32 v213, v212, v213
  v_cvt_pk_bf16_f32 v6, v212, v213
  s_nop 1
  v_mfma_f32_32x32x16_bf16 v[128:143], v[4:7], v[226:229], v[128:143]
  v_mfma_f32_32x32x16_bf16 v[144:159], v[224:227], v[4:7], v[144:159]
  s_lshl_b32 s9, s69, 13
  s_lshl_b32 s3, s72, 11
  s_add_u32 s9, s9, s3
  s_add_u32 s9, s9, 0x1800000
  s_lshl_b32 s25, s68, 7
  s_add_u32 s25, s25, s9
  s_add_u32 s8, s25, 0x180000
  s_xor_b32 s16, s8, 128
  buffer_load_dword v15, off, s[64:67], s8 sc1
  s_lshl_b32 s5, s68, 14
  s_add_u32 s5, s5, s75
  v_pk_mul_f32 v[128:129], v[128:129], v[234:235] op_sel_hi:[1,0]
  v_pk_mul_f32 v[130:131], v[130:131], v[234:235] op_sel_hi:[1,0]
  v_pk_mul_f32 v[132:133], v[132:133], v[234:235] op_sel_hi:[1,0]
  v_pk_mul_f32 v[134:135], v[134:135], v[234:235] op_sel_hi:[1,0]
  v_pk_mul_f32 v[136:137], v[136:137], v[234:235] op_sel_hi:[1,0]
  v_pk_mul_f32 v[138:139], v[138:139], v[234:235] op_sel_hi:[1,0]
  v_pk_mul_f32 v[140:141], v[140:141], v[234:235] op_sel_hi:[1,0]
  v_pk_mul_f32 v[142:143], v[142:143], v[234:235] op_sel_hi:[1,0]
  v_cvt_pk_bf16_f32 v208, v128, v129
  v_cvt_pk_bf16_f32 v209, v130, v131
  v_cvt_pk_bf16_f32 v210, v132, v133
  v_cvt_pk_bf16_f32 v211, v134, v135
  v_cvt_pk_bf16_f32 v212, v136, v137
  v_cvt_pk_bf16_f32 v213, v138, v139
  v_cvt_pk_bf16_f32 v214, v140, v141
  v_cvt_pk_bf16_f32 v215, v142, v143
  v_cndmask_b32 v214, v214, v230, s[90:91]
  v_cndmask_b32 v215, v215, v230, s[90:91]
  buffer_store_dwordx4 v[208:211], v1, s[64:67], s5 offen offset:0 sc1
  buffer_store_dwordx4 v[212:215], v1, s[64:67], s5 offen offset:1024 sc1
  s_waitcnt lgkmcnt(3)
  v_pk_mul_f32 v[144:145], v[144:145], v[160:161]
  v_pk_mul_f32 v[146:147], v[146:147], v[162:163]
  s_waitcnt lgkmcnt(2)
  v_pk_mul_f32 v[148:149], v[148:149], v[164:165]
  v_pk_mul_f32 v[150:151], v[150:151], v[166:167]
  s_waitcnt lgkmcnt(1)
  v_pk_mul_f32 v[152:153], v[152:153], v[168:169]
  v_pk_mul_f32 v[154:155], v[154:155], v[170:171]
  s_waitcnt lgkmcnt(0)
  v_pk_mul_f32 v[156:157], v[156:157], v[172:173]
  v_pk_mul_f32 v[158:159], v[158:159], v[174:175]
  v_cvt_pk_bf16_f32 v216, v144, v145
  v_cvt_pk_bf16_f32 v217, v146, v147
  v_cvt_pk_bf16_f32 v218, v148, v149
  v_cvt_pk_bf16_f32 v219, v150, v151
  v_cvt_pk_bf16_f32 v220, v152, v153
  v_cvt_pk_bf16_f32 v221, v154, v155
  v_cvt_pk_bf16_f32 v222, v156, v157
  v_cvt_pk_bf16_f32 v223, v158, v159
  v_cndmask_b32 v216, v216, v231, s[92:93]
  v_cndmask_b32 v217, v217, v231, s[92:93]
  v_cndmask_b32 v218, v218, v231, s[92:93]
  v_cndmask_b32 v219, v219, v231, s[92:93]
  v_cndmask_b32 v220, v220, v231, s[92:93]
  v_cndmask_b32 v221, v221, v231, s[92:93]
  v_cndmask_b32 v222, v222, v231, s[92:93]
  v_cndmask_b32 v223, v223, v231, s[92:93]
  buffer_store_dwordx4 v[216:219], v1, s[64:67], s5 offen offset:2048 sc1
  buffer_store_dwordx4 v[220:223], v1, s[64:67], s5 offen offset:3072 sc1
  v_and_b32 v13, 0xf0, v1
  buffer_load_dword v12, v13, s[60:63], 0 offen sc1
  s_waitcnt vmcnt(6)
  v_add_u32 v230, 57344, v233
  ds_read_b64_tr_b16 v[176:177], v230 offset:0
  ds_read_b64_tr_b16 v[178:179], v230 offset:256
  ds_read_b64_tr_b16 v[180:181], v230 offset:4096
  ds_read_b64_tr_b16 v[182:183], v230 offset:4352
  ds_read_b64_tr_b16 v[184:185], v230 offset:8192
  ds_read_b64_tr_b16 v[186:187], v230 offset:8448
  ds_read_b64_tr_b16 v[188:189], v230 offset:12288
  ds_read_b64_tr_b16 v[190:191], v230 offset:12544
  ds_read_b64_tr_b16 v[192:193], v230 offset:16384
  ds_read_b64_tr_b16 v[194:195], v230 offset:16640
  ds_read_b64_tr_b16 v[196:197], v230 offset:20480
  ds_read_b64_tr_b16 v[198:199], v230 offset:20736
  ds_read_b64_tr_b16 v[200:201], v230 offset:24576
  ds_read_b64_tr_b16 v[202:203], v230 offset:24832
  s_waitcnt lgkmcnt(13)
  v_dot2c_f32_bf16 v238, s94, v176
  v_dot2c_f32_bf16 v238, s94, v177
  s_waitcnt lgkmcnt(12)
  v_dot2c_f32_bf16 v238, s94, v178
  v_dot2c_f32_bf16 v238, s94, v179
  s_waitcnt lgkmcnt(11)
  v_dot2c_f32_bf16 v238, s94, v180
  v_dot2c_f32_bf16 v238, s94, v181
  s_waitcnt lgkmcnt(10)
  v_dot2c_f32_bf16 v238, s94, v182
  v_dot2c_f32_bf16 v238, s94, v183
  s_waitcnt lgkmcnt(9)
  v_dot2c_f32_bf16 v238, s94, v184
  v_dot2c_f32_bf16 v238, s94, v185
  s_waitcnt lgkmcnt(8)
  v_dot2c_f32_bf16 v238, s94, v186
  v_dot2c_f32_bf16 v238, s94, v187
  s_waitcnt lgkmcnt(7)
  v_dot2c_f32_bf16 v238, s94, v188
  v_dot2c_f32_bf16 v238, s94, v189
  s_waitcnt lgkmcnt(6)
  v_dot2c_f32_bf16 v238, s94, v190
  v_dot2c_f32_bf16 v238, s94, v191
  s_waitcnt lgkmcnt(5)
  v_dot2c_f32_bf16 v238, s94, v192
  v_dot2c_f32_bf16 v238, s94, v193
  s_waitcnt lgkmcnt(4)
  v_dot2c_f32_bf16 v238, s94, v194
  v_dot2c_f32_bf16 v238, s94, v195
  s_waitcnt lgkmcnt(3)
  v_dot2c_f32_bf16 v238, s94, v196
  v_dot2c_f32_bf16 v238, s94, v197
  s_waitcnt lgkmcnt(2)
  v_dot2c_f32_bf16 v238, s94, v198
  v_dot2c_f32_bf16 v238, s94, v199
  s_waitcnt lgkmcnt(1)
  v_dot2c_f32_bf16 v238, s94, v200
  v_dot2c_f32_bf16 v238, s94, v201
  s_waitcnt lgkmcnt(0)
  v_dot2c_f32_bf16 v238, s94, v202
  v_dot2c_f32_bf16 v238, s94, v203
  s_nop 2
  ds_write_b32 v11, v238 offset:2048
  v_add_u32 v239, 157696, v1
  v_add_u32 v233, 57344, v232
  s_waitcnt lgkmcnt(0)
  s_barrier
  ds_read_b128 v[204:207], v239
  ds_read_b64_tr_b16 v[128:129], v233 offset:0
  ds_read_b64_tr_b16 v[130:131], v233 offset:256
  ds_read_b64_tr_b16 v[132:133], v233 offset:1024
  ds_read_b64_tr_b16 v[134:135], v233 offset:1280
  ds_read_b64_tr_b16 v[136:137], v233 offset:2048
  ds_read_b64_tr_b16 v[138:139], v233 offset:2304
  ds_read_b64_tr_b16 v[140:141], v233 offset:3072
  ds_read_b64_tr_b16 v[142:143], v233 offset:3328
  ds_read_b64_tr_b16 v[144:145], v233 offset:4096
  ds_read_b64_tr_b16 v[146:147], v233 offset:4352
  ds_read_b64_tr_b16 v[148:149], v233 offset:5120
  ds_read_b64_tr_b16 v[150:151], v233 offset:5376
  s_and_b32 s19, s68, 14
  s_and_b32 s20, s68, 1
  v_add_u32 v232, s19, v0
  v_and_b32 v232, 15, v232
  v_lshlrev_b32 v232, 7, v232
  s_waitcnt lgkmcnt(10)
  v_mfma_f32_32x32x16_bf16 v[160:175], v[128:131], v[16:19], 0
  ds_read_b64_tr_b16 v[152:153], v233 offset:6144
  ds_read_b64_tr_b16 v[154:155], v233 offset:6400
  v_add_f32 v204, v204, v205
  v_add_f32 v206, v206, v207
  v_add_f32 v204, v204, v206
  s_waitcnt lgkmcnt(10)
  v_mfma_f32_32x32x16_bf16 v[160:175], v[132:135], v[20:23], v[160:175]
  ds_read_b64_tr_b16 v[156:157], v233 offset:7168
  ds_read_b64_tr_b16 v[158:159], v233 offset:7424
  v_cvt_pk_bf16_f32 v9, v204, 0
  v_lshlrev_b32 v205, 16, v9
  v_sub_f32 v205, v204, v205
  s_waitcnt lgkmcnt(10)
  v_mfma_f32_32x32x16_bf16 v[160:175], v[136:139], v[24:27], v[160:175]
  ds_read_b64_tr_b16 v[128:129], v233 offset:8192
  ds_read_b64_tr_b16 v[130:131], v233 offset:8448
  v_cvt_pk_bf16_f32 v8, v204, v205
  s_nop 1
  v_mfma_f32_32x32x16_bf16 v[160:175], v[6:9], v[224:227], v[160:175]
  s_add_u32 s10, s75, 0x0
  s_add_u32 s22, s19, s20
  s_waitcnt lgkmcnt(10)
  v_mfma_f32_32x32x16_bf16 v[160:175], v[140:143], v[28:31], v[160:175]
  ds_read_b64_tr_b16 v[132:133], v233 offset:9216
  ds_read_b64_tr_b16 v[134:135], v233 offset:9472
  s_lshl_b32 s22, s22, 14
  s_sub_u32 s23, s19, s20
  s_lshl_b32 s23, s23, 14
  s_waitcnt lgkmcnt(10)
  v_mfma_f32_32x32x16_bf16 v[160:175], v[144:147], v[32:35], v[160:175]
  ds_read_b64_tr_b16 v[136:137], v233 offset:10240
  ds_read_b64_tr_b16 v[138:139], v233 offset:10496
  s_lshl_b32 s18, s19, 14
  s_xor_b32 s4, s72, 1
  s_mul_i32 s4, s4, 12288
  s_waitcnt lgkmcnt(10)
  v_mfma_f32_32x32x16_bf16 v[160:175], v[148:151], v[36:39], v[160:175]
  ds_read_b64_tr_b16 v[140:141], v233 offset:11264
  ds_read_b64_tr_b16 v[142:143], v233 offset:11520
  s_add_u32 s4, s4, 0x1c000
  v_add_u32 v224, s4, v1
  s_xor_b32 s4, s72, 2
  s_waitcnt lgkmcnt(10)
  v_mfma_f32_32x32x16_bf16 v[160:175], v[152:155], v[40:43], v[160:175]
  ds_read_b64_tr_b16 v[144:145], v233 offset:12288
  ds_read_b64_tr_b16 v[146:147], v233 offset:12544
  s_mul_i32 s4, s4, 12288
  s_add_u32 s4, s4, 0x1d000
  v_add_u32 v225, s4, v1
  v_mov_b32 v14, 1
  s_waitcnt vmcnt(1)
  s_waitcnt vmcnt(0)
  v_cmp_eq_u32 vcc, 0, v12
  s_nop 0
  s_cbranch_vccnz L2
L3:
  s_getreg_b32 s24, hwreg(HW_REG_XCC_ID, 0, 4)
  s_add_u32 s99, s24, 1
  v_mov_b32 v12, s99
  s_mov_b64 exec, 1
  buffer_store_dword v14, off, s[64:67], s8
  buffer_store_dword v14, off, s[64:67], s25 sc1
  buffer_store_dword v12, off, s[64:67], s82 sc1
  s_mov_b64 exec, -1
  v_and_b32 v231, 31, v0
  v_lshlrev_b32 v231, 7, v231
  buffer_load_dword v15, v231, s[64:67], s5 offen sc1
  s_waitcnt lgkmcnt(10)
  v_mfma_f32_32x32x16_bf16 v[160:175], v[156:159], v[44:47], v[160:175]
  ds_read_b64_tr_b16 v[148:149], v233 offset:13312
  ds_read_b64_tr_b16 v[150:151], v233 offset:13568
  s_xor_b32 s4, s72, 3
  s_mul_i32 s4, s4, 12288
  s_add_u32 s4, s4, 0x1e000
  v_add_u32 v226, s4, v1
  s_waitcnt lgkmcnt(10)
  v_mfma_f32_32x32x16_bf16 v[160:175], v[128:131], v[48:51], v[160:175]
  ds_read_b64_tr_b16 v[152:153], v233 offset:14336
  ds_read_b64_tr_b16 v[154:155], v233 offset:14592
  v_add_u32 v227, s83, v1
  v_bfe_u32 v230, v0, 4, 1
  v_lshlrev_b32 v230, 2, v230
  s_waitcnt lgkmcnt(10)
  v_mfma_f32_32x32x16_bf16 v[160:175], v[132:135], v[52:55], v[160:175]
  ds_read_b64_tr_b16 v[156:157], v233 offset:15360
  ds_read_b64_tr_b16 v[158:159], v233 offset:15616
  v_and_b32 v236, 7, v0
  v_xor_b32 v236, v230, v236
  v_lshrrev_b32 v230, 3, v0
  s_waitcnt lgkmcnt(10)
  v_mfma_f32_32x32x16_bf16 v[160:175], v[136:139], v[56:59], v[160:175]
  ds_read_b64_tr_b16 v[128:129], v233 offset:16384
  ds_read_b64_tr_b16 v[130:131], v233 offset:16640
  v_mul_u32_u24 v230, 896, v230
  v_lshl_add_u32 v236, v236, 4, v230
  v_add_u32 v237, 6144, v236
  s_waitcnt lgkmcnt(10)
  v_mfma_f32_32x32x16_bf16 v[160:175], v[140:143], v[60:63], v[160:175]
  ds_read_b64_tr_b16 v[132:133], v233 offset:17408
  ds_read_b64_tr_b16 v[134:135], v233 offset:17664
  v_add_u32 v238, 12288, v236
  v_add_u32 v239, 18432, v236
  s_waitcnt lgkmcnt(10)
  v_mfma_f32_32x32x16_bf16 v[160:175], v[144:147], v[64:67], v[160:175]
  ds_read_b64_tr_b16 v[136:137], v233 offset:18432
  ds_read_b64_tr_b16 v[138:139], v233 offset:18688
  s_waitcnt lgkmcnt(10)
  v_mfma_f32_32x32x16_bf16 v[160:175], v[148:151], v[68:71], v[160:175]
  ds_read_b64_tr_b16 v[140:141], v233 offset:19456
  ds_read_b64_tr_b16 v[142:143], v233 offset:19712
  s_waitcnt lgkmcnt(10)
  v_mfma_f32_32x32x16_bf16 v[160:175], v[152:155], v[72:75], v[160:175]
  ds_read_b64_tr_b16 v[144:145], v233 offset:20480
  ds_read_b64_tr_b16 v[146:147], v233 offset:20736
  s_lshl_b32 s13, s71, 18
  s_lshl_b32 s3, s72, 16
  s_add_u32 s13, s13, s3
  s_add_u32 s13, s13, 0x1c00000
  s_cmp_lt_u32 s0, 14
  s_cselect_b32 s13, s13, 0x7f000000
  s_lshl_b32 s4, s71, 2
  s_lshr_b32 s4, 0xea75310, s4
  s_and_b32 s4, s4, 15
  v_mov_b32 v228, s4
  s_waitcnt lgkmcnt(10)
  v_mfma_f32_32x32x16_bf16 v[160:175], v[156:159], v[76:79], v[160:175]
  ds_read_b64_tr_b16 v[148:149], v233 offset:21504
  ds_read_b64_tr_b16 v[150:151], v233 offset:21760
  s_lshl_b32 s14, s72, 11
  s_add_u32 s14, s14, 0x1880000
  v_mov_b32 v229, s69
  s_waitcnt lgkmcnt(10)
  v_mfma_f32_32x32x16_bf16 v[160:175], v[128:131], v[80:83], v[160:175]
  ds_read_b64_tr_b16 v[152:153], v233 offset:22528
  ds_read_b64_tr_b16 v[154:155], v233 offset:22784
  v_cndmask_b32 v228, v228, v229, s[90:91]
  v_and_b32 v229, 15, v0
  v_lshlrev_b32 v229, 7, v229
  s_waitcnt lgkmcnt(10)
  v_mfma_f32_32x32x16_bf16 v[160:175], v[132:135], v[84:87], v[160:175]
  ds_read_b64_tr_b16 v[156:157], v233 offset:23552
  ds_read_b64_tr_b16 v[158:159], v233 offset:23808
  v_lshl_add_u32 v228, v228, 13, v229
  v_and_b32 v230, 15, v0
  v_lshlrev_b32 v230, 7, v230
  s_waitcnt lgkmcnt(10)
  v_mfma_f32_32x32x16_bf16 v[160:175], v[136:139], v[88:91], v[160:175]
  ds_read_b64_tr_b16 v[128:129], v233 offset:24576
  ds_read_b64_tr_b16 v[130:131], v233 offset:24832
  s_lshl_b32 s4, s72, 15
  s_lshl_b32 s3, s69, 11
  s_add_u32 s4, s4, s3
  s_add_u32 s4, s4, s73
  s_waitcnt lgkmcnt(10)
  v_mfma_f32_32x32x16_bf16 v[160:175], v[140:143], v[92:95], v[160:175]
  ds_read_b64_tr_b16 v[132:133], v233 offset:25600
  ds_read_b64_tr_b16 v[134:135], v233 offset:25856
  v_add_u32 v235, s4, v230
  s_mov_b32 s4, s79
  s_add_u32 s4, s4, s84
  s_waitcnt lgkmcnt(10)
  v_mfma_f32_32x32x16_bf16 v[160:175], v[144:147], v[96:99], v[160:175]
  ds_read_b64_tr_b16 v[136:137], v233 offset:26624
  ds_read_b64_tr_b16 v[138:139], v233 offset:26880
  s_add_u32 s4, s4, 0x20000
  v_add_u32 v230, s4, v230
  v_cndmask_b32 v235, v235, v230, s[90:91]
  buffer_load_dword v12, off, s[64:67], s16 sc1
  s_waitcnt lgkmcnt(10)
  v_mfma_f32_32x32x16_bf16 v[160:175], v[148:151], v[100:103], v[160:175]
  ds_read_b64_tr_b16 v[140:141], v233 offset:27648
  ds_read_b64_tr_b16 v[142:143], v233 offset:27904
  s_waitcnt lgkmcnt(10)
  v_mfma_f32_32x32x16_bf16 v[160:175], v[152:155], v[104:107], v[160:175]
  s_waitcnt lgkmcnt(8)
  v_mfma_f32_32x32x16_bf16 v[160:175], v[156:159], v[108:111], v[160:175]
  s_waitcnt lgkmcnt(6)
  v_mfma_f32_32x32x16_bf16 v[160:175], v[128:131], v[112:115], v[160:175]
  s_waitcnt lgkmcnt(4)
  v_mfma_f32_32x32x16_bf16 v[160:175], v[132:135], v[116:119], v[160:175]
  s_mul_i32 s4, s69, 1536
  s_mul_i32 s3, s72, 384
  s_add_u32 s4, s4, s3
  s_add_u32 s4, s4, s73
  s_add_u32 s4, s4, 0xb0000
  v_writelane_b32 v235, s4, 16
  s_add_u32 s4, s4, 128
  v_writelane_b32 v235, s4, 17
  s_add_u32 s4, s4, 128
  v_writelane_b32 v235, s4, 18
  s_add_u32 s4, s4, 128
  s_and_b32 s4, s69, 15
  s_lshl_b32 s4, s4, 7
  s_add_u32 s4, s4, s73
  s_add_u32 s4, s4, 0xc0000
  v_writelane_b32 v235, s4, 19
  s_waitcnt lgkmcnt(2)
  v_mfma_f32_32x32x16_bf16 v[160:175], v[136:139], v[120:123], v[160:175]
  s_waitcnt lgkmcnt(0)
  v_mfma_f32_32x32x16_bf16 v[160:175], v[140:143], v[124:127], v[160:175]
  v_mul_f32 v234, 0x3e8b97f6, v234
  v_mov_b32 v230, 0
  v_mov_b32 v13, 0
  s_lshl_b32 s4, s72, 11
  s_add_u32 s4, s4, 0x1e000
  v_add_u32 v231, s4, v1
  s_nop 5
  v_pk_mul_f32 v[160:161], v[160:161], v[234:235] op_sel_hi:[1,0]
  v_pk_mul_f32 v[162:163], v[162:163], v[234:235] op_sel_hi:[1,0]
  v_pk_mul_f32 v[164:165], v[164:165], v[234:235] op_sel_hi:[1,0]
  v_pk_mul_f32 v[166:167], v[166:167], v[234:235] op_sel_hi:[1,0]
  v_pk_mul_f32 v[168:169], v[168:169], v[234:235] op_sel_hi:[1,0]
  v_pk_mul_f32 v[170:171], v[170:171], v[234:235] op_sel_hi:[1,0]
  v_pk_mul_f32 v[172:173], v[172:173], v[234:235] op_sel_hi:[1,0]
  v_pk_mul_f32 v[174:175], v[174:175], v[234:235] op_sel_hi:[1,0]
  v_cvt_pk_bf16_f32 v40, v160, v161
  v_cvt_pk_bf16_f32 v41, v162, v163
  v_cvt_pk_bf16_f32 v42, v164, v165
  v_cvt_pk_bf16_f32 v43, v166, v167
  v_cvt_pk_bf16_f32 v44, v168, v169
  v_cvt_pk_bf16_f32 v45, v170, v171
  v_cvt_pk_bf16_f32 v46, v172, v173
  v_cvt_pk_bf16_f32 v47, v174, v175
  v_cndmask_b32 v46, v46, v230, s[90:91]
  v_cndmask_b32 v47, v47, v230, s[90:91]
  ds_write_b128 v231, v[40:43]
  ds_write_b128 v231, v[44:47] offset:1024
  s_add_u32 s11, s18, 32768
  s_and_b32 s11, s11, 245760
  s_add_u32 s11, s11, s10
  v_mfma_f32_32x32x16_bf16 v[112:127], v[208:211], v[40:43], 0
  v_mfma_f32_32x32x16_bf16 v[112:127], v[212:215], v[44:47], v[112:127]
  s_waitcnt lgkmcnt(0)
  s_barrier
  v_xor_b32 v230, 2048, v231
  ds_read_b128 v[16:19], v230
  ds_read_b128 v[20:23], v230 offset:1024
  v_xor_b32 v230, 4096, v231
  ds_read_b128 v[24:27], v230
  ds_read_b128 v[28:31], v230 offset:1024
  v_xor_b32 v230, 6144, v231
  ds_read_b128 v[32:35], v230
  ds_read_b128 v[36:39], v230 offset:1024
  s_mov_b64 exec, 0xc
  buffer_load_dword v13, v232, s[64:67], s9 offen sc1
  s_mov_b64 exec, -1
  s_xor_b32 s21, s68, 1
  s_lshl_b32 s21, s21, 14
  s_add_u32 s21, s21, s75
  s_waitcnt vmcnt(1)
  v_cmp_eq_u32 vcc, 0, v12
  s_nop 0
  s_cbranch_vccnz L4
L5:
  buffer_load_dwordx4 v[176:179], v1, s[64:67], s21 offen offset:0 sc1
  buffer_load_dwordx4 v[180:183], v1, s[64:67], s21 offen offset:1024 sc1
  buffer_load_dwordx4 v[184:187], v1, s[64:67], s21 offen offset:2048 sc1
  buffer_load_dwordx4 v[188:191], v1, s[64:67], s21 offen offset:3072 sc1
  v_exp_f32 v112, v112
  v_exp_f32 v113, v113
  v_exp_f32 v114, v114
  v_exp_f32 v115, v115
  v_cvt_pk_bf16_f32 v144, v112, v113
  v_cvt_pk_bf16_f32 v145, v114, v115
  v_exp_f32 v116, v116
  v_exp_f32 v117, v117
  v_exp_f32 v118, v118
  v_exp_f32 v119, v119
  s_waitcnt lgkmcnt(5)
  v_mfma_f32_32x32x16_bf16 v[128:143], v[208:211], v[16:19], 0
  v_cvt_pk_bf16_f32 v146, v116, v117
  v_cvt_pk_bf16_f32 v147, v118, v119
  v_exp_f32 v120, v120
  v_exp_f32 v121, v121
  v_exp_f32 v122, v122
  v_exp_f32 v123, v123
  s_waitcnt lgkmcnt(4)
  v_mfma_f32_32x32x16_bf16 v[128:143], v[212:215], v[20:23], v[128:143]
  v_cvt_pk_bf16_f32 v148, v120, v121
  v_cvt_pk_bf16_f32 v149, v122, v123
  v_exp_f32 v124, v124
  v_exp_f32 v125, v125
  v_exp_f32 v126, v126
  v_exp_f32 v127, v127
  v_cvt_pk_bf16_f32 v150, v124, v125
  v_cvt_pk_bf16_f32 v151, v126, v127
  s_waitcnt lgkmcnt(3)
  v_mfma_f32_32x32x16_bf16 v[112:127], v[208:211], v[24:27], 0
  s_nop 1
  v_exp_f32 v128, v128
  v_exp_f32 v129, v129
  v_exp_f32 v130, v130
  v_exp_f32 v131, v131
  s_waitcnt lgkmcnt(2)
  v_mfma_f32_32x32x16_bf16 v[112:127], v[212:215], v[28:31], v[112:127]
  v_cvt_pk_bf16_f32 v152, v128, v129
  v_cvt_pk_bf16_f32 v153, v130, v131
  v_exp_f32 v132, v132
  v_exp_f32 v133, v133
  v_exp_f32 v134, v134
  v_exp_f32 v135, v135
  v_mfma_f32_32x32x16_bf16 v[96:111], v[216:219], v[144:147], 0
  v_cvt_pk_bf16_f32 v154, v132, v133
  v_cvt_pk_bf16_f32 v155, v134, v135
  v_exp_f32 v136, v136
  v_exp_f32 v137, v137
  v_exp_f32 v138, v138
  v_exp_f32 v139, v139
  v_mfma_f32_32x32x16_bf16 v[96:111], v[220:223], v[148:151], v[96:111]
  v_cvt_pk_bf16_f32 v156, v136, v137
  v_cvt_pk_bf16_f32 v157, v138, v139
  v_exp_f32 v140, v140
  v_exp_f32 v141, v141
  v_exp_f32 v142, v142
  v_exp_f32 v143, v143
  v_cvt_pk_bf16_f32 v158, v140, v141
  v_cvt_pk_bf16_f32 v159, v142, v143
  s_waitcnt vmcnt(4)
  v_cmp_ne_u32 s[86:87], 0, v13
  s_nop 2
  s_andn2_b32 s3, 0xc, s86
  s_cbranch_scc1 L6
L7:
  s_waitcnt lgkmcnt(1)
  v_mfma_f32_32x32x16_bf16 v[128:143], v[208:211], v[32:35], 0
  buffer_load_dwordx4 v[192:195], v1, s[64:67], s11 offen offset:0 sc1
  v_exp_f32 v112, v112
  v_exp_f32 v113, v113
  v_exp_f32 v114, v114
  v_exp_f32 v115, v115
  s_waitcnt lgkmcnt(0)
  v_mfma_f32_32x32x16_bf16 v[128:143], v[212:215], v[36:39], v[128:143]
  buffer_load_dwordx4 v[196:199], v1, s[64:67], s11 offen offset:1024 sc1
  v_cvt_pk_bf16_f32 v144, v112, v113
  v_cvt_pk_bf16_f32 v145, v114, v115
  v_exp_f32 v116, v116
  v_exp_f32 v117, v117
  v_exp_f32 v118, v118
  v_exp_f32 v119, v119
  v_mfma_f32_32x32x16_bf16 v[48:63], v[216:219], v[152:155], 0
  buffer_load_dwordx4 v[200:203], v1, s[64:67], s11 offen offset:2048 sc1
  v_cvt_pk_bf16_f32 v146, v116, v117
  v_cvt_pk_bf16_f32 v147, v118, v119
  v_exp_f32 v120, v120
  v_exp_f32 v121, v121
  v_exp_f32 v122, v122
  v_exp_f32 v123, v123
  v_mfma_f32_32x32x16_bf16 v[48:63], v[220:223], v[156:159], v[48:63]
  buffer_load_dwordx4 v[204:207], v1, s[64:67], s11 offen offset:3072 sc1
  v_cvt_pk_bf16_f32 v148, v120, v121
  v_cvt_pk_bf16_f32 v149, v122, v123
  v_exp_f32 v124, v124
  v_exp_f32 v125, v125
  v_exp_f32 v126, v126
  v_exp_f32 v127, v127
  v_cvt_pk_bf16_f32 v150, v124, v125
  v_cvt_pk_bf16_f32 v151, v126, v127
  v_exp_f32 v128, v128
  v_exp_f32 v129, v129
  v_exp_f32 v130, v130
  v_exp_f32 v131, v131
  v_cvt_pk_bf16_f32 v152, v128, v129
  v_cvt_pk_bf16_f32 v153, v130, v131
  v_exp_f32 v132, v132
  v_exp_f32 v133, v133
  v_exp_f32 v134, v134
  v_exp_f32 v135, v135
  v_mfma_f32_32x32x16_bf16 v[64:79], v[216:219], v[144:147], 0
  s_add_u32 s21, s18, 49152
  v_cvt_pk_bf16_f32 v154, v132, v133
  v_cvt_pk_bf16_f32 v155, v134, v135
  v_exp_f32 v136, v136
  v_exp_f32 v137, v137
  v_exp_f32 v138, v138
  v_exp_f32 v139, v139
  v_mfma_f32_32x32x16_bf16 v[64:79], v[220:223], v[148:151], v[64:79]
  s_mov_b64 exec, 0x30
  buffer_load_dword v13, v232, s[64:67], s9 offen sc1
  s_mov_b64 exec, -1
  v_cvt_pk_bf16_f32 v156, v136, v137
  v_cvt_pk_bf16_f32 v157, v138, v139
  v_exp_f32 v140, v140
  v_exp_f32 v141, v141
  v_exp_f32 v142, v142
  v_exp_f32 v143, v143
  v_cvt_pk_bf16_f32 v158, v140, v141
  v_cvt_pk_bf16_f32 v159, v142, v143
  s_sub_u32 s3, s0, 11
  s_cmp_lt_u32 s3, 2
  s_cbranch_scc1 L9
L10:
  v_accvgpr_read_b32 v10, a224
  s_add_u32 s5, s89, 0x22000
  v_add_u32 v10, s5, v10
  v_xor_b32 v11, 64, v10
  ds_read_b64_tr_b16 v[240:241], v10 offset:0
  ds_read_b64_tr_b16 v[242:243], v10 offset:1024
  ds_read_b64_tr_b16 v[244:245], v11 offset:0
  ds_read_b64_tr_b16 v[246:247], v11 offset:1024
  ds_read_b64_tr_b16 v[248:249], v10 offset:2048
  ds_read_b64_tr_b16 v[250:251], v10 offset:3072
  ds_read_b64_tr_b16 v[252:253], v11 offset:2048
  ds_read_b64_tr_b16 v[254:255], v11 offset:3072
  s_lshl_b32 s7, s71, 18
  s_lshl_b32 s3, s72, 16
  s_add_u32 s7, s7, s3
  s_lshl_b32 s3, s68, 12
  s_add_u32 s7, s7, s3
  s_add_u32 s7, s7, 0x1c00000
  s_cmp_lt_u32 s68, 14
  s_cselect_b32 s7, s7, 0x7f000000
  s_cmp_lt_u32 s0, 7
  s_cselect_b32 s7, s7, 0x7f000000
  s_waitcnt lgkmcnt(6)
  buffer_store_dwordx4 v[240:243], v1, s[64:67], s7 offen offset:0 sc1
  s_waitcnt lgkmcnt(4)
  buffer_store_dwordx4 v[244:247], v1, s[64:67], s7 offen offset:1024 sc1
  s_waitcnt lgkmcnt(2)
  buffer_store_dwordx4 v[248:251], v1, s[64:67], s7 offen offset:2048 sc1
  s_waitcnt lgkmcnt(0)
  buffer_store_dwordx4 v[252:255], v1, s[64:67], s7 offen offset:3072 sc1
  s_waitcnt vmcnt(12)
  v_mfma_f32_32x32x16_bf16 v[112:127], v[176:179], v[16:19], 0
  s_waitcnt vmcnt(11)
  v_mfma_f32_32x32x16_bf16 v[112:127], v[180:183], v[20:23], v[112:127]
  v_mfma_f32_32x32x16_bf16 v[128:143], v[176:179], v[24:27], 0
  s_nop 10
  v_exp_f32 v112, v112
  v_exp_f32 v113, v113
  v_exp_f32 v114, v114
  v_exp_f32 v115, v115
  v_mfma_f32_32x32x16_bf16 v[128:143], v[180:183], v[28:31], v[128:143]
  s_and_b32 s21, s21, 245760
  v_cvt_pk_bf16_f32 v144, v112, v113
  v_cvt_pk_bf16_f32 v145, v114, v115
  v_exp_f32 v116, v116
  v_exp_f32 v117, v117
  v_exp_f32 v118, v118
  v_exp_f32 v119, v119
  v_mfma_f32_32x32x16_bf16 v[80:95], v[216:219], v[152:155], 0
  s_add_u32 s21, s21, s10
  v_cvt_pk_bf16_f32 v146, v116, v117
  v_cvt_pk_bf16_f32 v147, v118, v119
  v_exp_f32 v120, v120
  v_exp_f32 v121, v121
  v_exp_f32 v122, v122
  v_exp_f32 v123, v123
  v_mfma_f32_32x32x16_bf16 v[80:95], v[220:223], v[156:159], v[80:95]
  v_cvt_pk_bf16_f32 v148, v120, v121
  v_cvt_pk_bf16_f32 v149, v122, v123
  v_exp_f32 v124, v124
  v_exp_f32 v125, v125
  v_exp_f32 v126, v126
  v_exp_f32 v127, v127
  v_cvt_pk_bf16_f32 v150, v124, v125
  v_cvt_pk_bf16_f32 v151, v126, v127
  v_mfma_f32_32x32x16_bf16 v[112:127], v[176:179], v[32:35], 0
  buffer_load_dwordx4 v[160:163], v1, s[64:67], s21 offen offset:0 sc1
  v_exp_f32 v128, v128
  v_exp_f32 v129, v129
  v_exp_f32 v130, v130
  v_exp_f32 v131, v131
  v_mfma_f32_32x32x16_bf16 v[112:127], v[180:183], v[36:39], v[112:127]
  s_waitcnt vmcnt(10)
  v_cvt_pk_bf16_f32 v152, v128, v129
  v_cvt_pk_bf16_f32 v153, v130, v131
  v_exp_f32 v132, v132
  v_exp_f32 v133, v133
  v_exp_f32 v134, v134
  v_exp_f32 v135, v135
  v_mfma_f32_32x32x16_bf16 v[48:63], v[184:187], v[144:147], v[48:63]
  v_cvt_pk_bf16_f32 v154, v132, v133
  v_cvt_pk_bf16_f32 v155, v134, v135
  v_exp_f32 v136, v136
  v_exp_f32 v137, v137
  v_exp_f32 v138, v138
  v_exp_f32 v139, v139
  v_mfma_f32_32x32x16_bf16 v[48:63], v[188:191], v[148:151], v[48:63]
  v_cvt_pk_bf16_f32 v156, v136, v137
  v_cvt_pk_bf16_f32 v157, v138, v139
  v_exp_f32 v140, v140
  v_exp_f32 v141, v141
  v_exp_f32 v142, v142
  v_exp_f32 v143, v143
  v_cvt_pk_bf16_f32 v158, v140, v141
  v_cvt_pk_bf16_f32 v159, v142, v143
  v_mfma_f32_32x32x16_bf16 v[128:143], v[176:179], v[40:43], 0
  buffer_load_dwordx4 v[164:167], v1, s[64:67], s21 offen offset:1024 sc1
  v_exp_f32 v112, v112
  v_exp_f32 v113, v113
  v_exp_f32 v114, v114
  v_exp_f32 v115, v115
  v_mfma_f32_32x32x16_bf16 v[128:143], v[180:183], v[44:47], v[128:143]
  v_cvt_pk_bf16_f32 v144, v112, v113
  v_cvt_pk_bf16_f32 v145, v114, v115
  v_exp_f32 v116, v116
  v_exp_f32 v117, v117
  v_exp_f32 v118, v118
  v_exp_f32 v119, v119
  v_mfma_f32_32x32x16_bf16 v[64:79], v[184:187], v[152:155], v[64:79]
  s_add_u32 s11, s18, 65536
  v_cvt_pk_bf16_f32 v146, v116, v117
  v_cvt_pk_bf16_f32 v147, v118, v119
  v_exp_f32 v120, v120
  v_exp_f32 v121, v121
  v_exp_f32 v122, v122
  v_exp_f32 v123, v123
  v_mfma_f32_32x32x16_bf16 v[64:79], v[188:191], v[156:159], v[64:79]
  s_waitcnt vmcnt(9)
  v_cvt_pk_bf16_f32 v148, v120, v121
  v_cvt_pk_bf16_f32 v149, v122, v123
  v_exp_f32 v124, v124
  v_exp_f32 v125, v125
  v_exp_f32 v126, v126
  v_exp_f32 v127, v127
  v_cvt_pk_bf16_f32 v150, v124, v125
  v_cvt_pk_bf16_f32 v151, v126, v127
  v_mfma_f32_32x32x16_bf16 v[112:127], v[192:195], v[16:19], 0
  buffer_load_dwordx4 v[168:171], v1, s[64:67], s21 offen offset:2048 sc1
  v_exp_f32 v128, v128
  v_exp_f32 v129, v129
  v_exp_f32 v130, v130
  v_exp_f32 v131, v131
  v_mfma_f32_32x32x16_bf16 v[112:127], v[196:199], v[20:23], v[112:127]
  s_and_b32 s11, s11, 245760
  s_waitcnt vmcnt(7)
  v_cmp_ne_u32 s[86:87], 0, v13
  v_cvt_pk_bf16_f32 v152, v128, v129
  v_cvt_pk_bf16_f32 v153, v130, v131
  v_exp_f32 v132, v132
  v_exp_f32 v133, v133
  v_exp_f32 v134, v134
  v_exp_f32 v135, v135
  v_mfma_f32_32x32x16_bf16 v[80:95], v[184:187], v[144:147], v[80:95]
  buffer_load_dwordx4 v[172:175], v1, s[64:67], s21 offen offset:3072 sc1
  s_add_u32 s11, s11, s10
  v_cvt_pk_bf16_f32 v154, v132, v133
  v_cvt_pk_bf16_f32 v155, v134, v135
  v_exp_f32 v136, v136
  v_exp_f32 v137, v137
  v_exp_f32 v138, v138
  v_exp_f32 v139, v139
  v_mfma_f32_32x32x16_bf16 v[80:95], v[188:191], v[148:151], v[80:95]
  s_andn2_b32 s3, 0x30, s86
  s_cbranch_scc1 L11
L12:
  s_barrier
  v_cvt_pk_bf16_f32 v156, v136, v137
  v_cvt_pk_bf16_f32 v157, v138, v139
  v_exp_f32 v140, v140
  v_exp_f32 v141, v141
  v_exp_f32 v142, v142
  v_exp_f32 v143, v143
  v_cvt_pk_bf16_f32 v158, v140, v141
  v_cvt_pk_bf16_f32 v159, v142, v143
  v_mfma_f32_32x32x16_bf16 v[128:143], v[192:195], v[24:27], 0
  buffer_load_dwordx4 v[208:211], v1, s[64:67], s11 offen offset:0 sc1
  v_exp_f32 v112, v112
  v_exp_f32 v113, v113
  v_exp_f32 v114, v114
  v_exp_f32 v115, v115
  v_mfma_f32_32x32x16_bf16 v[128:143], v[196:199], v[28:31], v[128:143]
  v_cvt_pk_bf16_f32 v144, v112, v113
  v_cvt_pk_bf16_f32 v145, v114, v115
  v_exp_f32 v116, v116
  v_exp_f32 v117, v117
  v_exp_f32 v118, v118
  v_exp_f32 v119, v119
  v_mfma_f32_32x32x16_bf16 v[96:111], v[184:187], v[152:155], v[96:111]
  v_cvt_pk_bf16_f32 v146, v116, v117
  v_cvt_pk_bf16_f32 v147, v118, v119
  v_exp_f32 v120, v120
  v_exp_f32 v121, v121
  v_exp_f32 v122, v122
  v_exp_f32 v123, v123
  v_mfma_f32_32x32x16_bf16 v[96:111], v[188:191], v[156:159], v[96:111]
  v_cvt_pk_bf16_f32 v148, v120, v121
  v_cvt_pk_bf16_f32 v149, v122, v123
  v_exp_f32 v124, v124
  v_exp_f32 v125, v125
  v_exp_f32 v126, v126
  v_exp_f32 v127, v127
  v_cvt_pk_bf16_f32 v150, v124, v125
  v_cvt_pk_bf16_f32 v151, v126, v127
  v_mfma_f32_32x32x16_bf16 v[112:127], v[192:195], v[32:35], 0
  buffer_load_dwordx4 v[212:215], v1, s[64:67], s11 offen offset:1024 sc1
  v_exp_f32 v128, v128
  v_exp_f32 v129, v129
  v_exp_f32 v130, v130
  v_exp_f32 v131, v131
  v_mfma_f32_32x32x16_bf16 v[112:127], v[196:199], v[36:39], v[112:127]
  v_cvt_pk_bf16_f32 v152, v128, v129
  v_cvt_pk_bf16_f32 v153, v130, v131
  v_exp_f32 v132, v132
  v_exp_f32 v133, v133
  v_exp_f32 v134, v134
  v_exp_f32 v135, v135
  v_mfma_f32_32x32x16_bf16 v[48:63], v[200:203], v[144:147], v[48:63]
  s_add_u32 s21, s18, 81920
  s_add_u32 s25, s25, 524288
  s_waitcnt vmcnt(6)
  s_mov_b64 exec, 1
  buffer_store_dword v14, off, s[64:67], s25 sc1
  s_mov_b64 exec, -1
  v_cvt_pk_bf16_f32 v154, v132, v133
  v_cvt_pk_bf16_f32 v155, v134, v135
  v_exp_f32 v136, v136
  v_exp_f32 v137, v137
  v_exp_f32 v138, v138
  v_exp_f32 v139, v139
  v_mfma_f32_32x32x16_bf16 v[48:63], v[204:207], v[148:151], v[48:63]
  s_mov_b64 exec, 0xc0
  buffer_load_dword v13, v232, s[64:67], s9 offen sc1
  s_mov_b64 exec, -1
  v_cvt_pk_bf16_f32 v156, v136, v137
  v_cvt_pk_bf16_f32 v157, v138, v139
  v_exp_f32 v140, v140
  v_exp_f32 v141, v141
  v_exp_f32 v142, v142
  v_exp_f32 v143, v143
  v_cvt_pk_bf16_f32 v158, v140, v141
  v_cvt_pk_bf16_f32 v159, v142, v143
  v_mfma_f32_32x32x16_bf16 v[128:143], v[192:195], v[40:43], 0
  buffer_load_dwordx4 v[216:219], v1, s[64:67], s11 offen offset:2048 sc1
  v_exp_f32 v112, v112
  v_exp_f32 v113, v113
  v_exp_f32 v114, v114
  v_exp_f32 v115, v115
  v_mfma_f32_32x32x16_bf16 v[128:143], v[196:199], v[44:47], v[128:143]
  s_and_b32 s21, s21, 245760
  v_cvt_pk_bf16_f32 v144, v112, v113
  v_cvt_pk_bf16_f32 v145, v114, v115
  v_exp_f32 v116, v116
  v_exp_f32 v117, v117
  v_exp_f32 v118, v118
  v_exp_f32 v119, v119
  v_mfma_f32_32x32x16_bf16 v[64:79], v[200:203], v[152:155], v[64:79]
  buffer_load_dwordx4 v[220:223], v1, s[64:67], s11 offen offset:3072 sc1
  s_add_u32 s21, s21, s10
  v_cvt_pk_bf16_f32 v146, v116, v117
  v_cvt_pk_bf16_f32 v147, v118, v119
  v_exp_f32 v120, v120
  v_exp_f32 v121, v121
  v_exp_f32 v122, v122
  v_exp_f32 v123, v123
  v_mfma_f32_32x32x16_bf16 v[64:79], v[204:207], v[156:159], v[64:79]
  s_waitcnt vmcnt(8)
  v_cvt_pk_bf16_f32 v148, v120, v121
  v_cvt_pk_bf16_f32 v149, v122, v123
  v_exp_f32 v124, v124
  v_exp_f32 v125, v125
  v_exp_f32 v126, v126
  v_exp_f32 v127, v127
  v_cvt_pk_bf16_f32 v150, v124, v125
  v_cvt_pk_bf16_f32 v151, v126, v127
  v_mfma_f32_32x32x16_bf16 v[112:127], v[160:163], v[16:19], 0
  buffer_load_dwordx4 v[176:179], v1, s[64:67], s21 offen offset:0 sc1
  v_exp_f32 v128, v128
  v_exp_f32 v129, v129
  v_exp_f32 v130, v130
  v_exp_f32 v131, v131
  v_mfma_f32_32x32x16_bf16 v[112:127], v[164:167], v[20:23], v[112:127]
  s_and_b32 s101, s68, 1
  s_mul_i32 s100, s101, 50176
  v_cvt_pk_bf16_f32 v152, v128, v129
  v_cvt_pk_bf16_f32 v153, v130, v131
  v_exp_f32 v132, v132
  v_exp_f32 v133, v133
  v_exp_f32 v134, v134
  v_exp_f32 v135, v135
  v_mfma_f32_32x32x16_bf16 v[80:95], v[200:203], v[144:147], v[80:95]
  s_add_u32 s100, s100, s78
  v_cvt_pk_bf16_f32 v154, v132, v133
  v_cvt_pk_bf16_f32 v155, v134, v135
  v_exp_f32 v136, v136
  v_exp_f32 v137, v137
  v_exp_f32 v138, v138
  v_exp_f32 v139, v139
  v_mfma_f32_32x32x16_bf16 v[80:95], v[204:207], v[148:151], v[80:95]
  s_mul_i32 s101, s101, 7168
  s_add_u32 s101, s101, s76
  v_cvt_pk_bf16_f32 v156, v136, v137
  v_cvt_pk_bf16_f32 v157, v138, v139
  v_exp_f32 v140, v140
  v_exp_f32 v141, v141
  v_exp_f32 v142, v142
  v_exp_f32 v143, v143
  v_cvt_pk_bf16_f32 v158, v140, v141
  v_cvt_pk_bf16_f32 v159, v142, v143
  v_mfma_f32_32x32x16_bf16 v[128:143], v[160:163], v[24:27], 0
  buffer_load_dwordx4 v[180:183], v1, s[64:67], s21 offen offset:1024 sc1
  v_exp_f32 v112, v112
  v_exp_f32 v113, v113
  v_exp_f32 v114, v114
  v_exp_f32 v115, v115
  v_mfma_f32_32x32x16_bf16 v[128:143], v[164:167], v[28:31], v[128:143]
  s_add_u32 m0, s101, 0
  v_cvt_pk_bf16_f32 v144, v112, v113
  v_cvt_pk_bf16_f32 v145, v114, v115
  v_exp_f32 v116, v116
  v_exp_f32 v117, v117
  v_exp_f32 v118, v118
  v_exp_f32 v119, v119
  v_mfma_f32_32x32x16_bf16 v[96:111], v[200:203], v[152:155], v[96:111]
  s_add_u32 s12, s100, 0
  v_cvt_pk_bf16_f32 v146, v116, v117
  v_cvt_pk_bf16_f32 v147, v118, v119
  v_exp_f32 v120, v120
  v_exp_f32 v121, v121
  v_exp_f32 v122, v122
  v_exp_f32 v123, v123
  v_mfma_f32_32x32x16_bf16 v[96:111], v[204:207], v[156:159], v[96:111]
  buffer_load_dwordx4 v236, s[36:39], s12 offen offset:0  lds
  buffer_load_dwordx4 v237, s[36:39], s12 offen offset:1024  lds
  v_cvt_pk_bf16_f32 v148, v120, v121
  v_cvt_pk_bf16_f32 v149, v122, v123
  v_exp_f32 v124, v124
  v_exp_f32 v125, v125
  v_exp_f32 v126, v126
  v_exp_f32 v127, v127
  v_cvt_pk_bf16_f32 v150, v124, v125
  v_cvt_pk_bf16_f32 v151, v126, v127
  v_mfma_f32_32x32x16_bf16 v[112:127], v[160:163], v[32:35], 0
  buffer_load_dwordx4 v[184:187], v1, s[64:67], s21 offen offset:2048 sc1
  v_exp_f32 v128, v128
  v_exp_f32 v129, v129
  v_exp_f32 v130, v130
  v_exp_f32 v131, v131
  v_mfma_f32_32x32x16_bf16 v[112:127], v[164:167], v[36:39], v[112:127]
  s_waitcnt vmcnt(11)
  v_cvt_pk_bf16_f32 v152, v128, v129
  v_cvt_pk_bf16_f32 v153, v130, v131
  v_exp_f32 v132, v132
  v_exp_f32 v133, v133
  v_exp_f32 v134, v134
  v_exp_f32 v135, v135
  v_mfma_f32_32x32x16_bf16 v[48:63], v[168:171], v[144:147], v[48:63]
  buffer_load_dwordx4 v[188:191], v1, s[64:67], s21 offen offset:3072 sc1
  s_add_u32 s11, s22, 98304
  v_cvt_pk_bf16_f32 v154, v132, v133
  v_cvt_pk_bf16_f32 v155, v134, v135
  v_exp_f32 v136, v136
  v_exp_f32 v137, v137
  v_exp_f32 v138, v138
  v_exp_f32 v139, v139
  v_mfma_f32_32x32x16_bf16 v[48:63], v[172:175], v[148:151], v[48:63]
  buffer_load_dwordx4 v238, s[36:39], s12 offen offset:2048  lds
  v_cvt_pk_bf16_f32 v156, v136, v137
  v_cvt_pk_bf16_f32 v157, v138, v139
  v_exp_f32 v140, v140
  v_exp_f32 v141, v141
  v_exp_f32 v142, v142
  v_exp_f32 v143, v143
  v_cvt_pk_bf16_f32 v158, v140, v141
  v_cvt_pk_bf16_f32 v159, v142, v143
  v_mfma_f32_32x32x16_bf16 v[128:143], v[160:163], v[40:43], 0
  buffer_load_dwordx4 v239, s[36:39], s12 offen offset:3072  lds
  v_exp_f32 v112, v112
  v_exp_f32 v113, v113
  v_exp_f32 v114, v114
  v_exp_f32 v115, v115
  v_mfma_f32_32x32x16_bf16 v[128:143], v[164:167], v[44:47], v[128:143]
  s_and_b32 s11, s11, 245760
  s_waitcnt vmcnt(10)
  v_cmp_ne_u32 s[86:87], 0, v13
  v_cvt_pk_bf16_f32 v144, v112, v113
  v_cvt_pk_bf16_f32 v145, v114, v115
  v_exp_f32 v116, v116
  v_exp_f32 v117, v117
  v_exp_f32 v118, v118
  v_exp_f32 v119, v119
  v_mfma_f32_32x32x16_bf16 v[64:79], v[168:171], v[152:155], v[64:79]
  s_add_u32 s11, s11, s10
  v_cvt_pk_bf16_f32 v146, v116, v117
  v_cvt_pk_bf16_f32 v147, v118, v119
  v_exp_f32 v120, v120
  v_exp_f32 v121, v121
  v_exp_f32 v122, v122
  v_exp_f32 v123, v123
  v_mfma_f32_32x32x16_bf16 v[64:79], v[172:175], v[156:159], v[64:79]
  s_andn2_b32 s3, 0xc0, s86
  s_cbranch_scc1 L13
L14:
  v_cvt_pk_bf16_f32 v148, v120, v121
  v_cvt_pk_bf16_f32 v149, v122, v123
  v_exp_f32 v124, v124
  v_exp_f32 v125, v125
  v_exp_f32 v126, v126
  v_exp_f32 v127, v127
  v_cvt_pk_bf16_f32 v150, v124, v125
  v_cvt_pk_bf16_f32 v151, v126, v127
  v_mfma_f32_32x32x16_bf16 v[112:127], v[208:211], v[16:19], 0
  buffer_load_dwordx4 v[192:195], v1, s[64:67], s11 offen offset:0 sc1
  v_exp_f32 v128, v128
  v_exp_f32 v129, v129
  v_exp_f32 v130, v130
  v_exp_f32 v131, v131
  v_mfma_f32_32x32x16_bf16 v[112:127], v[212:215], v[20:23], v[112:127]
  s_add_u32 m0, s101, 4096
  s_add_u32 s12, s100, 28672
  v_cvt_pk_bf16_f32 v152, v128, v129
  v_cvt_pk_bf16_f32 v153, v130, v131
  v_exp_f32 v132, v132
  v_exp_f32 v133, v133
  v_exp_f32 v134, v134
  v_exp_f32 v135, v135
  v_mfma_f32_32x32x16_bf16 v[80:95], v[168:171], v[144:147], v[80:95]
  buffer_load_dwordx4 v236, s[36:39], s12 offen offset:0  lds
  v_cvt_pk_bf16_f32 v154, v132, v133
  v_cvt_pk_bf16_f32 v155, v134, v135
  v_exp_f32 v136, v136
  v_exp_f32 v137, v137
  v_exp_f32 v138, v138
  v_exp_f32 v139, v139
  v_mfma_f32_32x32x16_bf16 v[80:95], v[172:175], v[148:151], v[80:95]
  s_mov_b64 exec, 0xff00
  buffer_load_dword v13, v232, s[64:67], s9 offen sc1
  s_mov_b64 exec, -1
  v_cvt_pk_bf16_f32 v156, v136, v137
  v_cvt_pk_bf16_f32 v157, v138, v139
  v_exp_f32 v140, v140
  v_exp_f32 v141, v141
  v_exp_f32 v142, v142
  v_exp_f32 v143, v143
  v_cvt_pk_bf16_f32 v158, v140, v141
  v_cvt_pk_bf16_f32 v159, v142, v143
  v_mfma_f32_32x32x16_bf16 v[128:143], v[208:211], v[24:27], 0
  buffer_load_dwordx4 v[196:199], v1, s[64:67], s11 offen offset:1024 sc1
  v_exp_f32 v112, v112
  v_exp_f32 v113, v113
  v_exp_f32 v114, v114
  v_exp_f32 v115, v115
  v_mfma_f32_32x32x16_bf16 v[128:143], v[212:215], v[28:31], v[128:143]
  buffer_load_dwordx4 v237, s[36:39], s12 offen offset:1024  lds
  v_cvt_pk_bf16_f32 v144, v112, v113
  v_cvt_pk_bf16_f32 v145, v114, v115
  v_exp_f32 v116, v116
  v_exp_f32 v117, v117
  v_exp_f32 v118, v118
  v_exp_f32 v119, v119
  v_mfma_f32_32x32x16_bf16 v[96:111], v[168:171], v[152:155], v[96:111]
  buffer_load_dwordx4 v238, s[36:39], s12 offen offset:2048  lds
  s_and_b32 s101, s68, 1
  v_cvt_pk_bf16_f32 v146, v116, v117
  v_cvt_pk_bf16_f32 v147, v118, v119
  v_exp_f32 v120, v120
  v_exp_f32 v121, v121
  v_exp_f32 v122, v122
  v_exp_f32 v123, v123
  v_mfma_f32_32x32x16_bf16 v[96:111], v[172:175], v[156:159], v[96:111]
  s_mul_i32 s100, s101, 50176
  v_cvt_pk_bf16_f32 v148, v120, v121
  v_cvt_pk_bf16_f32 v149, v122, v123
  v_exp_f32 v124, v124
  v_exp_f32 v125, v125
  v_exp_f32 v126, v126
  v_exp_f32 v127, v127
  v_cvt_pk_bf16_f32 v150, v124, v125
  v_cvt_pk_bf16_f32 v151, v126, v127
  v_mfma_f32_32x32x16_bf16 v[112:127], v[208:211], v[32:35], 0
  buffer_load_dwordx4 v[200:203], v1, s[64:67], s11 offen offset:2048 sc1
  v_exp_f32 v128, v128
  v_exp_f32 v129, v129
  v_exp_f32 v130, v130
  v_exp_f32 v131, v131
  v_mfma_f32_32x32x16_bf16 v[112:127], v[212:215], v[36:39], v[112:127]
  s_waitcnt vmcnt(15)
  v_cvt_pk_bf16_f32 v152, v128, v129
  v_cvt_pk_bf16_f32 v153, v130, v131
  v_exp_f32 v132, v132
  v_exp_f32 v133, v133
  v_exp_f32 v134, v134
  v_exp_f32 v135, v135
  v_mfma_f32_32x32x16_bf16 v[48:63], v[216:219], v[144:147], v[48:63]
  s_add_u32 s21, s23, 114688
  v_cvt_pk_bf16_f32 v154, v132, v133
  v_cvt_pk_bf16_f32 v155, v134, v135
  v_exp_f32 v136, v136
  v_exp_f32 v137, v137
  v_exp_f32 v138, v138
  v_exp_f32 v139, v139
  v_mfma_f32_32x32x16_bf16 v[48:63], v[220:223], v[148:151], v[48:63]
  s_add_u32 s100, s100, s1
  v_cvt_pk_bf16_f32 v156, v136, v137
  v_cvt_pk_bf16_f32 v157, v138, v139
  v_exp_f32 v140, v140
  v_exp_f32 v141, v141
  v_exp_f32 v142, v142
  v_exp_f32 v143, v143
  v_cvt_pk_bf16_f32 v158, v140, v141
  v_cvt_pk_bf16_f32 v159, v142, v143
  v_mfma_f32_32x32x16_bf16 v[128:143], v[208:211], v[40:43], 0
  buffer_load_dwordx4 v[204:207], v1, s[64:67], s11 offen offset:3072 sc1
  v_exp_f32 v112, v112
  v_exp_f32 v113, v113
  v_exp_f32 v114, v114
  v_exp_f32 v115, v115
  v_mfma_f32_32x32x16_bf16 v[128:143], v[212:215], v[44:47], v[128:143]
  s_and_b32 s21, s21, 245760
  v_cvt_pk_bf16_f32 v144, v112, v113
  v_cvt_pk_bf16_f32 v145, v114, v115
  v_exp_f32 v116, v116
  v_exp_f32 v117, v117
  v_exp_f32 v118, v118
  v_exp_f32 v119, v119
  v_mfma_f32_32x32x16_bf16 v[64:79], v[216:219], v[152:155], v[64:79]
  s_add_u32 s21, s21, s10
  v_cvt_pk_bf16_f32 v146, v116, v117
  v_cvt_pk_bf16_f32 v147, v118, v119
  v_exp_f32 v120, v120
  v_exp_f32 v121, v121
  v_exp_f32 v122, v122
  v_exp_f32 v123, v123
  v_mfma_f32_32x32x16_bf16 v[64:79], v[220:223], v[156:159], v[64:79]
  s_waitcnt vmcnt(14)
  v_cvt_pk_bf16_f32 v148, v120, v121
  v_cvt_pk_bf16_f32 v149, v122, v123
  v_exp_f32 v124, v124
  v_exp_f32 v125, v125
  v_exp_f32 v126, v126
  v_exp_f32 v127, v127
  v_cvt_pk_bf16_f32 v150, v124, v125
  v_cvt_pk_bf16_f32 v151, v126, v127
  v_mfma_f32_32x32x16_bf16 v[112:127], v[176:179], v[16:19], 0
  buffer_load_dwordx4 v[160:163], v1, s[64:67], s21 offen offset:0 sc1
  v_exp_f32 v128, v128
  v_exp_f32 v129, v129
  v_exp_f32 v130, v130
  v_exp_f32 v131, v131
  v_mfma_f32_32x32x16_bf16 v[112:127], v[180:183], v[20:23], v[112:127]
  s_mul_i32 s101, s101, 7168
  s_add_u32 s101, s101, s77
  v_cvt_pk_bf16_f32 v152, v128, v129
  v_cvt_pk_bf16_f32 v153, v130, v131
  v_exp_f32 v132, v132
  v_exp_f32 v133, v133
  v_exp_f32 v134, v134
  v_exp_f32 v135, v135
  v_mfma_f32_32x32x16_bf16 v[80:95], v[216:219], v[144:147], v[80:95]
  s_add_u32 m0, s101, 0
  v_cvt_pk_bf16_f32 v154, v132, v133
  v_cvt_pk_bf16_f32 v155, v134, v135
  v_exp_f32 v136, v136
  v_exp_f32 v137, v137
  v_exp_f32 v138, v138
  v_exp_f32 v139, v139
  v_mfma_f32_32x32x16_bf16 v[80:95], v[220:223], v[148:151], v[80:95]
  s_add_u32 s12, s100, 0
  v_cvt_pk_bf16_f32 v156, v136, v137
  v_cvt_pk_bf16_f32 v157, v138, v139
  v_exp_f32 v140, v140
  v_exp_f32 v141, v141
  v_exp_f32 v142, v142
  v_exp_f32 v143, v143
  v_cvt_pk_bf16_f32 v158, v140, v141
  v_cvt_pk_bf16_f32 v159, v142, v143
  v_mfma_f32_32x32x16_bf16 v[128:143], v[176:179], v[24:27], 0
  buffer_load_dwordx4 v[164:167], v1, s[64:67], s21 offen offset:1024 sc1
  v_exp_f32 v112, v112
  v_exp_f32 v113, v113
  v_exp_f32 v114, v114
  v_exp_f32 v115, v115
  v_mfma_f32_32x32x16_bf16 v[128:143], v[180:183], v[28:31], v[128:143]
  buffer_load_dwordx4 v236, s[40:43], s12 offen offset:0  lds
  buffer_load_dwordx4 v237, s[40:43], s12 offen offset:1024  lds
  v_cvt_pk_bf16_f32 v144, v112, v113
  v_cvt_pk_bf16_f32 v145, v114, v115
  v_exp_f32 v116, v116
  v_exp_f32 v117, v117
  v_exp_f32 v118, v118
  v_exp_f32 v119, v119
  v_mfma_f32_32x32x16_bf16 v[96:111], v[216:219], v[152:155], v[96:111]
  buffer_load_dwordx4 v238, s[40:43], s12 offen offset:2048  lds
  v_cvt_pk_bf16_f32 v146, v116, v117
  v_cvt_pk_bf16_f32 v147, v118, v119
  v_exp_f32 v120, v120
  v_exp_f32 v121, v121
  v_exp_f32 v122, v122
  v_exp_f32 v123, v123
  v_mfma_f32_32x32x16_bf16 v[96:111], v[220:223], v[156:159], v[96:111]
  buffer_load_dwordx4 v239, s[40:43], s12 offen offset:3072  lds
  s_add_u32 m0, s101, 4096
  v_cvt_pk_bf16_f32 v148, v120, v121
  v_cvt_pk_bf16_f32 v149, v122, v123
  v_exp_f32 v124, v124
  v_exp_f32 v125, v125
  v_exp_f32 v126, v126
  v_exp_f32 v127, v127
  v_cvt_pk_bf16_f32 v150, v124, v125
  v_cvt_pk_bf16_f32 v151, v126, v127
  v_mfma_f32_32x32x16_bf16 v[112:127], v[176:179], v[32:35], 0
  buffer_load_dwordx4 v[168:171], v1, s[64:67], s21 offen offset:2048 sc1
  v_exp_f32 v128, v128
  v_exp_f32 v129, v129
  v_exp_f32 v130, v130
  v_exp_f32 v131, v131
  v_mfma_f32_32x32x16_bf16 v[112:127], v[180:183], v[36:39], v[112:127]
  s_waitcnt vmcnt(12)
  v_cmp_ne_u32 s[86:87], 0, v13
  v_cvt_pk_bf16_f32 v152, v128, v129
  v_cvt_pk_bf16_f32 v153, v130, v131
  v_exp_f32 v132, v132
  v_exp_f32 v133, v133
  v_exp_f32 v134, v134
  v_exp_f32 v135, v135
  v_mfma_f32_32x32x16_bf16 v[48:63], v[184:187], v[144:147], v[48:63]
  s_add_u32 s11, s22, 131072
  v_cvt_pk_bf16_f32 v154, v132, v133
  v_cvt_pk_bf16_f32 v155, v134, v135
  v_exp_f32 v136, v136
  v_exp_f32 v137, v137
  v_exp_f32 v138, v138
  v_exp_f32 v139, v139
  v_mfma_f32_32x32x16_bf16 v[48:63], v[188:191], v[148:151], v[48:63]
  s_add_u32 s12, s100, 28672
  v_cvt_pk_bf16_f32 v156, v136, v137
  v_cvt_pk_bf16_f32 v157, v138, v139
  v_exp_f32 v140, v140
  v_exp_f32 v141, v141
  v_exp_f32 v142, v142
  v_exp_f32 v143, v143
  v_cvt_pk_bf16_f32 v158, v140, v141
  v_cvt_pk_bf16_f32 v159, v142, v143
  v_mfma_f32_32x32x16_bf16 v[128:143], v[176:179], v[40:43], 0
  buffer_load_dwordx4 v[172:175], v1, s[64:67], s21 offen offset:3072 sc1
  v_exp_f32 v112, v112
  v_exp_f32 v113, v113
  v_exp_f32 v114, v114
  v_exp_f32 v115, v115
  v_mfma_f32_32x32x16_bf16 v[128:143], v[180:183], v[44:47], v[128:143]
  s_and_b32 s11, s11, 245760
  v_cvt_pk_bf16_f32 v144, v112, v113
  v_cvt_pk_bf16_f32 v145, v114, v115
  v_exp_f32 v116, v116
  v_exp_f32 v117, v117
  v_exp_f32 v118, v118
  v_exp_f32 v119, v119
  v_mfma_f32_32x32x16_bf16 v[64:79], v[184:187], v[152:155], v[64:79]
  s_add_u32 s11, s11, s10
  v_cvt_pk_bf16_f32 v146, v116, v117
  v_cvt_pk_bf16_f32 v147, v118, v119
  v_exp_f32 v120, v120
  v_exp_f32 v121, v121
  v_exp_f32 v122, v122
  v_exp_f32 v123, v123
  v_mfma_f32_32x32x16_bf16 v[64:79], v[188:191], v[156:159], v[64:79]
  s_andn2_b32 s3, 0xff00, s86
  s_cbranch_scc1 L15
L16:
  s_waitcnt vmcnt(12)
  v_cvt_pk_bf16_f32 v148, v120, v121
  v_cvt_pk_bf16_f32 v149, v122, v123
  v_exp_f32 v124, v124
  v_exp_f32 v125, v125
  v_exp_f32 v126, v126
  v_exp_f32 v127, v127
  v_cvt_pk_bf16_f32 v150, v124, v125
  v_cvt_pk_bf16_f32 v151, v126, v127
  v_mfma_f32_32x32x16_bf16 v[112:127], v[192:195], v[16:19], 0
  buffer_load_dwordx4 v[208:211], v1, s[64:67], s11 offen offset:0 sc1
  v_exp_f32 v128, v128
  v_exp_f32 v129, v129
  v_exp_f32 v130, v130
  v_exp_f32 v131, v131
  v_mfma_f32_32x32x16_bf16 v[112:127], v[196:199], v[20:23], v[112:127]
  buffer_load_dwordx4 v236, s[40:43], s12 offen offset:0  lds
  v_cvt_pk_bf16_f32 v152, v128, v129
  v_cvt_pk_bf16_f32 v153, v130, v131
  v_exp_f32 v132, v132
  v_exp_f32 v133, v133
  v_exp_f32 v134, v134
  v_exp_f32 v135, v135
  v_mfma_f32_32x32x16_bf16 v[80:95], v[184:187], v[144:147], v[80:95]
  buffer_load_dwordx4 v237, s[40:43], s12 offen offset:1024  lds
  buffer_load_dwordx4 v238, s[40:43], s12 offen offset:2048  lds
  v_cvt_pk_bf16_f32 v154, v132, v133
  v_cvt_pk_bf16_f32 v155, v134, v135
  v_exp_f32 v136, v136
  v_exp_f32 v137, v137
  v_exp_f32 v138, v138
  v_exp_f32 v139, v139
  v_mfma_f32_32x32x16_bf16 v[80:95], v[188:191], v[148:151], v[80:95]
  buffer_load_dword v229, v228, s[64:67], s14 offen sc1
  v_cvt_pk_bf16_f32 v156, v136, v137
  v_cvt_pk_bf16_f32 v157, v138, v139
  v_exp_f32 v140, v140
  v_exp_f32 v141, v141
  v_exp_f32 v142, v142
  v_exp_f32 v143, v143
  v_cvt_pk_bf16_f32 v158, v140, v141
  v_cvt_pk_bf16_f32 v159, v142, v143
  v_mfma_f32_32x32x16_bf16 v[128:143], v[192:195], v[24:27], 0
  buffer_load_dwordx4 v[212:215], v1, s[64:67], s11 offen offset:1024 sc1
  v_exp_f32 v112, v112
  v_exp_f32 v113, v113
  v_exp_f32 v114, v114
  v_exp_f32 v115, v115
  v_mfma_f32_32x32x16_bf16 v[128:143], v[196:199], v[28:31], v[128:143]
  v_accvgpr_read_b32 v10, a239
  v_add_u32 v10, 786432, v10
  buffer_load_dword v12, v10, s[64:67], s73 offen sc1
  v_cvt_pk_bf16_f32 v144, v112, v113
  v_cvt_pk_bf16_f32 v145, v114, v115
  v_exp_f32 v116, v116
  v_exp_f32 v117, v117
  v_exp_f32 v118, v118
  v_exp_f32 v119, v119
  v_mfma_f32_32x32x16_bf16 v[96:111], v[184:187], v[152:155], v[96:111]
  s_and_b32 s101, s68, 1
  s_xor_b32 s101, s101, 1
  v_cvt_pk_bf16_f32 v146, v116, v117
  v_cvt_pk_bf16_f32 v147, v118, v119
  v_exp_f32 v120, v120
  v_exp_f32 v121, v121
  v_exp_f32 v122, v122
  v_exp_f32 v123, v123
  v_mfma_f32_32x32x16_bf16 v[96:111], v[188:191], v[156:159], v[96:111]
  s_mul_i32 s100, s101, 50176
  v_cvt_pk_bf16_f32 v148, v120, v121
  v_cvt_pk_bf16_f32 v149, v122, v123
  v_exp_f32 v124, v124
  v_exp_f32 v125, v125
  v_exp_f32 v126, v126
  v_exp_f32 v127, v127
  v_cvt_pk_bf16_f32 v150, v124, v125
  v_cvt_pk_bf16_f32 v151, v126, v127
  v_mfma_f32_32x32x16_bf16 v[112:127], v[192:195], v[32:35], 0
  buffer_load_dwordx4 v[216:219], v1, s[64:67], s11 offen offset:2048 sc1
  v_exp_f32 v128, v128
  v_exp_f32 v129, v129
  v_exp_f32 v130, v130
  v_exp_f32 v131, v131
  v_mfma_f32_32x32x16_bf16 v[112:127], v[196:199], v[36:39], v[112:127]
  s_waitcnt vmcnt(16)
  v_cvt_pk_bf16_f32 v152, v128, v129
  v_cvt_pk_bf16_f32 v153, v130, v131
  v_exp_f32 v132, v132
  v_exp_f32 v133, v133
  v_exp_f32 v134, v134
  v_exp_f32 v135, v135
  v_mfma_f32_32x32x16_bf16 v[48:63], v[200:203], v[144:147], v[48:63]
  s_add_u32 s21, s23, 147456
  v_cvt_pk_bf16_f32 v154, v132, v133
  v_cvt_pk_bf16_f32 v155, v134, v135
  v_exp_f32 v136, v136
  v_exp_f32 v137, v137
  v_exp_f32 v138, v138
  v_exp_f32 v139, v139
  v_mfma_f32_32x32x16_bf16 v[48:63], v[204:207], v[148:151], v[48:63]
  s_add_u32 s100, s100, s78
  v_cvt_pk_bf16_f32 v156, v136, v137
  v_cvt_pk_bf16_f32 v157, v138, v139
  v_exp_f32 v140, v140
  v_exp_f32 v141, v141
  v_exp_f32 v142, v142
  v_exp_f32 v143, v143
  v_cvt_pk_bf16_f32 v158, v140, v141
  v_cvt_pk_bf16_f32 v159, v142, v143
  v_mfma_f32_32x32x16_bf16 v[128:143], v[192:195], v[40:43], 0
  buffer_load_dwordx4 v[220:223], v1, s[64:67], s11 offen offset:3072 sc1
  v_exp_f32 v112, v112
  v_exp_f32 v113, v113
  v_exp_f32 v114, v114
  v_exp_f32 v115, v115
  v_mfma_f32_32x32x16_bf16 v[128:143], v[196:199], v[44:47], v[128:143]
  s_and_b32 s21, s21, 245760
  v_cvt_pk_bf16_f32 v144, v112, v113
  v_cvt_pk_bf16_f32 v145, v114, v115
  v_exp_f32 v116, v116
  v_exp_f32 v117, v117
  v_exp_f32 v118, v118
  v_exp_f32 v119, v119
  v_mfma_f32_32x32x16_bf16 v[64:79], v[200:203], v[152:155], v[64:79]
  s_add_u32 s21, s21, s10
  v_cvt_pk_bf16_f32 v146, v116, v117
  v_cvt_pk_bf16_f32 v147, v118, v119
  v_exp_f32 v120, v120
  v_exp_f32 v121, v121
  v_exp_f32 v122, v122
  v_exp_f32 v123, v123
  v_mfma_f32_32x32x16_bf16 v[64:79], v[204:207], v[156:159], v[64:79]
  s_waitcnt vmcnt(15)
  v_cvt_pk_bf16_f32 v148, v120, v121
  v_cvt_pk_bf16_f32 v149, v122, v123
  v_exp_f32 v124, v124
  v_exp_f32 v125, v125
  v_exp_f32 v126, v126
  v_exp_f32 v127, v127
  v_cvt_pk_bf16_f32 v150, v124, v125
  v_cvt_pk_bf16_f32 v151, v126, v127
  v_mfma_f32_32x32x16_bf16 v[112:127], v[160:163], v[16:19], 0
  buffer_load_dwordx4 v[176:179], v1, s[64:67], s21 offen offset:0 sc1
  v_exp_f32 v128, v128
  v_exp_f32 v129, v129
  v_exp_f32 v130, v130
  v_exp_f32 v131, v131
  v_mfma_f32_32x32x16_bf16 v[112:127], v[164:167], v[20:23], v[112:127]
  s_mul_i32 s101, s101, 7168
  s_add_u32 s101, s101, s76
  v_cvt_pk_bf16_f32 v152, v128, v129
  v_cvt_pk_bf16_f32 v153, v130, v131
  v_exp_f32 v132, v132
  v_exp_f32 v133, v133
  v_exp_f32 v134, v134
  v_exp_f32 v135, v135
  v_mfma_f32_32x32x16_bf16 v[80:95], v[200:203], v[144:147], v[80:95]
  s_add_u32 m0, s101, 0
  v_cvt_pk_bf16_f32 v154, v132, v133
  v_cvt_pk_bf16_f32 v155, v134, v135
  v_exp_f32 v136, v136
  v_exp_f32 v137, v137
  v_exp_f32 v138, v138
  v_exp_f32 v139, v139
  v_mfma_f32_32x32x16_bf16 v[80:95], v[204:207], v[148:151], v[80:95]
  s_add_u32 s12, s100, 0
  v_cvt_pk_bf16_f32 v156, v136, v137
  v_cvt_pk_bf16_f32 v157, v138, v139
  v_exp_f32 v140, v140
  v_exp_f32 v141, v141
  v_exp_f32 v142, v142
  v_exp_f32 v143, v143
  v_cvt_pk_bf16_f32 v158, v140, v141
  v_cvt_pk_bf16_f32 v159, v142, v143
  v_mfma_f32_32x32x16_bf16 v[128:143], v[160:163], v[24:27], 0
  buffer_load_dwordx4 v[180:183], v1, s[64:67], s21 offen offset:1024 sc1
  v_exp_f32 v112, v112
  v_exp_f32 v113, v113
  v_exp_f32 v114, v114
  v_exp_f32 v115, v115
  v_mfma_f32_32x32x16_bf16 v[128:143], v[164:167], v[28:31], v[128:143]
  buffer_load_dwordx4 v236, s[36:39], s12 offen offset:0  lds
  buffer_load_dwordx4 v237, s[36:39], s12 offen offset:1024  lds
  v_cvt_pk_bf16_f32 v144, v112, v113
  v_cvt_pk_bf16_f32 v145, v114, v115
  v_exp_f32 v116, v116
  v_exp_f32 v117, v117
  v_exp_f32 v118, v118
  v_exp_f32 v119, v119
  v_mfma_f32_32x32x16_bf16 v[96:111], v[200:203], v[152:155], v[96:111]
  buffer_load_dwordx4 v238, s[36:39], s12 offen offset:2048  lds
  v_cvt_pk_bf16_f32 v146, v116, v117
  v_cvt_pk_bf16_f32 v147, v118, v119
  v_exp_f32 v120, v120
  v_exp_f32 v121, v121
  v_exp_f32 v122, v122
  v_exp_f32 v123, v123
  v_mfma_f32_32x32x16_bf16 v[96:111], v[204:207], v[156:159], v[96:111]
  buffer_load_dwordx4 v239, s[36:39], s12 offen offset:3072  lds
  v_cvt_pk_bf16_f32 v148, v120, v121
  v_cvt_pk_bf16_f32 v149, v122, v123
  v_exp_f32 v124, v124
  v_exp_f32 v125, v125
  v_exp_f32 v126, v126
  v_exp_f32 v127, v127
  v_cvt_pk_bf16_f32 v150, v124, v125
  v_cvt_pk_bf16_f32 v151, v126, v127
  v_mfma_f32_32x32x16_bf16 v[112:127], v[160:163], v[32:35], 0
  buffer_load_dwordx4 v[184:187], v1, s[64:67], s21 offen offset:2048 sc1
  v_exp_f32 v128, v128
  v_exp_f32 v129, v129
  v_exp_f32 v130, v130
  v_exp_f32 v131, v131
  v_mfma_f32_32x32x16_bf16 v[112:127], v[164:167], v[36:39], v[112:127]
  s_waitcnt vmcnt(16)
  v_cvt_pk_bf16_f32 v152, v128, v129
  v_cvt_pk_bf16_f32 v153, v130, v131
  v_exp_f32 v132, v132
  v_exp_f32 v133, v133
  v_exp_f32 v134, v134
  v_exp_f32 v135, v135
  v_mfma_f32_32x32x16_bf16 v[48:63], v[168:171], v[144:147], v[48:63]
  s_add_u32 s11, s22, 163840
  v_cvt_pk_bf16_f32 v154, v132, v133
  v_cvt_pk_bf16_f32 v155, v134, v135
  v_exp_f32 v136, v136
  v_exp_f32 v137, v137
  v_exp_f32 v138, v138
  v_exp_f32 v139, v139
  v_mfma_f32_32x32x16_bf16 v[48:63], v[172:175], v[148:151], v[48:63]
  s_add_u32 m0, s101, 4096
  s_add_u32 s12, s100, 28672
  v_cvt_pk_bf16_f32 v156, v136, v137
  v_cvt_pk_bf16_f32 v157, v138, v139
  v_exp_f32 v140, v140
  v_exp_f32 v141, v141
  v_exp_f32 v142, v142
  v_exp_f32 v143, v143
  v_cvt_pk_bf16_f32 v158, v140, v141
  v_cvt_pk_bf16_f32 v159, v142, v143
  v_mfma_f32_32x32x16_bf16 v[128:143], v[160:163], v[40:43], 0
  buffer_load_dwordx4 v[188:191], v1, s[64:67], s21 offen offset:3072 sc1
  v_exp_f32 v112, v112
  v_exp_f32 v113, v113
  v_exp_f32 v114, v114
  v_exp_f32 v115, v115
  v_mfma_f32_32x32x16_bf16 v[128:143], v[164:167], v[44:47], v[128:143]
  s_and_b32 s11, s11, 245760
  v_cvt_pk_bf16_f32 v144, v112, v113
  v_cvt_pk_bf16_f32 v145, v114, v115
  v_exp_f32 v116, v116
  v_exp_f32 v117, v117
  v_exp_f32 v118, v118
  v_exp_f32 v119, v119
  v_mfma_f32_32x32x16_bf16 v[64:79], v[168:171], v[152:155], v[64:79]
  s_add_u32 s11, s11, s10
  v_cvt_pk_bf16_f32 v146, v116, v117
  v_cvt_pk_bf16_f32 v147, v118, v119
  v_exp_f32 v120, v120
  v_exp_f32 v121, v121
  v_exp_f32 v122, v122
  v_exp_f32 v123, v123
  v_mfma_f32_32x32x16_bf16 v[64:79], v[172:175], v[156:159], v[64:79]
  s_waitcnt vmcnt(11)
  v_cvt_pk_bf16_f32 v148, v120, v121
  v_cvt_pk_bf16_f32 v149, v122, v123
  v_exp_f32 v124, v124
  v_exp_f32 v125, v125
  v_exp_f32 v126, v126
  v_exp_f32 v127, v127
  v_cvt_pk_bf16_f32 v150, v124, v125
  v_cvt_pk_bf16_f32 v151, v126, v127
  v_mfma_f32_32x32x16_bf16 v[112:127], v[208:211], v[16:19], 0
  buffer_load_dwordx4 v[192:195], v1, s[64:67], s11 offen offset:0 sc1
  v_exp_f32 v128, v128
  v_exp_f32 v129, v129
  v_exp_f32 v130, v130
  v_exp_f32 v131, v131
  v_mfma_f32_32x32x16_bf16 v[112:127], v[212:215], v[20:23], v[112:127]
  buffer_load_dwordx4 v236, s[36:39], s12 offen offset:0  lds
  v_cvt_pk_bf16_f32 v152, v128, v129
  v_cvt_pk_bf16_f32 v153, v130, v131
  v_exp_f32 v132, v132
  v_exp_f32 v133, v133
  v_exp_f32 v134, v134
  v_exp_f32 v135, v135
  v_mfma_f32_32x32x16_bf16 v[80:95], v[168:171], v[144:147], v[80:95]
  buffer_load_dwordx4 v237, s[36:39], s12 offen offset:1024  lds
  buffer_load_dwordx4 v238, s[36:39], s12 offen offset:2048  lds
  v_cvt_pk_bf16_f32 v154, v132, v133
  v_cvt_pk_bf16_f32 v155, v134, v135
  v_exp_f32 v136, v136
  v_exp_f32 v137, v137
  v_exp_f32 v138, v138
  v_exp_f32 v139, v139
  v_mfma_f32_32x32x16_bf16 v[80:95], v[172:175], v[148:151], v[80:95]
  v_and_b32 v11, 31, v0
  v_mul_u32_u24 v11, 896, v11
  v_lshrrev_b32 v230, 5, v0
  v_lshl_add_u32 v11, v230, 4, v11
  s_mul_i32 s15, s85, 57344
  s_mul_i32 s3, s80, 28672
  s_add_u32 s15, s15, s3
  s_lshl_b32 s3, s71, 7
  s_add_u32 s15, s15, s3
  s_lshl_b32 s3, s81, 6
  s_add_u32 s15, s15, s3
  v_cvt_pk_bf16_f32 v156, v136, v137
  v_cvt_pk_bf16_f32 v157, v138, v139
  v_exp_f32 v140, v140
  v_exp_f32 v141, v141
  v_exp_f32 v142, v142
  v_exp_f32 v143, v143
  v_cvt_pk_bf16_f32 v158, v140, v141
  v_cvt_pk_bf16_f32 v159, v142, v143
  v_mfma_f32_32x32x16_bf16 v[128:143], v[208:211], v[24:27], 0
  buffer_load_dwordx4 v[196:199], v1, s[64:67], s11 offen offset:1024 sc1
  v_exp_f32 v112, v112
  v_exp_f32 v113, v113
  v_exp_f32 v114, v114
  v_exp_f32 v115, v115
  v_mfma_f32_32x32x16_bf16 v[128:143], v[212:215], v[28:31], v[128:143]
  buffer_load_dwordx4 v[244:247], v11, s[28:31], s15 offen offset:0
  v_cvt_pk_bf16_f32 v144, v112, v113
  v_cvt_pk_bf16_f32 v145, v114, v115
  v_exp_f32 v116, v116
  v_exp_f32 v117, v117
  v_exp_f32 v118, v118
  v_exp_f32 v119, v119
  v_mfma_f32_32x32x16_bf16 v[96:111], v[168:171], v[152:155], v[96:111]
  buffer_load_dwordx4 v[252:255], v11, s[28:31], s15 offen offset:32
  v_cmp_eq_u32 vcc, 0, v229
  s_nop 0
  s_cbranch_vccnz L17
L18:
  v_cvt_pk_bf16_f32 v146, v116, v117
  v_cvt_pk_bf16_f32 v147, v118, v119
  v_exp_f32 v120, v120
  v_exp_f32 v121, v121
  v_exp_f32 v122, v122
  v_exp_f32 v123, v123
  v_mfma_f32_32x32x16_bf16 v[96:111], v[172:175], v[156:159], v[96:111]
  s_waitcnt vmcnt(17)
  v_cmp_eq_u32 vcc, 0, v12
  s_nop 0
  s_cbranch_vccnz L19
L20:
  v_cmp_ne_u32 vcc, s99, v12
  s_nop 2
  s_cmp_eq_u64 vcc, 0
  s_cselect_b32 s74, 1, 0
  v_cvt_pk_bf16_f32 v148, v120, v121
  v_cvt_pk_bf16_f32 v149, v122, v123
  v_exp_f32 v124, v124
  v_exp_f32 v125, v125
  v_exp_f32 v126, v126
  v_exp_f32 v127, v127
  v_cvt_pk_bf16_f32 v150, v124, v125
  v_cvt_pk_bf16_f32 v151, v126, v127
  v_mfma_f32_32x32x16_bf16 v[112:127], v[208:211], v[32:35], 0
  buffer_load_dwordx4 v[200:203], v1, s[64:67], s11 offen offset:2048 sc1
  v_exp_f32 v128, v128
  v_exp_f32 v129, v129
  v_exp_f32 v130, v130
  v_exp_f32 v131, v131
  v_mfma_f32_32x32x16_bf16 v[112:127], v[212:215], v[36:39], v[112:127]
  s_waitcnt vmcnt(16)
  v_cvt_pk_bf16_f32 v152, v128, v129
  v_cvt_pk_bf16_f32 v153, v130, v131
  v_exp_f32 v132, v132
  v_exp_f32 v133, v133
  v_exp_f32 v134, v134
  v_exp_f32 v135, v135
  v_mfma_f32_32x32x16_bf16 v[48:63], v[216:219], v[144:147], v[48:63]
  s_add_u32 s21, s23, 180224
  v_cvt_pk_bf16_f32 v154, v132, v133
  v_cvt_pk_bf16_f32 v155, v134, v135
  v_exp_f32 v136, v136
  v_exp_f32 v137, v137
  v_exp_f32 v138, v138
  v_exp_f32 v139, v139
  v_mfma_f32_32x32x16_bf16 v[48:63], v[220:223], v[148:151], v[48:63]
  s_and_b32 s101, s68, 1
  v_cvt_pk_bf16_f32 v156, v136, v137
  v_cvt_pk_bf16_f32 v157, v138, v139
  v_exp_f32 v140, v140
  v_exp_f32 v141, v141
  v_exp_f32 v142, v142
  v_exp_f32 v143, v143
  v_cvt_pk_bf16_f32 v158, v140, v141
  v_cvt_pk_bf16_f32 v159, v142, v143
  v_mfma_f32_32x32x16_bf16 v[128:143], v[208:211], v[40:43], 0
  buffer_load_dwordx4 v[204:207], v1, s[64:67], s11 offen offset:3072 sc1
  v_exp_f32 v112, v112
  v_exp_f32 v113, v113
  v_exp_f32 v114, v114
  v_exp_f32 v115, v115
  v_mfma_f32_32x32x16_bf16 v[128:143], v[212:215], v[44:47], v[128:143]
  s_and_b32 s21, s21, 245760
  v_cvt_pk_bf16_f32 v144, v112, v113
  v_cvt_pk_bf16_f32 v145, v114, v115
  v_exp_f32 v116, v116
  v_exp_f32 v117, v117
  v_exp_f32 v118, v118
  v_exp_f32 v119, v119
  v_mfma_f32_32x32x16_bf16 v[64:79], v[216:219], v[152:155], v[64:79]
  s_add_u32 s21, s21, s10
  v_cvt_pk_bf16_f32 v146, v116, v117
  v_cvt_pk_bf16_f32 v147, v118, v119
  v_exp_f32 v120, v120
  v_exp_f32 v121, v121
  v_exp_f32 v122, v122
  v_exp_f32 v123, v123
  v_mfma_f32_32x32x16_bf16 v[64:79], v[220:223], v[156:159], v[64:79]
  s_waitcnt vmcnt(15)
  v_cvt_pk_bf16_f32 v148, v120, v121
  v_cvt_pk_bf16_f32 v149, v122, v123
  v_exp_f32 v124, v124
  v_exp_f32 v125, v125
  v_exp_f32 v126, v126
  v_exp_f32 v127, v127
  v_cvt_pk_bf16_f32 v150, v124, v125
  v_cvt_pk_bf16_f32 v151, v126, v127
  v_mfma_f32_32x32x16_bf16 v[112:127], v[176:179], v[16:19], 0
  buffer_load_dwordx4 v[160:163], v1, s[64:67], s21 offen offset:0 sc1
  v_exp_f32 v128, v128
  v_exp_f32 v129, v129
  v_exp_f32 v130, v130
  v_exp_f32 v131, v131
  v_mfma_f32_32x32x16_bf16 v[112:127], v[180:183], v[20:23], v[112:127]
  s_and_b32 s17, s71, 0
  s_xor_b32 s17, s17, 0
  v_cvt_pk_bf16_f32 v152, v128, v129
  v_cvt_pk_bf16_f32 v153, v130, v131
  v_exp_f32 v132, v132
  v_exp_f32 v133, v133
  v_exp_f32 v134, v134
  v_exp_f32 v135, v135
  v_mfma_f32_32x32x16_bf16 v[80:95], v[216:219], v[144:147], v[80:95]
  s_xor_b32 s101, s101, 1
  v_cvt_pk_bf16_f32 v154, v132, v133
  v_cvt_pk_bf16_f32 v155, v134, v135
  v_exp_f32 v136, v136
  v_exp_f32 v137, v137
  v_exp_f32 v138, v138
  v_exp_f32 v139, v139
  v_mfma_f32_32x32x16_bf16 v[80:95], v[220:223], v[148:151], v[80:95]
  s_mul_i32 s17, s17, 14336
  v_cvt_pk_bf16_f32 v156, v136, v137
  v_cvt_pk_bf16_f32 v157, v138, v139
  v_exp_f32 v140, v140
  v_exp_f32 v141, v141
  v_exp_f32 v142, v142
  v_exp_f32 v143, v143
  v_cvt_pk_bf16_f32 v158, v140, v141
  v_cvt_pk_bf16_f32 v159, v142, v143
  v_mfma_f32_32x32x16_bf16 v[128:143], v[176:179], v[24:27], 0
  buffer_load_dwordx4 v[164:167], v1, s[64:67], s21 offen offset:1024 sc1
  v_exp_f32 v112, v112
  v_exp_f32 v113, v113
  v_exp_f32 v114, v114
  v_exp_f32 v115, v115
  v_mfma_f32_32x32x16_bf16 v[128:143], v[180:183], v[28:31], v[128:143]
  s_mul_i32 s100, s101, 50176
  s_add_u32 s17, s17, s13
  v_cvt_pk_bf16_f32 v144, v112, v113
  v_cvt_pk_bf16_f32 v145, v114, v115
  v_exp_f32 v116, v116
  v_exp_f32 v117, v117
  v_exp_f32 v118, v118
  v_exp_f32 v119, v119
  v_mfma_f32_32x32x16_bf16 v[96:111], v[216:219], v[152:155], v[96:111]
  s_add_u32 s11, s22, 196608
  v_cvt_pk_bf16_f32 v146, v116, v117
  v_cvt_pk_bf16_f32 v147, v118, v119
  v_exp_f32 v120, v120
  v_exp_f32 v121, v121
  v_exp_f32 v122, v122
  v_exp_f32 v123, v123
  v_mfma_f32_32x32x16_bf16 v[96:111], v[220:223], v[156:159], v[96:111]
  s_cmp_ge_u32 s0, 14
  s_cbranch_scc1 L21
L22:
  v_cvt_pk_bf16_f32 v148, v120, v121
  v_cvt_pk_bf16_f32 v149, v122, v123
  v_exp_f32 v124, v124
  v_exp_f32 v125, v125
  v_exp_f32 v126, v126
  v_exp_f32 v127, v127
  v_cvt_pk_bf16_f32 v150, v124, v125
  v_cvt_pk_bf16_f32 v151, v126, v127
  v_mfma_f32_32x32x16_bf16 v[112:127], v[176:179], v[32:35], 0
  buffer_load_dwordx4 v[168:171], v1, s[64:67], s21 offen offset:2048 sc1
  v_exp_f32 v128, v128
  v_exp_f32 v129, v129
  v_exp_f32 v130, v130
  v_exp_f32 v131, v131
  v_mfma_f32_32x32x16_bf16 v[112:127], v[180:183], v[36:39], v[112:127]
  s_and_b32 s11, s11, 245760
  s_waitcnt vmcnt(12)
  v_cvt_pk_bf16_f32 v152, v128, v129
  v_cvt_pk_bf16_f32 v153, v130, v131
  v_exp_f32 v132, v132
  v_exp_f32 v133, v133
  v_exp_f32 v134, v134
  v_exp_f32 v135, v135
  v_mfma_f32_32x32x16_bf16 v[48:63], v[184:187], v[144:147], v[48:63]
  buffer_load_dwordx4 v[172:175], v1, s[64:67], s21 offen offset:3072 sc1
  s_add_u32 s11, s11, s10
  v_cvt_pk_bf16_f32 v154, v132, v133
  v_cvt_pk_bf16_f32 v155, v134, v135
  v_exp_f32 v136, v136
  v_exp_f32 v137, v137
  v_exp_f32 v138, v138
  v_exp_f32 v139, v139
  v_mfma_f32_32x32x16_bf16 v[48:63], v[188:191], v[148:151], v[48:63]
  s_add_u32 s100, s100, s1
  v_cvt_pk_bf16_f32 v156, v136, v137
  v_cvt_pk_bf16_f32 v157, v138, v139
  v_exp_f32 v140, v140
  v_exp_f32 v141, v141
  v_exp_f32 v142, v142
  v_exp_f32 v143, v143
  v_cvt_pk_bf16_f32 v158, v140, v141
  v_cvt_pk_bf16_f32 v159, v142, v143
  v_mfma_f32_32x32x16_bf16 v[128:143], v[176:179], v[40:43], 0
  buffer_load_dwordx4 v[208:211], v1, s[64:67], s11 offen offset:0 sc1
  v_exp_f32 v112, v112
  v_exp_f32 v113, v113
  v_exp_f32 v114, v114
  v_exp_f32 v115, v115
  v_mfma_f32_32x32x16_bf16 v[128:143], v[180:183], v[44:47], v[128:143]
  buffer_load_dwordx4 a[0:3], v1, s[64:67], s17 offen offset:0 sc1
  v_cvt_pk_bf16_f32 v144, v112, v113
  v_cvt_pk_bf16_f32 v145, v114, v115
  v_exp_f32 v116, v116
  v_exp_f32 v117, v117
  v_exp_f32 v118, v118
  v_exp_f32 v119, v119
  v_mfma_f32_32x32x16_bf16 v[64:79], v[184:187], v[152:155], v[64:79]
  s_mul_i32 s101, s101, 7168
  buffer_load_dwordx4 a[4:7], v1, s[64:67], s17 offen offset:1024 sc1
  v_cvt_pk_bf16_f32 v146, v116, v117
  v_cvt_pk_bf16_f32 v147, v118, v119
  v_exp_f32 v120, v120
  v_exp_f32 v121, v121
  v_exp_f32 v122, v122
  v_exp_f32 v123, v123
  v_mfma_f32_32x32x16_bf16 v[64:79], v[188:191], v[156:159], v[64:79]
  s_waitcnt vmcnt(11)
  v_cvt_pk_bf16_f32 v148, v120, v121
  v_cvt_pk_bf16_f32 v149, v122, v123
  v_exp_f32 v124, v124
  v_exp_f32 v125, v125
  v_exp_f32 v126, v126
  v_exp_f32 v127, v127
  v_cvt_pk_bf16_f32 v150, v124, v125
  v_cvt_pk_bf16_f32 v151, v126, v127
  v_mfma_f32_32x32x16_bf16 v[112:127], v[192:195], v[16:19], 0
  buffer_load_dwordx4 v[212:215], v1, s[64:67], s11 offen offset:1024 sc1
  v_exp_f32 v128, v128
  v_exp_f32 v129, v129
  v_exp_f32 v130, v130
  v_exp_f32 v131, v131
  v_mfma_f32_32x32x16_bf16 v[112:127], v[196:199], v[20:23], v[112:127]
  buffer_load_dwordx4 a[8:11], v1, s[64:67], s17 offen offset:2048 sc1
  v_cvt_pk_bf16_f32 v152, v128, v129
  v_cvt_pk_bf16_f32 v153, v130, v131
  v_exp_f32 v132, v132
  v_exp_f32 v133, v133
  v_exp_f32 v134, v134
  v_exp_f32 v135, v135
  v_mfma_f32_32x32x16_bf16 v[80:95], v[184:187], v[144:147], v[80:95]
  s_add_u32 s21, s23, 212992
  v_cvt_pk_bf16_f32 v154, v132, v133
  v_cvt_pk_bf16_f32 v155, v134, v135
  v_exp_f32 v136, v136
  v_exp_f32 v137, v137
  v_exp_f32 v138, v138
  v_exp_f32 v139, v139
  v_mfma_f32_32x32x16_bf16 v[80:95], v[188:191], v[148:151], v[80:95]
  s_add_u32 s101, s101, s77
  v_cvt_pk_bf16_f32 v156, v136, v137
  v_cvt_pk_bf16_f32 v157, v138, v139
  v_exp_f32 v140, v140
  v_exp_f32 v141, v141
  v_exp_f32 v142, v142
  v_exp_f32 v143, v143
  v_cvt_pk_bf16_f32 v158, v140, v141
  v_cvt_pk_bf16_f32 v159, v142, v143
  v_mfma_f32_32x32x16_bf16 v[128:143], v[192:195], v[24:27], 0
  buffer_load_dwordx4 v[216:219], v1, s[64:67], s11 offen offset:2048 sc1
  v_exp_f32 v112, v112
  v_exp_f32 v113, v113
  v_exp_f32 v114, v114
  v_exp_f32 v115, v115
  v_mfma_f32_32x32x16_bf16 v[128:143], v[196:199], v[28:31], v[128:143]
  s_and_b32 s21, s21, 245760
  v_cvt_pk_bf16_f32 v144, v112, v113
  v_cvt_pk_bf16_f32 v145, v114, v115
  v_exp_f32 v116, v116
  v_exp_f32 v117, v117
  v_exp_f32 v118, v118
  v_exp_f32 v119, v119
  v_mfma_f32_32x32x16_bf16 v[96:111], v[184:187], v[152:155], v[96:111]
  buffer_load_dwordx4 v[220:223], v1, s[64:67], s11 offen offset:3072 sc1
  s_add_u32 s21, s21, s10
  v_cvt_pk_bf16_f32 v146, v116, v117
  v_cvt_pk_bf16_f32 v147, v118, v119
  v_exp_f32 v120, v120
  v_exp_f32 v121, v121
  v_exp_f32 v122, v122
  v_exp_f32 v123, v123
  v_mfma_f32_32x32x16_bf16 v[96:111], v[188:191], v[156:159], v[96:111]
  buffer_load_dwordx4 a[12:15], v1, s[64:67], s17 offen offset:3072 sc1
  s_add_u32 m0, s101, 0
  v_cvt_pk_bf16_f32 v148, v120, v121
  v_cvt_pk_bf16_f32 v149, v122, v123
  v_exp_f32 v124, v124
  v_exp_f32 v125, v125
  v_exp_f32 v126, v126
  v_exp_f32 v127, v127
  v_cvt_pk_bf16_f32 v150, v124, v125
  v_cvt_pk_bf16_f32 v151, v126, v127
  v_mfma_f32_32x32x16_bf16 v[112:127], v[192:195], v[32:35], 0
  buffer_load_dwordx4 v[176:179], v1, s[64:67], s21 offen offset:0 sc1
  v_exp_f32 v128, v128
  v_exp_f32 v129, v129
  v_exp_f32 v130, v130
  v_exp_f32 v131, v131
  v_mfma_f32_32x32x16_bf16 v[112:127], v[196:199], v[36:39], v[112:127]
  s_waitcnt vmcnt(13)
  v_cvt_pk_bf16_f32 v152, v128, v129
  v_cvt_pk_bf16_f32 v153, v130, v131
  v_exp_f32 v132, v132
  v_exp_f32 v133, v133
  v_exp_f32 v134, v134
  v_exp_f32 v135, v135
  v_mfma_f32_32x32x16_bf16 v[48:63], v[200:203], v[144:147], v[48:63]
  s_add_u32 s17, s17, 4096
  v_cvt_pk_bf16_f32 v154, v132, v133
  v_cvt_pk_bf16_f32 v155, v134, v135
  v_exp_f32 v136, v136
  v_exp_f32 v137, v137
  v_exp_f32 v138, v138
  v_exp_f32 v139, v139
  v_mfma_f32_32x32x16_bf16 v[48:63], v[204:207], v[148:151], v[48:63]
  s_add_u32 s12, s100, 0
  buffer_load_dwordx4 a[16:19], v1, s[64:67], s17 offen offset:0 sc1
  v_cvt_pk_bf16_f32 v156, v136, v137
  v_cvt_pk_bf16_f32 v157, v138, v139
  v_exp_f32 v140, v140
  v_exp_f32 v141, v141
  v_exp_f32 v142, v142
  v_exp_f32 v143, v143
  v_cvt_pk_bf16_f32 v158, v140, v141
  v_cvt_pk_bf16_f32 v159, v142, v143
  v_mfma_f32_32x32x16_bf16 v[128:143], v[192:195], v[40:43], 0
  buffer_load_dwordx4 v[180:183], v1, s[64:67], s21 offen offset:1024 sc1
  v_exp_f32 v112, v112
  v_exp_f32 v113, v113
  v_exp_f32 v114, v114
  v_exp_f32 v115, v115
  v_mfma_f32_32x32x16_bf16 v[128:143], v[196:199], v[44:47], v[128:143]
  buffer_load_dwordx4 v236, s[40:43], s12 offen offset:0  lds
  v_cvt_pk_bf16_f32 v144, v112, v113
  v_cvt_pk_bf16_f32 v145, v114, v115
  v_exp_f32 v116, v116
  v_exp_f32 v117, v117
  v_exp_f32 v118, v118
  v_exp_f32 v119, v119
  v_mfma_f32_32x32x16_bf16 v[64:79], v[200:203], v[152:155], v[64:79]
  s_add_u32 s11, s22, 229376
  v_cvt_pk_bf16_f32 v146, v116, v117
  v_cvt_pk_bf16_f32 v147, v118, v119
  v_exp_f32 v120, v120
  v_exp_f32 v121, v121
  v_exp_f32 v122, v122
  v_exp_f32 v123, v123
  v_mfma_f32_32x32x16_bf16 v[64:79], v[204:207], v[156:159], v[64:79]
  s_waitcnt vmcnt(14)
  v_cvt_pk_bf16_f32 v148, v120, v121
  v_cvt_pk_bf16_f32 v149, v122, v123
  v_exp_f32 v124, v124
  v_exp_f32 v125, v125
  v_exp_f32 v126, v126
  v_exp_f32 v127, v127
  v_cvt_pk_bf16_f32 v150, v124, v125
  v_cvt_pk_bf16_f32 v151, v126, v127
  v_mfma_f32_32x32x16_bf16 v[112:127], v[160:163], v[16:19], 0
  buffer_load_dwordx4 v[184:187], v1, s[64:67], s21 offen offset:2048 sc1
  v_exp_f32 v128, v128
  v_exp_f32 v129, v129
  v_exp_f32 v130, v130
  v_exp_f32 v131, v131
  v_mfma_f32_32x32x16_bf16 v[112:127], v[164:167], v[20:23], v[112:127]
  s_and_b32 s11, s11, 245760
  v_cvt_pk_bf16_f32 v152, v128, v129
  v_cvt_pk_bf16_f32 v153, v130, v131
  v_exp_f32 v132, v132
  v_exp_f32 v133, v133
  v_exp_f32 v134, v134
  v_exp_f32 v135, v135
  v_mfma_f32_32x32x16_bf16 v[80:95], v[200:203], v[144:147], v[80:95]
  buffer_load_dwordx4 v[188:191], v1, s[64:67], s21 offen offset:3072 sc1
  s_add_u32 s11, s11, s10
  v_cvt_pk_bf16_f32 v154, v132, v133
  v_cvt_pk_bf16_f32 v155, v134, v135
  v_exp_f32 v136, v136
  v_exp_f32 v137, v137
  v_exp_f32 v138, v138
  v_exp_f32 v139, v139
  v_mfma_f32_32x32x16_bf16 v[80:95], v[204:207], v[148:151], v[80:95]
  buffer_load_dwordx4 a[20:23], v1, s[64:67], s17 offen offset:1024 sc1
  v_cvt_pk_bf16_f32 v156, v136, v137
  v_cvt_pk_bf16_f32 v157, v138, v139
  v_exp_f32 v140, v140
  v_exp_f32 v141, v141
  v_exp_f32 v142, v142
  v_exp_f32 v143, v143
  v_cvt_pk_bf16_f32 v158, v140, v141
  v_cvt_pk_bf16_f32 v159, v142, v143
  v_mfma_f32_32x32x16_bf16 v[128:143], v[160:163], v[24:27], 0
  buffer_load_dwordx4 v[192:195], v1, s[64:67], s11 offen offset:0 sc1
  v_exp_f32 v112, v112
  v_exp_f32 v113, v113
  v_exp_f32 v114, v114
  v_exp_f32 v115, v115
  v_mfma_f32_32x32x16_bf16 v[128:143], v[164:167], v[28:31], v[128:143]
  buffer_load_dwordx4 a[24:27], v1, s[64:67], s17 offen offset:2048 sc1
  buffer_load_dwordx4 v237, s[40:43], s12 offen offset:1024  lds
  v_cvt_pk_bf16_f32 v144, v112, v113
  v_cvt_pk_bf16_f32 v145, v114, v115
  v_exp_f32 v116, v116
  v_exp_f32 v117, v117
  v_exp_f32 v118, v118
  v_exp_f32 v119, v119
  v_mfma_f32_32x32x16_bf16 v[96:111], v[200:203], v[152:155], v[96:111]
  buffer_load_dwordx4 a[28:31], v1, s[64:67], s17 offen offset:3072 sc1
  v_cvt_pk_bf16_f32 v146, v116, v117
  v_cvt_pk_bf16_f32 v147, v118, v119
  v_exp_f32 v120, v120
  v_exp_f32 v121, v121
  v_exp_f32 v122, v122
  v_exp_f32 v123, v123
  v_mfma_f32_32x32x16_bf16 v[96:111], v[204:207], v[156:159], v[96:111]
  buffer_load_dwordx4 v238, s[40:43], s12 offen offset:2048  lds
  v_cvt_pk_bf16_f32 v148, v120, v121
  v_cvt_pk_bf16_f32 v149, v122, v123
  v_exp_f32 v124, v124
  v_exp_f32 v125, v125
  v_exp_f32 v126, v126
  v_exp_f32 v127, v127
  v_cvt_pk_bf16_f32 v150, v124, v125
  v_cvt_pk_bf16_f32 v151, v126, v127
  v_mfma_f32_32x32x16_bf16 v[112:127], v[160:163], v[32:35], 0
  buffer_load_dwordx4 v[196:199], v1, s[64:67], s11 offen offset:1024 sc1
  v_exp_f32 v128, v128
  v_exp_f32 v129, v129
  v_exp_f32 v130, v130
  v_exp_f32 v131, v131
  v_mfma_f32_32x32x16_bf16 v[112:127], v[164:167], v[36:39], v[112:127]
  s_waitcnt vmcnt(21)
  v_cvt_pk_bf16_f32 v152, v128, v129
  v_cvt_pk_bf16_f32 v153, v130, v131
  v_exp_f32 v132, v132
  v_exp_f32 v133, v133
  v_exp_f32 v134, v134
  v_exp_f32 v135, v135
  v_mfma_f32_32x32x16_bf16 v[48:63], v[168:171], v[144:147], v[48:63]
  s_add_u32 s21, s23, 245760
  v_cvt_pk_bf16_f32 v154, v132, v133
  v_cvt_pk_bf16_f32 v155, v134, v135
  v_exp_f32 v136, v136
  v_exp_f32 v137, v137
  v_exp_f32 v138, v138
  v_exp_f32 v139, v139
  v_mfma_f32_32x32x16_bf16 v[48:63], v[172:175], v[148:151], v[48:63]
  s_add_u32 s17, s17, 4096
  buffer_load_dwordx4 v239, s[40:43], s12 offen offset:3072  lds
  v_cvt_pk_bf16_f32 v156, v136, v137
  v_cvt_pk_bf16_f32 v157, v138, v139
  v_exp_f32 v140, v140
  v_exp_f32 v141, v141
  v_exp_f32 v142, v142
  v_exp_f32 v143, v143
  v_cvt_pk_bf16_f32 v158, v140, v141
  v_cvt_pk_bf16_f32 v159, v142, v143
  v_mfma_f32_32x32x16_bf16 v[128:143], v[160:163], v[40:43], 0
  buffer_load_dwordx4 v[200:203], v1, s[64:67], s11 offen offset:2048 sc1
  v_exp_f32 v112, v112
  v_exp_f32 v113, v113
  v_exp_f32 v114, v114
  v_exp_f32 v115, v115
  v_mfma_f32_32x32x16_bf16 v[128:143], v[164:167], v[44:47], v[128:143]
  s_and_b32 s21, s21, 245760
  v_cvt_pk_bf16_f32 v144, v112, v113
  v_cvt_pk_bf16_f32 v145, v114, v115
  v_exp_f32 v116, v116
  v_exp_f32 v117, v117
  v_exp_f32 v118, v118
  v_exp_f32 v119, v119
  v_mfma_f32_32x32x16_bf16 v[64:79], v[168:171], v[152:155], v[64:79]
  buffer_load_dwordx4 v[204:207], v1, s[64:67], s11 offen offset:3072 sc1
  s_add_u32 s21, s21, s10
  v_cvt_pk_bf16_f32 v146, v116, v117
  v_cvt_pk_bf16_f32 v147, v118, v119
  v_exp_f32 v120, v120
  v_exp_f32 v121, v121
  v_exp_f32 v122, v122
  v_exp_f32 v123, v123
  v_mfma_f32_32x32x16_bf16 v[64:79], v[172:175], v[156:159], v[64:79]
  s_waitcnt vmcnt(20)
  v_cvt_pk_bf16_f32 v148, v120, v121
  v_cvt_pk_bf16_f32 v149, v122, v123
  v_exp_f32 v124, v124
  v_exp_f32 v125, v125
  v_exp_f32 v126, v126
  v_exp_f32 v127, v127
  v_cvt_pk_bf16_f32 v150, v124, v125
  v_cvt_pk_bf16_f32 v151, v126, v127
  v_mfma_f32_32x32x16_bf16 v[112:127], v[208:211], v[16:19], 0
  buffer_load_dwordx4 v[160:163], v1, s[64:67], s21 offen offset:0 sc1
  v_exp_f32 v128, v128
  v_exp_f32 v129, v129
  v_exp_f32 v130, v130
  v_exp_f32 v131, v131
  v_mfma_f32_32x32x16_bf16 v[112:127], v[212:215], v[20:23], v[112:127]
  buffer_load_dwordx4 a[32:35], v1, s[64:67], s17 offen offset:0 sc1
  v_cvt_pk_bf16_f32 v152, v128, v129
  v_cvt_pk_bf16_f32 v153, v130, v131
  v_exp_f32 v132, v132
  v_exp_f32 v133, v133
  v_exp_f32 v134, v134
  v_exp_f32 v135, v135
  v_mfma_f32_32x32x16_bf16 v[80:95], v[168:171], v[144:147], v[80:95]
  s_add_u32 m0, s101, 4096
  v_cvt_pk_bf16_f32 v154, v132, v133
  v_cvt_pk_bf16_f32 v155, v134, v135
  v_exp_f32 v136, v136
  v_exp_f32 v137, v137
  v_exp_f32 v138, v138
  v_exp_f32 v139, v139
  v_mfma_f32_32x32x16_bf16 v[80:95], v[172:175], v[148:151], v[80:95]
  buffer_load_dwordx4 a[36:39], v1, s[64:67], s17 offen offset:1024 sc1
  buffer_load_dwordx4 a[40:43], v1, s[64:67], s17 offen offset:2048 sc1
  v_cvt_pk_bf16_f32 v156, v136, v137
  v_cvt_pk_bf16_f32 v157, v138, v139
  v_exp_f32 v140, v140
  v_exp_f32 v141, v141
  v_exp_f32 v142, v142
  v_exp_f32 v143, v143
  v_cvt_pk_bf16_f32 v158, v140, v141
  v_cvt_pk_bf16_f32 v159, v142, v143
  v_mfma_f32_32x32x16_bf16 v[128:143], v[208:211], v[24:27], 0
  buffer_load_dwordx4 v[164:167], v1, s[64:67], s21 offen offset:1024 sc1
  v_exp_f32 v112, v112
  v_exp_f32 v113, v113
  v_exp_f32 v114, v114
  v_exp_f32 v115, v115
  v_mfma_f32_32x32x16_bf16 v[128:143], v[212:215], v[28:31], v[128:143]
  s_add_u32 s12, s100, 28672
  v_cvt_pk_bf16_f32 v144, v112, v113
  v_cvt_pk_bf16_f32 v145, v114, v115
  v_exp_f32 v116, v116
  v_exp_f32 v117, v117
  v_exp_f32 v118, v118
  v_exp_f32 v119, v119
  v_mfma_f32_32x32x16_bf16 v[96:111], v[168:171], v[152:155], v[96:111]
  buffer_load_dwordx4 a[44:47], v1, s[64:67], s17 offen offset:3072 sc1
  v_cvt_pk_bf16_f32 v146, v116, v117
  v_cvt_pk_bf16_f32 v147, v118, v119
  v_exp_f32 v120, v120
  v_exp_f32 v121, v121
  v_exp_f32 v122, v122
  v_exp_f32 v123, v123
  v_mfma_f32_32x32x16_bf16 v[96:111], v[172:175], v[156:159], v[96:111]
  buffer_load_dwordx4 v236, s[40:43], s12 offen offset:0  lds
  s_add_u32 s17, s17, 4096
  v_cvt_pk_bf16_f32 v148, v120, v121
  v_cvt_pk_bf16_f32 v149, v122, v123
  v_exp_f32 v124, v124
  v_exp_f32 v125, v125
  v_exp_f32 v126, v126
  v_exp_f32 v127, v127
  v_cvt_pk_bf16_f32 v150, v124, v125
  v_cvt_pk_bf16_f32 v151, v126, v127
  v_mfma_f32_32x32x16_bf16 v[112:127], v[208:211], v[32:35], 0
  buffer_load_dwordx4 v[168:171], v1, s[64:67], s21 offen offset:2048 sc1
  v_exp_f32 v128, v128
  v_exp_f32 v129, v129
  v_exp_f32 v130, v130
  v_exp_f32 v131, v131
  v_mfma_f32_32x32x16_bf16 v[112:127], v[212:215], v[36:39], v[112:127]
  s_waitcnt vmcnt(25)
  v_cvt_pk_bf16_f32 v152, v128, v129
  v_cvt_pk_bf16_f32 v153, v130, v131
  v_exp_f32 v132, v132
  v_exp_f32 v133, v133
  v_exp_f32 v134, v134
  v_exp_f32 v135, v135
  v_mfma_f32_32x32x16_bf16 v[48:63], v[216:219], v[144:147], v[48:63]
  buffer_load_dwordx4 v[172:175], v1, s[64:67], s21 offen offset:3072 sc1
  v_cvt_pk_bf16_f32 v154, v132, v133
  v_cvt_pk_bf16_f32 v155, v134, v135
  v_exp_f32 v136, v136
  v_exp_f32 v137, v137
  v_exp_f32 v138, v138
  v_exp_f32 v139, v139
  v_mfma_f32_32x32x16_bf16 v[48:63], v[220:223], v[148:151], v[48:63]
  buffer_load_dwordx4 v237, s[40:43], s12 offen offset:1024  lds
  v_cvt_pk_bf16_f32 v156, v136, v137
  v_cvt_pk_bf16_f32 v157, v138, v139
  v_exp_f32 v140, v140
  v_exp_f32 v141, v141
  v_exp_f32 v142, v142
  v_exp_f32 v143, v143
  v_cvt_pk_bf16_f32 v158, v140, v141
  v_cvt_pk_bf16_f32 v159, v142, v143
  v_mfma_f32_32x32x16_bf16 v[128:143], v[208:211], v[40:43], 0
  buffer_load_dwordx4 a[48:51], v1, s[64:67], s17 offen offset:0 sc1
  v_exp_f32 v112, v112
  v_exp_f32 v113, v113
  v_exp_f32 v114, v114
  v_exp_f32 v115, v115
  v_mfma_f32_32x32x16_bf16 v[128:143], v[212:215], v[44:47], v[128:143]
  buffer_load_dwordx4 v238, s[40:43], s12 offen offset:2048  lds
  buffer_load_dwordx4 a[52:55], v1, s[64:67], s17 offen offset:1024 sc1
  v_cvt_pk_bf16_f32 v144, v112, v113
  v_cvt_pk_bf16_f32 v145, v114, v115
  v_exp_f32 v116, v116
  v_exp_f32 v117, v117
  v_exp_f32 v118, v118
  v_exp_f32 v119, v119
  v_mfma_f32_32x32x16_bf16 v[64:79], v[216:219], v[152:155], v[64:79]
  s_and_b32 s17, s71, 0
  v_cvt_pk_bf16_f32 v146, v116, v117
  v_cvt_pk_bf16_f32 v147, v118, v119
  v_exp_f32 v120, v120
  v_exp_f32 v121, v121
  v_exp_f32 v122, v122
  v_exp_f32 v123, v123
  v_mfma_f32_32x32x16_bf16 v[64:79], v[220:223], v[156:159], v[64:79]
  s_waitcnt vmcnt(26)
  v_cvt_pk_bf16_f32 v148, v120, v121
  v_cvt_pk_bf16_f32 v149, v122, v123
  v_exp_f32 v124, v124
  v_exp_f32 v125, v125
  v_exp_f32 v126, v126
  v_exp_f32 v127, v127
  v_cvt_pk_bf16_f32 v150, v124, v125
  v_cvt_pk_bf16_f32 v151, v126, v127
  v_mfma_f32_32x32x16_bf16 v[112:127], v[176:179], v[16:19], 0
  s_xor_b32 s17, s17, 1
  s_mul_i32 s17, s17, 14336
  v_exp_f32 v128, v128
  v_exp_f32 v129, v129
  v_exp_f32 v130, v130
  v_exp_f32 v131, v131
  v_mfma_f32_32x32x16_bf16 v[112:127], v[180:183], v[20:23], v[112:127]
  s_add_u32 s17, s17, s13
  v_cvt_pk_bf16_f32 v152, v128, v129
  v_cvt_pk_bf16_f32 v153, v130, v131
  v_exp_f32 v132, v132
  v_exp_f32 v133, v133
  v_exp_f32 v134, v134
  v_exp_f32 v135, v135
  v_mfma_f32_32x32x16_bf16 v[80:95], v[216:219], v[144:147], v[80:95]
  buffer_load_dwordx4 a[56:59], v1, s[64:67], s17 offen offset:0 sc1
  v_cvt_pk_bf16_f32 v154, v132, v133
  v_cvt_pk_bf16_f32 v155, v134, v135
  v_exp_f32 v136, v136
  v_exp_f32 v137, v137
  v_exp_f32 v138, v138
  v_exp_f32 v139, v139
  v_mfma_f32_32x32x16_bf16 v[80:95], v[220:223], v[148:151], v[80:95]
  s_waitcnt vmcnt(17)
  v_cvt_pk_bf16_f32 v156, v136, v137
  v_cvt_pk_bf16_f32 v157, v138, v139
  v_exp_f32 v140, v140
  v_exp_f32 v141, v141
  v_exp_f32 v142, v142
  v_exp_f32 v143, v143
  v_cvt_pk_bf16_f32 v158, v140, v141
  v_cvt_pk_bf16_f32 v159, v142, v143
  v_mfma_f32_32x32x16_bf16 v[128:143], v[192:195], v[16:19], 0
  buffer_load_dwordx4 a[60:63], v1, s[64:67], s17 offen offset:1024 sc1
  buffer_load_dwordx4 a[64:67], v1, s[64:67], s17 offen offset:2048 sc1
  v_exp_f32 v112, v112
  v_exp_f32 v113, v113
  v_exp_f32 v114, v114
  v_exp_f32 v115, v115
  v_mfma_f32_32x32x16_bf16 v[128:143], v[196:199], v[20:23], v[128:143]
  buffer_load_dwordx4 a[68:71], v1, s[64:67], s17 offen offset:3072 sc1
  v_cvt_pk_bf16_f32 v144, v112, v113
  v_cvt_pk_bf16_f32 v145, v114, v115
  v_exp_f32 v116, v116
  v_exp_f32 v117, v117
  v_exp_f32 v118, v118
  v_exp_f32 v119, v119
  v_mfma_f32_32x32x16_bf16 v[96:111], v[216:219], v[152:155], v[96:111]
  s_add_u32 s17, s17, 4096
  v_cvt_pk_bf16_f32 v146, v116, v117
  v_cvt_pk_bf16_f32 v147, v118, v119
  v_exp_f32 v120, v120
  v_exp_f32 v121, v121
  v_exp_f32 v122, v122
  v_exp_f32 v123, v123
  v_mfma_f32_32x32x16_bf16 v[96:111], v[220:223], v[156:159], v[96:111]
  s_waitcnt vmcnt(12)
  v_cvt_pk_bf16_f32 v148, v120, v121
  v_cvt_pk_bf16_f32 v149, v122, v123
  v_exp_f32 v124, v124
  v_exp_f32 v125, v125
  v_exp_f32 v126, v126
  v_exp_f32 v127, v127
  v_cvt_pk_bf16_f32 v150, v124, v125
  v_cvt_pk_bf16_f32 v151, v126, v127
  v_mfma_f32_32x32x16_bf16 v[112:127], v[160:163], v[16:19], 0
  buffer_load_dwordx4 a[72:75], v1, s[64:67], s17 offen offset:0 sc1
  buffer_load_dwordx4 a[76:79], v1, s[64:67], s17 offen offset:1024 sc1
  v_exp_f32 v128, v128
  v_exp_f32 v129, v129
  v_exp_f32 v130, v130
  v_exp_f32 v131, v131
  v_mfma_f32_32x32x16_bf16 v[112:127], v[164:167], v[20:23], v[112:127]
  v_cvt_pk_bf16_f32 v152, v128, v129
  v_cvt_pk_bf16_f32 v153, v130, v131
  v_exp_f32 v132, v132
  v_exp_f32 v133, v133
  v_exp_f32 v134, v134
  v_exp_f32 v135, v135
  v_mfma_f32_32x32x16_bf16 v[48:63], v[184:187], v[144:147], v[48:63]
  buffer_load_dwordx4 a[80:83], v1, s[64:67], s17 offen offset:2048 sc1
  v_cvt_pk_bf16_f32 v154, v132, v133
  v_cvt_pk_bf16_f32 v155, v134, v135
  v_exp_f32 v136, v136
  v_exp_f32 v137, v137
  v_exp_f32 v138, v138
  v_exp_f32 v139, v139
  v_mfma_f32_32x32x16_bf16 v[48:63], v[188:191], v[148:151], v[48:63]
  buffer_load_dwordx4 a[84:87], v1, s[64:67], s17 offen offset:3072 sc1
  v_cvt_pk_bf16_f32 v156, v136, v137
  v_cvt_pk_bf16_f32 v157, v138, v139
  v_exp_f32 v140, v140
  v_exp_f32 v141, v141
  v_exp_f32 v142, v142
  v_exp_f32 v143, v143
  v_cvt_pk_bf16_f32 v158, v140, v141
  v_cvt_pk_bf16_f32 v159, v142, v143
  v_mfma_f32_32x32x16_bf16 v[128:143], v[176:179], v[24:27], 0
  s_add_u32 s17, s17, 4096
  buffer_load_dwordx4 a[88:91], v1, s[64:67], s17 offen offset:0 sc1
  v_exp_f32 v112, v112
  v_exp_f32 v113, v113
  v_exp_f32 v114, v114
  v_exp_f32 v115, v115
  v_mfma_f32_32x32x16_bf16 v[128:143], v[180:183], v[28:31], v[128:143]
  v_cvt_pk_bf16_f32 v144, v112, v113
  v_cvt_pk_bf16_f32 v145, v114, v115
  v_exp_f32 v116, v116
  v_exp_f32 v117, v117
  v_exp_f32 v118, v118
  v_exp_f32 v119, v119
  v_mfma_f32_32x32x16_bf16 v[48:63], v[200:203], v[152:155], v[48:63]
  buffer_load_dwordx4 a[92:95], v1, s[64:67], s17 offen offset:1024 sc1
  v_cvt_pk_bf16_f32 v146, v116, v117
  v_cvt_pk_bf16_f32 v147, v118, v119
  v_exp_f32 v120, v120
  v_exp_f32 v121, v121
  v_exp_f32 v122, v122
  v_exp_f32 v123, v123
  v_mfma_f32_32x32x16_bf16 v[48:63], v[204:207], v[156:159], v[48:63]
  buffer_load_dwordx4 a[96:99], v1, s[64:67], s17 offen offset:2048 sc1
  v_cvt_pk_bf16_f32 v148, v120, v121
  v_cvt_pk_bf16_f32 v149, v122, v123
  v_exp_f32 v124, v124
  v_exp_f32 v125, v125
  v_exp_f32 v126, v126
  v_exp_f32 v127, v127
  v_cvt_pk_bf16_f32 v150, v124, v125
  v_cvt_pk_bf16_f32 v151, v126, v127
  v_mfma_f32_32x32x16_bf16 v[112:127], v[192:195], v[24:27], 0
  buffer_load_dwordx4 a[100:103], v1, s[64:67], s17 offen offset:3072 sc1
  s_add_u32 s17, s17, 4096
  v_exp_f32 v128, v128
  v_exp_f32 v129, v129
  v_exp_f32 v130, v130
  v_exp_f32 v131, v131
  v_mfma_f32_32x32x16_bf16 v[112:127], v[196:199], v[28:31], v[112:127]
  s_waitcnt vmcnt(16)
  v_cvt_pk_bf16_f32 v152, v128, v129
  v_cvt_pk_bf16_f32 v153, v130, v131
  v_exp_f32 v132, v132
  v_exp_f32 v133, v133
  v_exp_f32 v134, v134
  v_exp_f32 v135, v135
  v_mfma_f32_32x32x16_bf16 v[48:63], v[168:171], v[144:147], v[48:63]
  buffer_load_dwordx4 a[104:107], v1, s[64:67], s17 offen offset:0 sc1
  v_cvt_pk_bf16_f32 v154, v132, v133
  v_cvt_pk_bf16_f32 v155, v134, v135
  v_exp_f32 v136, v136
  v_exp_f32 v137, v137
  v_exp_f32 v138, v138
  v_exp_f32 v139, v139
  v_mfma_f32_32x32x16_bf16 v[48:63], v[172:175], v[148:151], v[48:63]
  buffer_load_dwordx4 a[108:111], v1, s[64:67], s17 offen offset:1024 sc1
  v_cvt_pk_bf16_f32 v156, v136, v137
  v_cvt_pk_bf16_f32 v157, v138, v139
  v_exp_f32 v140, v140
  v_exp_f32 v141, v141
  v_exp_f32 v142, v142
  v_exp_f32 v143, v143
  v_cvt_pk_bf16_f32 v158, v140, v141
  v_cvt_pk_bf16_f32 v159, v142, v143
  v_mfma_f32_32x32x16_bf16 v[128:143], v[160:163], v[24:27], 0
  s_nop 1
  ds_write_b128 v224, v[48:51] offset:0
  v_exp_f32 v112, v112
  v_exp_f32 v113, v113
  v_exp_f32 v114, v114
  v_exp_f32 v115, v115
  v_mfma_f32_32x32x16_bf16 v[128:143], v[164:167], v[28:31], v[128:143]
  ds_write_b128 v224, v[52:55] offset:1024
  s_mov_b32 exec_hi, 0
  buffer_load_dword v15, v235, s[64:67], 0 offen sc1
  s_mov_b64 exec, -1
  v_cvt_pk_bf16_f32 v144, v112, v113
  v_cvt_pk_bf16_f32 v145, v114, v115
  v_exp_f32 v116, v116
  v_exp_f32 v117, v117
  v_exp_f32 v118, v118
  v_exp_f32 v119, v119
  v_mfma_f32_32x32x16_bf16 v[64:79], v[184:187], v[152:155], v[64:79]
  ds_write_b128 v224, v[56:59] offset:2048
  v_cvt_pk_bf16_f32 v146, v116, v117
  v_cvt_pk_bf16_f32 v147, v118, v119
  v_exp_f32 v120, v120
  v_exp_f32 v121, v121
  v_exp_f32 v122, v122
  v_exp_f32 v123, v123
  v_mfma_f32_32x32x16_bf16 v[64:79], v[188:191], v[156:159], v[64:79]
  ds_write_b128 v224, v[60:63] offset:3072
  s_lshl_b32 s7, s2, 2
  s_add_u32 s7, s7, s72
  v_cvt_pk_bf16_f32 v148, v120, v121
  v_cvt_pk_bf16_f32 v149, v122, v123
  v_exp_f32 v124, v124
  v_exp_f32 v125, v125
  v_exp_f32 v126, v126
  v_exp_f32 v127, v127
  v_cvt_pk_bf16_f32 v150, v124, v125
  v_cvt_pk_bf16_f32 v151, v126, v127
  v_mfma_f32_32x32x16_bf16 v[112:127], v[176:179], v[32:35], 0
  v_exp_f32 v128, v128
  v_exp_f32 v129, v129
  v_exp_f32 v130, v130
  v_exp_f32 v131, v131
  v_mfma_f32_32x32x16_bf16 v[112:127], v[180:183], v[36:39], v[112:127]
  s_lshl_b32 s4, s7, 9
  v_min_u32 v230, 3, v0
  v_lshlrev_b32 v230, 7, v230
  buffer_load_dword v15, v230, s[44:47], s4 offen sc1
  v_cvt_pk_bf16_f32 v152, v128, v129
  v_cvt_pk_bf16_f32 v153, v130, v131
  v_exp_f32 v132, v132
  v_exp_f32 v133, v133
  v_exp_f32 v134, v134
  v_exp_f32 v135, v135
  v_mfma_f32_32x32x16_bf16 v[64:79], v[200:203], v[144:147], v[64:79]
  v_cvt_pk_bf16_f32 v154, v132, v133
  v_cvt_pk_bf16_f32 v155, v134, v135
  v_exp_f32 v136, v136
  v_exp_f32 v137, v137
  v_exp_f32 v138, v138
  v_exp_f32 v139, v139
  v_mfma_f32_32x32x16_bf16 v[64:79], v[204:207], v[148:151], v[64:79]
  v_cvt_pk_bf16_f32 v156, v136, v137
  v_cvt_pk_bf16_f32 v157, v138, v139
  v_exp_f32 v140, v140
  v_exp_f32 v141, v141
  v_exp_f32 v142, v142
  v_exp_f32 v143, v143
  v_cvt_pk_bf16_f32 v158, v140, v141
  v_cvt_pk_bf16_f32 v159, v142, v143
  v_mfma_f32_32x32x16_bf16 v[128:143], v[192:195], v[32:35], 0
  v_exp_f32 v112, v112
  v_exp_f32 v113, v113
  v_exp_f32 v114, v114
  v_exp_f32 v115, v115
  v_mfma_f32_32x32x16_bf16 v[128:143], v[196:199], v[36:39], v[128:143]
  s_mul_i32 s4, s7, 1664
  v_min_u32 v230, 12, v0
  v_lshlrev_b32 v230, 7, v230
  buffer_load_dword v15, v230, s[48:51], s4 offen sc1
  v_cvt_pk_bf16_f32 v144, v112, v113
  v_cvt_pk_bf16_f32 v145, v114, v115
  v_exp_f32 v116, v116
  v_exp_f32 v117, v117
  v_exp_f32 v118, v118
  v_exp_f32 v119, v119
  v_mfma_f32_32x32x16_bf16 v[64:79], v[168:171], v[152:155], v[64:79]
  v_cvt_pk_bf16_f32 v146, v116, v117
  v_cvt_pk_bf16_f32 v147, v118, v119
  v_exp_f32 v120, v120
  v_exp_f32 v121, v121
  v_exp_f32 v122, v122
  v_exp_f32 v123, v123
  v_mfma_f32_32x32x16_bf16 v[64:79], v[172:175], v[156:159], v[64:79]
  s_lshr_b32 s4, s2, 3
  s_lshl_b32 s4, s4, 10
  s_lshl_b32 s3, s72, 15
  s_add_u32 s4, s4, s3
  v_and_b32 v230, 7, v0
  v_lshlrev_b32 v230, 7, v230
  v_add_u32 v230, s4, v230
  v_min_u32 v230, L_last-L_pc, v230
  global_load_dword v15, v230, s[26:27]
  v_cvt_pk_bf16_f32 v148, v120, v121
  v_cvt_pk_bf16_f32 v149, v122, v123
  v_exp_f32 v124, v124
  v_exp_f32 v125, v125
  v_exp_f32 v126, v126
  v_exp_f32 v127, v127
  v_cvt_pk_bf16_f32 v150, v124, v125
  v_cvt_pk_bf16_f32 v151, v126, v127
  v_mfma_f32_32x32x16_bf16 v[112:127], v[160:163], v[32:35], 0
  ds_write_b128 v225, v[64:67] offset:0
  v_exp_f32 v128, v128
  v_exp_f32 v129, v129
  v_exp_f32 v130, v130
  v_exp_f32 v131, v131
  v_mfma_f32_32x32x16_bf16 v[112:127], v[164:167], v[36:39], v[112:127]
  ds_write_b128 v225, v[68:71] offset:1024
  s_mov_b32 exec_lo, 0
  buffer_load_dword v15, v235, s[64:67], 0 offen sc1
  s_mov_b64 exec, -1
  v_cvt_pk_bf16_f32 v152, v128, v129
  v_cvt_pk_bf16_f32 v153, v130, v131
  v_exp_f32 v132, v132
  v_exp_f32 v133, v133
  v_exp_f32 v134, v134
  v_exp_f32 v135, v135
  v_mfma_f32_32x32x16_bf16 v[80:95], v[184:187], v[144:147], v[80:95]
  ds_write_b128 v225, v[72:75] offset:2048
  v_cvt_pk_bf16_f32 v154, v132, v133
  v_cvt_pk_bf16_f32 v155, v134, v135
  v_exp_f32 v136, v136
  v_exp_f32 v137, v137
  v_exp_f32 v138, v138
  v_exp_f32 v139, v139
  v_mfma_f32_32x32x16_bf16 v[80:95], v[188:191], v[148:151], v[80:95]
  ds_write_b128 v225, v[76:79] offset:3072
  v_cvt_pk_bf16_f32 v156, v136, v137
  v_cvt_pk_bf16_f32 v157, v138, v139
  v_exp_f32 v140, v140
  v_exp_f32 v141, v141
  v_exp_f32 v142, v142
  v_exp_f32 v143, v143
  v_cvt_pk_bf16_f32 v158, v140, v141
  v_cvt_pk_bf16_f32 v159, v142, v143
  v_mfma_f32_32x32x16_bf16 v[128:143], v[176:179], v[40:43], 0
  v_exp_f32 v112, v112
  v_exp_f32 v113, v113
  v_exp_f32 v114, v114
  v_exp_f32 v115, v115
  v_mfma_f32_32x32x16_bf16 v[128:143], v[180:183], v[44:47], v[128:143]
  v_cvt_pk_bf16_f32 v144, v112, v113
  v_cvt_pk_bf16_f32 v145, v114, v115
  v_exp_f32 v116, v116
  v_exp_f32 v117, v117
  v_exp_f32 v118, v118
  v_exp_f32 v119, v119
  v_mfma_f32_32x32x16_bf16 v[80:95], v[200:203], v[152:155], v[80:95]
  v_cvt_pk_bf16_f32 v146, v116, v117
  v_cvt_pk_bf16_f32 v147, v118, v119
  v_exp_f32 v120, v120
  v_exp_f32 v121, v121
  v_exp_f32 v122, v122
  v_exp_f32 v123, v123
  v_mfma_f32_32x32x16_bf16 v[80:95], v[204:207], v[156:159], v[80:95]
  v_cvt_pk_bf16_f32 v148, v120, v121
  v_cvt_pk_bf16_f32 v149, v122, v123
  v_exp_f32 v124, v124
  v_exp_f32 v125, v125
  v_exp_f32 v126, v126
  v_exp_f32 v127, v127
  v_cvt_pk_bf16_f32 v150, v124, v125
  v_cvt_pk_bf16_f32 v151, v126, v127
  v_mfma_f32_32x32x16_bf16 v[112:127], v[192:195], v[40:43], 0
  v_exp_f32 v128, v128
  v_exp_f32 v129, v129
  v_exp_f32 v130, v130
  v_exp_f32 v131, v131
  v_mfma_f32_32x32x16_bf16 v[112:127], v[196:199], v[44:47], v[112:127]
  v_cvt_pk_bf16_f32 v152, v128, v129
  v_cvt_pk_bf16_f32 v153, v130, v131
  v_exp_f32 v132, v132
  v_exp_f32 v133, v133
  v_exp_f32 v134, v134
  v_exp_f32 v135, v135
  v_mfma_f32_32x32x16_bf16 v[80:95], v[168:171], v[144:147], v[80:95]
  v_cvt_pk_bf16_f32 v154, v132, v133
  v_cvt_pk_bf16_f32 v155, v134, v135
  v_exp_f32 v136, v136
  v_exp_f32 v137, v137
  v_exp_f32 v138, v138
  v_exp_f32 v139, v139
  v_mfma_f32_32x32x16_bf16 v[80:95], v[172:175], v[148:151], v[80:95]
  v_cvt_pk_bf16_f32 v156, v136, v137
  v_cvt_pk_bf16_f32 v157, v138, v139
  v_exp_f32 v140, v140
  v_exp_f32 v141, v141
  v_exp_f32 v142, v142
  v_exp_f32 v143, v143
  v_cvt_pk_bf16_f32 v158, v140, v141
  v_cvt_pk_bf16_f32 v159, v142, v143
  v_mfma_f32_32x32x16_bf16 v[128:143], v[160:163], v[40:43], 0
  s_nop 2
  ds_write_b128 v226, v[80:83] offset:0
  v_exp_f32 v112, v112
  v_exp_f32 v113, v113
  v_exp_f32 v114, v114
  v_exp_f32 v115, v115
  v_mfma_f32_32x32x16_bf16 v[128:143], v[164:167], v[44:47], v[128:143]
  ds_write_b128 v226, v[84:87] offset:1024
  v_cvt_pk_bf16_f32 v144, v112, v113
  v_cvt_pk_bf16_f32 v145, v114, v115
  v_exp_f32 v116, v116
  v_exp_f32 v117, v117
  v_exp_f32 v118, v118
  v_exp_f32 v119, v119
  v_mfma_f32_32x32x16_bf16 v[96:111], v[184:187], v[152:155], v[96:111]
  ds_write_b128 v226, v[88:91] offset:2048
  v_cvt_pk_bf16_f32 v146, v116, v117
  v_cvt_pk_bf16_f32 v147, v118, v119
  v_exp_f32 v120, v120
  v_exp_f32 v121, v121
  v_exp_f32 v122, v122
  v_exp_f32 v123, v123
  v_mfma_f32_32x32x16_bf16 v[96:111], v[188:191], v[156:159], v[96:111]
  ds_write_b128 v226, v[92:95] offset:3072
  v_cvt_pk_bf16_f32 v148, v120, v121
  v_cvt_pk_bf16_f32 v149, v122, v123
  v_exp_f32 v124, v124
  v_exp_f32 v125, v125
  v_exp_f32 v126, v126
  v_exp_f32 v127, v127
  v_cvt_pk_bf16_f32 v150, v124, v125
  v_cvt_pk_bf16_f32 v151, v126, v127
  s_waitcnt lgkmcnt(0)
  s_barrier
  ds_read_b128 v[48:51], v227 offset:0
  ds_read_b128 v[52:55], v227 offset:1024
  ds_read_b128 v[56:59], v227 offset:2048
  v_exp_f32 v128, v128
  v_exp_f32 v129, v129
  v_exp_f32 v130, v130
  v_exp_f32 v131, v131
  ds_read_b128 v[60:63], v227 offset:3072
  ds_read_b128 v[64:67], v227 offset:4096
  ds_read_b128 v[68:71], v227 offset:5120
  v_cvt_pk_bf16_f32 v152, v128, v129
  v_cvt_pk_bf16_f32 v153, v130, v131
  v_exp_f32 v132, v132
  v_exp_f32 v133, v133
  v_exp_f32 v134, v134
  v_exp_f32 v135, v135
  v_mfma_f32_32x32x16_bf16 v[96:111], v[200:203], v[144:147], v[96:111]
  ds_read_b128 v[72:75], v227 offset:6144
  ds_read_b128 v[76:79], v227 offset:7168
  ds_read_b128 v[208:211], v227 offset:8192
  v_cvt_pk_bf16_f32 v154, v132, v133
  v_cvt_pk_bf16_f32 v155, v134, v135
  v_exp_f32 v136, v136
  v_exp_f32 v137, v137
  v_exp_f32 v138, v138
  v_exp_f32 v139, v139
  v_mfma_f32_32x32x16_bf16 v[96:111], v[204:207], v[148:151], v[96:111]
  ds_read_b128 v[212:215], v227 offset:9216
  ds_read_b128 v[216:219], v227 offset:10240
  ds_read_b128 v[220:223], v227 offset:11264
  v_cvt_pk_bf16_f32 v156, v136, v137
  v_cvt_pk_bf16_f32 v157, v138, v139
  v_exp_f32 v140, v140
  v_exp_f32 v141, v141
  v_exp_f32 v142, v142
  v_exp_f32 v143, v143
  v_cvt_pk_bf16_f32 v158, v140, v141
  v_cvt_pk_bf16_f32 v159, v142, v143
  v_mfma_f32_32x32x16_bf16 v[96:111], v[168:171], v[152:155], v[96:111]
  s_nop 0
  v_mfma_f32_32x32x16_bf16 v[96:111], v[172:175], v[156:159], v[96:111]
  s_waitcnt lgkmcnt(7)
  v_add_f32 v48, v48, v64
  v_add_f32 v49, v49, v65
  v_add_f32 v50, v50, v66
  v_add_f32 v51, v51, v67
  s_waitcnt lgkmcnt(6)
  v_add_f32 v52, v52, v68
  v_add_f32 v53, v53, v69
  v_add_f32 v54, v54, v70
  v_add_f32 v55, v55, v71
  s_waitcnt lgkmcnt(5)
  v_add_f32 v56, v56, v72
  v_add_f32 v57, v57, v73
  v_add_f32 v58, v58, v74
  v_add_f32 v59, v59, v75
  s_waitcnt lgkmcnt(4)
  v_add_f32 v60, v60, v76
  v_add_f32 v61, v61, v77
  v_add_f32 v62, v62, v78
  v_add_f32 v63, v63, v79
  s_lshl_b32 s4, s72, 15
  s_lshl_b32 s3, s69, 11
  s_add_u32 s4, s4, s3
  s_add_u32 s4, s4, s73
  s_waitcnt lgkmcnt(3)
  v_pk_add_f32 v[48:49], v[48:49], v[208:209]
  v_pk_add_f32 v[50:51], v[50:51], v[210:211]
  s_waitcnt lgkmcnt(2)
  v_pk_add_f32 v[52:53], v[52:53], v[212:213]
  v_pk_add_f32 v[54:55], v[54:55], v[214:215]
  s_waitcnt lgkmcnt(1)
  v_pk_add_f32 v[56:57], v[56:57], v[216:217]
  v_pk_add_f32 v[58:59], v[58:59], v[218:219]
  s_waitcnt lgkmcnt(0)
  v_pk_add_f32 v[60:61], v[60:61], v[220:221]
  v_pk_add_f32 v[62:63], v[62:63], v[222:223]
  v_pk_add_f32 v[108:109], v[108:109], v[60:61]
  v_pk_add_f32 v[96:97], v[96:97], v[48:49]
  v_pk_add_f32 v[98:99], v[98:99], v[50:51]
  v_pk_add_f32 v[100:101], v[100:101], v[52:53]
  v_pk_add_f32 v[102:103], v[102:103], v[54:55]
  v_pk_add_f32 v[104:105], v[104:105], v[56:57]
  v_pk_add_f32 v[106:107], v[106:107], v[58:59]
  v_pk_add_f32 v[110:111], v[110:111], v[62:63]
  v_mov_b32 v230, v108
  v_mov_b32 v232, v108
  s_nop 1
  v_permlane32_swap_b32 v230, v232
  v_subrev_u32 v230, 0x21800000, v232
  v_cmp_lt_u32 vcc, 0x3c000000, v230
  s_nop 0
  s_cbranch_vccnz L23
L24:
  v_rcp_f32 v232, v232
  v_mov_b32 v230, 0
  v_pk_mul_f32 v[96:97], v[96:97], v[232:233] op_sel_hi:[1,0]
  v_pk_mul_f32 v[98:99], v[98:99], v[232:233] op_sel_hi:[1,0]
  v_pk_mul_f32 v[100:101], v[100:101], v[232:233] op_sel_hi:[1,0]
  v_pk_mul_f32 v[102:103], v[102:103], v[232:233] op_sel_hi:[1,0]
  v_pk_mul_f32 v[104:105], v[104:105], v[232:233] op_sel_hi:[1,0]
  v_pk_mul_f32 v[106:107], v[106:107], v[232:233] op_sel_hi:[1,0]
  v_pk_mul_f32 v[108:109], v[108:109], v[232:233] op_sel_hi:[1,0]
  v_pk_mul_f32 v[110:111], v[110:111], v[232:233] op_sel_hi:[1,0]
  v_cvt_pk_bf16_f32 v144, v96, v97
  v_cvt_pk_bf16_f32 v145, v98, v99
  v_cvt_pk_bf16_f32 v146, v100, v101
  v_cvt_pk_bf16_f32 v147, v102, v103
  v_cvt_pk_bf16_f32 v148, v104, v105
  v_cvt_pk_bf16_f32 v149, v106, v107
  v_cvt_pk_bf16_f32 v150, v108, v109
  v_cvt_pk_bf16_f32 v151, v110, v111
  v_cndmask_b32 v150, v150, v230, s[90:91]
  v_cndmask_b32 v151, v151, v230, s[90:91]
  s_cmp_eq_u32 s74, 0
  s_cbranch_scc1 L25
  buffer_store_dwordx4 v[144:147], v1, s[64:67], s4 offen offset:0
  buffer_store_dwordx4 v[148:151], v1, s[64:67], s4 offen offset:1024
L26:
  v_accvgpr_read_b32 v228, a224
  v_xor_b32 v229, 64, v228
  s_mul_i32 s18, s81, 28672
  v_accvgpr_read_b32 v234, a239
  s_add_u32 s88, s73, 0xc0200
  v_add_u32 v230, s18, v228
  v_add_u32 v231, s18, v229
  v_and_b32 v222, 0xfffffdff, v230
  v_and_b32 v223, 0xfffffdff, v231
  ds_read_b64_tr_b16 v[16:17], v230 offset:0
  ds_read_b64_tr_b16 v[18:19], v230 offset:1024
  ds_read_b64_tr_b16 v[20:21], v231 offset:0
  ds_read_b64_tr_b16 v[22:23], v231 offset:1024
  ds_read_b64_tr_b16 v[24:25], v230 offset:2048
  ds_read_b64_tr_b16 v[26:27], v222 offset:3072
  ds_read_b64_tr_b16 v[28:29], v231 offset:2048
  ds_read_b64_tr_b16 v[30:31], v223 offset:3072
  ds_read_b64_tr_b16 v[32:33], v230 offset:3584
  ds_read_b64_tr_b16 v[34:35], v230 offset:4608
  ds_read_b64_tr_b16 v[36:37], v231 offset:3584
  ds_read_b64_tr_b16 v[38:39], v231 offset:4608
  ds_read_b64_tr_b16 v[40:41], v230 offset:5632
  ds_read_b64_tr_b16 v[42:43], v222 offset:6656
  ds_read_b64_tr_b16 v[44:45], v231 offset:5632
  ds_read_b64_tr_b16 v[46:47], v223 offset:6656
  ds_read_b64_tr_b16 v[48:49], v230 offset:7168
  ds_read_b64_tr_b16 v[50:51], v230 offset:8192
  ds_read_b64_tr_b16 v[52:53], v231 offset:7168
  ds_read_b64_tr_b16 v[54:55], v231 offset:8192
  ds_read_b64_tr_b16 v[56:57], v230 offset:9216
  ds_read_b64_tr_b16 v[58:59], v222 offset:10240
  ds_read_b64_tr_b16 v[60:61], v231 offset:9216
  ds_read_b64_tr_b16 v[62:63], v223 offset:10240
  v_mov_b32 v233, 1
  s_mov_b64 exec, 1
  s_waitcnt vmcnt(0)
  s_barrier
  s_cmp_eq_u32 s74, 0
  s_cbranch_scc1 L29
  buffer_store_dword v233, off, s[64:67], s82 offset:512
L30:
  s_mov_b64 exec, -1
  s_cmp_ge_u32 s0, 14
  s_cbranch_scc1 L27
  buffer_load_dword v235, v234, s[64:67], s88 offen sc1
  s_mov_b32 s95, 131072
  s_lshl_b32 s20, s81, 14
  s_add_u32 s20, s20, s79
  s_mov_b32 s24, s79
  s_add_u32 s24, s24, s84
  s_add_u32 s24, s24, 0x20000
  v_permlane32_swap_b32 v244, v246
  v_permlane32_swap_b32 v245, v247
  v_lshlrev_b32 v240, 16, v244
  v_and_b32 v241, 0xffff0000, v244
  v_lshlrev_b32 v242, 16, v245
  v_and_b32 v243, 0xffff0000, v245
  v_lshlrev_b32 v244, 16, v246
  v_and_b32 v245, 0xffff0000, v246
  v_lshlrev_b32 v246, 16, v247
  v_and_b32 v247, 0xffff0000, v247
  v_permlane32_swap_b32 v252, v254
  v_permlane32_swap_b32 v253, v255
  v_lshlrev_b32 v248, 16, v252
  v_and_b32 v249, 0xffff0000, v252
  v_lshlrev_b32 v250, 16, v253
  v_and_b32 v251, 0xffff0000, v253
  v_lshlrev_b32 v252, 16, v254
  v_and_b32 v253, 0xffff0000, v254
  v_lshlrev_b32 v254, 16, v255
  v_and_b32 v255, 0xffff0000, v255
  v_mov_b32 v220, 0x7f000000
  v_cndmask_b32 v11, v2, v220, s[90:91]
  s_lshl_b32 s25, s71, 8
  s_lshl_b32 s3, s81, 7
  s_add_u32 s25, s25, s3
  s_add_u32 s25, s25, 0x1857000
  ds_read_b64_tr_b16 v[64:65], v230 offset:10752
  ds_read_b64_tr_b16 v[66:67], v230 offset:11776
  ds_read_b64_tr_b16 v[68:69], v231 offset:10752
  ds_read_b64_tr_b16 v[70:71], v231 offset:11776
  ds_read_b64_tr_b16 v[72:73], v230 offset:12800
  ds_read_b64_tr_b16 v[74:75], v222 offset:13824
  ds_read_b64_tr_b16 v[76:77], v231 offset:12800
  ds_read_b64_tr_b16 v[78:79], v223 offset:13824
  ds_read_b64_tr_b16 v[80:81], v230 offset:14336
  ds_read_b64_tr_b16 v[82:83], v230 offset:15360
  buffer_load_dword v13, v234, s[64:67], s88 offen sc1
L31:
  s_waitcnt vmcnt(1)
  v_cmp_eq_u32 vcc, 0, v235
  s_nop 0
  s_cbranch_vccz L32
  buffer_load_dword v235, v234, s[64:67], s88 offen sc1
  s_waitcnt vmcnt(1)
  v_cmp_eq_u32 vcc, 0, v13
  s_nop 0
  s_cbranch_vccz L32
  buffer_load_dword v13, v234, s[64:67], s88 offen sc1
  s_sub_u32 s95, s95, 1
  s_cbranch_scc0 L31
  s_branch L_abort
L32:
  s_add_u32 s23, s20, 0
  buffer_load_dwordx4 v[144:147], v1, s[64:67], s23 offen offset:0 sc1
  buffer_load_dwordx4 v[148:151], v1, s[64:67], s23 offen offset:1024 sc1
  buffer_load_dwordx4 v[152:155], v1, s[64:67], s23 offen offset:2048 sc1
  buffer_load_dwordx4 v[156:159], v1, s[64:67], s23 offen offset:3072 sc1
  s_add_u32 s23, s20, 4096
  buffer_load_dwordx4 v[160:163], v1, s[64:67], s23 offen offset:0 sc1
  buffer_load_dwordx4 v[164:167], v1, s[64:67], s23 offen offset:1024 sc1
  buffer_load_dwordx4 v[168:171], v1, s[64:67], s23 offen offset:2048 sc1
  ds_read_b64_tr_b16 v[84:85], v231 offset:14336
  ds_read_b64_tr_b16 v[86:87], v231 offset:15360
  ds_read_b64_tr_b16 v[88:89], v230 offset:16384
  ds_read_b64_tr_b16 v[90:91], v222 offset:17408
  ds_read_b64_tr_b16 v[92:93], v231 offset:16384
  ds_read_b64_tr_b16 v[94:95], v223 offset:17408
  ds_read_b64_tr_b16 v[96:97], v230 offset:17920
  ds_read_b64_tr_b16 v[98:99], v230 offset:18944
  ds_read_b64_tr_b16 v[100:101], v231 offset:17920
  ds_read_b64_tr_b16 v[102:103], v231 offset:18944
  ds_read_b64_tr_b16 v[104:105], v230 offset:19968
  ds_read_b64_tr_b16 v[106:107], v222 offset:20992
  ds_read_b64_tr_b16 v[108:109], v231 offset:19968
  ds_read_b64_tr_b16 v[110:111], v223 offset:20992
  ds_read_b64_tr_b16 v[112:113], v230 offset:21504
  ds_read_b64_tr_b16 v[114:115], v230 offset:22528
  ds_read_b64_tr_b16 v[116:117], v231 offset:21504
  ds_read_b64_tr_b16 v[118:119], v231 offset:22528
  ds_read_b64_tr_b16 v[120:121], v230 offset:23552
  ds_read_b64_tr_b16 v[122:123], v222 offset:24576
  s_waitcnt vmcnt(6) lgkmcnt(15)
  v_mfma_f32_32x32x16_bf16 v[192:207], v[20:23], v[144:147], 0
  buffer_load_dwordx4 v[172:175], v1, s[64:67], s23 offen offset:3072 sc1
  ds_read_b64_tr_b16 v[124:125], v231 offset:23552
  v_mfma_f32_32x32x16_bf16 v[240:255], v[16:19], v[144:147], v[240:255]
  ds_read_b64_tr_b16 v[126:127], v223 offset:24576
  s_waitcnt vmcnt(6)
  v_mfma_f32_32x32x16_bf16 v[192:207], v[28:31], v[148:151], v[192:207]
  s_add_u32 s23, s20, 8192
  buffer_load_dwordx4 v[144:147], v1, s[64:67], s23 offen offset:0 sc1
  v_mfma_f32_32x32x16_bf16 v[240:255], v[24:27], v[148:151], v[240:255]
  ds_read_b64_tr_b16 v[128:129], v230 offset:25088
  s_waitcnt vmcnt(6)
  v_mfma_f32_32x32x16_bf16 v[192:207], v[36:39], v[152:155], v[192:207]
  buffer_load_dwordx4 v[148:151], v1, s[64:67], s23 offen offset:1024 sc1
  ds_read_b64_tr_b16 v[130:131], v230 offset:26112
  v_mfma_f32_32x32x16_bf16 v[240:255], v[32:35], v[152:155], v[240:255]
  s_waitcnt vmcnt(6)
  v_mfma_f32_32x32x16_bf16 v[192:207], v[44:47], v[156:159], v[192:207]
  buffer_load_dwordx4 v[152:155], v1, s[64:67], s23 offen offset:2048 sc1
  ds_read_b64_tr_b16 v[132:133], v231 offset:25088
  v_mfma_f32_32x32x16_bf16 v[240:255], v[40:43], v[156:159], v[240:255]
  s_waitcnt vmcnt(6)
  v_mfma_f32_32x32x16_bf16 v[192:207], v[52:55], v[160:163], v[192:207]
  buffer_load_dwordx4 v[156:159], v1, s[64:67], s23 offen offset:3072 sc1
  ds_read_b64_tr_b16 v[134:135], v231 offset:26112
  v_mfma_f32_32x32x16_bf16 v[240:255], v[48:51], v[160:163], v[240:255]
  ds_read_b64_tr_b16 v[136:137], v230 offset:27136
  s_waitcnt vmcnt(6)
  v_mfma_f32_32x32x16_bf16 v[192:207], v[60:63], v[164:167], v[192:207]
  s_add_u32 s23, s20, 12288
  buffer_load_dwordx4 v[160:163], v1, s[64:67], s23 offen offset:0 sc1
  v_mfma_f32_32x32x16_bf16 v[240:255], v[56:59], v[164:167], v[240:255]
  ds_read_b64_tr_b16 v[138:139], v222 offset:28160
  s_waitcnt vmcnt(6)
  v_mfma_f32_32x32x16_bf16 v[192:207], v[68:71], v[168:171], v[192:207]
  buffer_load_dwordx4 v[164:167], v1, s[64:67], s23 offen offset:1024 sc1
  ds_read_b64_tr_b16 v[140:141], v231 offset:27136
  v_mfma_f32_32x32x16_bf16 v[240:255], v[64:67], v[168:171], v[240:255]
  s_waitcnt vmcnt(6)
  v_mfma_f32_32x32x16_bf16 v[192:207], v[76:79], v[172:175], v[192:207]
  buffer_load_dwordx4 v[168:171], v1, s[64:67], s23 offen offset:2048 sc1
  ds_read_b64_tr_b16 v[142:143], v223 offset:28160
  v_mfma_f32_32x32x16_bf16 v[240:255], v[72:75], v[172:175], v[240:255]
  s_waitcnt vmcnt(6)
  v_mfma_f32_32x32x16_bf16 v[192:207], v[84:87], v[144:147], v[192:207]
  buffer_load_dwordx4 v[172:175], v1, s[64:67], s23 offen offset:3072 sc1
  v_mfma_f32_32x32x16_bf16 v[240:255], v[80:83], v[144:147], v[240:255]
  s_waitcnt lgkmcnt(0)
  s_barrier
  s_waitcnt vmcnt(6)
  v_mfma_f32_32x32x16_bf16 v[192:207], v[92:95], v[148:151], v[192:207]
  s_and_b32 s101, s68, 1
  s_mul_i32 s100, s101, 50176
  s_add_u32 s100, s100, s78
  s_mul_i32 s101, s101, 7168
  s_add_u32 s101, s101, s76
  s_add_u32 m0, s101, 0
  s_add_u32 s22, s100, 0
  buffer_load_dwordx4 v236, s[44:47], s22 offen offset:0  lds
  v_mfma_f32_32x32x16_bf16 v[240:255], v[88:91], v[148:151], v[240:255]
  s_waitcnt vmcnt(6)
  v_mfma_f32_32x32x16_bf16 v[192:207], v[100:103], v[152:155], v[192:207]
  buffer_load_dwordx4 v237, s[44:47], s22 offen offset:1024  lds
  s_waitcnt vmcnt(6)
  v_mfma_f32_32x32x16_bf16 v[192:207], v[108:111], v[156:159], v[192:207]
  buffer_load_dwordx4 v238, s[44:47], s22 offen offset:2048  lds
  s_waitcnt vmcnt(6)
  v_mfma_f32_32x32x16_bf16 v[192:207], v[116:119], v[160:163], v[192:207]
  buffer_load_dwordx4 v239, s[44:47], s22 offen offset:3072  lds
  s_add_u32 m0, s101, 4096
  s_add_u32 s22, s100, 28672
  buffer_load_dwordx4 v236, s[44:47], s22 offen offset:0  lds
  s_waitcnt vmcnt(7)
  v_mfma_f32_32x32x16_bf16 v[192:207], v[124:127], v[164:167], v[192:207]
  buffer_load_dwordx4 v237, s[44:47], s22 offen offset:1024  lds
  s_waitcnt vmcnt(7)
  v_mfma_f32_32x32x16_bf16 v[192:207], v[132:135], v[168:171], v[192:207]
  buffer_load_dwordx4 v238, s[44:47], s22 offen offset:2048  lds
  s_waitcnt vmcnt(7)
  v_mfma_f32_32x32x16_bf16 v[192:207], v[140:143], v[172:175], v[192:207]
  buffer_load_dword v208, v11, s[64:67], s25 offen sc1
  v_mfma_f32_32x32x16_bf16 v[240:255], v[96:99], v[152:155], v[240:255]
  v_mfma_f32_32x32x16_bf16 v[240:255], v[104:107], v[156:159], v[240:255]
  s_nop 8
  ds_write_b128 v224, v[192:195] offset:0
  v_mfma_f32_32x32x16_bf16 v[240:255], v[112:115], v[160:163], v[240:255]
  ds_write_b128 v224, v[196:199] offset:1024
  v_mfma_f32_32x32x16_bf16 v[240:255], v[120:123], v[164:167], v[240:255]
  ds_write_b128 v224, v[200:203] offset:2048
  v_mfma_f32_32x32x16_bf16 v[240:255], v[128:131], v[168:171], v[240:255]
  ds_write_b128 v224, v[204:207] offset:3072
  v_mfma_f32_32x32x16_bf16 v[240:255], v[136:139], v[172:175], v[240:255]
  s_waitcnt lgkmcnt(0)
  s_barrier
  ds_read_b128 v[144:147], v227 offset:0
  ds_read_b128 v[148:151], v227 offset:1024
  ds_read_b128 v[152:155], v227 offset:2048
  ds_read_b128 v[156:159], v227 offset:3072
  s_waitcnt lgkmcnt(3)
  s_nop 4
  v_pk_add_f32 v[240:241], v[240:241], v[144:145]
  v_pk_add_f32 v[242:243], v[242:243], v[146:147]
  s_waitcnt lgkmcnt(2)
  v_pk_add_f32 v[244:245], v[244:245], v[148:149]
  v_pk_add_f32 v[246:247], v[246:247], v[150:151]
  s_waitcnt lgkmcnt(1)
  v_pk_add_f32 v[248:249], v[248:249], v[152:153]
  v_pk_add_f32 v[250:251], v[250:251], v[154:155]
  s_waitcnt lgkmcnt(0)
  v_pk_add_f32 v[252:253], v[252:253], v[156:157]
  v_pk_add_f32 v[254:255], v[254:255], v[158:159]
  v_cvt_pk_bf16_f32 v192, v240, v241
  v_cvt_pk_bf16_f32 v193, v242, v243
  v_cvt_pk_bf16_f32 v194, v244, v245
  v_cvt_pk_bf16_f32 v195, v246, v247
  v_cvt_pk_bf16_f32 v196, v248, v249
  v_cvt_pk_bf16_f32 v197, v250, v251
  v_cvt_pk_bf16_f32 v198, v252, v253
  v_cvt_pk_bf16_f32 v199, v254, v255
  s_cmp_eq_u32 s74, 0
  s_cbranch_scc1 L33
  buffer_store_dwordx4 v[192:195], v1, s[64:67], s24 offen offset:0
  buffer_store_dwordx4 v[196:199], v1, s[64:67], s24 offen offset:1024
L34:
  s_mul_i32 s18, s81, 28672
  s_add_u32 s18, s18, 0xe000
  v_accvgpr_read_b32 v234, a236
  s_add_u32 s88, s73, 0xc0300
  s_and_b32 s101, s68, 1
  s_xor_b32 s101, s101, 1
  s_mul_i32 s100, s101, 50176
  s_add_u32 s100, s100, s78
  s_mul_i32 s101, s101, 7168
  s_add_u32 s101, s101, s76
  v_pk_add_f32 v[144:145], v[240:241], v[242:243]
  v_pk_mul_f32 v[146:147], v[240:241], v[240:241]
  v_pk_fma_f32 v[146:147], v[242:243], v[242:243], v[146:147]
  v_pk_add_f32 v[144:145], v[144:145], v[244:245]
  s_add_u32 m0, s101, 0
  s_add_u32 s22, s100, 0
  buffer_load_dwordx4 v236, s[44:47], s22 offen offset:0  lds
  v_pk_fma_f32 v[146:147], v[244:245], v[244:245], v[146:147]
  v_pk_add_f32 v[144:145], v[144:145], v[246:247]
  v_pk_fma_f32 v[146:147], v[246:247], v[246:247], v[146:147]
  v_pk_add_f32 v[144:145], v[144:145], v[248:249]
  buffer_load_dwordx4 v237, s[44:47], s22 offen offset:1024  lds
  v_pk_fma_f32 v[146:147], v[248:249], v[248:249], v[146:147]
  v_pk_add_f32 v[144:145], v[144:145], v[250:251]
  v_pk_fma_f32 v[146:147], v[250:251], v[250:251], v[146:147]
  v_pk_add_f32 v[144:145], v[144:145], v[252:253]
  buffer_load_dwordx4 v238, s[44:47], s22 offen offset:2048  lds
  v_pk_fma_f32 v[146:147], v[252:253], v[252:253], v[146:147]
  v_pk_add_f32 v[144:145], v[144:145], v[254:255]
  v_pk_fma_f32 v[146:147], v[254:255], v[254:255], v[146:147]
  v_add_f32 v144, v144, v145
  buffer_load_dwordx4 v239, s[44:47], s22 offen offset:3072  lds
  v_add_f32 v146, v146, v147
  v_add_u32 v145, s83, v2
  s_nop 0
  v_permlane32_swap_b32 v144, v146
  v_add_f32 v232, v144, v146
  s_add_u32 m0, s101, 4096
  s_add_u32 s22, s100, 28672
  buffer_load_dwordx4 v236, s[44:47], s22 offen offset:0  lds
  ds_write_b32 v145, v232
  v_add_u32 v230, s18, v228
  v_add_u32 v231, s18, v229
  ds_read_b64_tr_b16 v[16:17], v230 offset:0
  buffer_load_dwordx4 v237, s[44:47], s22 offen offset:1024  lds
  ds_read_b64_tr_b16 v[18:19], v230 offset:1024
  ds_read_b64_tr_b16 v[20:21], v231 offset:0
  ds_read_b64_tr_b16 v[22:23], v231 offset:1024
  ds_read_b64_tr_b16 v[24:25], v230 offset:2048
  buffer_load_dwordx4 v238, s[44:47], s22 offen offset:2048  lds
  ds_read_b64_tr_b16 v[26:27], v230 offset:3072
  ds_read_b64_tr_b16 v[28:29], v231 offset:2048
  ds_read_b64_tr_b16 v[30:31], v231 offset:3072
  v_mov_b32 v233, 1
  s_lshl_b32 s89, s70, 12
  s_lshl_b32 s3, s80, 11
  s_add_u32 s89, s89, s3
  s_lshl_b32 s3, s71, 8
  s_add_u32 s89, s89, s3
  s_add_u32 s89, s89, s73
  s_add_u32 s89, s89, 0xb0000
  s_cmp_eq_u32 s81, 1
  s_cselect_b32 s89, s89, 0x7f000000
  s_sub_u32 s4, s83, 12288
  v_add_u32 v14, s4, v2
  s_waitcnt lgkmcnt(8)
  s_mov_b64 exec, 1
  s_waitcnt vmcnt(7)
  s_barrier
  s_cmp_eq_u32 s74, 0
  s_cbranch_scc1 L35
  buffer_store_dword v233, off, s[64:67], s82 offset:768
L36:
  s_mov_b64 exec, -1
  ds_read_b32 v14, v14
  buffer_load_dword v235, v234, s[64:67], s88 offen sc1
  s_mov_b32 s95, 131072
  s_waitcnt lgkmcnt(0)
  v_add_f32 v14, v14, v232
  s_cmp_eq_u32 s74, 0
  s_cbranch_scc1 L39
  buffer_store_dword v14, v2, s[64:67], s89 offen
L40:
  s_mul_i32 s20, s81, 14336
  s_add_u32 s20, s20, s79
  s_add_u32 s20, s20, 0x20000
  s_lshl_b32 s14, s70, 12
  s_lshl_b32 s3, s80, 11
  s_add_u32 s14, s14, s3
  s_add_u32 s14, s14, s73
  s_add_u32 s14, s14, 0xb0000
  s_lshl_b32 s16, s0, 7
  s_mul_i32 s3, s72, 401408
  s_add_u32 s16, s16, s3
  s_lshl_b32 s24, s70, 16
  s_add_u32 s24, s24, s73
  s_add_u32 s24, s24, s84
  s_mov_b32 s15, 0
  v_accvgpr_read_b32 v236, a226
  v_accvgpr_read_b32 v216, a230
  v_accvgpr_read_b32 v237, a227
  v_accvgpr_read_b32 v217, a231
  v_accvgpr_read_b32 v238, a228
  v_accvgpr_read_b32 v218, a232
  v_accvgpr_read_b32 v239, a229
  v_accvgpr_read_b32 v219, a233
  v_cmp_eq_u32 vcc, -1, v208
  s_nop 0
  s_cbranch_vccnz L41
L42:
  v_cvt_pk_bf16_f32 v215, v208, 0
  v_lshlrev_b32 v213, 16, v215
  v_sub_f32 v213, v208, v213
  v_cvt_pk_bf16_f32 v214, v208, v213
  v_accvgpr_write_b32 a240, v214
  v_accvgpr_write_b32 a241, v215
  v_accvgpr_write_b32 a242, 0
  v_accvgpr_write_b32 a243, 0
  s_lshl_b32 s25, s0, 8
  s_add_u32 s25, s25, 0x1847000
  s_add_u32 s9, s25, 0x8000
  ds_read_b64_tr_b16 v[32:33], v230 offset:4096
  ds_read_b64_tr_b16 v[34:35], v230 offset:5120
  ds_read_b64_tr_b16 v[36:37], v231 offset:4096
  ds_read_b64_tr_b16 v[38:39], v231 offset:5120
  ds_read_b64_tr_b16 v[40:41], v230 offset:6144
  ds_read_b64_tr_b16 v[42:43], v230 offset:7168
  ds_read_b64_tr_b16 v[44:45], v231 offset:6144
  buffer_load_dword v13, v234, s[64:67], s88 offen sc1
  ds_read_b64_tr_b16 v[46:47], v231 offset:7168
  ds_read_b64_tr_b16 v[48:49], v230 offset:8192
  ds_read_b64_tr_b16 v[50:51], v230 offset:9216
L37:
  s_waitcnt vmcnt(1)
  v_cmp_eq_u32 vcc, 0, v235
  s_nop 0
  s_cbranch_vccz L38
  buffer_load_dword v235, v234, s[64:67], s88 offen sc1
  s_waitcnt vmcnt(1)
  v_cmp_eq_u32 vcc, 0, v13
  s_nop 0
  s_cbranch_vccz L38
  buffer_load_dword v13, v234, s[64:67], s88 offen sc1
  s_sub_u32 s95, s95, 1
  s_cbranch_scc0 L37
  s_branch L_abort
L38:
  s_add_u32 s23, s20, 0
  buffer_load_dwordx4 v[144:147], v1, s[64:67], s23 offen offset:0 sc1
  buffer_load_dwordx4 v[148:151], v1, s[64:67], s23 offen offset:1024 sc1
  buffer_load_dwordx4 v[152:155], v1, s[64:67], s23 offen offset:2048 sc1
  buffer_load_dwordx4 v[156:159], v1, s[64:67], s23 offen offset:3072 sc1
  s_add_u32 s23, s20, 4096
  buffer_load_dwordx4 v[160:163], v1, s[64:67], s23 offen offset:0 sc1
  buffer_load_dwordx4 v[164:167], v1, s[64:67], s23 offen offset:1024 sc1
  buffer_load_dwordx4 v[168:171], v1, s[64:67], s23 offen offset:2048 sc1
  ds_read_b64_tr_b16 v[52:53], v231 offset:8192
  ds_read_b64_tr_b16 v[54:55], v231 offset:9216
  ds_read_b64_tr_b16 v[56:57], v230 offset:10240
  ds_read_b64_tr_b16 v[58:59], v230 offset:11264
  ds_read_b64_tr_b16 v[60:61], v231 offset:10240
  ds_read_b64_tr_b16 v[62:63], v231 offset:11264
  ds_read_b64_tr_b16 v[64:65], v230 offset:12288
  ds_read_b64_tr_b16 v[66:67], v230 offset:13312
  ds_read_b64_tr_b16 v[68:69], v231 offset:12288
  ds_read_b64_tr_b16 v[70:71], v231 offset:13312
  ds_read_b64_tr_b16 v[72:73], v230 offset:14336
  ds_read_b64_tr_b16 v[74:75], v230 offset:15360
  ds_read_b64_tr_b16 v[76:77], v231 offset:14336
  ds_read_b64_tr_b16 v[78:79], v231 offset:15360
  ds_read_b64_tr_b16 v[80:81], v230 offset:16384
  ds_read_b64_tr_b16 v[82:83], v230 offset:17408
  ds_read_b64_tr_b16 v[84:85], v231 offset:16384
  ds_read_b64_tr_b16 v[86:87], v231 offset:17408
  ds_read_b64_tr_b16 v[88:89], v230 offset:18432
  ds_read_b64_tr_b16 v[90:91], v230 offset:19456
  s_waitcnt vmcnt(6)
  v_mfma_f32_32x32x16_bf16 v[192:207], v[20:23], v[144:147], 0
  buffer_load_dwordx4 v[172:175], v1, s[64:67], s23 offen offset:3072 sc1
  ds_read_b64_tr_b16 v[92:93], v231 offset:18432
  ds_read_b64_tr_b16 v[94:95], v231 offset:19456
  v_mfma_f32_32x32x16_bf16 v[176:191], v[16:19], v[144:147], 0
  ds_read_b64_tr_b16 v[96:97], v230 offset:20480
  s_waitcnt vmcnt(6)
  v_mfma_f32_32x32x16_bf16 v[192:207], v[28:31], v[148:151], v[192:207]
  s_add_u32 s23, s20, 8192
  buffer_load_dwordx4 v[144:147], v1, s[64:67], s23 offen offset:0 sc1
  ds_read_b64_tr_b16 v[98:99], v230 offset:21504
  ds_read_b64_tr_b16 v[100:101], v231 offset:20480
  v_mfma_f32_32x32x16_bf16 v[176:191], v[24:27], v[148:151], v[176:191]
  ds_read_b64_tr_b16 v[102:103], v231 offset:21504
  s_waitcnt vmcnt(6) lgkmcnt(15)
  v_mfma_f32_32x32x16_bf16 v[192:207], v[36:39], v[152:155], v[192:207]
  buffer_load_dwordx4 v[148:151], v1, s[64:67], s23 offen offset:1024 sc1
  ds_read_b64_tr_b16 v[104:105], v230 offset:22528
  ds_read_b64_tr_b16 v[106:107], v230 offset:23552
  v_mfma_f32_32x32x16_bf16 v[176:191], v[32:35], v[152:155], v[176:191]
  ds_read_b64_tr_b16 v[108:109], v231 offset:22528
  s_waitcnt vmcnt(6)
  v_mfma_f32_32x32x16_bf16 v[192:207], v[44:47], v[156:159], v[192:207]
  buffer_load_dwordx4 v[152:155], v1, s[64:67], s23 offen offset:2048 sc1
  ds_read_b64_tr_b16 v[110:111], v231 offset:23552
  ds_read_b64_tr_b16 v[112:113], v230 offset:24576
  v_mfma_f32_32x32x16_bf16 v[176:191], v[40:43], v[156:159], v[176:191]
  ds_read_b64_tr_b16 v[114:115], v230 offset:25600
  s_waitcnt vmcnt(6)
  v_mfma_f32_32x32x16_bf16 v[192:207], v[52:55], v[160:163], v[192:207]
  buffer_load_dwordx4 v[156:159], v1, s[64:67], s23 offen offset:3072 sc1
  ds_read_b64_tr_b16 v[116:117], v231 offset:24576
  ds_read_b64_tr_b16 v[118:119], v231 offset:25600
  v_mfma_f32_32x32x16_bf16 v[176:191], v[48:51], v[160:163], v[176:191]
  ds_read_b64_tr_b16 v[120:121], v230 offset:26624
  s_waitcnt vmcnt(6)
  v_mfma_f32_32x32x16_bf16 v[192:207], v[60:63], v[164:167], v[192:207]
  s_add_u32 s23, s20, 12288
  buffer_load_dwordx4 v[160:163], v1, s[64:67], s23 offen offset:0 sc1
  ds_read_b64_tr_b16 v[122:123], v230 offset:27648
  ds_read_b64_tr_b16 v[124:125], v231 offset:26624
  v_mfma_f32_32x32x16_bf16 v[176:191], v[56:59], v[164:167], v[176:191]
  ds_read_b64_tr_b16 v[126:127], v231 offset:27648
  s_waitcnt vmcnt(6)
  v_mfma_f32_32x32x16_bf16 v[192:207], v[68:71], v[168:171], v[192:207]
  buffer_load_dwordx4 v[164:167], v1, s[64:67], s23 offen offset:1024 sc1
  buffer_load_dword v208, v2, s[64:67], s14 offen offset:0 sc1
  buffer_load_dword v209, v2, s[64:67], s14 offen offset:256 sc1
  buffer_load_dword v210, v2, s[64:67], s14 offen offset:512 sc1
  buffer_load_dword v211, v2, s[64:67], s14 offen offset:768 sc1
  v_mfma_f32_32x32x16_bf16 v[176:191], v[64:67], v[168:171], v[176:191]
  buffer_load_dword v212, v2, s[64:67], s14 offen offset:1024 sc1
  buffer_load_dword v213, v2, s[64:67], s14 offen offset:1280 sc1
  buffer_load_dword v214, v2, s[64:67], s14 offen offset:1536 sc1
  s_waitcnt lgkmcnt(0)
  s_barrier
  s_waitcnt vmcnt(13)
  v_mfma_f32_32x32x16_bf16 v[192:207], v[76:79], v[172:175], v[192:207]
  s_and_b32 s101, s68, 1
  s_mul_i32 s100, s101, 200704
  s_add_u32 s100, s100, s16
  s_mul_i32 s101, s101, 7168
  s_add_u32 s101, s101, s77
  s_add_u32 m0, s101, 0
  s_add_u32 s22, s100, 0
  buffer_load_dwordx4 v236, s[48:51], s22 offen offset:0  lds
  v_mfma_f32_32x32x16_bf16 v[176:191], v[72:75], v[172:175], v[176:191]
  s_waitcnt vmcnt(13)
  v_mfma_f32_32x32x16_bf16 v[192:207], v[84:87], v[144:147], v[192:207]
  buffer_load_dwordx4 v237, s[48:51], s22 offen offset:1024  lds
  buffer_load_dwordx4 v238, s[48:51], s22 offen offset:2048  lds
  v_mfma_f32_32x32x16_bf16 v[176:191], v[80:83], v[144:147], v[176:191]
  s_waitcnt vmcnt(14)
  v_mfma_f32_32x32x16_bf16 v[192:207], v[92:95], v[148:151], v[192:207]
  buffer_load_dwordx4 v239, s[48:51], s22 offen offset:3072  lds
  s_add_u32 m0, s101, 4096
  s_add_u32 s22, s100, 114688
  buffer_load_dwordx4 v236, s[48:51], s22 offen offset:0  lds
  v_mfma_f32_32x32x16_bf16 v[176:191], v[88:91], v[148:151], v[176:191]
  s_waitcnt vmcnt(15)
  v_mfma_f32_32x32x16_bf16 v[192:207], v[100:103], v[152:155], v[192:207]
  buffer_load_dwordx4 v237, s[48:51], s22 offen offset:1024  lds
  v_mfma_f32_32x32x16_bf16 v[176:191], v[96:99], v[152:155], v[176:191]
  s_waitcnt vmcnt(15)
  v_mfma_f32_32x32x16_bf16 v[192:207], v[108:111], v[156:159], v[192:207]
  buffer_load_dwordx4 v238, s[48:51], s22 offen offset:2048  lds
  buffer_load_dword v220, v11, s[64:67], s25 offen offset:0 sc1
  v_mfma_f32_32x32x16_bf16 v[176:191], v[104:107], v[156:159], v[176:191]
  s_waitcnt vmcnt(16)
  v_mfma_f32_32x32x16_bf16 v[192:207], v[116:119], v[160:163], v[192:207]
  buffer_load_dword v221, v11, s[64:67], s25 offen offset:128 sc1
  buffer_load_dword v222, v11, s[64:67], s9 offen offset:0 sc1
  s_waitcnt vmcnt(17)
  v_mfma_f32_32x32x16_bf16 v[192:207], v[124:127], v[164:167], v[192:207]
  buffer_load_dword v223, v11, s[64:67], s9 offen offset:128 sc1
  v_mfma_f32_32x32x16_bf16 v[176:191], v[112:115], v[160:163], v[176:191]
  s_waitcnt vmcnt(15)
  v_max3_u32 v141, v208, v209, v210
  s_waitcnt vmcnt(12)
  v_max3_u32 v140, v211, v212, v213
  s_waitcnt vmcnt(11)
  v_max3_u32 v141, v141, v140, v214
  v_cmp_eq_u32 vcc, -1, v141
  s_nop 0
  s_cbranch_vccnz L43
L44:
  v_add_f32 v140, v208, v209
  v_add_f32 v141, v210, v211
  v_add_f32 v140, v140, v212
  v_add_f32 v141, v141, v213
  ds_write_b128 v224, v[192:195] offset:0
  v_add_f32 v140, v140, v214
  v_add_f32 v140, v140, v141
  v_mov_b32 v141, v140
  s_nop 1
  v_permlane32_swap_b32 v140, v141
  v_mul_f32 v10, 0x3b124925, v140
  v_mul_f32 v141, 0x3b124925, v141
  v_fma_f32 v140, -v10, v10, v141
  ds_write_b128 v224, v[196:199] offset:1024
  v_mfma_f32_32x32x16_bf16 v[176:191], v[120:123], v[164:167], v[176:191]
  v_max_f32 v140, 0, v140
  v_add_f32 v141, 0x3727c5ac, v140
  v_rsq_f32 v12, v141
  v_cvt_pk_bf16_f32 v130, -v10, -v10
  v_mov_b32 v128, 0
  v_mov_b32 v129, 0
  v_lshlrev_b32 v142, 16, v130
  v_mov_b32 v132, 0
  ds_write_b128 v224, v[200:203] offset:2048
  v_add_f32 v142, v10, v142
  v_mov_b32 v133, 0
  v_cvt_pk_bf16_f32 v131, -v142, 0
  v_mul_f32 v140, v140, v12
  v_mul_f32 v140, v140, v12
  v_mfma_f32_32x32x16_bf16 v[176:191], a[240:243], v[130:133], v[176:191]
  v_add_f32 v140, 0x3727c5ac, v140
  ds_write_b128 v224, v[204:207] offset:3072
  v_rsq_f32 v140, v140
  s_nop 0
  v_mul_f32 v140, v140, v12
  v_rcp_f32 v138, v140
  v_mul_f32 v134, 0xc0135761, v140
  v_mul_f32 v136, v140, v140
  v_mul_f32 v136, v136, v134
  v_mul_f32 v136, 0x3d372713, v136
  s_waitcnt lgkmcnt(0)
  s_barrier
  ds_read_b128 v[144:147], v227 offset:0
  ds_read_b128 v[148:151], v227 offset:1024
  ds_read_b128 v[152:155], v227 offset:2048
  ds_read_b128 v[156:159], v227 offset:3072
  s_waitcnt lgkmcnt(3)
  v_pk_add_f32 v[176:177], v[176:177], v[144:145]
  v_pk_add_f32 v[178:179], v[178:179], v[146:147]
  s_waitcnt lgkmcnt(2)
  v_pk_add_f32 v[180:181], v[180:181], v[148:149]
  v_pk_add_f32 v[182:183], v[182:183], v[150:151]
  s_waitcnt lgkmcnt(1)
  v_pk_add_f32 v[184:185], v[184:185], v[152:153]
  v_pk_add_f32 v[186:187], v[186:187], v[154:155]
  s_waitcnt lgkmcnt(0)
  v_pk_add_f32 v[188:189], v[188:189], v[156:157]
  v_pk_add_f32 v[190:191], v[190:191], v[158:159]
  v_pk_mul_f32 v[144:145], v[176:177], v[176:177]
  v_pk_mul_f32 v[146:147], v[178:179], v[178:179]
  v_pk_mul_f32 v[148:149], v[180:181], v[180:181]
  v_pk_mul_f32 v[150:151], v[182:183], v[182:183]
  v_pk_fma_f32 v[144:145], v[144:145], v[136:137], v[134:135] op_sel_hi:[1,0,0]
  v_pk_fma_f32 v[146:147], v[146:147], v[136:137], v[134:135] op_sel_hi:[1,0,0]
  v_pk_fma_f32 v[148:149], v[148:149], v[136:137], v[134:135] op_sel_hi:[1,0,0]
  v_pk_fma_f32 v[150:151], v[150:151], v[136:137], v[134:135] op_sel_hi:[1,0,0]
  v_pk_mul_f32 v[144:145], v[144:145], v[176:177]
  v_pk_mul_f32 v[146:147], v[146:147], v[178:179]
  v_pk_mul_f32 v[148:149], v[148:149], v[180:181]
  v_pk_mul_f32 v[150:151], v[150:151], v[182:183]
  v_exp_f32 v144, v144
  v_exp_f32 v145, v145
  v_exp_f32 v146, v146
  v_exp_f32 v147, v147
  v_exp_f32 v148, v148
  v_exp_f32 v149, v149
  v_exp_f32 v150, v150
  v_exp_f32 v151, v151
  v_pk_fma_f32 v[144:145], v[144:145], v[138:139], v[138:139] op_sel_hi:[1,0,0]
  v_pk_fma_f32 v[146:147], v[146:147], v[138:139], v[138:139] op_sel_hi:[1,0,0]
  v_pk_fma_f32 v[148:149], v[148:149], v[138:139], v[138:139] op_sel_hi:[1,0,0]
  v_pk_fma_f32 v[150:151], v[150:151], v[138:139], v[138:139] op_sel_hi:[1,0,0]
  v_rcp_f32 v144, v144
  v_rcp_f32 v145, v145
  v_rcp_f32 v146, v146
  v_rcp_f32 v147, v147
  v_rcp_f32 v148, v148
  v_rcp_f32 v149, v149
  v_rcp_f32 v150, v150
  v_rcp_f32 v151, v151
  v_pk_mul_f32 v[144:145], v[176:177], v[144:145]
  v_pk_mul_f32 v[146:147], v[178:179], v[146:147]
  v_pk_mul_f32 v[148:149], v[180:181], v[148:149]
  v_pk_mul_f32 v[150:151], v[182:183], v[150:151]
  v_cvt_pk_bf16_f32 v192, v144, v145
  v_cvt_pk_bf16_f32 v193, v146, v147
  v_cvt_pk_bf16_f32 v194, v148, v149
  v_cvt_pk_bf16_f32 v195, v150, v151
  s_cmp_eq_u32 s74, 0
  s_cbranch_scc1 L45
  buffer_store_dwordx4 v[192:195], v216, s[64:67], s24 offen offset:0
L46:
  v_pk_mul_f32 v[144:145], v[184:185], v[184:185]
  v_pk_mul_f32 v[146:147], v[186:187], v[186:187]
  v_pk_mul_f32 v[148:149], v[188:189], v[188:189]
  v_pk_mul_f32 v[150:151], v[190:191], v[190:191]
  v_pk_fma_f32 v[144:145], v[144:145], v[136:137], v[134:135] op_sel_hi:[1,0,0]
  v_pk_fma_f32 v[146:147], v[146:147], v[136:137], v[134:135] op_sel_hi:[1,0,0]
  v_pk_fma_f32 v[148:149], v[148:149], v[136:137], v[134:135] op_sel_hi:[1,0,0]
  v_pk_fma_f32 v[150:151], v[150:151], v[136:137], v[134:135] op_sel_hi:[1,0,0]
  v_pk_mul_f32 v[144:145], v[144:145], v[184:185]
  v_pk_mul_f32 v[146:147], v[146:147], v[186:187]
  v_pk_mul_f32 v[148:149], v[148:149], v[188:189]
  v_pk_mul_f32 v[150:151], v[150:151], v[190:191]
  v_exp_f32 v144, v144
  v_exp_f32 v145, v145
  v_exp_f32 v146, v146
  v_exp_f32 v147, v147
  v_exp_f32 v148, v148
  v_exp_f32 v149, v149
  v_exp_f32 v150, v150
  v_exp_f32 v151, v151
  v_pk_fma_f32 v[144:145], v[144:145], v[138:139], v[138:139] op_sel_hi:[1,0,0]
  v_pk_fma_f32 v[146:147], v[146:147], v[138:139], v[138:139] op_sel_hi:[1,0,0]
  v_pk_fma_f32 v[148:149], v[148:149], v[138:139], v[138:139] op_sel_hi:[1,0,0]
  v_pk_fma_f32 v[150:151], v[150:151], v[138:139], v[138:139] op_sel_hi:[1,0,0]
  v_rcp_f32 v144, v144
  v_rcp_f32 v145, v145
  v_rcp_f32 v146, v146
  v_rcp_f32 v147, v147
  v_rcp_f32 v148, v148
  v_rcp_f32 v149, v149
  v_rcp_f32 v150, v150
  v_rcp_f32 v151, v151
  v_pk_mul_f32 v[144:145], v[184:185], v[144:145]
  v_pk_mul_f32 v[146:147], v[186:187], v[146:147]
  v_pk_mul_f32 v[148:149], v[188:189], v[148:149]
  v_pk_mul_f32 v[150:151], v[190:191], v[150:151]
  v_cvt_pk_bf16_f32 v196, v144, v145
  v_cvt_pk_bf16_f32 v197, v146, v147
  v_cvt_pk_bf16_f32 v198, v148, v149
  v_cvt_pk_bf16_f32 v199, v150, v151
  s_cmp_eq_u32 s74, 0
  s_cbranch_scc1 L47
  buffer_store_dwordx4 v[196:199], v217, s[64:67], s24 offen offset:1024
L48:
  buffer_store_dwordx4 v[192:195], v218, s[64:67], s15 offen sc1
  buffer_store_dwordx4 v[196:199], v219, s[64:67], s15 offen sc1
  s_lshl_b32 s6, s81, 1
  s_add_u32 s6, s6, s80
  s_xor_b32 s7, s6, 1
  s_mul_i32 s18, s7, 14336
  s_mul_i32 s19, s6, 14336
  s_mul_i32 s20, s7, 7168
  s_add_u32 s20, s20, s79
  s_mul_i32 s21, s6, 7168
  s_add_u32 s21, s21, s79
  v_accvgpr_read_b32 v234, a236
  s_add_u32 s88, s73, 0xc0400
  s_and_b32 s101, s68, 1
  s_xor_b32 s101, s101, 1
  s_mul_i32 s100, s101, 200704
  s_add_u32 s100, s100, s16
  s_mul_i32 s101, s101, 7168
  s_add_u32 s101, s101, s77
  v_add_u32 v230, s18, v228
  v_add_u32 v231, s18, v229
  ds_read_b64_tr_b16 v[16:17], v230 offset:0
  s_add_u32 m0, s101, 0
  s_add_u32 s22, s100, 0
  buffer_load_dwordx4 v236, s[48:51], s22 offen offset:0  lds
  ds_read_b64_tr_b16 v[18:19], v230 offset:1024
  ds_read_b64_tr_b16 v[20:21], v231 offset:0
  ds_read_b64_tr_b16 v[22:23], v231 offset:1024
  buffer_load_dwordx4 v237, s[48:51], s22 offen offset:1024  lds
  ds_read_b64_tr_b16 v[24:25], v230 offset:2048
  ds_read_b64_tr_b16 v[26:27], v230 offset:3072
  ds_read_b64_tr_b16 v[28:29], v231 offset:2048
  buffer_load_dwordx4 v238, s[48:51], s22 offen offset:2048  lds
  ds_read_b64_tr_b16 v[30:31], v231 offset:3072
  ds_read_b64_tr_b16 v[32:33], v230 offset:4096
  buffer_load_dwordx4 v239, s[48:51], s22 offen offset:3072  lds
  ds_read_b64_tr_b16 v[34:35], v230 offset:5120
  ds_read_b64_tr_b16 v[36:37], v231 offset:4096
  ds_read_b64_tr_b16 v[38:39], v231 offset:5120
  s_add_u32 m0, s101, 4096
  s_add_u32 s22, s100, 114688
  buffer_load_dwordx4 v236, s[48:51], s22 offen offset:0  lds
  ds_read_b64_tr_b16 v[40:41], v230 offset:6144
  ds_read_b64_tr_b16 v[42:43], v230 offset:7168
  ds_read_b64_tr_b16 v[44:45], v231 offset:6144
  buffer_load_dwordx4 v237, s[48:51], s22 offen offset:1024  lds
  ds_read_b64_tr_b16 v[46:47], v231 offset:7168
  ds_read_b64_tr_b16 v[48:49], v230 offset:8192
  ds_read_b64_tr_b16 v[50:51], v230 offset:9216
  buffer_load_dwordx4 v238, s[48:51], s22 offen offset:2048  lds
  ds_read_b64_tr_b16 v[52:53], v231 offset:8192
  ds_read_b64_tr_b16 v[54:55], v231 offset:9216
  v_mov_b32 v233, 1
  s_mov_b64 exec, 1
  s_waitcnt vmcnt(9)
  s_barrier
  s_cmp_eq_u32 s74, 0
  s_cbranch_scc1 L49
  buffer_store_dword v233, off, s[64:67], s82 offset:1024
L50:
  s_mov_b64 exec, -1
  buffer_load_dword v235, v234, s[64:67], s88 offen sc1
  s_mov_b32 s95, 131072
  v_max3_u32 v217, v220, v221, v222
  v_max_u32 v217, v217, v223
  v_cmp_eq_u32 vcc, -1, v217
  s_nop 0
  s_cbranch_vccnz L53
L54:
  v_cvt_pk_bf16_f32 v215, v220, 0
  v_lshlrev_b32 v213, 16, v215
  v_sub_f32 v213, v220, v213
  v_cvt_pk_bf16_f32 v214, v220, v213
  v_accvgpr_write_b32 a248, v214
  v_accvgpr_write_b32 a249, v215
  v_cvt_pk_bf16_f32 v215, v221, 0
  v_lshlrev_b32 v213, 16, v215
  v_sub_f32 v213, v221, v213
  v_cvt_pk_bf16_f32 v214, v221, v213
  v_accvgpr_write_b32 a250, v214
  v_accvgpr_write_b32 a251, v215
  v_cvt_pk_bf16_f32 v215, v222, 0
  v_lshlrev_b32 v213, 16, v215
  v_sub_f32 v213, v222, v213
  v_cvt_pk_bf16_f32 v214, v222, v213
  v_accvgpr_write_b32 a252, v214
  v_accvgpr_write_b32 a253, v215
  v_cvt_pk_bf16_f32 v215, v223, 0
  v_lshlrev_b32 v213, 16, v215
  v_sub_f32 v213, v223, v213
  v_cvt_pk_bf16_f32 v214, v223, v213
  v_accvgpr_write_b32 a254, v214
  v_accvgpr_write_b32 a255, v215
  s_mov_b32 s24, s79
  s_add_u32 s24, s24, s84
  s_add_u32 s24, s24, 0x20000
  v_accvgpr_read_b32 v216, a234
  v_pk_add_f32 v[128:129], v[240:241], v[10:11] op_sel_hi:[1,0] neg_lo:[0,1] neg_hi:[0,1]
  v_pk_add_f32 v[130:131], v[242:243], v[10:11] op_sel_hi:[1,0] neg_lo:[0,1] neg_hi:[0,1]
  v_pk_add_f32 v[132:133], v[244:245], v[10:11] op_sel_hi:[1,0] neg_lo:[0,1] neg_hi:[0,1]
  v_pk_add_f32 v[134:135], v[246:247], v[10:11] op_sel_hi:[1,0] neg_lo:[0,1] neg_hi:[0,1]
  v_pk_add_f32 v[136:137], v[248:249], v[10:11] op_sel_hi:[1,0] neg_lo:[0,1] neg_hi:[0,1]
  v_pk_add_f32 v[138:139], v[250:251], v[10:11] op_sel_hi:[1,0] neg_lo:[0,1] neg_hi:[0,1]
  v_pk_add_f32 v[140:141], v[252:253], v[10:11] op_sel_hi:[1,0] neg_lo:[0,1] neg_hi:[0,1]
  v_pk_add_f32 v[142:143], v[254:255], v[10:11] op_sel_hi:[1,0] neg_lo:[0,1] neg_hi:[0,1]
  v_pk_mul_f32 v[128:129], v[128:129], v[12:13] op_sel_hi:[1,0]
  v_pk_mul_f32 v[130:131], v[130:131], v[12:13] op_sel_hi:[1,0]
  v_pk_mul_f32 v[132:133], v[132:133], v[12:13] op_sel_hi:[1,0]
  v_pk_mul_f32 v[134:135], v[134:135], v[12:13] op_sel_hi:[1,0]
  v_pk_mul_f32 v[136:137], v[136:137], v[12:13] op_sel_hi:[1,0]
  v_pk_mul_f32 v[138:139], v[138:139], v[12:13] op_sel_hi:[1,0]
  v_pk_mul_f32 v[140:141], v[140:141], v[12:13] op_sel_hi:[1,0]
  v_pk_mul_f32 v[142:143], v[142:143], v[12:13] op_sel_hi:[1,0]
  ds_read_b64_tr_b16 v[56:57], v230 offset:10240
  buffer_load_dword v13, v234, s[64:67], s88 offen sc1
  ds_read_b64_tr_b16 v[58:59], v230 offset:11264
  ds_read_b64_tr_b16 v[60:61], v231 offset:10240
  ds_read_b64_tr_b16 v[62:63], v231 offset:11264
  ds_read_b64_tr_b16 v[64:65], v230 offset:12288
  ds_read_b64_tr_b16 v[66:67], v230 offset:13312
  ds_read_b64_tr_b16 v[68:69], v231 offset:12288
  ds_read_b64_tr_b16 v[70:71], v231 offset:13312
  v_add_u32 v230, s19, v228
  v_add_u32 v231, s19, v229
L51:
  s_waitcnt vmcnt(1)
  v_cmp_eq_u32 vcc, 0, v235
  s_nop 0
  s_cbranch_vccz L52
  buffer_load_dword v235, v234, s[64:67], s88 offen sc1
  s_waitcnt vmcnt(1)
  v_cmp_eq_u32 vcc, 0, v13
  s_nop 0
  s_cbranch_vccz L52
  buffer_load_dword v13, v234, s[64:67], s88 offen sc1
  s_sub_u32 s95, s95, 1
  s_cbranch_scc0 L51
  s_branch L_abort
L52:
  s_add_u32 s23, s20, 0
  buffer_load_dwordx4 v[144:147], v1, s[64:67], s23 offen offset:0 sc1
  buffer_load_dwordx4 v[148:151], v1, s[64:67], s23 offen offset:1024 sc1
  buffer_load_dwordx4 v[152:155], v1, s[64:67], s23 offen offset:2048 sc1
  buffer_load_dwordx4 v[156:159], v1, s[64:67], s23 offen offset:3072 sc1
  s_add_u32 s23, s20, 4096
  buffer_load_dwordx4 v[160:163], v1, s[64:67], s23 offen offset:0 sc1
  buffer_load_dwordx4 v[164:167], v1, s[64:67], s23 offen offset:1024 sc1
  buffer_load_dwordx4 v[168:171], v1, s[64:67], s23 offen offset:2048 sc1
  ds_read_b64_tr_b16 v[72:73], v230 offset:0
  ds_read_b64_tr_b16 v[74:75], v230 offset:1024
  ds_read_b64_tr_b16 v[76:77], v231 offset:0
  ds_read_b64_tr_b16 v[78:79], v231 offset:1024
  ds_read_b64_tr_b16 v[80:81], v230 offset:2048
  ds_read_b64_tr_b16 v[82:83], v230 offset:3072
  ds_read_b64_tr_b16 v[84:85], v231 offset:2048
  ds_read_b64_tr_b16 v[86:87], v231 offset:3072
  ds_read_b64_tr_b16 v[88:89], v230 offset:4096
  ds_read_b64_tr_b16 v[90:91], v230 offset:5120
  ds_read_b64_tr_b16 v[92:93], v231 offset:4096
  ds_read_b64_tr_b16 v[94:95], v231 offset:5120
  ds_read_b64_tr_b16 v[96:97], v230 offset:6144
  ds_read_b64_tr_b16 v[98:99], v230 offset:7168
  ds_read_b64_tr_b16 v[100:101], v231 offset:6144
  ds_read_b64_tr_b16 v[102:103], v231 offset:7168
  ds_read_b64_tr_b16 v[104:105], v230 offset:8192
  ds_read_b64_tr_b16 v[106:107], v230 offset:9216
  ds_read_b64_tr_b16 v[108:109], v231 offset:8192
  ds_read_b64_tr_b16 v[110:111], v231 offset:9216
  s_waitcnt vmcnt(6) lgkmcnt(15)
  v_mfma_f32_32x32x16_bf16 v[192:207], v[20:23], v[144:147], 0
  s_add_u32 s23, s21, 0
  buffer_load_dwordx4 v[172:175], v216, s[64:67], s23 offen offset:0 sc1
  ds_read_b64_tr_b16 v[112:113], v230 offset:10240
  v_mfma_f32_32x32x16_bf16 v[176:191], v[16:19], v[144:147], v[128:143]
  ds_read_b64_tr_b16 v[114:115], v230 offset:11264
  s_waitcnt vmcnt(6)
  v_mfma_f32_32x32x16_bf16 v[192:207], v[28:31], v[148:151], v[192:207]
  buffer_load_dwordx4 v[144:147], v216, s[64:67], s23 offen offset:1024 sc1
  v_mfma_f32_32x32x16_bf16 v[176:191], v[24:27], v[148:151], v[176:191]
  ds_read_b64_tr_b16 v[116:117], v231 offset:10240
  s_waitcnt vmcnt(6)
  v_mfma_f32_32x32x16_bf16 v[192:207], v[36:39], v[152:155], v[192:207]
  buffer_load_dwordx4 v[148:151], v216, s[64:67], s23 offen offset:2048 sc1
  ds_read_b64_tr_b16 v[118:119], v231 offset:11264
  v_mfma_f32_32x32x16_bf16 v[176:191], v[32:35], v[152:155], v[176:191]
  s_waitcnt vmcnt(6)
  v_mfma_f32_32x32x16_bf16 v[192:207], v[44:47], v[156:159], v[192:207]
  buffer_load_dwordx4 v[152:155], v216, s[64:67], s23 offen offset:3072 sc1
  ds_read_b64_tr_b16 v[120:121], v230 offset:12288
  v_mfma_f32_32x32x16_bf16 v[176:191], v[40:43], v[156:159], v[176:191]
  ds_read_b64_tr_b16 v[122:123], v230 offset:13312
  s_waitcnt vmcnt(6)
  v_mfma_f32_32x32x16_bf16 v[192:207], v[52:55], v[160:163], v[192:207]
  s_add_u32 s23, s21, 4096
  buffer_load_dwordx4 v[156:159], v216, s[64:67], s23 offen offset:0 sc1
  v_mfma_f32_32x32x16_bf16 v[176:191], v[48:51], v[160:163], v[176:191]
  ds_read_b64_tr_b16 v[124:125], v231 offset:12288
  s_waitcnt vmcnt(6)
  v_mfma_f32_32x32x16_bf16 v[192:207], v[60:63], v[164:167], v[192:207]
  buffer_load_dwordx4 v[160:163], v216, s[64:67], s23 offen offset:1024 sc1
  ds_read_b64_tr_b16 v[126:127], v231 offset:13312
  v_mfma_f32_32x32x16_bf16 v[176:191], v[56:59], v[164:167], v[176:191]
  s_waitcnt vmcnt(6)
  v_mfma_f32_32x32x16_bf16 v[192:207], v[68:71], v[168:171], v[192:207]
  buffer_load_dwordx4 v[164:167], v216, s[64:67], s23 offen offset:2048 sc1
  v_mfma_f32_32x32x16_bf16 v[176:191], v[64:67], v[168:171], v[176:191]
  s_waitcnt vmcnt(6)
  v_max_u32 v217, v172, v173
  v_max3_u32 v217, v217, v174, v175
  v_cmp_eq_u32 vcc, -1, v217
  s_nop 0
  s_cbranch_vccnz L55
L56:
  s_waitcnt lgkmcnt(0)
  s_barrier
  v_mfma_f32_32x32x16_bf16 v[192:207], v[76:79], v[172:175], v[192:207]
  s_and_b32 s101, s68, 1
  s_mul_i32 s100, s101, 200704
  s_add_u32 s100, s100, s16
  s_mul_i32 s101, s101, 7168
  s_add_u32 s101, s101, s76
  s_add_u32 m0, s101, 0
  s_add_u32 s22, s100, 1792
  buffer_load_dwordx4 v236, s[48:51], s22 offen offset:0  lds
  v_mfma_f32_32x32x16_bf16 v[176:191], v[72:75], v[172:175], v[176:191]
  s_waitcnt vmcnt(6)
  v_mfma_f32_32x32x16_bf16 v[192:207], v[84:87], v[144:147], v[192:207]
  buffer_load_dwordx4 v237, s[48:51], s22 offen offset:1024  lds
  v_max3_u32 v217, v217, v144, v145
  v_max3_u32 v217, v217, v146, v147
  s_waitcnt vmcnt(6)
  v_mfma_f32_32x32x16_bf16 v[192:207], v[92:95], v[148:151], v[192:207]
  buffer_load_dwordx4 v238, s[48:51], s22 offen offset:2048  lds
  v_max3_u32 v217, v217, v148, v149
  v_max3_u32 v217, v217, v150, v151
  s_waitcnt vmcnt(6)
  v_mfma_f32_32x32x16_bf16 v[192:207], v[100:103], v[152:155], v[192:207]
  buffer_load_dwordx4 v239, s[48:51], s22 offen offset:3072  lds
  v_max3_u32 v217, v217, v152, v153
  v_max3_u32 v217, v217, v154, v155
  s_waitcnt vmcnt(6)
  v_mfma_f32_32x32x16_bf16 v[192:207], v[108:111], v[156:159], v[192:207]
  s_add_u32 m0, s101, 4096
  s_add_u32 s22, s100, 116480
  buffer_load_dwordx4 v236, s[48:51], s22 offen offset:0  lds
  v_max3_u32 v217, v217, v156, v157
  v_max3_u32 v217, v217, v158, v159
  s_waitcnt vmcnt(6)
  v_mfma_f32_32x32x16_bf16 v[192:207], v[116:119], v[160:163], v[192:207]
  buffer_load_dwordx4 v237, s[48:51], s22 offen offset:1024  lds
  v_max3_u32 v217, v217, v160, v161
  v_max3_u32 v217, v217, v162, v163
  s_waitcnt vmcnt(6)
  v_mfma_f32_32x32x16_bf16 v[192:207], v[124:127], v[164:167], v[192:207]
  buffer_load_dwordx4 v238, s[48:51], s22 offen offset:2048  lds
  v_max3_u32 v217, v217, v164, v165
  v_max3_u32 v217, v217, v166, v167
  v_cmp_eq_u32 vcc, -1, v217
  s_nop 0
  s_cbranch_vccnz L57
L58:
  v_mfma_f32_32x32x16_bf16 v[176:191], v[80:83], v[144:147], v[176:191]
  v_mfma_f32_32x32x16_bf16 v[176:191], v[88:91], v[148:151], v[176:191]
  s_nop 3
  ds_write_b128 v224, v[192:195] offset:0
  v_mfma_f32_32x32x16_bf16 v[176:191], v[96:99], v[152:155], v[176:191]
  ds_write_b128 v224, v[196:199] offset:1024
  v_mfma_f32_32x32x16_bf16 v[176:191], v[104:107], v[156:159], v[176:191]
  ds_write_b128 v224, v[200:203] offset:2048
  v_mfma_f32_32x32x16_bf16 v[176:191], v[112:115], v[160:163], v[176:191]
  ds_write_b128 v224, v[204:207] offset:3072
  v_mfma_f32_32x32x16_bf16 v[176:191], v[120:123], v[164:167], v[176:191]
  s_waitcnt lgkmcnt(0)
  s_barrier
  ds_read_b128 v[144:147], v227 offset:0
  ds_read_b128 v[148:151], v227 offset:1024
  ds_read_b128 v[152:155], v227 offset:2048
  ds_read_b128 v[156:159], v227 offset:3072
  s_waitcnt lgkmcnt(3)
  s_nop 4
  v_pk_add_f32 v[176:177], v[176:177], v[144:145]
  v_pk_add_f32 v[178:179], v[178:179], v[146:147]
  s_waitcnt lgkmcnt(2)
  v_pk_add_f32 v[180:181], v[180:181], v[148:149]
  v_pk_add_f32 v[182:183], v[182:183], v[150:151]
  s_waitcnt lgkmcnt(1)
  v_pk_add_f32 v[184:185], v[184:185], v[152:153]
  v_pk_add_f32 v[186:187], v[186:187], v[154:155]
  s_waitcnt lgkmcnt(0)
  v_pk_add_f32 v[188:189], v[188:189], v[156:157]
  v_pk_add_f32 v[190:191], v[190:191], v[158:159]
  v_cvt_pk_bf16_f32 v192, v176, v177
  v_cvt_pk_bf16_f32 v193, v178, v179
  v_cvt_pk_bf16_f32 v194, v180, v181
  v_cvt_pk_bf16_f32 v195, v182, v183
  v_cvt_pk_bf16_f32 v196, v184, v185
  v_cvt_pk_bf16_f32 v197, v186, v187
  v_cvt_pk_bf16_f32 v198, v188, v189
  v_cvt_pk_bf16_f32 v199, v190, v191
  s_cmp_eq_u32 s74, 0
  s_cbranch_scc1 L59
  buffer_store_dwordx4 v[192:195], v1, s[64:67], s24 offen offset:0
  buffer_store_dwordx4 v[196:199], v1, s[64:67], s24 offen offset:1024
L60:
  v_accvgpr_read_b32 v234, a237
  s_add_u32 s88, s73, 0xc0500
  s_and_b32 s101, s68, 1
  s_xor_b32 s101, s101, 1
  s_mul_i32 s100, s101, 200704
  s_add_u32 s100, s100, s16
  s_mul_i32 s101, s101, 7168
  s_add_u32 s101, s101, s76
  v_pk_add_f32 v[144:145], v[176:177], v[178:179]
  v_pk_mul_f32 v[146:147], v[176:177], v[176:177]
  v_pk_fma_f32 v[146:147], v[178:179], v[178:179], v[146:147]
  v_pk_add_f32 v[144:145], v[144:145], v[180:181]
  s_add_u32 m0, s101, 0
  s_add_u32 s22, s100, 1792
  buffer_load_dwordx4 v236, s[48:51], s22 offen offset:0  lds
  v_pk_fma_f32 v[146:147], v[180:181], v[180:181], v[146:147]
  v_pk_add_f32 v[144:145], v[144:145], v[182:183]
  v_pk_fma_f32 v[146:147], v[182:183], v[182:183], v[146:147]
  v_pk_add_f32 v[144:145], v[144:145], v[184:185]
  buffer_load_dwordx4 v237, s[48:51], s22 offen offset:1024  lds
  v_pk_fma_f32 v[146:147], v[184:185], v[184:185], v[146:147]
  v_pk_add_f32 v[144:145], v[144:145], v[186:187]
  v_pk_fma_f32 v[146:147], v[186:187], v[186:187], v[146:147]
  buffer_load_dwordx4 v238, s[48:51], s22 offen offset:2048  lds
  v_pk_add_f32 v[144:145], v[144:145], v[188:189]
  v_pk_fma_f32 v[146:147], v[188:189], v[188:189], v[146:147]
  v_pk_add_f32 v[144:145], v[144:145], v[190:191]
  v_pk_fma_f32 v[146:147], v[190:191], v[190:191], v[146:147]
  buffer_load_dwordx4 v239, s[48:51], s22 offen offset:3072  lds
  v_add_f32 v144, v144, v145
  v_add_f32 v146, v146, v147
  v_add_u32 v145, s83, v2
  s_nop 0
  v_permlane32_swap_b32 v144, v146
  s_add_u32 m0, s101, 4096
  s_add_u32 s22, s100, 116480
  buffer_load_dwordx4 v236, s[48:51], s22 offen offset:0  lds
  v_add_f32 v232, v144, v146
  ds_write_b32 v145, v232
  v_pk_add_f32 v[240:241], v[240:241], v[176:177]
  buffer_load_dwordx4 v237, s[48:51], s22 offen offset:1024  lds
  v_pk_add_f32 v[242:243], v[242:243], v[178:179]
  v_pk_add_f32 v[244:245], v[244:245], v[180:181]
  v_pk_add_f32 v[246:247], v[246:247], v[182:183]
  v_pk_add_f32 v[248:249], v[248:249], v[184:185]
  buffer_load_dwordx4 v238, s[48:51], s22 offen offset:2048  lds
  v_pk_add_f32 v[250:251], v[250:251], v[186:187]
  v_pk_add_f32 v[252:253], v[252:253], v[188:189]
  v_pk_add_f32 v[254:255], v[254:255], v[190:191]
  v_mov_b32 v233, 1
  s_lshl_b32 s89, s70, 12
  s_lshl_b32 s3, s80, 11
  s_add_u32 s89, s89, s3
  s_lshl_b32 s3, s71, 8
  s_add_u32 s89, s89, s3
  s_add_u32 s89, s89, s73
  s_add_u32 s89, s89, 0xb2000
  s_cmp_eq_u32 s81, 1
  s_cselect_b32 s89, s89, 0x7f000000
  s_sub_u32 s4, s83, 12288
  v_add_u32 v14, s4, v2
  s_waitcnt lgkmcnt(0)
  s_mov_b64 exec, 1
  s_waitcnt vmcnt(7)
  s_barrier
  s_cmp_eq_u32 s74, 0
  s_cbranch_scc1 L61
  buffer_store_dword v233, off, s[64:67], s82 offset:1280
L62:
  s_mov_b64 exec, -1
  ds_read_b32 v14, v14
  buffer_load_dword v235, v234, s[64:67], s88 offen sc1
  s_mov_b32 s95, 131072
  s_waitcnt lgkmcnt(0)
  v_add_f32 v14, v14, v232
  s_cmp_eq_u32 s74, 0
  s_cbranch_scc1 L65
  buffer_store_dword v14, v2, s[64:67], s89 offen
L66:
  v_accvgpr_read_b32 v230, a225
  v_xor_b32 v231, 64, v230
  v_add_u32 v228, 57344, v230
  v_add_u32 v229, 57344, v231
  ds_read_b64_tr_b16 v[192:193], v228 offset:0
  ds_read_b64_tr_b16 v[194:195], v228 offset:1024
  ds_read_b64_tr_b16 v[196:197], v229 offset:0
  ds_read_b64_tr_b16 v[198:199], v229 offset:1024
  ds_read_b64_tr_b16 v[200:201], v228 offset:2048
  ds_read_b64_tr_b16 v[202:203], v228 offset:3072
  ds_read_b64_tr_b16 v[204:205], v229 offset:2048
  ds_read_b64_tr_b16 v[206:207], v229 offset:3072
  ds_read_b64_tr_b16 v[208:209], v228 offset:4096
  ds_read_b64_tr_b16 v[210:211], v228 offset:5120
  s_lshl_b32 s7, s72, 15
  s_add_u32 s7, s7, s73
  s_add_u32 s7, s7, 0x20000
  s_lshl_b32 s8, s72, 11
  s_add_u32 s8, s8, s73
  s_add_u32 s8, s8, 0xb2000
  s_mul_i32 s10, s72, 114688
  s_lshl_b32 s3, s0, 12
  s_add_u32 s10, s10, s3
  s_add_u32 s10, s10, s73
  s_add_u32 s10, s10, 0x40000
  s_add_u32 s11, s10, 0xe000
  buffer_load_dword v13, v234, s[64:67], s88 offen sc1
L63:
  s_waitcnt vmcnt(1)
  v_cmp_eq_u32 vcc, 0, v235
  s_nop 0
  s_cbranch_vccz L64
  buffer_load_dword v235, v234, s[64:67], s88 offen sc1
  s_waitcnt vmcnt(1)
  v_cmp_eq_u32 vcc, 0, v13
  s_nop 0
  s_cbranch_vccz L64
  buffer_load_dword v13, v234, s[64:67], s88 offen sc1
  s_sub_u32 s95, s95, 1
  s_cbranch_scc0 L63
  s_branch L_abort
L64:
  buffer_load_dwordx4 v[16:19], v1, s[64:67], s7 offen offset:0 sc1
  buffer_load_dwordx4 v[20:23], v1, s[64:67], s7 offen offset:1024 sc1
  buffer_load_dwordx4 v[24:27], v1, s[64:67], s7 offen offset:2048 sc1
  buffer_load_dwordx4 v[28:31], v1, s[64:67], s7 offen offset:3072 sc1
  s_add_u32 s7, s7, 4096
  buffer_load_dwordx4 v[32:35], v1, s[64:67], s7 offen offset:0 sc1
  buffer_load_dwordx4 v[36:39], v1, s[64:67], s7 offen offset:1024 sc1
  buffer_load_dwordx4 v[40:43], v1, s[64:67], s7 offen offset:2048 sc1
  s_waitcnt lgkmcnt(0)
  s_barrier
  s_waitcnt vmcnt(6)
  v_mfma_f32_32x32x16_bf16 v[128:143], v[192:195], v[16:19], 0
  ds_read_b64_tr_b16 v[212:213], v229 offset:4096
  ds_read_b64_tr_b16 v[214:215], v229 offset:5120
  buffer_load_dwordx4 v[44:47], v1, s[64:67], s7 offen offset:3072 sc1
  v_mfma_f32_32x32x16_bf16 v[144:159], v[196:199], v[16:19], 0
  ds_read_b64_tr_b16 v[192:193], v228 offset:6144
  ds_read_b64_tr_b16 v[194:195], v228 offset:7168
  s_waitcnt vmcnt(6)
  v_mfma_f32_32x32x16_bf16 v[128:143], v[200:203], v[20:23], v[128:143]
  ds_read_b64_tr_b16 v[196:197], v229 offset:6144
  ds_read_b64_tr_b16 v[198:199], v229 offset:7168
  s_add_u32 s7, s7, 4096
  buffer_load_dwordx4 v[48:51], v1, s[64:67], s7 offen offset:0 sc1
  v_mfma_f32_32x32x16_bf16 v[144:159], v[204:207], v[20:23], v[144:159]
  ds_read_b64_tr_b16 v[200:201], v228 offset:8192
  ds_read_b64_tr_b16 v[202:203], v228 offset:9216
  s_waitcnt vmcnt(6)
  v_mfma_f32_32x32x16_bf16 v[128:143], v[208:211], v[24:27], v[128:143]
  ds_read_b64_tr_b16 v[204:205], v229 offset:8192
  ds_read_b64_tr_b16 v[206:207], v229 offset:9216
  buffer_load_dwordx4 v[52:55], v1, s[64:67], s7 offen offset:1024 sc1
  s_waitcnt lgkmcnt(8)
  v_mfma_f32_32x32x16_bf16 v[144:159], v[212:215], v[24:27], v[144:159]
  ds_read_b64_tr_b16 v[208:209], v228 offset:10240
  ds_read_b64_tr_b16 v[210:211], v228 offset:11264
  s_waitcnt vmcnt(6) lgkmcnt(8)
  v_mfma_f32_32x32x16_bf16 v[128:143], v[192:195], v[28:31], v[128:143]
  ds_read_b64_tr_b16 v[212:213], v229 offset:10240
  ds_read_b64_tr_b16 v[214:215], v229 offset:11264
  buffer_load_dwordx4 v[56:59], v1, s[64:67], s7 offen offset:2048 sc1
  s_waitcnt lgkmcnt(8)
  v_mfma_f32_32x32x16_bf16 v[144:159], v[196:199], v[28:31], v[144:159]
  ds_read_b64_tr_b16 v[192:193], v228 offset:12288
  ds_read_b64_tr_b16 v[194:195], v228 offset:13312
  s_waitcnt vmcnt(6) lgkmcnt(8)
  v_mfma_f32_32x32x16_bf16 v[128:143], v[200:203], v[32:35], v[128:143]
  ds_read_b64_tr_b16 v[196:197], v229 offset:12288
  ds_read_b64_tr_b16 v[198:199], v229 offset:13312
  buffer_load_dwordx4 v[60:63], v1, s[64:67], s7 offen offset:3072 sc1
  s_waitcnt lgkmcnt(8)
  v_mfma_f32_32x32x16_bf16 v[144:159], v[204:207], v[32:35], v[144:159]
  ds_read_b64_tr_b16 v[200:201], v228 offset:14336
  ds_read_b64_tr_b16 v[202:203], v228 offset:15360
  s_waitcnt vmcnt(6) lgkmcnt(8)
  v_mfma_f32_32x32x16_bf16 v[128:143], v[208:211], v[36:39], v[128:143]
  ds_read_b64_tr_b16 v[204:205], v229 offset:14336
  ds_read_b64_tr_b16 v[206:207], v229 offset:15360
  s_add_u32 s7, s7, 4096
  buffer_load_dwordx4 v[64:67], v1, s[64:67], s7 offen offset:0 sc1
  s_waitcnt lgkmcnt(8)
  v_mfma_f32_32x32x16_bf16 v[144:159], v[212:215], v[36:39], v[144:159]
  ds_read_b64_tr_b16 v[208:209], v228 offset:16384
  ds_read_b64_tr_b16 v[210:211], v228 offset:17408
  buffer_load_dword v176, v2, s[64:67], s8 offen offset:0 sc1
  buffer_load_dword v177, v2, s[64:67], s8 offen offset:256 sc1
  s_waitcnt vmcnt(8) lgkmcnt(8)
  v_mfma_f32_32x32x16_bf16 v[128:143], v[192:195], v[40:43], v[128:143]
  ds_read_b64_tr_b16 v[212:213], v229 offset:16384
  ds_read_b64_tr_b16 v[214:215], v229 offset:17408
  buffer_load_dwordx4 v[68:71], v1, s[64:67], s7 offen offset:1024 sc1
  s_waitcnt lgkmcnt(8)
  v_mfma_f32_32x32x16_bf16 v[144:159], v[196:199], v[40:43], v[144:159]
  ds_read_b64_tr_b16 v[192:193], v228 offset:18432
  ds_read_b64_tr_b16 v[194:195], v228 offset:19456
  buffer_load_dword v178, v2, s[64:67], s8 offen offset:512 sc1
  buffer_load_dword v179, v2, s[64:67], s8 offen offset:768 sc1
  s_waitcnt vmcnt(10) lgkmcnt(8)
  v_mfma_f32_32x32x16_bf16 v[128:143], v[200:203], v[44:47], v[128:143]
  ds_read_b64_tr_b16 v[196:197], v229 offset:18432
  ds_read_b64_tr_b16 v[198:199], v229 offset:19456
  buffer_load_dwordx4 v[72:75], v1, s[64:67], s7 offen offset:2048 sc1
  s_waitcnt lgkmcnt(8)
  v_mfma_f32_32x32x16_bf16 v[144:159], v[204:207], v[44:47], v[144:159]
  ds_read_b64_tr_b16 v[200:201], v228 offset:20480
  ds_read_b64_tr_b16 v[202:203], v228 offset:21504
  buffer_load_dword v180, v2, s[64:67], s8 offen offset:1024 sc1
  buffer_load_dword v181, v2, s[64:67], s8 offen offset:1280 sc1
  s_waitcnt vmcnt(12) lgkmcnt(8)
  v_mfma_f32_32x32x16_bf16 v[128:143], v[208:211], v[48:51], v[128:143]
  ds_read_b64_tr_b16 v[204:205], v229 offset:20480
  ds_read_b64_tr_b16 v[206:207], v229 offset:21504
  buffer_load_dwordx4 v[76:79], v1, s[64:67], s7 offen offset:3072 sc1
  s_waitcnt lgkmcnt(8)
  v_mfma_f32_32x32x16_bf16 v[144:159], v[212:215], v[48:51], v[144:159]
  ds_read_b64_tr_b16 v[208:209], v228 offset:22528
  ds_read_b64_tr_b16 v[210:211], v228 offset:23552
  buffer_load_dword v182, v2, s[64:67], s8 offen offset:1536 sc1
  s_waitcnt vmcnt(13) lgkmcnt(8)
  v_mfma_f32_32x32x16_bf16 v[128:143], v[192:195], v[52:55], v[128:143]
  ds_read_b64_tr_b16 v[212:213], v229 offset:22528
  ds_read_b64_tr_b16 v[214:215], v229 offset:23552
  s_add_u32 s7, s7, 4096
  buffer_load_dwordx4 v[80:83], v1, s[64:67], s7 offen offset:0 sc1
  s_waitcnt lgkmcnt(8)
  v_mfma_f32_32x32x16_bf16 v[144:159], v[196:199], v[52:55], v[144:159]
  ds_read_b64_tr_b16 v[192:193], v228 offset:24576
  ds_read_b64_tr_b16 v[194:195], v228 offset:25600
  s_mul_i32 s21, s70, 229376
  s_mul_i32 s3, s80, 114688
  s_add_u32 s21, s21, s3
  s_mul_i32 s3, s72, 14336
  s_add_u32 s21, s21, s3
  s_add_u32 s21, s21, s73
  s_add_u32 s21, s21, 0x40000
  s_waitcnt vmcnt(13) lgkmcnt(8)
  v_mfma_f32_32x32x16_bf16 v[128:143], v[200:203], v[56:59], v[128:143]
  ds_read_b64_tr_b16 v[196:197], v229 offset:24576
  ds_read_b64_tr_b16 v[198:199], v229 offset:25600
  buffer_load_dwordx4 v[84:87], v1, s[64:67], s7 offen offset:1024 sc1
  s_waitcnt lgkmcnt(8)
  v_mfma_f32_32x32x16_bf16 v[144:159], v[204:207], v[56:59], v[144:159]
  ds_read_b64_tr_b16 v[200:201], v228 offset:26624
  ds_read_b64_tr_b16 v[202:203], v228 offset:27648
  s_xor_b32 s4, s80, 1
  s_mul_i32 s20, s70, 229376
  s_mul_i32 s3, s4, 114688
  s_add_u32 s20, s20, s3
  s_mul_i32 s3, s72, 14336
  s_add_u32 s20, s20, s3
  s_add_u32 s20, s20, s73
  s_add_u32 s20, s20, 0x40000
  s_waitcnt vmcnt(13) lgkmcnt(8)
  v_mfma_f32_32x32x16_bf16 v[128:143], v[208:211], v[60:63], v[128:143]
  ds_read_b64_tr_b16 v[204:205], v229 offset:26624
  ds_read_b64_tr_b16 v[206:207], v229 offset:27648
  buffer_load_dwordx4 v[88:91], v1, s[64:67], s7 offen offset:2048 sc1
  s_waitcnt lgkmcnt(8)
  v_mfma_f32_32x32x16_bf16 v[144:159], v[212:215], v[60:63], v[144:159]
  ds_read_b64_tr_b16 v[208:209], v228 offset:28672
  ds_read_b64_tr_b16 v[210:211], v228 offset:29696
  s_and_b32 s4, s71, 0
  s_mul_i32 s4, s4, 7168
  s_sub_u32 s18, s20, s4
  s_add_u32 s20, s20, s4
  s_sub_u32 s19, s21, s4
  s_add_u32 s21, s21, s4
  s_waitcnt vmcnt(13) lgkmcnt(8)
  v_mfma_f32_32x32x16_bf16 v[128:143], v[192:195], v[64:67], v[128:143]
  ds_read_b64_tr_b16 v[212:213], v229 offset:28672
  ds_read_b64_tr_b16 v[214:215], v229 offset:29696
  buffer_load_dwordx4 v[92:95], v1, s[64:67], s7 offen offset:3072 sc1
  s_waitcnt lgkmcnt(8)
  v_mfma_f32_32x32x16_bf16 v[144:159], v[196:199], v[64:67], v[144:159]
  ds_read_b64_tr_b16 v[192:193], v228 offset:30720
  ds_read_b64_tr_b16 v[194:195], v228 offset:31744
  v_accvgpr_read_b32 v13, a238
  s_waitcnt vmcnt(11) lgkmcnt(8)
  v_mfma_f32_32x32x16_bf16 v[128:143], v[200:203], v[68:71], v[128:143]
  ds_read_b64_tr_b16 v[196:197], v229 offset:30720
  ds_read_b64_tr_b16 v[198:199], v229 offset:31744
  s_add_u32 s7, s7, 4096
  buffer_load_dwordx4 v[96:99], v1, s[64:67], s7 offen offset:0 sc1
  s_waitcnt lgkmcnt(8)
  v_mfma_f32_32x32x16_bf16 v[144:159], v[204:207], v[68:71], v[144:159]
  ds_read_b64_tr_b16 v[200:201], v228 offset:32768
  ds_read_b64_tr_b16 v[202:203], v228 offset:33792
  s_add_u32 s88, s73, 0xc0600
  s_waitcnt vmcnt(9) lgkmcnt(8)
  v_mfma_f32_32x32x16_bf16 v[128:143], v[208:211], v[72:75], v[128:143]
  ds_read_b64_tr_b16 v[204:205], v229 offset:32768
  ds_read_b64_tr_b16 v[206:207], v229 offset:33792
  buffer_load_dwordx4 v[100:103], v1, s[64:67], s7 offen offset:1024 sc1
  s_waitcnt lgkmcnt(8)
  v_mfma_f32_32x32x16_bf16 v[144:159], v[212:215], v[72:75], v[144:159]
  ds_read_b64_tr_b16 v[208:209], v228 offset:34816
  ds_read_b64_tr_b16 v[210:211], v228 offset:35840
  s_add_u32 s89, s73, 0xc0100
  s_waitcnt vmcnt(7) lgkmcnt(8)
  v_mfma_f32_32x32x16_bf16 v[128:143], v[192:195], v[76:79], v[128:143]
  ds_read_b64_tr_b16 v[212:213], v229 offset:34816
  ds_read_b64_tr_b16 v[214:215], v229 offset:35840
  buffer_load_dwordx4 v[104:107], v1, s[64:67], s7 offen offset:2048 sc1
  s_waitcnt lgkmcnt(8)
  v_mfma_f32_32x32x16_bf16 v[144:159], v[196:199], v[76:79], v[144:159]
  ds_read_b64_tr_b16 v[192:193], v228 offset:36864
  ds_read_b64_tr_b16 v[194:195], v228 offset:37888
  s_mov_b32 s24, s79
  s_add_u32 s24, s24, s84
  s_add_u32 s24, s24, 0x20000
  s_waitcnt vmcnt(6) lgkmcnt(8)
  v_mfma_f32_32x32x16_bf16 v[128:143], v[200:203], v[80:83], v[128:143]
  ds_read_b64_tr_b16 v[196:197], v229 offset:36864
  ds_read_b64_tr_b16 v[198:199], v229 offset:37888
  buffer_load_dwordx4 v[108:111], v1, s[64:67], s7 offen offset:3072 sc1
  s_waitcnt lgkmcnt(8)
  v_mfma_f32_32x32x16_bf16 v[144:159], v[204:207], v[80:83], v[144:159]
  ds_read_b64_tr_b16 v[200:201], v228 offset:38912
  ds_read_b64_tr_b16 v[202:203], v228 offset:39936
  s_waitcnt vmcnt(6) lgkmcnt(8)
  v_mfma_f32_32x32x16_bf16 v[128:143], v[208:211], v[84:87], v[128:143]
  ds_read_b64_tr_b16 v[204:205], v229 offset:38912
  ds_read_b64_tr_b16 v[206:207], v229 offset:39936
  s_add_u32 s7, s7, 4096
  buffer_load_dwordx4 v[112:115], v1, s[64:67], s7 offen offset:0 sc1
  v_max3_u32 v239, v176, v177, v178
  v_max3_u32 v238, v179, v180, v181
  s_waitcnt lgkmcnt(8)
  v_mfma_f32_32x32x16_bf16 v[144:159], v[212:215], v[84:87], v[144:159]
  ds_read_b64_tr_b16 v[208:209], v228 offset:40960
  ds_read_b64_tr_b16 v[210:211], v228 offset:41984
  v_max3_u32 v239, v239, v238, v182
  v_cmp_eq_u32 vcc, -1, v239
  s_nop 0
  s_cbranch_vccnz L67
L68:
  s_waitcnt vmcnt(6) lgkmcnt(8)
  v_mfma_f32_32x32x16_bf16 v[128:143], v[192:195], v[88:91], v[128:143]
  ds_read_b64_tr_b16 v[212:213], v229 offset:40960
  ds_read_b64_tr_b16 v[214:215], v229 offset:41984
  buffer_load_dwordx4 v[116:119], v1, s[64:67], s7 offen offset:1024 sc1
  v_add_f32 v238, v176, v177
  s_waitcnt lgkmcnt(8)
  v_mfma_f32_32x32x16_bf16 v[144:159], v[196:199], v[88:91], v[144:159]
  ds_read_b64_tr_b16 v[192:193], v228 offset:43008
  ds_read_b64_tr_b16 v[194:195], v228 offset:44032
  v_add_f32 v239, v178, v179
  v_add_f32 v238, v238, v180
  s_waitcnt vmcnt(6) lgkmcnt(8)
  v_mfma_f32_32x32x16_bf16 v[128:143], v[200:203], v[92:95], v[128:143]
  ds_read_b64_tr_b16 v[196:197], v229 offset:43008
  ds_read_b64_tr_b16 v[198:199], v229 offset:44032
  buffer_load_dwordx4 v[120:123], v1, s[64:67], s7 offen offset:2048 sc1
  v_add_f32 v239, v239, v181
  v_add_f32 v238, v238, v182
  s_waitcnt lgkmcnt(8)
  v_mfma_f32_32x32x16_bf16 v[144:159], v[204:207], v[92:95], v[144:159]
  ds_read_b64_tr_b16 v[200:201], v228 offset:45056
  ds_read_b64_tr_b16 v[202:203], v228 offset:46080
  v_add_f32 v238, v238, v239
  s_waitcnt vmcnt(6) lgkmcnt(8)
  v_mfma_f32_32x32x16_bf16 v[128:143], v[208:211], v[96:99], v[128:143]
  ds_read_b64_tr_b16 v[204:205], v229 offset:45056
  ds_read_b64_tr_b16 v[206:207], v229 offset:46080
  buffer_load_dwordx4 v[124:127], v1, s[64:67], s7 offen offset:3072 sc1
  v_mov_b32 v239, v238
  s_nop 1
  v_permlane32_swap_b32 v238, v239
  s_waitcnt lgkmcnt(8)
  v_mfma_f32_32x32x16_bf16 v[144:159], v[212:215], v[96:99], v[144:159]
  ds_read_b64_tr_b16 v[208:209], v228 offset:47104
  ds_read_b64_tr_b16 v[210:211], v228 offset:48128
  v_mul_f32 v232, 0x3b124925, v238
  v_mul_f32 v239, 0x3b124925, v239
  s_waitcnt vmcnt(6) lgkmcnt(8)
  v_mfma_f32_32x32x16_bf16 v[128:143], v[192:195], v[100:103], v[128:143]
  ds_read_b64_tr_b16 v[212:213], v229 offset:47104
  ds_read_b64_tr_b16 v[214:215], v229 offset:48128
  v_fma_f32 v238, -v232, v232, v239
  s_waitcnt lgkmcnt(8)
  v_mfma_f32_32x32x16_bf16 v[144:159], v[196:199], v[100:103], v[144:159]
  ds_read_b64_tr_b16 v[192:193], v228 offset:49152
  ds_read_b64_tr_b16 v[194:195], v228 offset:50176
  v_max_f32 v238, 0, v238
  v_add_f32 v238, 0x3727c5ac, v238
  s_waitcnt vmcnt(5) lgkmcnt(8)
  v_mfma_f32_32x32x16_bf16 v[128:143], v[200:203], v[104:107], v[128:143]
  ds_read_b64_tr_b16 v[196:197], v229 offset:49152
  ds_read_b64_tr_b16 v[198:199], v229 offset:50176
  v_rsq_f32 v238, v238
  v_cvt_pk_bf16_f32 v218, -v232, -v232
  s_waitcnt lgkmcnt(8)
  v_mfma_f32_32x32x16_bf16 v[144:159], v[204:207], v[104:107], v[144:159]
  ds_read_b64_tr_b16 v[200:201], v228 offset:51200
  ds_read_b64_tr_b16 v[202:203], v228 offset:52224
  v_mov_b32 v216, 0
  s_waitcnt vmcnt(4) lgkmcnt(8)
  v_mfma_f32_32x32x16_bf16 v[128:143], v[208:211], v[108:111], v[128:143]
  ds_read_b64_tr_b16 v[204:205], v229 offset:51200
  ds_read_b64_tr_b16 v[206:207], v229 offset:52224
  v_mov_b32 v217, 0
  v_lshlrev_b32 v239, 16, v218
  s_waitcnt lgkmcnt(8)
  v_mfma_f32_32x32x16_bf16 v[144:159], v[212:215], v[108:111], v[144:159]
  ds_read_b64_tr_b16 v[208:209], v228 offset:53248
  ds_read_b64_tr_b16 v[210:211], v228 offset:54272
  v_mov_b32 v220, 0
  v_add_f32 v239, v232, v239
  s_waitcnt vmcnt(3) lgkmcnt(8)
  v_mfma_f32_32x32x16_bf16 v[128:143], v[192:195], v[112:115], v[128:143]
  ds_read_b64_tr_b16 v[212:213], v229 offset:53248
  ds_read_b64_tr_b16 v[214:215], v229 offset:54272
  v_mov_b32 v221, 0
  s_waitcnt lgkmcnt(8)
  v_mfma_f32_32x32x16_bf16 v[144:159], v[196:199], v[112:115], v[144:159]
  ds_read_b64_tr_b16 v[192:193], v228 offset:55296
  ds_read_b64_tr_b16 v[194:195], v228 offset:56320
  v_cvt_pk_bf16_f32 v219, -v239, 0
  v_rcp_f32 v222, v238
  s_waitcnt vmcnt(2) lgkmcnt(8)
  v_mfma_f32_32x32x16_bf16 v[128:143], v[200:203], v[116:119], v[128:143]
  ds_read_b64_tr_b16 v[196:197], v229 offset:55296
  ds_read_b64_tr_b16 v[198:199], v229 offset:56320
  v_mul_f32 v10, 0xc0135761, v238
  v_mul_f32 v12, v238, v238
  s_and_b32 s17, s71, 0
  s_xor_b32 s17, s17, 0
  s_mul_i32 s17, s17, 14336
  s_add_u32 s17, s17, s13
  s_add_u32 s17, s17, 0x7000
  buffer_load_dwordx4 a[112:115], v1, s[64:67], s17 offen offset:0 sc1
  s_waitcnt lgkmcnt(8)
  v_mfma_f32_32x32x16_bf16 v[144:159], v[204:207], v[116:119], v[144:159]
  ds_read_b64_tr_b16 v[200:201], v230 offset:0
  ds_read_b64_tr_b16 v[202:203], v230 offset:1024
  v_mul_f32 v12, v12, v10
  buffer_load_dwordx4 a[116:119], v1, s[64:67], s17 offen offset:1024 sc1
  s_waitcnt vmcnt(3) lgkmcnt(8)
  v_mfma_f32_32x32x16_bf16 v[128:143], v[208:211], v[120:123], v[128:143]
  ds_read_b64_tr_b16 v[204:205], v230 offset:2048
  ds_read_b64_tr_b16 v[206:207], v230 offset:3072
  v_mul_f32 v12, 0x3d372713, v12
  v_mfma_f32_32x32x16_bf16 v[128:143], a[248:251], v[218:221], v[128:143]
  s_waitcnt lgkmcnt(8)
  v_mfma_f32_32x32x16_bf16 v[144:159], v[212:215], v[120:123], v[144:159]
  ds_read_b64_tr_b16 v[208:209], v230 offset:4096
  ds_read_b64_tr_b16 v[210:211], v230 offset:5120
  v_mfma_f32_32x32x16_bf16 v[144:159], a[248:251], v[216:219], v[144:159]
  buffer_load_dwordx4 a[120:123], v1, s[64:67], s17 offen offset:2048 sc1
  s_waitcnt vmcnt(3) lgkmcnt(8)
  v_mfma_f32_32x32x16_bf16 v[128:143], v[192:195], v[124:127], v[128:143]
  ds_read_b64_tr_b16 v[212:213], v230 offset:6144
  ds_read_b64_tr_b16 v[214:215], v230 offset:7168
  buffer_load_dwordx4 a[124:127], v1, s[64:67], s17 offen offset:3072 sc1
  s_waitcnt lgkmcnt(8)
  v_mfma_f32_32x32x16_bf16 v[144:159], v[196:199], v[124:127], v[144:159]
  ds_read_b64_tr_b16 v[192:193], v230 offset:8192
  ds_read_b64_tr_b16 v[194:195], v230 offset:9216
  s_nop 4
  v_pk_mul_f32 v[232:233], v[128:129], v[128:129]
  v_pk_mul_f32 v[234:235], v[130:131], v[130:131]
  v_pk_mul_f32 v[236:237], v[132:133], v[132:133]
  v_pk_mul_f32 v[238:239], v[134:135], v[134:135]
  v_pk_fma_f32 v[232:233], v[232:233], v[12:13], v[10:11] op_sel_hi:[1,0,0]
  v_pk_fma_f32 v[234:235], v[234:235], v[12:13], v[10:11] op_sel_hi:[1,0,0]
  v_pk_fma_f32 v[236:237], v[236:237], v[12:13], v[10:11] op_sel_hi:[1,0,0]
  v_pk_fma_f32 v[238:239], v[238:239], v[12:13], v[10:11] op_sel_hi:[1,0,0]
  v_pk_mul_f32 v[232:233], v[232:233], v[128:129]
  v_pk_mul_f32 v[234:235], v[234:235], v[130:131]
  v_pk_mul_f32 v[236:237], v[236:237], v[132:133]
  v_pk_mul_f32 v[238:239], v[238:239], v[134:135]
  v_exp_f32 v232, v232
  v_exp_f32 v233, v233
  v_exp_f32 v234, v234
  v_exp_f32 v235, v235
  v_exp_f32 v236, v236
  v_exp_f32 v237, v237
  v_exp_f32 v238, v238
  v_exp_f32 v239, v239
  v_pk_fma_f32 v[232:233], v[232:233], v[222:223], v[222:223] op_sel_hi:[1,0,0]
  v_pk_fma_f32 v[234:235], v[234:235], v[222:223], v[222:223] op_sel_hi:[1,0,0]
  v_pk_fma_f32 v[236:237], v[236:237], v[222:223], v[222:223] op_sel_hi:[1,0,0]
  v_pk_fma_f32 v[238:239], v[238:239], v[222:223], v[222:223] op_sel_hi:[1,0,0]
  v_rcp_f32 v232, v232
  v_rcp_f32 v233, v233
  v_rcp_f32 v234, v234
  v_rcp_f32 v235, v235
  v_rcp_f32 v236, v236
  v_rcp_f32 v237, v237
  v_rcp_f32 v238, v238
  v_rcp_f32 v239, v239
  v_pk_mul_f32 v[232:233], v[128:129], v[232:233]
  v_pk_mul_f32 v[234:235], v[130:131], v[234:235]
  v_pk_mul_f32 v[236:237], v[132:133], v[236:237]
  v_pk_mul_f32 v[238:239], v[134:135], v[238:239]
  v_cvt_pk_bf16_f32 v128, v232, v233
  v_cvt_pk_bf16_f32 v129, v234, v235
  v_cvt_pk_bf16_f32 v130, v236, v237
  v_cvt_pk_bf16_f32 v131, v238, v239
  buffer_store_dwordx4 v[128:131], v1, s[64:67], s10 offen offset:0 sc1
  s_add_u32 s17, s17, 4096
  buffer_load_dwordx4 a[128:131], v1, s[64:67], s17 offen offset:0 sc1
  buffer_load_dwordx4 a[132:135], v1, s[64:67], s17 offen offset:1024 sc1
  v_pk_mul_f32 v[232:233], v[136:137], v[136:137]
  v_pk_mul_f32 v[234:235], v[138:139], v[138:139]
  v_pk_mul_f32 v[236:237], v[140:141], v[140:141]
  v_pk_mul_f32 v[238:239], v[142:143], v[142:143]
  v_pk_fma_f32 v[232:233], v[232:233], v[12:13], v[10:11] op_sel_hi:[1,0,0]
  v_pk_fma_f32 v[234:235], v[234:235], v[12:13], v[10:11] op_sel_hi:[1,0,0]
  v_pk_fma_f32 v[236:237], v[236:237], v[12:13], v[10:11] op_sel_hi:[1,0,0]
  v_pk_fma_f32 v[238:239], v[238:239], v[12:13], v[10:11] op_sel_hi:[1,0,0]
  v_pk_mul_f32 v[232:233], v[232:233], v[136:137]
  v_pk_mul_f32 v[234:235], v[234:235], v[138:139]
  v_pk_mul_f32 v[236:237], v[236:237], v[140:141]
  v_pk_mul_f32 v[238:239], v[238:239], v[142:143]
  v_exp_f32 v232, v232
  v_exp_f32 v233, v233
  v_exp_f32 v234, v234
  v_exp_f32 v235, v235
  v_exp_f32 v236, v236
  v_exp_f32 v237, v237
  v_exp_f32 v238, v238
  v_exp_f32 v239, v239
  v_pk_fma_f32 v[232:233], v[232:233], v[222:223], v[222:223] op_sel_hi:[1,0,0]
  v_pk_fma_f32 v[234:235], v[234:235], v[222:223], v[222:223] op_sel_hi:[1,0,0]
  v_pk_fma_f32 v[236:237], v[236:237], v[222:223], v[222:223] op_sel_hi:[1,0,0]
  v_pk_fma_f32 v[238:239], v[238:239], v[222:223], v[222:223] op_sel_hi:[1,0,0]
  v_rcp_f32 v232, v232
  v_rcp_f32 v233, v233
  v_rcp_f32 v234, v234
  v_rcp_f32 v235, v235
  v_rcp_f32 v236, v236
  v_rcp_f32 v237, v237
  v_rcp_f32 v238, v238
  v_rcp_f32 v239, v239
  v_pk_mul_f32 v[232:233], v[136:137], v[232:233]
  v_pk_mul_f32 v[234:235], v[138:139], v[234:235]
  v_pk_mul_f32 v[236:237], v[140:141], v[236:237]
  v_pk_mul_f32 v[238:239], v[142:143], v[238:239]
  v_cvt_pk_bf16_f32 v136, v232, v233
  v_cvt_pk_bf16_f32 v137, v234, v235
  v_cvt_pk_bf16_f32 v138, v236, v237
  v_cvt_pk_bf16_f32 v139, v238, v239
  buffer_store_dwordx4 v[136:139], v1, s[64:67], s10 offen offset:1024 sc1
  buffer_load_dwordx4 a[136:139], v1, s[64:67], s17 offen offset:2048 sc1
  buffer_load_dwordx4 a[140:143], v1, s[64:67], s17 offen offset:3072 sc1
  s_waitcnt lgkmcnt(8)
  v_mfma_f32_32x32x16_bf16 v[160:175], v[200:203], v[16:19], 0
  s_waitcnt lgkmcnt(4)
  ds_read_b64_tr_b16 v[196:197], v230 offset:10240
  ds_read_b64_tr_b16 v[198:199], v230 offset:11264
  s_add_u32 s17, s17, 4096
  buffer_load_dwordx4 a[144:147], v1, s[64:67], s17 offen offset:0 sc1
  v_mul_f32 v232, v144, v144
  v_mul_f32 v233, v145, v145
  v_mul_f32 v234, v146, v146
  v_mul_f32 v235, v147, v147
  v_fma_f32 v232, v232, v12, v10
  v_fma_f32 v233, v233, v12, v10
  v_fma_f32 v234, v234, v12, v10
  v_fma_f32 v235, v235, v12, v10
  v_mul_f32 v232, v232, v144
  v_mfma_f32_32x32x16_bf16 v[160:175], v[204:207], v[20:23], v[160:175]
  ds_read_b64_tr_b16 v[200:201], v230 offset:12288
  ds_read_b64_tr_b16 v[202:203], v230 offset:13312
  buffer_load_dwordx4 a[148:151], v1, s[64:67], s17 offen offset:1024 sc1
  v_mul_f32 v233, v233, v145
  v_mul_f32 v234, v234, v146
  v_mul_f32 v235, v235, v147
  v_exp_f32 v232, v232
  v_exp_f32 v233, v233
  v_mfma_f32_32x32x16_bf16 v[160:175], v[208:211], v[24:27], v[160:175]
  s_waitcnt lgkmcnt(4)
  ds_read_b64_tr_b16 v[204:205], v230 offset:14336
  ds_read_b64_tr_b16 v[206:207], v230 offset:15360
  v_exp_f32 v234, v234
  v_exp_f32 v235, v235
  v_fma_f32 v232, v232, v222, v222
  v_fma_f32 v233, v233, v222, v222
  v_fma_f32 v234, v234, v222, v222
  v_fma_f32 v235, v235, v222, v222
  v_rcp_f32 v232, v232
  v_mfma_f32_32x32x16_bf16 v[160:175], v[212:215], v[28:31], v[160:175]
  ds_read_b64_tr_b16 v[208:209], v230 offset:16384
  ds_read_b64_tr_b16 v[210:211], v230 offset:17408
  buffer_load_dwordx4 a[152:155], v1, s[64:67], s17 offen offset:2048 sc1
  v_rcp_f32 v233, v233
  v_rcp_f32 v234, v234
  v_rcp_f32 v235, v235
  v_mul_f32 v232, v144, v232
  v_mul_f32 v233, v145, v233
  v_mfma_f32_32x32x16_bf16 v[160:175], v[192:195], v[32:35], v[160:175]
  s_waitcnt lgkmcnt(4)
  ds_read_b64_tr_b16 v[212:213], v230 offset:18432
  ds_read_b64_tr_b16 v[214:215], v230 offset:19456
  buffer_load_dwordx4 a[156:159], v1, s[64:67], s17 offen offset:3072 sc1
  v_mul_f32 v234, v146, v234
  v_mul_f32 v235, v147, v235
  v_cvt_pk_bf16_f32 v144, v232, v233
  v_cvt_pk_bf16_f32 v145, v234, v235
  v_mul_f32 v236, v148, v148
  v_mul_f32 v237, v149, v149
  v_mul_f32 v238, v150, v150
  v_mul_f32 v239, v151, v151
  v_fma_f32 v236, v236, v12, v10
  v_mfma_f32_32x32x16_bf16 v[160:175], v[196:199], v[36:39], v[160:175]
  ds_read_b64_tr_b16 v[192:193], v230 offset:20480
  ds_read_b64_tr_b16 v[194:195], v230 offset:21504
  v_fma_f32 v237, v237, v12, v10
  v_fma_f32 v238, v238, v12, v10
  v_fma_f32 v239, v239, v12, v10
  v_mul_f32 v236, v236, v148
  v_mul_f32 v237, v237, v149
  v_mul_f32 v238, v238, v150
  v_mul_f32 v239, v239, v151
  v_mfma_f32_32x32x16_bf16 v[160:175], v[200:203], v[40:43], v[160:175]
  s_waitcnt lgkmcnt(4)
  ds_read_b64_tr_b16 v[196:197], v230 offset:22528
  ds_read_b64_tr_b16 v[198:199], v230 offset:23552
  s_add_u32 s17, s17, 4096
  buffer_load_dwordx4 a[160:163], v1, s[64:67], s17 offen offset:0 sc1
  v_exp_f32 v236, v236
  v_exp_f32 v237, v237
  v_exp_f32 v238, v238
  v_exp_f32 v239, v239
  v_fma_f32 v236, v236, v222, v222
  v_fma_f32 v237, v237, v222, v222
  v_mfma_f32_32x32x16_bf16 v[160:175], v[204:207], v[44:47], v[160:175]
  ds_read_b64_tr_b16 v[200:201], v230 offset:24576
  ds_read_b64_tr_b16 v[202:203], v230 offset:25600
  buffer_load_dwordx4 a[164:167], v1, s[64:67], s17 offen offset:1024 sc1
  v_fma_f32 v238, v238, v222, v222
  v_fma_f32 v239, v239, v222, v222
  v_rcp_f32 v236, v236
  v_rcp_f32 v237, v237
  v_rcp_f32 v238, v238
  v_mfma_f32_32x32x16_bf16 v[160:175], v[208:211], v[48:51], v[160:175]
  s_waitcnt lgkmcnt(4)
  ds_read_b64_tr_b16 v[204:205], v230 offset:26624
  ds_read_b64_tr_b16 v[206:207], v230 offset:27648
  v_rcp_f32 v239, v239
  v_mul_f32 v236, v148, v236
  v_mul_f32 v237, v149, v237
  v_mul_f32 v238, v150, v238
  v_mul_f32 v239, v151, v239
  v_cvt_pk_bf16_f32 v146, v236, v237
  v_cvt_pk_bf16_f32 v147, v238, v239
  buffer_store_dwordx4 v[144:147], v1, s[64:67], s10 offen offset:2048 sc1
  v_mfma_f32_32x32x16_bf16 v[160:175], v[212:215], v[52:55], v[160:175]
  ds_read_b64_tr_b16 v[208:209], v230 offset:28672
  ds_read_b64_tr_b16 v[210:211], v230 offset:29696
  s_and_b32 s17, s71, 0
  s_xor_b32 s17, s17, 1
  s_mul_i32 s17, s17, 14336
  s_add_u32 s17, s17, s13
  s_add_u32 s17, s17, 0x7000
  buffer_load_dwordx4 a[168:171], v1, s[64:67], s17 offen offset:0 sc1
  v_mul_f32 v232, v152, v152
  v_mul_f32 v233, v153, v153
  v_mul_f32 v234, v154, v154
  v_mul_f32 v235, v155, v155
  v_fma_f32 v232, v232, v12, v10
  v_fma_f32 v233, v233, v12, v10
  v_fma_f32 v234, v234, v12, v10
  v_fma_f32 v235, v235, v12, v10
  v_mfma_f32_32x32x16_bf16 v[160:175], v[192:195], v[56:59], v[160:175]
  s_waitcnt lgkmcnt(4)
  ds_read_b64_tr_b16 v[212:213], v230 offset:30720
  ds_read_b64_tr_b16 v[214:215], v230 offset:31744
  buffer_load_dwordx4 a[172:175], v1, s[64:67], s17 offen offset:1024 sc1
  v_mul_f32 v232, v232, v152
  v_mul_f32 v233, v233, v153
  v_mul_f32 v234, v234, v154
  v_mul_f32 v235, v235, v155
  v_exp_f32 v232, v232
  v_exp_f32 v233, v233
  v_mfma_f32_32x32x16_bf16 v[160:175], v[196:199], v[60:63], v[160:175]
  ds_read_b64_tr_b16 v[192:193], v230 offset:32768
  ds_read_b64_tr_b16 v[194:195], v230 offset:33792
  v_exp_f32 v234, v234
  v_exp_f32 v235, v235
  v_fma_f32 v232, v232, v222, v222
  v_fma_f32 v233, v233, v222, v222
  v_fma_f32 v234, v234, v222, v222
  v_fma_f32 v235, v235, v222, v222
  v_mfma_f32_32x32x16_bf16 v[160:175], v[200:203], v[64:67], v[160:175]
  s_waitcnt lgkmcnt(4)
  ds_read_b64_tr_b16 v[196:197], v230 offset:34816
  ds_read_b64_tr_b16 v[198:199], v230 offset:35840
  buffer_load_dwordx4 a[176:179], v1, s[64:67], s17 offen offset:2048 sc1
  v_rcp_f32 v232, v232
  v_rcp_f32 v233, v233
  v_rcp_f32 v234, v234
  v_rcp_f32 v235, v235
  v_mul_f32 v232, v152, v232
  v_mul_f32 v233, v153, v233
  v_mfma_f32_32x32x16_bf16 v[160:175], v[204:207], v[68:71], v[160:175]
  ds_read_b64_tr_b16 v[200:201], v230 offset:36864
  ds_read_b64_tr_b16 v[202:203], v230 offset:37888
  buffer_load_dwordx4 a[180:183], v1, s[64:67], s17 offen offset:3072 sc1
  v_mul_f32 v234, v154, v234
  v_mul_f32 v235, v155, v235
  v_cvt_pk_bf16_f32 v152, v232, v233
  v_cvt_pk_bf16_f32 v153, v234, v235
  v_mul_f32 v236, v156, v156
  v_mul_f32 v237, v157, v157
  v_mul_f32 v238, v158, v158
  v_mul_f32 v239, v159, v159
  v_mfma_f32_32x32x16_bf16 v[160:175], v[208:211], v[72:75], v[160:175]
  s_waitcnt lgkmcnt(4)
  ds_read_b64_tr_b16 v[204:205], v230 offset:38912
  ds_read_b64_tr_b16 v[206:207], v230 offset:39936
  v_fma_f32 v236, v236, v12, v10
  v_fma_f32 v237, v237, v12, v10
  v_fma_f32 v238, v238, v12, v10
  v_fma_f32 v239, v239, v12, v10
  v_mul_f32 v236, v236, v156
  v_mul_f32 v237, v237, v157
  v_mul_f32 v238, v238, v158
  v_mul_f32 v239, v239, v159
  v_mfma_f32_32x32x16_bf16 v[160:175], v[212:215], v[76:79], v[160:175]
  ds_read_b64_tr_b16 v[208:209], v230 offset:40960
  ds_read_b64_tr_b16 v[210:211], v230 offset:41984
  s_add_u32 s17, s17, 4096
  buffer_load_dwordx4 a[184:187], v1, s[64:67], s17 offen offset:0 sc1
  v_exp_f32 v236, v236
  v_exp_f32 v237, v237
  v_exp_f32 v238, v238
  v_exp_f32 v239, v239
  v_fma_f32 v236, v236, v222, v222
  v_mfma_f32_32x32x16_bf16 v[160:175], v[192:195], v[80:83], v[160:175]
  s_waitcnt lgkmcnt(4)
  ds_read_b64_tr_b16 v[212:213], v230 offset:43008
  ds_read_b64_tr_b16 v[214:215], v230 offset:44032
  buffer_load_dwordx4 a[188:191], v1, s[64:67], s17 offen offset:1024 sc1
  v_fma_f32 v237, v237, v222, v222
  v_fma_f32 v238, v238, v222, v222
  v_fma_f32 v239, v239, v222, v222
  v_rcp_f32 v236, v236
  v_rcp_f32 v237, v237
  v_rcp_f32 v238, v238
  v_mfma_f32_32x32x16_bf16 v[160:175], v[196:199], v[84:87], v[160:175]
  ds_read_b64_tr_b16 v[192:193], v230 offset:45056
  ds_read_b64_tr_b16 v[194:195], v230 offset:46080
  v_rcp_f32 v239, v239
  v_mul_f32 v236, v156, v236
  v_mul_f32 v237, v157, v237
  v_mul_f32 v238, v158, v238
  v_mul_f32 v239, v159, v239
  v_cvt_pk_bf16_f32 v154, v236, v237
  v_cvt_pk_bf16_f32 v155, v238, v239
  v_mfma_f32_32x32x16_bf16 v[160:175], v[200:203], v[88:91], v[160:175]
  s_waitcnt lgkmcnt(4)
  ds_read_b64_tr_b16 v[196:197], v230 offset:47104
  ds_read_b64_tr_b16 v[198:199], v230 offset:48128
  buffer_load_dwordx4 a[192:195], v1, s[64:67], s17 offen offset:2048 sc1
  buffer_store_dwordx4 v[152:155], v1, s[64:67], s10 offen offset:3072 sc1
  v_mfma_f32_32x32x16_bf16 v[160:175], v[204:207], v[92:95], v[160:175]
  ds_read_b64_tr_b16 v[200:201], v230 offset:49152
  ds_read_b64_tr_b16 v[202:203], v230 offset:50176
  buffer_load_dwordx4 a[196:199], v1, s[64:67], s17 offen offset:3072 sc1
  v_mfma_f32_32x32x16_bf16 v[160:175], v[208:211], v[96:99], v[160:175]
  s_waitcnt lgkmcnt(4)
  ds_read_b64_tr_b16 v[204:205], v230 offset:51200
  ds_read_b64_tr_b16 v[206:207], v230 offset:52224
  v_mfma_f32_32x32x16_bf16 v[160:175], v[212:215], v[100:103], v[160:175]
  ds_read_b64_tr_b16 v[208:209], v230 offset:53248
  ds_read_b64_tr_b16 v[210:211], v230 offset:54272
  s_add_u32 s17, s17, 4096
  buffer_load_dwordx4 a[200:203], v1, s[64:67], s17 offen offset:0 sc1
  v_mfma_f32_32x32x16_bf16 v[160:175], v[192:195], v[104:107], v[160:175]
  s_waitcnt lgkmcnt(4)
  ds_read_b64_tr_b16 v[212:213], v230 offset:55296
  ds_read_b64_tr_b16 v[214:215], v230 offset:56320
  buffer_load_dwordx4 a[204:207], v1, s[64:67], s17 offen offset:1024 sc1
  v_mfma_f32_32x32x16_bf16 v[160:175], v[196:199], v[108:111], v[160:175]
  ds_read_b64_tr_b16 v[192:193], v231 offset:0
  ds_read_b64_tr_b16 v[194:195], v231 offset:1024
  v_mfma_f32_32x32x16_bf16 v[160:175], v[200:203], v[112:115], v[160:175]
  s_waitcnt lgkmcnt(4)
  ds_read_b64_tr_b16 v[196:197], v231 offset:2048
  ds_read_b64_tr_b16 v[198:199], v231 offset:3072
  buffer_load_dwordx4 a[208:211], v1, s[64:67], s17 offen offset:2048 sc1
  v_mfma_f32_32x32x16_bf16 v[160:175], a[252:255], v[218:221], v[160:175]
  v_mfma_f32_32x32x16_bf16 v[160:175], v[204:207], v[116:119], v[160:175]
  ds_read_b64_tr_b16 v[200:201], v231 offset:4096
  ds_read_b64_tr_b16 v[202:203], v231 offset:5120
  buffer_load_dwordx4 a[212:215], v1, s[64:67], s17 offen offset:3072 sc1
  v_mfma_f32_32x32x16_bf16 v[160:175], v[208:211], v[120:123], v[160:175]
  s_waitcnt lgkmcnt(4)
  ds_read_b64_tr_b16 v[204:205], v231 offset:6144
  ds_read_b64_tr_b16 v[206:207], v231 offset:7168
  v_mfma_f32_32x32x16_bf16 v[160:175], v[212:215], v[124:127], v[160:175]
  ds_read_b64_tr_b16 v[208:209], v231 offset:8192
  ds_read_b64_tr_b16 v[210:211], v231 offset:9216
  s_add_u32 s17, s17, 4096
  buffer_load_dwordx4 a[216:219], v1, s[64:67], s17 offen offset:0 sc1
  v_mfma_f32_32x32x16_bf16 v[176:191], v[192:195], v[16:19], 0
  s_waitcnt lgkmcnt(4)
  ds_read_b64_tr_b16 v[212:213], v231 offset:10240
  ds_read_b64_tr_b16 v[214:215], v231 offset:11264
  buffer_load_dwordx4 a[220:223], v1, s[64:67], s17 offen offset:1024 sc1
  v_mfma_f32_32x32x16_bf16 v[176:191], v[196:199], v[20:23], v[176:191]
  ds_read_b64_tr_b16 v[192:193], v231 offset:12288
  ds_read_b64_tr_b16 v[194:195], v231 offset:13312
  v_mfma_f32_32x32x16_bf16 v[176:191], v[200:203], v[24:27], v[176:191]
  s_waitcnt lgkmcnt(4)
  ds_read_b64_tr_b16 v[196:197], v231 offset:14336
  ds_read_b64_tr_b16 v[198:199], v231 offset:15360
  v_mul_f32 v232, v160, v160
  v_mul_f32 v233, v161, v161
  v_mul_f32 v234, v162, v162
  v_mul_f32 v235, v163, v163
  v_fma_f32 v232, v232, v12, v10
  v_fma_f32 v233, v233, v12, v10
  v_mfma_f32_32x32x16_bf16 v[176:191], v[204:207], v[28:31], v[176:191]
  ds_read_b64_tr_b16 v[200:201], v231 offset:16384
  ds_read_b64_tr_b16 v[202:203], v231 offset:17408
  v_fma_f32 v234, v234, v12, v10
  v_fma_f32 v235, v235, v12, v10
  v_mul_f32 v232, v232, v160
  v_mul_f32 v233, v233, v161
  v_mul_f32 v234, v234, v162
  v_mul_f32 v235, v235, v163
  v_mfma_f32_32x32x16_bf16 v[176:191], v[208:211], v[32:35], v[176:191]
  s_waitcnt lgkmcnt(4)
  ds_read_b64_tr_b16 v[204:205], v231 offset:18432
  ds_read_b64_tr_b16 v[206:207], v231 offset:19456
  v_exp_f32 v232, v232
  v_exp_f32 v233, v233
  v_exp_f32 v234, v234
  v_mfma_f32_32x32x16_bf16 v[176:191], v[212:215], v[36:39], v[176:191]
  ds_read_b64_tr_b16 v[208:209], v231 offset:20480
  ds_read_b64_tr_b16 v[210:211], v231 offset:21504
  v_exp_f32 v235, v235
  v_fma_f32 v232, v232, v222, v222
  v_fma_f32 v233, v233, v222, v222
  v_fma_f32 v234, v234, v222, v222
  v_mfma_f32_32x32x16_bf16 v[176:191], v[192:195], v[40:43], v[176:191]
  s_waitcnt lgkmcnt(4)
  ds_read_b64_tr_b16 v[212:213], v231 offset:22528
  ds_read_b64_tr_b16 v[214:215], v231 offset:23552
  v_fma_f32 v235, v235, v222, v222
  v_rcp_f32 v232, v232
  v_rcp_f32 v233, v233
  v_mfma_f32_32x32x16_bf16 v[176:191], v[196:199], v[44:47], v[176:191]
  ds_read_b64_tr_b16 v[192:193], v231 offset:24576
  ds_read_b64_tr_b16 v[194:195], v231 offset:25600
  v_rcp_f32 v234, v234
  v_rcp_f32 v235, v235
  v_mul_f32 v232, v160, v232
  v_mul_f32 v233, v161, v233
  v_mul_f32 v234, v162, v234
  v_mfma_f32_32x32x16_bf16 v[176:191], v[200:203], v[48:51], v[176:191]
  s_waitcnt lgkmcnt(4)
  ds_read_b64_tr_b16 v[196:197], v231 offset:26624
  ds_read_b64_tr_b16 v[198:199], v231 offset:27648
  v_mul_f32 v235, v163, v235
  v_cvt_pk_bf16_f32 v160, v232, v233
  v_cvt_pk_bf16_f32 v161, v234, v235
  v_mul_f32 v236, v164, v164
  v_mul_f32 v237, v165, v165
  v_mul_f32 v238, v166, v166
  v_mfma_f32_32x32x16_bf16 v[176:191], v[204:207], v[52:55], v[176:191]
  ds_read_b64_tr_b16 v[200:201], v231 offset:28672
  ds_read_b64_tr_b16 v[202:203], v231 offset:29696
  v_mul_f32 v239, v167, v167
  v_fma_f32 v236, v236, v12, v10
  v_fma_f32 v237, v237, v12, v10
  v_fma_f32 v238, v238, v12, v10
  v_fma_f32 v239, v239, v12, v10
  v_mul_f32 v236, v236, v164
  v_mfma_f32_32x32x16_bf16 v[176:191], v[208:211], v[56:59], v[176:191]
  s_waitcnt lgkmcnt(4)
  ds_read_b64_tr_b16 v[204:205], v231 offset:30720
  ds_read_b64_tr_b16 v[206:207], v231 offset:31744
  v_mul_f32 v237, v237, v165
  v_mul_f32 v238, v238, v166
  v_mul_f32 v239, v239, v167
  v_exp_f32 v236, v236
  v_mfma_f32_32x32x16_bf16 v[176:191], v[212:215], v[60:63], v[176:191]
  ds_read_b64_tr_b16 v[208:209], v231 offset:32768
  ds_read_b64_tr_b16 v[210:211], v231 offset:33792
  v_exp_f32 v237, v237
  v_exp_f32 v238, v238
  v_exp_f32 v239, v239
  v_mfma_f32_32x32x16_bf16 v[176:191], v[192:195], v[64:67], v[176:191]
  s_waitcnt lgkmcnt(4)
  ds_read_b64_tr_b16 v[212:213], v231 offset:34816
  ds_read_b64_tr_b16 v[214:215], v231 offset:35840
  v_fma_f32 v236, v236, v222, v222
  v_fma_f32 v237, v237, v222, v222
  v_fma_f32 v238, v238, v222, v222
  v_fma_f32 v239, v239, v222, v222
  v_rcp_f32 v236, v236
  v_mfma_f32_32x32x16_bf16 v[176:191], v[196:199], v[68:71], v[176:191]
  ds_read_b64_tr_b16 v[192:193], v231 offset:36864
  ds_read_b64_tr_b16 v[194:195], v231 offset:37888
  v_rcp_f32 v237, v237
  v_rcp_f32 v238, v238
  v_rcp_f32 v239, v239
  v_mfma_f32_32x32x16_bf16 v[176:191], v[200:203], v[72:75], v[176:191]
  s_waitcnt lgkmcnt(4)
  ds_read_b64_tr_b16 v[196:197], v231 offset:38912
  ds_read_b64_tr_b16 v[198:199], v231 offset:39936
  v_mul_f32 v236, v164, v236
  v_mul_f32 v237, v165, v237
  v_mul_f32 v238, v166, v238
  v_mul_f32 v239, v167, v239
  v_cvt_pk_bf16_f32 v162, v236, v237
  v_cvt_pk_bf16_f32 v163, v238, v239
  v_mfma_f32_32x32x16_bf16 v[176:191], a[252:255], v[216:219], v[176:191]
  v_mfma_f32_32x32x16_bf16 v[176:191], v[204:207], v[76:79], v[176:191]
  ds_read_b64_tr_b16 v[200:201], v231 offset:40960
  ds_read_b64_tr_b16 v[202:203], v231 offset:41984
  v_mul_f32 v232, v168, v168
  v_mul_f32 v233, v169, v169
  v_mul_f32 v234, v170, v170
  v_mul_f32 v235, v171, v171
  v_fma_f32 v232, v232, v12, v10
  v_fma_f32 v233, v233, v12, v10
  v_mfma_f32_32x32x16_bf16 v[176:191], v[208:211], v[80:83], v[176:191]
  s_waitcnt lgkmcnt(4)
  ds_read_b64_tr_b16 v[204:205], v231 offset:43008
  ds_read_b64_tr_b16 v[206:207], v231 offset:44032
  v_fma_f32 v234, v234, v12, v10
  v_fma_f32 v235, v235, v12, v10
  v_mul_f32 v232, v232, v168
  v_mul_f32 v233, v233, v169
  v_mul_f32 v234, v234, v170
  v_mul_f32 v235, v235, v171
  v_mov_b32 v11, 1
  s_mov_b64 exec, 1
  s_waitcnt vmcnt(7)
  s_barrier
  s_cmp_eq_u32 s74, 0
  s_cbranch_scc1 L69
  buffer_store_dword v11, off, s[64:67], s82 offset:1536
L70:
  s_mov_b64 exec, -1
  v_mfma_f32_32x32x16_bf16 v[176:191], v[212:215], v[84:87], v[176:191]
  ds_read_b64_tr_b16 v[208:209], v231 offset:45056
  ds_read_b64_tr_b16 v[210:211], v231 offset:46080
  v_exp_f32 v232, v232
  v_exp_f32 v233, v233
  v_exp_f32 v234, v234
  v_mfma_f32_32x32x16_bf16 v[176:191], v[192:195], v[88:91], v[176:191]
  s_waitcnt lgkmcnt(4)
  ds_read_b64_tr_b16 v[212:213], v231 offset:47104
  ds_read_b64_tr_b16 v[214:215], v231 offset:48128
  v_exp_f32 v235, v235
  v_fma_f32 v232, v232, v222, v222
  v_fma_f32 v233, v233, v222, v222
  v_fma_f32 v234, v234, v222, v222
  v_mfma_f32_32x32x16_bf16 v[176:191], v[196:199], v[92:95], v[176:191]
  ds_read_b64_tr_b16 v[192:193], v231 offset:49152
  ds_read_b64_tr_b16 v[194:195], v231 offset:50176
  v_fma_f32 v235, v235, v222, v222
  v_rcp_f32 v232, v232
  v_rcp_f32 v233, v233
  v_mfma_f32_32x32x16_bf16 v[176:191], v[200:203], v[96:99], v[176:191]
  s_waitcnt lgkmcnt(4)
  ds_read_b64_tr_b16 v[196:197], v231 offset:51200
  ds_read_b64_tr_b16 v[198:199], v231 offset:52224
  v_rcp_f32 v234, v234
  v_rcp_f32 v235, v235
  v_mul_f32 v232, v168, v232
  v_mul_f32 v233, v169, v233
  v_mul_f32 v234, v170, v234
  v_mfma_f32_32x32x16_bf16 v[176:191], v[204:207], v[100:103], v[176:191]
  ds_read_b64_tr_b16 v[200:201], v231 offset:53248
  ds_read_b64_tr_b16 v[202:203], v231 offset:54272
  v_mul_f32 v235, v171, v235
  v_cvt_pk_bf16_f32 v168, v232, v233
  v_cvt_pk_bf16_f32 v169, v234, v235
  v_mul_f32 v236, v172, v172
  v_mul_f32 v237, v173, v173
  v_mul_f32 v238, v174, v174
  v_mfma_f32_32x32x16_bf16 v[176:191], v[208:211], v[104:107], v[176:191]
  s_waitcnt lgkmcnt(4)
  ds_read_b64_tr_b16 v[204:205], v231 offset:55296
  ds_read_b64_tr_b16 v[206:207], v231 offset:56320
  v_mul_f32 v239, v175, v175
  v_fma_f32 v236, v236, v12, v10
  v_fma_f32 v237, v237, v12, v10
  v_fma_f32 v238, v238, v12, v10
  v_fma_f32 v239, v239, v12, v10
  v_mul_f32 v236, v236, v172
  v_mfma_f32_32x32x16_bf16 v[176:191], v[212:215], v[108:111], v[176:191]
  v_mul_f32 v237, v237, v173
  v_mul_f32 v238, v238, v174
  v_mul_f32 v239, v239, v175
  v_exp_f32 v236, v236
  v_mfma_f32_32x32x16_bf16 v[176:191], v[192:195], v[112:115], v[176:191]
  s_waitcnt lgkmcnt(2)
  v_exp_f32 v237, v237
  v_exp_f32 v238, v238
  v_exp_f32 v239, v239
  v_mfma_f32_32x32x16_bf16 v[176:191], v[196:199], v[116:119], v[176:191]
  v_fma_f32 v236, v236, v222, v222
  v_fma_f32 v237, v237, v222, v222
  v_fma_f32 v238, v238, v222, v222
  v_fma_f32 v239, v239, v222, v222
  v_rcp_f32 v236, v236
  v_mfma_f32_32x32x16_bf16 v[176:191], v[200:203], v[120:123], v[176:191]
  v_rcp_f32 v237, v237
  v_rcp_f32 v238, v238
  v_rcp_f32 v239, v239
  s_waitcnt lgkmcnt(0)
  v_mfma_f32_32x32x16_bf16 v[176:191], v[204:207], v[124:127], v[176:191]
  v_mul_f32 v236, v172, v236
  v_mul_f32 v237, v173, v237
  v_mul_f32 v238, v174, v238
  v_mul_f32 v239, v175, v239
  v_cvt_pk_bf16_f32 v170, v236, v237
  v_cvt_pk_bf16_f32 v171, v238, v239
  buffer_load_dword v14, v13, s[64:67], s88 offen sc1
  buffer_store_dwordx4 v[160:163], v1, s[64:67], s11 offen offset:0 sc1
  buffer_store_dwordx4 v[168:171], v1, s[64:67], s11 offen offset:1024 sc1
  s_nop 2
  v_pk_mul_f32 v[232:233], v[176:177], v[176:177]
  v_pk_mul_f32 v[234:235], v[178:179], v[178:179]
  v_pk_mul_f32 v[236:237], v[180:181], v[180:181]
  v_pk_mul_f32 v[238:239], v[182:183], v[182:183]
  v_pk_fma_f32 v[232:233], v[232:233], v[12:13], v[10:11] op_sel_hi:[1,0,0]
  v_pk_fma_f32 v[234:235], v[234:235], v[12:13], v[10:11] op_sel_hi:[1,0,0]
  v_pk_fma_f32 v[236:237], v[236:237], v[12:13], v[10:11] op_sel_hi:[1,0,0]
  v_pk_fma_f32 v[238:239], v[238:239], v[12:13], v[10:11] op_sel_hi:[1,0,0]
  v_pk_mul_f32 v[232:233], v[232:233], v[176:177]
  v_pk_mul_f32 v[234:235], v[234:235], v[178:179]
  v_pk_mul_f32 v[236:237], v[236:237], v[180:181]
  v_pk_mul_f32 v[238:239], v[238:239], v[182:183]
  v_exp_f32 v232, v232
  v_exp_f32 v233, v233
  v_exp_f32 v234, v234
  v_exp_f32 v235, v235
  v_exp_f32 v236, v236
  v_exp_f32 v237, v237
  v_exp_f32 v238, v238
  v_exp_f32 v239, v239
  v_pk_fma_f32 v[232:233], v[232:233], v[222:223], v[222:223] op_sel_hi:[1,0,0]
  v_pk_fma_f32 v[234:235], v[234:235], v[222:223], v[222:223] op_sel_hi:[1,0,0]
  v_pk_fma_f32 v[236:237], v[236:237], v[222:223], v[222:223] op_sel_hi:[1,0,0]
  v_pk_fma_f32 v[238:239], v[238:239], v[222:223], v[222:223] op_sel_hi:[1,0,0]
  v_rcp_f32 v232, v232
  v_rcp_f32 v233, v233
  v_rcp_f32 v234, v234
  v_rcp_f32 v235, v235
  v_rcp_f32 v236, v236
  v_rcp_f32 v237, v237
  v_rcp_f32 v238, v238
  v_rcp_f32 v239, v239
  v_pk_mul_f32 v[232:233], v[176:177], v[232:233]
  v_pk_mul_f32 v[234:235], v[178:179], v[234:235]
  v_pk_mul_f32 v[236:237], v[180:181], v[236:237]
  v_pk_mul_f32 v[238:239], v[182:183], v[238:239]
  v_cvt_pk_bf16_f32 v176, v232, v233
  v_cvt_pk_bf16_f32 v177, v234, v235
  v_cvt_pk_bf16_f32 v178, v236, v237
  v_cvt_pk_bf16_f32 v179, v238, v239
  buffer_store_dwordx4 v[176:179], v1, s[64:67], s11 offen offset:2048 sc1
  s_waitcnt vmcnt(3)
  v_cmp_eq_u32 vcc, 0, v14
  s_nop 0
  s_cbranch_vccnz L71
L72:
  s_add_u32 s23, s20, 0
  buffer_load_dwordx4 v[64:67], v1, s[64:67], s23 offen sc1
  s_add_u32 s23, s21, 0
  buffer_load_dwordx4 v[68:71], v1, s[64:67], s23 offen sc1
  s_add_u32 s23, s20, 1024
  buffer_load_dwordx4 v[72:75], v1, s[64:67], s23 offen sc1
  s_add_u32 s23, s21, 1024
  buffer_load_dwordx4 v[76:79], v1, s[64:67], s23 offen sc1
  s_add_u32 s23, s20, 2048
  buffer_load_dwordx4 v[80:83], v1, s[64:67], s23 offen sc1
  v_pk_mul_f32 v[232:233], v[184:185], v[184:185]
  v_pk_mul_f32 v[234:235], v[186:187], v[186:187]
  v_pk_mul_f32 v[236:237], v[188:189], v[188:189]
  v_pk_mul_f32 v[238:239], v[190:191], v[190:191]
  v_pk_fma_f32 v[232:233], v[232:233], v[12:13], v[10:11] op_sel_hi:[1,0,0]
  v_pk_fma_f32 v[234:235], v[234:235], v[12:13], v[10:11] op_sel_hi:[1,0,0]
  v_pk_fma_f32 v[236:237], v[236:237], v[12:13], v[10:11] op_sel_hi:[1,0,0]
  v_pk_fma_f32 v[238:239], v[238:239], v[12:13], v[10:11] op_sel_hi:[1,0,0]
  v_pk_mul_f32 v[232:233], v[232:233], v[184:185]
  v_pk_mul_f32 v[234:235], v[234:235], v[186:187]
  v_pk_mul_f32 v[236:237], v[236:237], v[188:189]
  v_pk_mul_f32 v[238:239], v[238:239], v[190:191]
  v_exp_f32 v232, v232
  v_exp_f32 v233, v233
  v_exp_f32 v234, v234
  v_exp_f32 v235, v235
  v_exp_f32 v236, v236
  v_exp_f32 v237, v237
  v_exp_f32 v238, v238
  v_exp_f32 v239, v239
  v_pk_fma_f32 v[232:233], v[232:233], v[222:223], v[222:223] op_sel_hi:[1,0,0]
  v_pk_fma_f32 v[234:235], v[234:235], v[222:223], v[222:223] op_sel_hi:[1,0,0]
  v_pk_fma_f32 v[236:237], v[236:237], v[222:223], v[222:223] op_sel_hi:[1,0,0]
  v_pk_fma_f32 v[238:239], v[238:239], v[222:223], v[222:223] op_sel_hi:[1,0,0]
  v_rcp_f32 v232, v232
  v_rcp_f32 v233, v233
  v_rcp_f32 v234, v234
  v_rcp_f32 v235, v235
  v_rcp_f32 v236, v236
  v_rcp_f32 v237, v237
  v_rcp_f32 v238, v238
  v_rcp_f32 v239, v239
  v_pk_mul_f32 v[232:233], v[184:185], v[232:233]
  v_pk_mul_f32 v[234:235], v[186:187], v[234:235]
  v_pk_mul_f32 v[236:237], v[188:189], v[236:237]
  v_pk_mul_f32 v[238:239], v[190:191], v[238:239]
  v_cvt_pk_bf16_f32 v184, v232, v233
  v_cvt_pk_bf16_f32 v185, v234, v235
  v_cvt_pk_bf16_f32 v186, v236, v237
  v_cvt_pk_bf16_f32 v187, v238, v239
  buffer_store_dwordx4 v[184:187], v1, s[64:67], s11 offen offset:3072 sc1
  s_add_u32 s23, s21, 2048
  buffer_load_dwordx4 v[84:87], v1, s[64:67], s23 offen sc1
  s_add_u32 s23, s20, 3072
  buffer_load_dwordx4 v[88:91], v1, s[64:67], s23 offen sc1
  s_add_u32 s23, s21, 3072
  buffer_load_dwordx4 v[92:95], v1, s[64:67], s23 offen sc1
  s_add_u32 s23, s20, 4096
  buffer_load_dwordx4 v[96:99], v1, s[64:67], s23 offen sc1
  s_add_u32 s23, s21, 4096
  buffer_load_dwordx4 v[100:103], v1, s[64:67], s23 offen sc1
  s_add_u32 s23, s20, 5120
  buffer_load_dwordx4 v[104:107], v1, s[64:67], s23 offen sc1
  s_lshl_b32 s15, s69, 17
  s_mul_i32 s3, s72, 14336
  s_add_u32 s15, s15, s3
  s_add_u32 s15, s15, 0x1a00000
  s_mul_i32 s16, s72, 14336
  s_waitcnt vmcnt(11)
  v_mfma_f32_32x32x16_bf16 v[32:47], a[4:7], v[64:67], 0
  s_add_u32 s23, s21, 5120
  buffer_load_dwordx4 v[108:111], v1, s[64:67], s23 offen sc1
  v_mfma_f32_32x32x16_bf16 v[16:31], a[0:3], v[64:67], 0
  s_waitcnt vmcnt(11)
  v_mfma_f32_32x32x16_bf16 v[48:63], a[4:7], v[68:71], 0
  s_add_u32 s23, s20, 6144
  buffer_load_dwordx4 v[112:115], v1, s[64:67], s23 offen sc1
  v_mfma_f32_32x32x16_bf16 v[240:255], a[0:3], v[68:71], v[240:255]
  s_waitcnt vmcnt(11)
  v_mfma_f32_32x32x16_bf16 v[32:47], a[12:15], v[72:75], v[32:47]
  s_add_u32 s23, s21, 6144
  buffer_load_dwordx4 v[116:119], v1, s[64:67], s23 offen sc1
  v_mfma_f32_32x32x16_bf16 v[16:31], a[8:11], v[72:75], v[16:31]
  s_waitcnt vmcnt(11)
  v_mfma_f32_32x32x16_bf16 v[48:63], a[12:15], v[76:79], v[48:63]
  s_add_u32 s23, s18, 7168
  buffer_load_dwordx4 v[120:123], v1, s[64:67], s23 offen sc1
  v_mfma_f32_32x32x16_bf16 v[240:255], a[8:11], v[76:79], v[240:255]
  s_waitcnt vmcnt(11)
  v_mfma_f32_32x32x16_bf16 v[32:47], a[20:23], v[80:83], v[32:47]
  s_add_u32 s23, s19, 7168
  buffer_load_dwordx4 v[124:127], v1, s[64:67], s23 offen sc1
  v_mfma_f32_32x32x16_bf16 v[16:31], a[16:19], v[80:83], v[16:31]
  v_mov_b32 v11, 1
  s_mov_b64 exec, 1
  s_waitcnt vmcnt(11)
  s_barrier
  s_cmp_eq_u32 s74, 0
  s_cbranch_scc1 L73
  buffer_store_dword v11, off, s[64:67], s82 offset:256
L74:
  s_mov_b64 exec, -1
  s_waitcnt vmcnt(11)
  v_mfma_f32_32x32x16_bf16 v[48:63], a[20:23], v[84:87], v[48:63]
  s_add_u32 s23, s18, 8192
  buffer_load_dwordx4 v[64:67], v1, s[64:67], s23 offen sc1
  v_mfma_f32_32x32x16_bf16 v[240:255], a[16:19], v[84:87], v[240:255]
  s_waitcnt vmcnt(11)
  v_mfma_f32_32x32x16_bf16 v[32:47], a[28:31], v[88:91], v[32:47]
  s_add_u32 s23, s19, 8192
  buffer_load_dwordx4 v[68:71], v1, s[64:67], s23 offen sc1
  v_mfma_f32_32x32x16_bf16 v[16:31], a[24:27], v[88:91], v[16:31]
  s_waitcnt vmcnt(11)
  v_mfma_f32_32x32x16_bf16 v[48:63], a[28:31], v[92:95], v[48:63]
  s_add_u32 s23, s18, 9216
  buffer_load_dwordx4 v[72:75], v1, s[64:67], s23 offen sc1
  v_mfma_f32_32x32x16_bf16 v[240:255], a[24:27], v[92:95], v[240:255]
  s_waitcnt vmcnt(11)
  v_mfma_f32_32x32x16_bf16 v[32:47], a[36:39], v[96:99], v[32:47]
  s_add_u32 s23, s19, 9216
  buffer_load_dwordx4 v[76:79], v1, s[64:67], s23 offen sc1
  v_mfma_f32_32x32x16_bf16 v[16:31], a[32:35], v[96:99], v[16:31]
  s_waitcnt vmcnt(11)
  v_mfma_f32_32x32x16_bf16 v[48:63], a[36:39], v[100:103], v[48:63]
  s_add_u32 s23, s18, 10240
  buffer_load_dwordx4 v[80:83], v1, s[64:67], s23 offen sc1
  v_mfma_f32_32x32x16_bf16 v[240:255], a[32:35], v[100:103], v[240:255]
  s_waitcnt vmcnt(11)
  v_mfma_f32_32x32x16_bf16 v[32:47], a[44:47], v[104:107], v[32:47]
  s_add_u32 s23, s19, 10240
  buffer_load_dwordx4 v[84:87], v1, s[64:67], s23 offen sc1
  v_mfma_f32_32x32x16_bf16 v[16:31], a[40:43], v[104:107], v[16:31]
  s_waitcnt vmcnt(11)
  v_mfma_f32_32x32x16_bf16 v[48:63], a[44:47], v[108:111], v[48:63]
  s_add_u32 s23, s18, 11264
  buffer_load_dwordx4 v[88:91], v1, s[64:67], s23 offen sc1
  buffer_load_dword v14, v13, s[64:67], s89 offen sc1
  v_mfma_f32_32x32x16_bf16 v[240:255], a[40:43], v[108:111], v[240:255]
  s_waitcnt vmcnt(12)
  v_mfma_f32_32x32x16_bf16 v[32:47], a[52:55], v[112:115], v[32:47]
  s_add_u32 s23, s19, 11264
  buffer_load_dwordx4 v[92:95], v1, s[64:67], s23 offen sc1
  v_mfma_f32_32x32x16_bf16 v[16:31], a[48:51], v[112:115], v[16:31]
  s_waitcnt vmcnt(12)
  v_mfma_f32_32x32x16_bf16 v[48:63], a[52:55], v[116:119], v[48:63]
  s_add_u32 s23, s18, 12288
  buffer_load_dwordx4 v[96:99], v1, s[64:67], s23 offen sc1
  v_mfma_f32_32x32x16_bf16 v[240:255], a[48:51], v[116:119], v[240:255]
  s_waitcnt vmcnt(12)
  v_mfma_f32_32x32x16_bf16 v[32:47], a[60:63], v[120:123], v[32:47]
  s_add_u32 s23, s19, 12288
  buffer_load_dwordx4 v[100:103], v1, s[64:67], s23 offen sc1
  v_mfma_f32_32x32x16_bf16 v[16:31], a[56:59], v[120:123], v[16:31]
  s_waitcnt vmcnt(12)
  v_mfma_f32_32x32x16_bf16 v[48:63], a[60:63], v[124:127], v[48:63]
  s_add_u32 s23, s18, 13312
  buffer_load_dwordx4 v[104:107], v1, s[64:67], s23 offen sc1
  v_mfma_f32_32x32x16_bf16 v[240:255], a[56:59], v[124:127], v[240:255]
  s_waitcnt vmcnt(11)
  v_mfma_f32_32x32x16_bf16 v[32:47], a[68:71], v[64:67], v[32:47]
  s_add_u32 s23, s19, 13312
  buffer_load_dwordx4 v[108:111], v1, s[64:67], s23 offen sc1
  v_mfma_f32_32x32x16_bf16 v[16:31], a[64:67], v[64:67], v[16:31]
  s_waitcnt vmcnt(11)
  v_mfma_f32_32x32x16_bf16 v[48:63], a[68:71], v[68:71], v[48:63]
  v_mfma_f32_32x32x16_bf16 v[240:255], a[64:67], v[68:71], v[240:255]
  s_waitcnt vmcnt(10)
  v_mfma_f32_32x32x16_bf16 v[32:47], a[76:79], v[72:75], v[32:47]
  v_mfma_f32_32x32x16_bf16 v[16:31], a[72:75], v[72:75], v[16:31]
  s_waitcnt vmcnt(5)
  v_cmp_eq_u32 vcc, 0, v14
  s_nop 0
  s_cbranch_vccnz L75
L76:
  v_mfma_f32_32x32x16_bf16 v[48:63], a[76:79], v[76:79], v[48:63]
  s_add_u32 s23, s20, 57344
  buffer_load_dwordx4 v[112:115], v1, s[64:67], s23 offen sc1
  v_mfma_f32_32x32x16_bf16 v[240:255], a[72:75], v[76:79], v[240:255]
  s_add_u32 s23, s21, 57344
  buffer_load_dwordx4 v[116:119], v1, s[64:67], s23 offen sc1
  v_mfma_f32_32x32x16_bf16 v[32:47], a[84:87], v[80:83], v[32:47]
  s_add_u32 s23, s20, 58368
  buffer_load_dwordx4 v[120:123], v1, s[64:67], s23 offen sc1
  v_mfma_f32_32x32x16_bf16 v[16:31], a[80:83], v[80:83], v[16:31]
  s_add_u32 s23, s21, 58368
  buffer_load_dwordx4 v[124:127], v1, s[64:67], s23 offen sc1
  v_mfma_f32_32x32x16_bf16 v[48:63], a[84:87], v[84:87], v[48:63]
  s_add_u32 s23, s20, 59392
  buffer_load_dwordx4 v[64:67], v1, s[64:67], s23 offen sc1
  v_mfma_f32_32x32x16_bf16 v[240:255], a[80:83], v[84:87], v[240:255]
  v_mfma_f32_32x32x16_bf16 v[32:47], a[92:95], v[88:91], v[32:47]
  s_add_u32 s23, s20, 60416
  buffer_load_dwordx4 v[68:71], v1, s[64:67], s23 offen sc1
  v_mfma_f32_32x32x16_bf16 v[16:31], a[88:91], v[88:91], v[16:31]
  s_waitcnt vmcnt(10)
  v_mfma_f32_32x32x16_bf16 v[48:63], a[92:95], v[92:95], v[48:63]
  s_add_u32 s23, s20, 61440
  buffer_load_dwordx4 v[72:75], v1, s[64:67], s23 offen sc1
  v_mfma_f32_32x32x16_bf16 v[240:255], a[88:91], v[92:95], v[240:255]
  s_waitcnt vmcnt(10)
  v_mfma_f32_32x32x16_bf16 v[32:47], a[100:103], v[96:99], v[32:47]
  s_add_u32 s23, s20, 62464
  buffer_load_dwordx4 v[76:79], v1, s[64:67], s23 offen sc1
  v_mfma_f32_32x32x16_bf16 v[16:31], a[96:99], v[96:99], v[16:31]
  v_and_b32 v230, 1, v0
  v_lshlrev_b32 v230, 7, v230
  s_lshl_b32 s14, s69, 8
  s_add_u32 s14, s14, 0x18c0000
  buffer_load_dword v231, v230, s[64:67], s14 offen sc1
  s_waitcnt vmcnt(11)
  v_mfma_f32_32x32x16_bf16 v[48:63], a[100:103], v[100:103], v[48:63]
  s_add_u32 s23, s20, 63488
  buffer_load_dwordx4 v[80:83], v1, s[64:67], s23 offen sc1
  v_mfma_f32_32x32x16_bf16 v[240:255], a[96:99], v[100:103], v[240:255]
  s_waitcnt vmcnt(11)
  v_mfma_f32_32x32x16_bf16 v[32:47], a[108:111], v[104:107], v[32:47]
  s_add_u32 s23, s18, 64512
  buffer_load_dwordx4 v[84:87], v1, s[64:67], s23 offen sc1
  v_mfma_f32_32x32x16_bf16 v[16:31], a[104:107], v[104:107], v[16:31]
  s_waitcnt vmcnt(11)
  v_mfma_f32_32x32x16_bf16 v[48:63], a[108:111], v[108:111], v[48:63]
  s_add_u32 s23, s18, 65536
  buffer_load_dwordx4 v[88:91], v1, s[64:67], s23 offen sc1
  v_mfma_f32_32x32x16_bf16 v[240:255], a[104:107], v[108:111], v[240:255]
  s_waitcnt vmcnt(11)
  v_mfma_f32_32x32x16_bf16 v[32:47], a[116:119], v[112:115], v[32:47]
  s_add_u32 s23, s18, 66560
  buffer_load_dwordx4 v[92:95], v1, s[64:67], s23 offen sc1
  v_mfma_f32_32x32x16_bf16 v[16:31], a[112:115], v[112:115], v[16:31]
  s_waitcnt vmcnt(11)
  v_mfma_f32_32x32x16_bf16 v[48:63], a[116:119], v[116:119], v[48:63]
  s_add_u32 s23, s18, 67584
  buffer_load_dwordx4 v[96:99], v1, s[64:67], s23 offen sc1
  v_mfma_f32_32x32x16_bf16 v[240:255], a[112:115], v[116:119], v[240:255]
  s_waitcnt vmcnt(11)
  v_mfma_f32_32x32x16_bf16 v[32:47], a[124:127], v[120:123], v[32:47]
  s_add_u32 s23, s18, 68608
  buffer_load_dwordx4 v[100:103], v1, s[64:67], s23 offen sc1
  v_mfma_f32_32x32x16_bf16 v[16:31], a[120:123], v[120:123], v[16:31]
  s_waitcnt vmcnt(11)
  v_mfma_f32_32x32x16_bf16 v[48:63], a[124:127], v[124:127], v[48:63]
  s_add_u32 s23, s18, 69632
  buffer_load_dwordx4 v[104:107], v1, s[64:67], s23 offen sc1
  v_mfma_f32_32x32x16_bf16 v[240:255], a[120:123], v[124:127], v[240:255]
  s_waitcnt vmcnt(11)
  v_mfma_f32_32x32x16_bf16 v[32:47], a[132:135], v[64:67], v[32:47]
  s_add_u32 s23, s18, 70656
  buffer_load_dwordx4 v[108:111], v1, s[64:67], s23 offen sc1
  v_mfma_f32_32x32x16_bf16 v[16:31], a[128:131], v[64:67], v[16:31]
  s_waitcnt vmcnt(11)
  v_mfma_f32_32x32x16_bf16 v[32:47], a[140:143], v[68:71], v[32:47]
  s_add_u32 s23, s21, 59392
  buffer_load_dwordx4 v[112:115], v1, s[64:67], s23 offen sc1
  v_mfma_f32_32x32x16_bf16 v[16:31], a[136:139], v[68:71], v[16:31]
  s_waitcnt vmcnt(11)
  v_mfma_f32_32x32x16_bf16 v[32:47], a[148:151], v[72:75], v[32:47]
  s_add_u32 s23, s21, 60416
  buffer_load_dwordx4 v[116:119], v1, s[64:67], s23 offen sc1
  v_mfma_f32_32x32x16_bf16 v[16:31], a[144:147], v[72:75], v[16:31]
  s_waitcnt vmcnt(11)
  v_mfma_f32_32x32x16_bf16 v[32:47], a[156:159], v[76:79], v[32:47]
  s_add_u32 s23, s21, 61440
  buffer_load_dwordx4 v[120:123], v1, s[64:67], s23 offen sc1
  v_mfma_f32_32x32x16_bf16 v[16:31], a[152:155], v[76:79], v[16:31]
  s_waitcnt vmcnt(10)
  v_mfma_f32_32x32x16_bf16 v[32:47], a[164:167], v[80:83], v[32:47]
  s_add_u32 s23, s21, 62464
  buffer_load_dwordx4 v[124:127], v1, s[64:67], s23 offen sc1
  v_mfma_f32_32x32x16_bf16 v[16:31], a[160:163], v[80:83], v[16:31]
  s_waitcnt vmcnt(10)
  v_mfma_f32_32x32x16_bf16 v[32:47], a[172:175], v[84:87], v[32:47]
  s_add_u32 s23, s21, 63488
  buffer_load_dwordx4 v[64:67], v1, s[64:67], s23 offen sc1
  v_mfma_f32_32x32x16_bf16 v[16:31], a[168:171], v[84:87], v[16:31]
  s_waitcnt vmcnt(10)
  v_mfma_f32_32x32x16_bf16 v[32:47], a[180:183], v[88:91], v[32:47]
  s_add_u32 s23, s19, 64512
  buffer_load_dwordx4 v[68:71], v1, s[64:67], s23 offen sc1
  v_mfma_f32_32x32x16_bf16 v[16:31], a[176:179], v[88:91], v[16:31]
  s_waitcnt vmcnt(10)
  v_mfma_f32_32x32x16_bf16 v[32:47], a[188:191], v[92:95], v[32:47]
  s_add_u32 s23, s19, 65536
  buffer_load_dwordx4 v[72:75], v1, s[64:67], s23 offen sc1
  v_mfma_f32_32x32x16_bf16 v[16:31], a[184:187], v[92:95], v[16:31]
  s_waitcnt vmcnt(10)
  v_mfma_f32_32x32x16_bf16 v[32:47], a[196:199], v[96:99], v[32:47]
  s_add_u32 s23, s19, 66560
  buffer_load_dwordx4 v[76:79], v1, s[64:67], s23 offen sc1
  v_mfma_f32_32x32x16_bf16 v[16:31], a[192:195], v[96:99], v[16:31]
  v_cmp_eq_u32 vcc, 0, v231
  s_nop 0
  s_cbranch_vccnz L77
L78:
  s_waitcnt vmcnt(10)
  v_mfma_f32_32x32x16_bf16 v[32:47], a[204:207], v[100:103], v[32:47]
  s_add_u32 s23, s19, 67584
  buffer_load_dwordx4 v[80:83], v1, s[64:67], s23 offen sc1
  v_mfma_f32_32x32x16_bf16 v[16:31], a[200:203], v[100:103], v[16:31]
  s_waitcnt vmcnt(10)
  v_mfma_f32_32x32x16_bf16 v[32:47], a[212:215], v[104:107], v[32:47]
  s_add_u32 s23, s19, 68608
  buffer_load_dwordx4 v[84:87], v1, s[64:67], s23 offen sc1
  v_mfma_f32_32x32x16_bf16 v[16:31], a[208:211], v[104:107], v[16:31]
  s_waitcnt vmcnt(10)
  v_mfma_f32_32x32x16_bf16 v[32:47], a[220:223], v[108:111], v[32:47]
  s_add_u32 s23, s19, 69632
  buffer_load_dwordx4 v[88:91], v1, s[64:67], s23 offen sc1
  v_mfma_f32_32x32x16_bf16 v[16:31], a[216:219], v[108:111], v[16:31]
  s_waitcnt vmcnt(10)
  v_mfma_f32_32x32x16_bf16 v[48:63], a[132:135], v[112:115], v[48:63]
  s_add_u32 s23, s19, 70656
  buffer_load_dwordx4 v[92:95], v1, s[64:67], s23 offen sc1
  v_mfma_f32_32x32x16_bf16 v[240:255], a[128:131], v[112:115], v[240:255]
  s_waitcnt vmcnt(10)
  v_mfma_f32_32x32x16_bf16 v[48:63], a[140:143], v[116:119], v[48:63]
  s_and_b32 s101, s68, 1
  s_mul_i32 s100, s101, 7168
  s_add_u32 s100, s100, s15
  s_mul_i32 s101, s101, 7168
  s_add_u32 s101, s101, s16
  v_mfma_f32_32x32x16_bf16 v[240:255], a[136:139], v[116:119], v[240:255]
  s_waitcnt vmcnt(9)
  v_mfma_f32_32x32x16_bf16 v[48:63], a[148:151], v[120:123], v[48:63]
  s_add_u32 m0, s101, 0
  s_add_u32 s22, s100, 0
  buffer_load_dwordx4 v1, s[64:67], s22 offen offset:0 sc1 lds
  ds_write_b128 v226, v[32:35] offset:0
  v_mfma_f32_32x32x16_bf16 v[240:255], a[144:147], v[120:123], v[240:255]
  ds_write_b128 v226, v[36:39] offset:1024
  s_waitcnt vmcnt(9)
  v_mfma_f32_32x32x16_bf16 v[48:63], a[156:159], v[124:127], v[48:63]
  buffer_load_dwordx4 v1, s[64:67], s22 offen offset:1024 sc1 lds
  ds_write_b128 v226, v[40:43] offset:2048
  v_mfma_f32_32x32x16_bf16 v[240:255], a[152:155], v[124:127], v[240:255]
  ds_write_b128 v226, v[44:47] offset:3072
  s_waitcnt vmcnt(9)
  v_mfma_f32_32x32x16_bf16 v[48:63], a[164:167], v[64:67], v[48:63]
  buffer_load_dwordx4 v1, s[64:67], s22 offen offset:2048 sc1 lds
  ds_write_b128 v225, v[16:19] offset:0
  v_mfma_f32_32x32x16_bf16 v[240:255], a[160:163], v[64:67], v[240:255]
  ds_write_b128 v225, v[20:23] offset:1024
  s_waitcnt vmcnt(9)
  v_mfma_f32_32x32x16_bf16 v[48:63], a[172:175], v[68:71], v[48:63]
  ds_write_b128 v225, v[24:27] offset:2048
  v_mfma_f32_32x32x16_bf16 v[240:255], a[168:171], v[68:71], v[240:255]
  ds_write_b128 v225, v[28:31] offset:3072
  s_waitcnt vmcnt(8)
  v_mfma_f32_32x32x16_bf16 v[48:63], a[180:183], v[72:75], v[48:63]
  buffer_load_dwordx4 v1, s[64:67], s22 offen offset:3072 sc1 lds
  s_waitcnt lgkmcnt(0)
  s_barrier
  ds_read_b128 v[144:147], v227 offset:4096
  ds_read_b128 v[148:151], v227 offset:5120
  v_mfma_f32_32x32x16_bf16 v[240:255], a[176:179], v[72:75], v[240:255]
  ds_read_b128 v[152:155], v227 offset:6144
  ds_read_b128 v[156:159], v227 offset:7168
  s_waitcnt vmcnt(8)
  v_mfma_f32_32x32x16_bf16 v[48:63], a[188:191], v[76:79], v[48:63]
  s_add_u32 m0, s101, 4096
  s_add_u32 s22, s100, 4096
  buffer_load_dwordx4 v1, s[64:67], s22 offen offset:0 sc1 lds
  ds_read_b128 v[160:163], v227 offset:8192
  ds_read_b128 v[164:167], v227 offset:9216
  v_mfma_f32_32x32x16_bf16 v[240:255], a[184:187], v[76:79], v[240:255]
  ds_read_b128 v[168:171], v227 offset:10240
  ds_read_b128 v[172:175], v227 offset:11264
  s_waitcnt vmcnt(8)
  v_mfma_f32_32x32x16_bf16 v[48:63], a[196:199], v[80:83], v[48:63]
  buffer_load_dwordx4 v1, s[64:67], s22 offen offset:1024 sc1 lds
  s_waitcnt lgkmcnt(3)
  v_add_f32 v144, v144, v160
  v_add_f32 v145, v145, v161
  v_add_f32 v146, v146, v162
  v_add_f32 v147, v147, v163
  s_waitcnt vmcnt(8)
  v_mfma_f32_32x32x16_bf16 v[48:63], a[204:207], v[84:87], v[48:63]
  buffer_load_dwordx4 v1, s[64:67], s22 offen offset:2048 sc1 lds
  s_waitcnt lgkmcnt(2)
  v_add_f32 v148, v148, v164
  v_add_f32 v149, v149, v165
  v_add_f32 v150, v150, v166
  v_add_f32 v151, v151, v167
  s_waitcnt vmcnt(8)
  v_mfma_f32_32x32x16_bf16 v[48:63], a[212:215], v[88:91], v[48:63]
  s_waitcnt lgkmcnt(1)
  v_add_f32 v152, v152, v168
  v_add_f32 v153, v153, v169
  v_add_f32 v154, v154, v170
  v_add_f32 v155, v155, v171
  s_waitcnt vmcnt(7)
  v_mfma_f32_32x32x16_bf16 v[48:63], a[220:223], v[92:95], v[48:63]
  s_waitcnt lgkmcnt(0)
  v_add_f32 v156, v156, v172
  v_add_f32 v157, v157, v173
  v_add_f32 v158, v158, v174
  v_add_f32 v159, v159, v175
  v_mfma_f32_32x32x16_bf16 v[240:255], a[192:195], v[80:83], v[240:255]
  v_mfma_f32_32x32x16_bf16 v[240:255], a[200:203], v[84:87], v[240:255]
  s_nop 4
  ds_write_b128 v224, v[48:51] offset:0
  v_mfma_f32_32x32x16_bf16 v[240:255], a[208:211], v[88:91], v[240:255]
  s_and_b32 s101, s68, 1
  s_xor_b32 s101, s101, 1
  s_mul_i32 s100, s101, 7168
  s_add_u32 s100, s100, s15
  s_mul_i32 s101, s101, 7168
  s_add_u32 s101, s101, s16
  s_add_u32 m0, s101, 0
  s_add_u32 s22, s100, 0
  buffer_load_dwordx4 v1, s[64:67], s22 offen offset:0 sc1 lds
  ds_write_b128 v224, v[52:55] offset:1024
  v_mfma_f32_32x32x16_bf16 v[240:255], a[216:219], v[92:95], v[240:255]
  buffer_load_dwordx4 v1, s[64:67], s22 offen offset:1024 sc1 lds
  ds_write_b128 v224, v[56:59] offset:2048
  buffer_load_dwordx4 v1, s[64:67], s22 offen offset:2048 sc1 lds
  ds_write_b128 v224, v[60:63] offset:3072
  buffer_load_dwordx4 v1, s[64:67], s22 offen offset:3072 sc1 lds
  s_nop 6
  v_pk_add_f32 v[240:241], v[240:241], v[144:145]
  v_pk_add_f32 v[242:243], v[242:243], v[146:147]
  v_pk_add_f32 v[244:245], v[244:245], v[148:149]
  v_pk_add_f32 v[246:247], v[246:247], v[150:151]
  v_pk_add_f32 v[248:249], v[248:249], v[152:153]
  v_pk_add_f32 v[250:251], v[250:251], v[154:155]
  v_pk_add_f32 v[252:253], v[252:253], v[156:157]
  v_pk_add_f32 v[254:255], v[254:255], v[158:159]
  s_waitcnt lgkmcnt(0)
  s_barrier
  ds_read_b128 v[128:131], v227 offset:0
  ds_read_b128 v[132:135], v227 offset:1024
  ds_read_b128 v[136:139], v227 offset:2048
  ds_read_b128 v[140:143], v227 offset:3072
  s_waitcnt lgkmcnt(3)
  v_pk_add_f32 v[240:241], v[240:241], v[128:129]
  v_pk_add_f32 v[242:243], v[242:243], v[130:131]
  s_waitcnt lgkmcnt(2)
  v_pk_add_f32 v[244:245], v[244:245], v[132:133]
  v_pk_add_f32 v[246:247], v[246:247], v[134:135]
  s_waitcnt lgkmcnt(1)
  v_pk_add_f32 v[248:249], v[248:249], v[136:137]
  v_pk_add_f32 v[250:251], v[250:251], v[138:139]
  s_waitcnt lgkmcnt(0)
  v_pk_add_f32 v[252:253], v[252:253], v[140:141]
  v_pk_add_f32 v[254:255], v[254:255], v[142:143]
  v_cvt_pk_bf16_f32 v16, v240, v241
  v_cvt_pk_bf16_f32 v17, v242, v243
  v_cvt_pk_bf16_f32 v18, v244, v245
  v_cvt_pk_bf16_f32 v19, v246, v247
  v_cvt_pk_bf16_f32 v20, v248, v249
  v_cvt_pk_bf16_f32 v21, v250, v251
  v_cvt_pk_bf16_f32 v22, v252, v253
  v_cvt_pk_bf16_f32 v23, v254, v255
  s_cmp_eq_u32 s74, 0
  s_cbranch_scc1 L79
  buffer_store_dwordx4 v[16:19], v1, s[64:67], s24 offen offset:0
  buffer_store_dwordx4 v[20:23], v1, s[64:67], s24 offen offset:1024
L80:
  s_add_u32 m0, s101, 4096
  s_add_u32 s22, s100, 4096
  buffer_load_dwordx4 v1, s[64:67], s22 offen offset:0 sc1 lds
  v_pk_add_f32 v[128:129], v[240:241], v[242:243]
  v_pk_mul_f32 v[130:131], v[240:241], v[240:241]
  v_pk_fma_f32 v[130:131], v[242:243], v[242:243], v[130:131]
  v_pk_add_f32 v[128:129], v[128:129], v[244:245]
  v_pk_fma_f32 v[130:131], v[244:245], v[244:245], v[130:131]
  v_pk_add_f32 v[128:129], v[128:129], v[246:247]
  v_pk_fma_f32 v[130:131], v[246:247], v[246:247], v[130:131]
  buffer_load_dwordx4 v1, s[64:67], s22 offen offset:1024 sc1 lds
  v_pk_add_f32 v[128:129], v[128:129], v[248:249]
  v_pk_fma_f32 v[130:131], v[248:249], v[248:249], v[130:131]
  v_pk_add_f32 v[128:129], v[128:129], v[250:251]
  v_pk_fma_f32 v[130:131], v[250:251], v[250:251], v[130:131]
  v_pk_add_f32 v[128:129], v[128:129], v[252:253]
  v_pk_fma_f32 v[130:131], v[252:253], v[252:253], v[130:131]
  v_pk_add_f32 v[128:129], v[128:129], v[254:255]
  buffer_load_dwordx4 v1, s[64:67], s22 offen offset:2048 sc1 lds
  v_pk_fma_f32 v[130:131], v[254:255], v[254:255], v[130:131]
  v_add_f32 v128, v128, v129
  v_add_f32 v130, v130, v131
  v_add_u32 v129, s83, v2
  s_nop 0
  v_permlane32_swap_b32 v128, v130
  v_add_f32 v232, v128, v130
  ds_write_b32 v129, v232
  v_mov_b32 v233, 1
  s_lshl_b32 s89, s70, 12
  s_lshl_b32 s3, s80, 11
  s_add_u32 s89, s89, s3
  s_lshl_b32 s3, s71, 8
  s_add_u32 s89, s89, s3
  s_add_u32 s89, s89, s73
  s_add_u32 s89, s89, 0xb4000
  s_cmp_eq_u32 s81, 1
  s_cselect_b32 s89, s89, 0x7f000000
  s_sub_u32 s4, s83, 12288
  v_add_u32 v14, s4, v2
  s_waitcnt lgkmcnt(0)
  s_mov_b64 exec, 1
  s_waitcnt vmcnt(3)
  s_barrier
  s_cmp_eq_u32 s74, 0
  s_cbranch_scc1 L81
  buffer_store_dword v233, off, s[64:67], s82 offset:1792
L82:
  s_mov_b64 exec, -1
  ds_read_b32 v14, v14
  s_waitcnt lgkmcnt(0)
  v_add_f32 v14, v14, v232
  s_cmp_eq_u32 s74, 0
  s_cbranch_scc1 L83
  buffer_store_dword v14, v2, s[64:67], s89 offen
L84:
L28:
  v_accvgpr_read_b32 v230, a237
  s_add_u32 s5, s73, 0xc0700
  buffer_load_dword v231, v230, s[64:67], s5 offen sc1
  s_mov_b32 s95, 131072
  s_lshl_b32 s7, s72, 15
  s_add_u32 s7, s7, s73
  s_add_u32 s7, s7, 0x20000
  s_lshl_b32 s8, s72, 11
  s_add_u32 s8, s8, s73
  s_add_u32 s8, s8, 0xb4000
  s_lshl_b32 s17, s72, 8
  s_add_u32 s17, s17, 0x27000
  s_lshl_b32 s15, s69, 17
  s_mul_i32 s3, s72, 7168
  s_add_u32 s15, s15, s3
  s_add_u32 s15, s15, 0x1a0e000
  s_mul_i32 s16, s72, 7168
  s_add_u32 s16, s16, 0xe000
  buffer_load_dword v13, v230, s[64:67], s5 offen sc1
L85:
  s_waitcnt vmcnt(1)
  v_cmp_eq_u32 vcc, 0, v231
  s_nop 0
  s_cbranch_vccz L86
  buffer_load_dword v231, v230, s[64:67], s5 offen sc1
  s_waitcnt vmcnt(1)
  v_cmp_eq_u32 vcc, 0, v13
  s_nop 0
  s_cbranch_vccz L86
  buffer_load_dword v13, v230, s[64:67], s5 offen sc1
  s_sub_u32 s95, s95, 1
  s_cbranch_scc0 L85
  s_branch L_abort
L86:
  buffer_load_dwordx4 v[16:19], v1, s[64:67], s7 offen offset:0 sc1
  buffer_load_dwordx4 v[20:23], v1, s[64:67], s7 offen offset:1024 sc1
  buffer_load_dwordx4 v[24:27], v1, s[64:67], s7 offen offset:2048 sc1
  buffer_load_dwordx4 v[28:31], v1, s[64:67], s7 offen offset:3072 sc1
  s_add_u32 s7, s7, 4096
  buffer_load_dwordx4 v[32:35], v1, s[64:67], s7 offen offset:0 sc1
  buffer_load_dwordx4 v[36:39], v1, s[64:67], s7 offen offset:1024 sc1
  buffer_load_dwordx4 v[40:43], v1, s[64:67], s7 offen offset:2048 sc1
  s_barrier
  ds_read_b128 v[176:179], v1 offset:0
  ds_read_b128 v[180:183], v1 offset:28672
  ds_read_b128 v[184:187], v1 offset:1024
  ds_read_b128 v[188:191], v1 offset:29696
  ds_read_b128 v[192:195], v1 offset:2048
  ds_read_b128 v[196:199], v1 offset:30720
  s_waitcnt vmcnt(6) lgkmcnt(5)
  v_mfma_f32_32x32x16_bf16 v[128:143], v[176:179], v[16:19], 0
  ds_read_b128 v[200:203], v1 offset:3072
  buffer_load_dwordx4 v[44:47], v1, s[64:67], s7 offen offset:3072 sc1
  s_waitcnt lgkmcnt(5)
  v_mfma_f32_32x32x16_bf16 v[144:159], v[16:19], v[180:183], 0
  ds_read_b128 v[204:207], v1 offset:31744
  s_waitcnt vmcnt(6) lgkmcnt(5)
  v_mfma_f32_32x32x16_bf16 v[128:143], v[184:187], v[20:23], v[128:143]
  ds_read_b128 v[176:179], v1 offset:4096
  s_add_u32 s7, s7, 4096
  buffer_load_dwordx4 v[48:51], v1, s[64:67], s7 offen offset:0 sc1
  s_waitcnt lgkmcnt(5)
  v_mfma_f32_32x32x16_bf16 v[144:159], v[20:23], v[188:191], v[144:159]
  ds_read_b128 v[180:183], v1 offset:32768
  s_waitcnt vmcnt(6) lgkmcnt(5)
  v_mfma_f32_32x32x16_bf16 v[128:143], v[192:195], v[24:27], v[128:143]
  ds_read_b128 v[184:187], v1 offset:5120
  buffer_load_dwordx4 v[52:55], v1, s[64:67], s7 offen offset:1024 sc1
  s_waitcnt lgkmcnt(5)
  v_mfma_f32_32x32x16_bf16 v[144:159], v[24:27], v[196:199], v[144:159]
  ds_read_b128 v[188:191], v1 offset:33792
  s_waitcnt vmcnt(6) lgkmcnt(5)
  v_mfma_f32_32x32x16_bf16 v[128:143], v[200:203], v[28:31], v[128:143]
  ds_read_b128 v[192:195], v1 offset:6144
  buffer_load_dwordx4 v[56:59], v1, s[64:67], s7 offen offset:2048 sc1
  s_waitcnt lgkmcnt(5)
  v_mfma_f32_32x32x16_bf16 v[144:159], v[28:31], v[204:207], v[144:159]
  ds_read_b128 v[196:199], v1 offset:34816
  s_waitcnt vmcnt(6) lgkmcnt(5)
  v_mfma_f32_32x32x16_bf16 v[128:143], v[176:179], v[32:35], v[128:143]
  ds_read_b128 v[200:203], v1 offset:7168
  buffer_load_dwordx4 v[60:63], v1, s[64:67], s7 offen offset:3072 sc1
  s_waitcnt lgkmcnt(5)
  v_mfma_f32_32x32x16_bf16 v[144:159], v[32:35], v[180:183], v[144:159]
  ds_read_b128 v[204:207], v1 offset:35840
  s_waitcnt vmcnt(6) lgkmcnt(5)
  v_mfma_f32_32x32x16_bf16 v[128:143], v[184:187], v[36:39], v[128:143]
  ds_read_b128 v[176:179], v1 offset:8192
  s_add_u32 s7, s7, 4096
  buffer_load_dwordx4 v[64:67], v1, s[64:67], s7 offen offset:0 sc1
  s_waitcnt lgkmcnt(5)
  v_mfma_f32_32x32x16_bf16 v[144:159], v[36:39], v[188:191], v[144:159]
  ds_read_b128 v[180:183], v1 offset:36864
  buffer_load_dword v208, v2, s[64:67], s8 offen offset:0 sc1
  buffer_load_dword v209, v2, s[64:67], s8 offen offset:256 sc1
  s_waitcnt vmcnt(8) lgkmcnt(5)
  v_mfma_f32_32x32x16_bf16 v[128:143], v[192:195], v[40:43], v[128:143]
  ds_read_b128 v[184:187], v1 offset:9216
  buffer_load_dwordx4 v[68:71], v1, s[64:67], s7 offen offset:1024 sc1
  s_waitcnt lgkmcnt(5)
  v_mfma_f32_32x32x16_bf16 v[144:159], v[40:43], v[196:199], v[144:159]
  ds_read_b128 v[188:191], v1 offset:37888
  buffer_load_dword v210, v2, s[64:67], s8 offen offset:512 sc1
  buffer_load_dword v211, v2, s[64:67], s8 offen offset:768 sc1
  s_waitcnt vmcnt(10) lgkmcnt(5)
  v_mfma_f32_32x32x16_bf16 v[128:143], v[200:203], v[44:47], v[128:143]
  ds_read_b128 v[192:195], v1 offset:10240
  buffer_load_dwordx4 v[72:75], v1, s[64:67], s7 offen offset:2048 sc1
  s_waitcnt lgkmcnt(5)
  v_mfma_f32_32x32x16_bf16 v[144:159], v[44:47], v[204:207], v[144:159]
  ds_read_b128 v[196:199], v1 offset:38912
  buffer_load_dword v212, v2, s[64:67], s8 offen offset:1024 sc1
  buffer_load_dword v213, v2, s[64:67], s8 offen offset:1280 sc1
  s_waitcnt vmcnt(12) lgkmcnt(5)
  v_mfma_f32_32x32x16_bf16 v[128:143], v[176:179], v[48:51], v[128:143]
  ds_read_b128 v[200:203], v1 offset:11264
  buffer_load_dwordx4 v[76:79], v1, s[64:67], s7 offen offset:3072 sc1
  s_waitcnt lgkmcnt(5)
  v_mfma_f32_32x32x16_bf16 v[144:159], v[48:51], v[180:183], v[144:159]
  ds_read_b128 v[204:207], v1 offset:39936
  buffer_load_dword v214, v2, s[64:67], s8 offen offset:1536 sc1
  s_waitcnt vmcnt(13) lgkmcnt(5)
  v_mfma_f32_32x32x16_bf16 v[128:143], v[184:187], v[52:55], v[128:143]
  ds_read_b128 v[176:179], v1 offset:12288
  s_add_u32 s7, s7, 4096
  buffer_load_dwordx4 v[80:83], v1, s[64:67], s7 offen offset:0 sc1
  s_waitcnt lgkmcnt(5)
  v_mfma_f32_32x32x16_bf16 v[144:159], v[52:55], v[188:191], v[144:159]
  ds_read_b128 v[180:183], v1 offset:40960
  s_waitcnt vmcnt(13) lgkmcnt(5)
  v_mfma_f32_32x32x16_bf16 v[128:143], v[192:195], v[56:59], v[128:143]
  ds_read_b128 v[184:187], v1 offset:13312
  buffer_load_dwordx4 v[84:87], v1, s[64:67], s7 offen offset:1024 sc1
  s_waitcnt lgkmcnt(5)
  v_mfma_f32_32x32x16_bf16 v[144:159], v[56:59], v[196:199], v[144:159]
  ds_read_b128 v[188:191], v1 offset:41984
  s_waitcnt vmcnt(13) lgkmcnt(5)
  v_mfma_f32_32x32x16_bf16 v[128:143], v[200:203], v[60:63], v[128:143]
  ds_read_b128 v[192:195], v1 offset:14336
  buffer_load_dwordx4 v[88:91], v1, s[64:67], s7 offen offset:2048 sc1
  s_waitcnt lgkmcnt(5)
  v_mfma_f32_32x32x16_bf16 v[144:159], v[60:63], v[204:207], v[144:159]
  ds_read_b128 v[196:199], v1 offset:43008
  s_waitcnt vmcnt(13) lgkmcnt(5)
  v_mfma_f32_32x32x16_bf16 v[128:143], v[176:179], v[64:67], v[128:143]
  ds_read_b128 v[200:203], v1 offset:15360
  buffer_load_dwordx4 v[92:95], v1, s[64:67], s7 offen offset:3072 sc1
  s_waitcnt lgkmcnt(5)
  v_mfma_f32_32x32x16_bf16 v[144:159], v[64:67], v[180:183], v[144:159]
  ds_read_b128 v[204:207], v1 offset:44032
  s_waitcnt vmcnt(11) lgkmcnt(5)
  v_mfma_f32_32x32x16_bf16 v[128:143], v[184:187], v[68:71], v[128:143]
  ds_read_b128 v[176:179], v1 offset:16384
  s_add_u32 s7, s7, 4096
  buffer_load_dwordx4 v[96:99], v1, s[64:67], s7 offen offset:0 sc1
  s_waitcnt lgkmcnt(5)
  v_mfma_f32_32x32x16_bf16 v[144:159], v[68:71], v[188:191], v[144:159]
  ds_read_b128 v[180:183], v1 offset:45056
  s_waitcnt vmcnt(9) lgkmcnt(5)
  v_mfma_f32_32x32x16_bf16 v[128:143], v[192:195], v[72:75], v[128:143]
  ds_read_b128 v[184:187], v1 offset:17408
  buffer_load_dwordx4 v[100:103], v1, s[64:67], s7 offen offset:1024 sc1
  s_waitcnt lgkmcnt(5)
  v_mfma_f32_32x32x16_bf16 v[144:159], v[72:75], v[196:199], v[144:159]
  ds_read_b128 v[188:191], v1 offset:46080
  s_waitcnt vmcnt(7) lgkmcnt(5)
  v_mfma_f32_32x32x16_bf16 v[128:143], v[200:203], v[76:79], v[128:143]
  ds_read_b128 v[192:195], v1 offset:18432
  buffer_load_dwordx4 v[104:107], v1, s[64:67], s7 offen offset:2048 sc1
  s_waitcnt lgkmcnt(5)
  v_mfma_f32_32x32x16_bf16 v[144:159], v[76:79], v[204:207], v[144:159]
  ds_read_b128 v[196:199], v1 offset:47104
  s_waitcnt vmcnt(6) lgkmcnt(5)
  v_mfma_f32_32x32x16_bf16 v[128:143], v[176:179], v[80:83], v[128:143]
  ds_read_b128 v[200:203], v1 offset:19456
  buffer_load_dwordx4 v[108:111], v1, s[64:67], s7 offen offset:3072 sc1
  s_waitcnt lgkmcnt(5)
  v_mfma_f32_32x32x16_bf16 v[144:159], v[80:83], v[180:183], v[144:159]
  ds_read_b128 v[204:207], v1 offset:48128
  s_waitcnt vmcnt(6) lgkmcnt(5)
  v_mfma_f32_32x32x16_bf16 v[128:143], v[184:187], v[84:87], v[128:143]
  ds_read_b128 v[176:179], v1 offset:20480
  s_add_u32 s7, s7, 4096
  buffer_load_dwordx4 v[112:115], v1, s[64:67], s7 offen offset:0 sc1
  v_max3_u32 v235, v208, v209, v210
  v_max3_u32 v234, v211, v212, v213
  s_waitcnt lgkmcnt(5)
  v_mfma_f32_32x32x16_bf16 v[144:159], v[84:87], v[188:191], v[144:159]
  ds_read_b128 v[180:183], v1 offset:49152
  v_max3_u32 v235, v235, v234, v214
  v_cmp_eq_u32 vcc, -1, v235
  s_nop 0
  s_cbranch_vccnz L87
L88:
  s_waitcnt vmcnt(6) lgkmcnt(5)
  v_mfma_f32_32x32x16_bf16 v[128:143], v[192:195], v[88:91], v[128:143]
  ds_read_b128 v[184:187], v1 offset:21504
  buffer_load_dwordx4 v[116:119], v1, s[64:67], s7 offen offset:1024 sc1
  v_add_f32 v234, v208, v209
  v_add_f32 v235, v210, v211
  s_waitcnt lgkmcnt(5)
  v_mfma_f32_32x32x16_bf16 v[144:159], v[88:91], v[196:199], v[144:159]
  ds_read_b128 v[188:191], v1 offset:50176
  v_add_f32 v234, v234, v212
  v_add_f32 v235, v235, v213
  s_waitcnt vmcnt(6) lgkmcnt(5)
  v_mfma_f32_32x32x16_bf16 v[128:143], v[200:203], v[92:95], v[128:143]
  ds_read_b128 v[192:195], v1 offset:22528
  buffer_load_dwordx4 v[120:123], v1, s[64:67], s7 offen offset:2048 sc1
  v_add_f32 v234, v234, v214
  v_add_f32 v234, v234, v235
  s_waitcnt lgkmcnt(5)
  v_mfma_f32_32x32x16_bf16 v[144:159], v[92:95], v[204:207], v[144:159]
  ds_read_b128 v[196:199], v1 offset:51200
  v_mov_b32 v235, v234
  s_nop 1
  v_permlane32_swap_b32 v234, v235
  s_waitcnt vmcnt(6) lgkmcnt(5)
  v_mfma_f32_32x32x16_bf16 v[128:143], v[176:179], v[96:99], v[128:143]
  ds_read_b128 v[200:203], v1 offset:23552
  buffer_load_dwordx4 v[124:127], v1, s[64:67], s7 offen offset:3072 sc1
  v_mul_f32 v230, 0x3b124925, v234
  v_mul_f32 v235, 0x3b124925, v235
  s_waitcnt lgkmcnt(5)
  v_mfma_f32_32x32x16_bf16 v[144:159], v[96:99], v[180:183], v[144:159]
  ds_read_b128 v[204:207], v1 offset:52224
  v_fma_f32 v234, -v230, v230, v235
  v_max_f32 v234, 0, v234
  s_waitcnt vmcnt(6) lgkmcnt(5)
  v_mfma_f32_32x32x16_bf16 v[128:143], v[184:187], v[100:103], v[128:143]
  ds_read_b128 v[176:179], v1 offset:24576
  s_add_u32 m0, s16, 0
  s_add_u32 s22, s15, 0
  buffer_load_dwordx4 v1, s[64:67], s22 offen offset:0 sc1 lds
  v_add_f32 v234, 0x3727c5ac, v234
  v_rsq_f32 v234, v234
  s_waitcnt lgkmcnt(5)
  v_mfma_f32_32x32x16_bf16 v[144:159], v[100:103], v[188:191], v[144:159]
  ds_read_b128 v[180:183], v1 offset:53248
  v_add_u32 v235, s17, v2
  v_cvt_pk_bf16_f32 v226, -v230, -v230
  s_waitcnt vmcnt(6) lgkmcnt(5)
  v_mfma_f32_32x32x16_bf16 v[128:143], v[192:195], v[104:107], v[128:143]
  ds_read_b128 v[184:187], v1 offset:25600
  buffer_load_dwordx4 v1, s[64:67], s22 offen offset:1024 sc1 lds
  v_mov_b32 v224, 0
  v_mov_b32 v225, 0
  s_waitcnt lgkmcnt(5)
  v_mfma_f32_32x32x16_bf16 v[144:159], v[104:107], v[196:199], v[144:159]
  ds_read_b128 v[188:191], v1 offset:54272
  v_lshlrev_b32 v231, 16, v226
  v_mov_b32 v228, 0
  s_waitcnt vmcnt(6) lgkmcnt(5)
  v_mfma_f32_32x32x16_bf16 v[128:143], v[200:203], v[108:111], v[128:143]
  ds_read_b128 v[192:195], v1 offset:26624
  buffer_load_dwordx4 v1, s[64:67], s22 offen offset:2048 sc1 lds
  v_add_f32 v231, v230, v231
  v_mov_b32 v229, 0
  s_waitcnt lgkmcnt(5)
  v_mfma_f32_32x32x16_bf16 v[144:159], v[108:111], v[204:207], v[144:159]
  ds_read_b128 v[196:199], v1 offset:55296
  v_cvt_pk_bf16_f32 v227, -v231, 0
  ds_write_b32 v235, v234
  s_waitcnt vmcnt(6) lgkmcnt(6)
  v_mfma_f32_32x32x16_bf16 v[128:143], v[176:179], v[112:115], v[128:143]
  ds_read_b128 v[200:203], v1 offset:27648
  buffer_load_dwordx4 v1, s[64:67], s22 offen offset:3072 sc1 lds
  v_lshrrev_b32 v231, 5, v0
  v_lshlrev_b32 v231, 4, v231
  s_waitcnt lgkmcnt(6)
  v_mfma_f32_32x32x16_bf16 v[144:159], v[112:115], v[180:183], v[144:159]
  ds_read_b128 v[204:207], v1 offset:56320
  v_add_u32 v231, s17, v231
  s_waitcnt lgkmcnt(0)
  s_waitcnt vmcnt(6)
  v_mfma_f32_32x32x16_bf16 v[128:143], v[184:187], v[116:119], v[128:143]
  s_add_u32 m0, s16, 4096
  s_add_u32 s22, s15, 4096
  buffer_load_dwordx4 v1, s[64:67], s22 offen offset:0 sc1 lds
  ds_read_b128 v[160:163], v231 offset:0
  ds_read_b128 v[164:167], v231 offset:32
  v_mfma_f32_32x32x16_bf16 v[144:159], v[116:119], v[188:191], v[144:159]
  ds_read_b128 v[168:171], v231 offset:64
  ds_read_b128 v[172:175], v231 offset:96
  s_waitcnt vmcnt(6)
  v_mfma_f32_32x32x16_bf16 v[128:143], v[192:195], v[120:123], v[128:143]
  buffer_load_dwordx4 v1, s[64:67], s22 offen offset:1024 sc1 lds
  v_mov_b32 v230, 0
  v_and_b32 v235, 31, v0
  v_mfma_f32_32x32x16_bf16 v[144:159], v[120:123], v[196:199], v[144:159]
  v_cmp_eq_u32 vcc, 28, v235
  v_mov_b32 v231, s94
  s_nop 0
  v_cndmask_b32 v231, v230, v231, vcc
  s_waitcnt vmcnt(6)
  v_mfma_f32_32x32x16_bf16 v[128:143], v[200:203], v[124:127], v[128:143]
  buffer_load_dwordx4 v1, s[64:67], s22 offen offset:2048 sc1 lds
  v_mfma_f32_32x32x16_bf16 v[144:159], v[124:127], v[204:207], v[144:159]
  v_mfma_f32_32x32x16_bf16 v[128:143], v[4:7], v[226:229], v[128:143]
  v_mfma_f32_32x32x16_bf16 v[144:159], v[224:227], v[4:7], v[144:159]
  s_lshl_b32 s9, s69, 13
  s_lshl_b32 s3, s72, 11
  s_add_u32 s9, s9, s3
  s_add_u32 s9, s9, 0x1820000
  s_lshl_b32 s25, s68, 7
  s_add_u32 s25, s25, s9
  s_add_u32 s8, s25, 0x180000
  s_xor_b32 s16, s8, 128
  buffer_load_dword v15, off, s[64:67], s8 sc1
  s_lshl_b32 s5, s68, 14
  s_add_u32 s5, s5, s75
  s_add_u32 s5, s5, 0x40000
  v_pk_mul_f32 v[128:129], v[128:129], v[234:235] op_sel_hi:[1,0]
  v_pk_mul_f32 v[130:131], v[130:131], v[234:235] op_sel_hi:[1,0]
  v_pk_mul_f32 v[132:133], v[132:133], v[234:235] op_sel_hi:[1,0]
  v_pk_mul_f32 v[134:135], v[134:135], v[234:235] op_sel_hi:[1,0]
  v_pk_mul_f32 v[136:137], v[136:137], v[234:235] op_sel_hi:[1,0]
  v_pk_mul_f32 v[138:139], v[138:139], v[234:235] op_sel_hi:[1,0]
  v_pk_mul_f32 v[140:141], v[140:141], v[234:235] op_sel_hi:[1,0]
  v_pk_mul_f32 v[142:143], v[142:143], v[234:235] op_sel_hi:[1,0]
  v_cvt_pk_bf16_f32 v208, v128, v129
  v_cvt_pk_bf16_f32 v209, v130, v131
  v_cvt_pk_bf16_f32 v210, v132, v133
  v_cvt_pk_bf16_f32 v211, v134, v135
  v_cvt_pk_bf16_f32 v212, v136, v137
  v_cvt_pk_bf16_f32 v213, v138, v139
  v_cvt_pk_bf16_f32 v214, v140, v141
  v_cvt_pk_bf16_f32 v215, v142, v143
  v_cndmask_b32 v214, v214, v230, s[90:91]
  v_cndmask_b32 v215, v215, v230, s[90:91]
  buffer_store_dwordx4 v[208:211], v1, s[64:67], s5 offen offset:0 sc1
  buffer_store_dwordx4 v[212:215], v1, s[64:67], s5 offen offset:1024 sc1
  s_waitcnt lgkmcnt(3)
  v_pk_mul_f32 v[144:145], v[144:145], v[160:161]
  v_pk_mul_f32 v[146:147], v[146:147], v[162:163]
  s_waitcnt lgkmcnt(2)
  v_pk_mul_f32 v[148:149], v[148:149], v[164:165]
  v_pk_mul_f32 v[150:151], v[150:151], v[166:167]
  s_waitcnt lgkmcnt(1)
  v_pk_mul_f32 v[152:153], v[152:153], v[168:169]
  v_pk_mul_f32 v[154:155], v[154:155], v[170:171]
  s_waitcnt lgkmcnt(0)
  v_pk_mul_f32 v[156:157], v[156:157], v[172:173]
  v_pk_mul_f32 v[158:159], v[158:159], v[174:175]
  v_cvt_pk_bf16_f32 v216, v144, v145
  v_cvt_pk_bf16_f32 v217, v146, v147
  v_cvt_pk_bf16_f32 v218, v148, v149
  v_cvt_pk_bf16_f32 v219, v150, v151
  v_cvt_pk_bf16_f32 v220, v152, v153
  v_cvt_pk_bf16_f32 v221, v154, v155
  v_cvt_pk_bf16_f32 v222, v156, v157
  v_cvt_pk_bf16_f32 v223, v158, v159
  v_cndmask_b32 v216, v216, v231, s[92:93]
  v_cndmask_b32 v217, v217, v231, s[92:93]
  v_cndmask_b32 v218, v218, v231, s[92:93]
  v_cndmask_b32 v219, v219, v231, s[92:93]
  v_cndmask_b32 v220, v220, v231, s[92:93]
  v_cndmask_b32 v221, v221, v231, s[92:93]
  v_cndmask_b32 v222, v222, v231, s[92:93]
  v_cndmask_b32 v223, v223, v231, s[92:93]
  buffer_store_dwordx4 v[216:219], v1, s[64:67], s5 offen offset:2048 sc1
  buffer_store_dwordx4 v[220:223], v1, s[64:67], s5 offen offset:3072 sc1
  v_add_u32 v233, 57344, v1
  s_waitcnt vmcnt(5)
  s_barrier
  ds_read_b128 v[128:131], v233 offset:0
  ds_read_b128 v[132:135], v233 offset:1024
  ds_read_b128 v[136:139], v233 offset:2048
  ds_read_b128 v[140:143], v233 offset:3072
  ds_read_b128 v[144:147], v233 offset:4096
  ds_read_b128 v[148:151], v233 offset:5120
  s_and_b32 s19, s68, 14
  s_and_b32 s20, s68, 1
  v_add_u32 v232, s19, v0
  v_and_b32 v232, 15, v232
  v_lshlrev_b32 v232, 7, v232
  s_waitcnt lgkmcnt(5)
  v_mfma_f32_32x32x16_bf16 v[160:175], v[128:131], v[16:19], 0
  ds_read_b128 v[152:155], v233 offset:6144
  v_mfma_f32_32x32x16_bf16 v[160:175], v[6:9], v[224:227], v[160:175]
  s_add_u32 s10, s75, 0x40000
  s_waitcnt lgkmcnt(5)
  v_mfma_f32_32x32x16_bf16 v[160:175], v[132:135], v[20:23], v[160:175]
  ds_read_b128 v[156:159], v233 offset:7168
  s_add_u32 s22, s19, s20
  s_lshl_b32 s22, s22, 14
  s_waitcnt lgkmcnt(5)
  v_mfma_f32_32x32x16_bf16 v[160:175], v[136:139], v[24:27], v[160:175]
  ds_read_b128 v[128:131], v233 offset:8192
  s_sub_u32 s23, s19, s20
  s_lshl_b32 s23, s23, 14
  s_lshl_b32 s18, s19, 14
  s_waitcnt lgkmcnt(5)
  v_mfma_f32_32x32x16_bf16 v[160:175], v[140:143], v[28:31], v[160:175]
  ds_read_b128 v[132:135], v233 offset:9216
  s_xor_b32 s4, s72, 1
  s_mul_i32 s4, s4, 12288
  s_waitcnt lgkmcnt(5)
  v_mfma_f32_32x32x16_bf16 v[160:175], v[144:147], v[32:35], v[160:175]
  ds_read_b128 v[136:139], v233 offset:10240
  s_add_u32 s4, s4, 0x1c000
  v_add_u32 v224, s4, v1
  s_waitcnt lgkmcnt(5)
  v_mfma_f32_32x32x16_bf16 v[160:175], v[148:151], v[36:39], v[160:175]
  ds_read_b128 v[140:143], v233 offset:11264
  s_xor_b32 s4, s72, 2
  s_mul_i32 s4, s4, 12288
  s_waitcnt lgkmcnt(5)
  v_mfma_f32_32x32x16_bf16 v[160:175], v[152:155], v[40:43], v[160:175]
  ds_read_b128 v[144:147], v233 offset:12288
  s_add_u32 s4, s4, 0x1d000
  v_add_u32 v225, s4, v1
  s_xor_b32 s4, s72, 3
  s_waitcnt lgkmcnt(5)
  v_mfma_f32_32x32x16_bf16 v[160:175], v[156:159], v[44:47], v[160:175]
  ds_read_b128 v[148:151], v233 offset:13312
  s_mul_i32 s4, s4, 12288
  s_add_u32 s4, s4, 0x1e000
  s_waitcnt lgkmcnt(5)
  v_mfma_f32_32x32x16_bf16 v[160:175], v[128:131], v[48:51], v[160:175]
  ds_read_b128 v[152:155], v233 offset:14336
  v_add_u32 v226, s4, v1
  v_add_u32 v227, s83, v1
  s_waitcnt lgkmcnt(5)
  v_mfma_f32_32x32x16_bf16 v[160:175], v[132:135], v[52:55], v[160:175]
  ds_read_b128 v[156:159], v233 offset:15360
  v_bfe_u32 v230, v0, 4, 1
  v_lshlrev_b32 v230, 2, v230
  s_waitcnt lgkmcnt(5)
  v_mfma_f32_32x32x16_bf16 v[160:175], v[136:139], v[56:59], v[160:175]
  ds_read_b128 v[128:131], v233 offset:16384
  v_and_b32 v236, 7, v0
  v_xor_b32 v236, v230, v236
  v_lshrrev_b32 v230, 3, v0
  s_waitcnt lgkmcnt(5)
  v_mfma_f32_32x32x16_bf16 v[160:175], v[140:143], v[60:63], v[160:175]
  ds_read_b128 v[132:135], v233 offset:17408
  v_mul_u32_u24 v230, 896, v230
  v_lshl_add_u32 v236, v236, 4, v230
  s_waitcnt lgkmcnt(5)
  v_mfma_f32_32x32x16_bf16 v[160:175], v[144:147], v[64:67], v[160:175]
  ds_read_b128 v[136:139], v233 offset:18432
  v_add_u32 v237, 6144, v236
  v_add_u32 v238, 12288, v236
  s_waitcnt lgkmcnt(5)
  v_mfma_f32_32x32x16_bf16 v[160:175], v[148:151], v[68:71], v[160:175]
  ds_read_b128 v[140:143], v233 offset:19456
  v_add_u32 v239, 18432, v236
  v_and_b32 v230, 15, v0
  s_waitcnt lgkmcnt(5)
  v_mfma_f32_32x32x16_bf16 v[160:175], v[152:155], v[72:75], v[160:175]
  ds_read_b128 v[144:147], v233 offset:20480
  v_lshlrev_b32 v230, 7, v230
  s_lshl_b32 s4, s72, 15
  s_waitcnt lgkmcnt(5)
  v_mfma_f32_32x32x16_bf16 v[160:175], v[156:159], v[76:79], v[160:175]
  ds_read_b128 v[148:151], v233 offset:21504
  s_lshl_b32 s3, s69, 11
  s_add_u32 s4, s4, s3
  s_add_u32 s4, s4, s73
  s_waitcnt lgkmcnt(5)
  v_mfma_f32_32x32x16_bf16 v[160:175], v[128:131], v[80:83], v[160:175]
  ds_read_b128 v[152:155], v233 offset:22528
  v_add_u32 v235, s4, v230
  s_mov_b32 s4, s79
  s_waitcnt lgkmcnt(5)
  v_mfma_f32_32x32x16_bf16 v[160:175], v[132:135], v[84:87], v[160:175]
  ds_read_b128 v[156:159], v233 offset:23552
  s_add_u32 s4, s4, s84
  s_add_u32 s4, s4, 0x20000
  s_waitcnt lgkmcnt(5)
  v_mfma_f32_32x32x16_bf16 v[160:175], v[136:139], v[88:91], v[160:175]
  ds_read_b128 v[128:131], v233 offset:24576
  v_add_u32 v230, s4, v230
  v_cndmask_b32 v235, v235, v230, s[90:91]
  s_waitcnt lgkmcnt(5)
  v_mfma_f32_32x32x16_bf16 v[160:175], v[140:143], v[92:95], v[160:175]
  ds_read_b128 v[132:135], v233 offset:25600
  s_waitcnt lgkmcnt(5)
  v_mfma_f32_32x32x16_bf16 v[160:175], v[144:147], v[96:99], v[160:175]
  ds_read_b128 v[136:139], v233 offset:26624
  v_mov_b32 v14, 1
  s_waitcnt vmcnt(0)
  s_mov_b64 exec, 1
  buffer_store_dword v14, off, s[64:67], s8
  buffer_store_dword v14, off, s[64:67], s25 sc1
  s_mov_b64 exec, -1
  s_waitcnt lgkmcnt(5)
  v_mfma_f32_32x32x16_bf16 v[160:175], v[148:151], v[100:103], v[160:175]
  ds_read_b128 v[140:143], v233 offset:27648
  s_waitcnt lgkmcnt(5)
  v_mfma_f32_32x32x16_bf16 v[160:175], v[152:155], v[104:107], v[160:175]
  s_waitcnt lgkmcnt(4)
  v_mfma_f32_32x32x16_bf16 v[160:175], v[156:159], v[108:111], v[160:175]
  s_waitcnt lgkmcnt(3)
  v_mfma_f32_32x32x16_bf16 v[160:175], v[128:131], v[112:115], v[160:175]
  s_waitcnt lgkmcnt(2)
  v_mfma_f32_32x32x16_bf16 v[160:175], v[132:135], v[116:119], v[160:175]
  s_mul_i32 s4, s69, 1536
  s_mul_i32 s3, s72, 384
  s_add_u32 s4, s4, s3
  s_add_u32 s4, s4, s73
  s_add_u32 s4, s4, 0xb6000
  v_writelane_b32 v235, s4, 16
  s_add_u32 s4, s4, 128
  v_writelane_b32 v235, s4, 17
  s_add_u32 s4, s4, 128
  v_writelane_b32 v235, s4, 18
  s_add_u32 s4, s4, 128
  s_and_b32 s4, s69, 15
  s_lshl_b32 s4, s4, 7
  s_add_u32 s4, s4, s73
  s_add_u32 s4, s4, 0xc0800
  v_writelane_b32 v235, s4, 19
  s_waitcnt lgkmcnt(1)
  v_mfma_f32_32x32x16_bf16 v[160:175], v[136:139], v[120:123], v[160:175]
  s_waitcnt lgkmcnt(0)
  v_mfma_f32_32x32x16_bf16 v[160:175], v[140:143], v[124:127], v[160:175]
  buffer_load_dword v12, off, s[64:67], s16 sc1
  v_mul_f32 v234, 0x3e8b97f6, v234
  v_mov_b32 v230, 0
  v_mov_b32 v13, 0
  s_lshl_b32 s4, s72, 11
  s_add_u32 s4, s4, 0x1e000
  v_add_u32 v231, s4, v1
  s_nop 4
  v_pk_mul_f32 v[160:161], v[160:161], v[234:235] op_sel_hi:[1,0]
  v_pk_mul_f32 v[162:163], v[162:163], v[234:235] op_sel_hi:[1,0]
  v_pk_mul_f32 v[164:165], v[164:165], v[234:235] op_sel_hi:[1,0]
  v_pk_mul_f32 v[166:167], v[166:167], v[234:235] op_sel_hi:[1,0]
  v_pk_mul_f32 v[168:169], v[168:169], v[234:235] op_sel_hi:[1,0]
  v_pk_mul_f32 v[170:171], v[170:171], v[234:235] op_sel_hi:[1,0]
  v_pk_mul_f32 v[172:173], v[172:173], v[234:235] op_sel_hi:[1,0]
  v_pk_mul_f32 v[174:175], v[174:175], v[234:235] op_sel_hi:[1,0]
  v_cvt_pk_bf16_f32 v40, v160, v161
  v_cvt_pk_bf16_f32 v41, v162, v163
  v_cvt_pk_bf16_f32 v42, v164, v165
  v_cvt_pk_bf16_f32 v43, v166, v167
  v_cvt_pk_bf16_f32 v44, v168, v169
  v_cvt_pk_bf16_f32 v45, v170, v171
  v_cvt_pk_bf16_f32 v46, v172, v173
  v_cvt_pk_bf16_f32 v47, v174, v175
  v_cndmask_b32 v46, v46, v230, s[90:91]
  v_cndmask_b32 v47, v47, v230, s[90:91]
  ds_write_b128 v231, v[40:43]
  ds_write_b128 v231, v[44:47] offset:1024
  s_add_u32 s11, s18, 32768
  s_and_b32 s11, s11, 245760
  s_add_u32 s11, s11, s10
  v_mfma_f32_32x32x16_bf16 v[112:127], v[208:211], v[40:43], 0
  v_mfma_f32_32x32x16_bf16 v[112:127], v[212:215], v[44:47], v[112:127]
  s_waitcnt lgkmcnt(0)
  s_barrier
  v_xor_b32 v230, 2048, v231
  ds_read_b128 v[16:19], v230
  ds_read_b128 v[20:23], v230 offset:1024
  v_xor_b32 v230, 4096, v231
  ds_read_b128 v[24:27], v230
  ds_read_b128 v[28:31], v230 offset:1024
  v_xor_b32 v230, 6144, v231
  ds_read_b128 v[32:35], v230
  ds_read_b128 v[36:39], v230 offset:1024
  s_mov_b64 exec, 0xc
  buffer_load_dword v13, v232, s[64:67], s9 offen sc1
  s_mov_b64 exec, -1
  s_xor_b32 s21, s68, 1
  s_lshl_b32 s21, s21, 14
  s_add_u32 s21, s21, s75
  s_add_u32 s21, s21, 262144
  s_waitcnt vmcnt(1)
  v_cmp_eq_u32 vcc, 0, v12
  s_nop 0
  s_cbranch_vccnz L89
L90:
  buffer_load_dwordx4 v[176:179], v1, s[64:67], s21 offen offset:0 sc1
  buffer_load_dwordx4 v[180:183], v1, s[64:67], s21 offen offset:1024 sc1
  buffer_load_dwordx4 v[184:187], v1, s[64:67], s21 offen offset:2048 sc1
  buffer_load_dwordx4 v[188:191], v1, s[64:67], s21 offen offset:3072 sc1
  v_exp_f32 v112, v112
  v_exp_f32 v113, v113
  v_exp_f32 v114, v114
  v_exp_f32 v115, v115
  v_cvt_pk_bf16_f32 v144, v112, v113
  v_cvt_pk_bf16_f32 v145, v114, v115
  v_exp_f32 v116, v116
  v_exp_f32 v117, v117
  v_exp_f32 v118, v118
  v_exp_f32 v119, v119
  s_waitcnt lgkmcnt(5)
  v_mfma_f32_32x32x16_bf16 v[128:143], v[208:211], v[16:19], 0
  v_cvt_pk_bf16_f32 v146, v116, v117
  v_cvt_pk_bf16_f32 v147, v118, v119
  v_exp_f32 v120, v120
  v_exp_f32 v121, v121
  v_exp_f32 v122, v122
  v_exp_f32 v123, v123
  s_waitcnt lgkmcnt(4)
  v_mfma_f32_32x32x16_bf16 v[128:143], v[212:215], v[20:23], v[128:143]
  v_cvt_pk_bf16_f32 v148, v120, v121
  v_cvt_pk_bf16_f32 v149, v122, v123
  v_exp_f32 v124, v124
  v_exp_f32 v125, v125
  v_exp_f32 v126, v126
  v_exp_f32 v127, v127
  v_cvt_pk_bf16_f32 v150, v124, v125
  v_cvt_pk_bf16_f32 v151, v126, v127
  s_waitcnt lgkmcnt(3)
  v_mfma_f32_32x32x16_bf16 v[112:127], v[208:211], v[24:27], 0
  s_nop 1
  v_exp_f32 v128, v128
  v_exp_f32 v129, v129
  v_exp_f32 v130, v130
  v_exp_f32 v131, v131
  s_waitcnt lgkmcnt(2)
  v_mfma_f32_32x32x16_bf16 v[112:127], v[212:215], v[28:31], v[112:127]
  v_cvt_pk_bf16_f32 v152, v128, v129
  v_cvt_pk_bf16_f32 v153, v130, v131
  v_exp_f32 v132, v132
  v_exp_f32 v133, v133
  v_exp_f32 v134, v134
  v_exp_f32 v135, v135
  v_mfma_f32_32x32x16_bf16 v[96:111], v[216:219], v[144:147], 0
  v_cvt_pk_bf16_f32 v154, v132, v133
  v_cvt_pk_bf16_f32 v155, v134, v135
  v_exp_f32 v136, v136
  v_exp_f32 v137, v137
  v_exp_f32 v138, v138
  v_exp_f32 v139, v139
  v_mfma_f32_32x32x16_bf16 v[96:111], v[220:223], v[148:151], v[96:111]
  v_cvt_pk_bf16_f32 v156, v136, v137
  v_cvt_pk_bf16_f32 v157, v138, v139
  v_exp_f32 v140, v140
  v_exp_f32 v141, v141
  v_exp_f32 v142, v142
  v_exp_f32 v143, v143
  v_cvt_pk_bf16_f32 v158, v140, v141
  v_cvt_pk_bf16_f32 v159, v142, v143
  s_waitcnt vmcnt(4)
  v_cmp_ne_u32 s[86:87], 0, v13
  s_nop 2
  s_andn2_b32 s3, 0xc, s86
  s_cbranch_scc1 L91
L92:
  s_waitcnt lgkmcnt(1)
  v_mfma_f32_32x32x16_bf16 v[128:143], v[208:211], v[32:35], 0
  buffer_load_dwordx4 v[192:195], v1, s[64:67], s11 offen offset:0 sc1
  v_exp_f32 v112, v112
  v_exp_f32 v113, v113
  v_exp_f32 v114, v114
  v_exp_f32 v115, v115
  s_waitcnt lgkmcnt(0)
  v_mfma_f32_32x32x16_bf16 v[128:143], v[212:215], v[36:39], v[128:143]
  buffer_load_dwordx4 v[196:199], v1, s[64:67], s11 offen offset:1024 sc1
  v_cvt_pk_bf16_f32 v144, v112, v113
  v_cvt_pk_bf16_f32 v145, v114, v115
  v_exp_f32 v116, v116
  v_exp_f32 v117, v117
  v_exp_f32 v118, v118
  v_exp_f32 v119, v119
  v_mfma_f32_32x32x16_bf16 v[48:63], v[216:219], v[152:155], 0
  buffer_load_dwordx4 v[200:203], v1, s[64:67], s11 offen offset:2048 sc1
  v_cvt_pk_bf16_f32 v146, v116, v117
  v_cvt_pk_bf16_f32 v147, v118, v119
  v_exp_f32 v120, v120
  v_exp_f32 v121, v121
  v_exp_f32 v122, v122
  v_exp_f32 v123, v123
  v_mfma_f32_32x32x16_bf16 v[48:63], v[220:223], v[156:159], v[48:63]
  buffer_load_dwordx4 v[204:207], v1, s[64:67], s11 offen offset:3072 sc1
  v_cvt_pk_bf16_f32 v148, v120, v121
  v_cvt_pk_bf16_f32 v149, v122, v123
  v_exp_f32 v124, v124
  v_exp_f32 v125, v125
  v_exp_f32 v126, v126
  v_exp_f32 v127, v127
  v_cvt_pk_bf16_f32 v150, v124, v125
  v_cvt_pk_bf16_f32 v151, v126, v127
  v_exp_f32 v128, v128
  v_exp_f32 v129, v129
  v_exp_f32 v130, v130
  v_exp_f32 v131, v131
  v_cvt_pk_bf16_f32 v152, v128, v129
  v_cvt_pk_bf16_f32 v153, v130, v131
  v_exp_f32 v132, v132
  v_exp_f32 v133, v133
  v_exp_f32 v134, v134
  v_exp_f32 v135, v135
  v_mfma_f32_32x32x16_bf16 v[64:79], v[216:219], v[144:147], 0
  s_add_u32 s21, s18, 49152
  v_cvt_pk_bf16_f32 v154, v132, v133
  v_cvt_pk_bf16_f32 v155, v134, v135
  v_exp_f32 v136, v136
  v_exp_f32 v137, v137
  v_exp_f32 v138, v138
  v_exp_f32 v139, v139
  v_mfma_f32_32x32x16_bf16 v[64:79], v[220:223], v[148:151], v[64:79]
  s_mov_b64 exec, 0x30
  buffer_load_dword v13, v232, s[64:67], s9 offen sc1
  s_mov_b64 exec, -1
  v_cvt_pk_bf16_f32 v156, v136, v137
  v_cvt_pk_bf16_f32 v157, v138, v139
  v_exp_f32 v140, v140
  v_exp_f32 v141, v141
  v_exp_f32 v142, v142
  v_exp_f32 v143, v143
  v_cvt_pk_bf16_f32 v158, v140, v141
  v_cvt_pk_bf16_f32 v159, v142, v143
  s_waitcnt vmcnt(8)
  v_mfma_f32_32x32x16_bf16 v[112:127], v[176:179], v[16:19], 0
  s_waitcnt vmcnt(7)
  v_mfma_f32_32x32x16_bf16 v[112:127], v[180:183], v[20:23], v[112:127]
  v_mfma_f32_32x32x16_bf16 v[128:143], v[176:179], v[24:27], 0
  s_nop 10
  v_exp_f32 v112, v112
  v_exp_f32 v113, v113
  v_exp_f32 v114, v114
  v_exp_f32 v115, v115
  v_mfma_f32_32x32x16_bf16 v[128:143], v[180:183], v[28:31], v[128:143]
  s_and_b32 s21, s21, 245760
  v_cvt_pk_bf16_f32 v144, v112, v113
  v_cvt_pk_bf16_f32 v145, v114, v115
  v_exp_f32 v116, v116
  v_exp_f32 v117, v117
  v_exp_f32 v118, v118
  v_exp_f32 v119, v119
  v_mfma_f32_32x32x16_bf16 v[80:95], v[216:219], v[152:155], 0
  s_add_u32 s21, s21, s10
  v_cvt_pk_bf16_f32 v146, v116, v117
  v_cvt_pk_bf16_f32 v147, v118, v119
  v_exp_f32 v120, v120
  v_exp_f32 v121, v121
  v_exp_f32 v122, v122
  v_exp_f32 v123, v123
  v_mfma_f32_32x32x16_bf16 v[80:95], v[220:223], v[156:159], v[80:95]
  v_cvt_pk_bf16_f32 v148, v120, v121
  v_cvt_pk_bf16_f32 v149, v122, v123
  v_exp_f32 v124, v124
  v_exp_f32 v125, v125
  v_exp_f32 v126, v126
  v_exp_f32 v127, v127
  v_cvt_pk_bf16_f32 v150, v124, v125
  v_cvt_pk_bf16_f32 v151, v126, v127
  v_mfma_f32_32x32x16_bf16 v[112:127], v[176:179], v[32:35], 0
  buffer_load_dwordx4 v[160:163], v1, s[64:67], s21 offen offset:0 sc1
  v_exp_f32 v128, v128
  v_exp_f32 v129, v129
  v_exp_f32 v130, v130
  v_exp_f32 v131, v131
  v_mfma_f32_32x32x16_bf16 v[112:127], v[180:183], v[36:39], v[112:127]
  s_waitcnt vmcnt(6)
  v_cvt_pk_bf16_f32 v152, v128, v129
  v_cvt_pk_bf16_f32 v153, v130, v131
  v_exp_f32 v132, v132
  v_exp_f32 v133, v133
  v_exp_f32 v134, v134
  v_exp_f32 v135, v135
  v_mfma_f32_32x32x16_bf16 v[48:63], v[184:187], v[144:147], v[48:63]
  v_cvt_pk_bf16_f32 v154, v132, v133
  v_cvt_pk_bf16_f32 v155, v134, v135
  v_exp_f32 v136, v136
  v_exp_f32 v137, v137
  v_exp_f32 v138, v138
  v_exp_f32 v139, v139
  v_mfma_f32_32x32x16_bf16 v[48:63], v[188:191], v[148:151], v[48:63]
  v_cvt_pk_bf16_f32 v156, v136, v137
  v_cvt_pk_bf16_f32 v157, v138, v139
  v_exp_f32 v140, v140
  v_exp_f32 v141, v141
  v_exp_f32 v142, v142
  v_exp_f32 v143, v143
  v_cvt_pk_bf16_f32 v158, v140, v141
  v_cvt_pk_bf16_f32 v159, v142, v143
  v_mfma_f32_32x32x16_bf16 v[128:143], v[176:179], v[40:43], 0
  buffer_load_dwordx4 v[164:167], v1, s[64:67], s21 offen offset:1024 sc1
  v_exp_f32 v112, v112
  v_exp_f32 v113, v113
  v_exp_f32 v114, v114
  v_exp_f32 v115, v115
  v_mfma_f32_32x32x16_bf16 v[128:143], v[180:183], v[44:47], v[128:143]
  v_cvt_pk_bf16_f32 v144, v112, v113
  v_cvt_pk_bf16_f32 v145, v114, v115
  v_exp_f32 v116, v116
  v_exp_f32 v117, v117
  v_exp_f32 v118, v118
  v_exp_f32 v119, v119
  v_mfma_f32_32x32x16_bf16 v[64:79], v[184:187], v[152:155], v[64:79]
  s_add_u32 s11, s18, 65536
  v_cvt_pk_bf16_f32 v146, v116, v117
  v_cvt_pk_bf16_f32 v147, v118, v119
  v_exp_f32 v120, v120
  v_exp_f32 v121, v121
  v_exp_f32 v122, v122
  v_exp_f32 v123, v123
  v_mfma_f32_32x32x16_bf16 v[64:79], v[188:191], v[156:159], v[64:79]
  s_waitcnt vmcnt(5)
  v_cvt_pk_bf16_f32 v148, v120, v121
  v_cvt_pk_bf16_f32 v149, v122, v123
  v_exp_f32 v124, v124
  v_exp_f32 v125, v125
  v_exp_f32 v126, v126
  v_exp_f32 v127, v127
  v_cvt_pk_bf16_f32 v150, v124, v125
  v_cvt_pk_bf16_f32 v151, v126, v127
  v_mfma_f32_32x32x16_bf16 v[112:127], v[192:195], v[16:19], 0
  buffer_load_dwordx4 v[168:171], v1, s[64:67], s21 offen offset:2048 sc1
  v_exp_f32 v128, v128
  v_exp_f32 v129, v129
  v_exp_f32 v130, v130
  v_exp_f32 v131, v131
  v_mfma_f32_32x32x16_bf16 v[112:127], v[196:199], v[20:23], v[112:127]
  s_and_b32 s11, s11, 245760
  s_waitcnt vmcnt(3)
  v_cmp_ne_u32 s[86:87], 0, v13
  v_cvt_pk_bf16_f32 v152, v128, v129
  v_cvt_pk_bf16_f32 v153, v130, v131
  v_exp_f32 v132, v132
  v_exp_f32 v133, v133
  v_exp_f32 v134, v134
  v_exp_f32 v135, v135
  v_mfma_f32_32x32x16_bf16 v[80:95], v[184:187], v[144:147], v[80:95]
  buffer_load_dwordx4 v[172:175], v1, s[64:67], s21 offen offset:3072 sc1
  s_add_u32 s11, s11, s10
  v_cvt_pk_bf16_f32 v154, v132, v133
  v_cvt_pk_bf16_f32 v155, v134, v135
  v_exp_f32 v136, v136
  v_exp_f32 v137, v137
  v_exp_f32 v138, v138
  v_exp_f32 v139, v139
  v_mfma_f32_32x32x16_bf16 v[80:95], v[188:191], v[148:151], v[80:95]
  s_andn2_b32 s3, 0x30, s86
  s_cbranch_scc1 L93
L94:
  s_barrier
  v_cvt_pk_bf16_f32 v156, v136, v137
  v_cvt_pk_bf16_f32 v157, v138, v139
  v_exp_f32 v140, v140
  v_exp_f32 v141, v141
  v_exp_f32 v142, v142
  v_exp_f32 v143, v143
  v_cvt_pk_bf16_f32 v158, v140, v141
  v_cvt_pk_bf16_f32 v159, v142, v143
  v_mfma_f32_32x32x16_bf16 v[128:143], v[192:195], v[24:27], 0
  buffer_load_dwordx4 v[208:211], v1, s[64:67], s11 offen offset:0 sc1
  v_exp_f32 v112, v112
  v_exp_f32 v113, v113
  v_exp_f32 v114, v114
  v_exp_f32 v115, v115
  v_mfma_f32_32x32x16_bf16 v[128:143], v[196:199], v[28:31], v[128:143]
  v_cvt_pk_bf16_f32 v144, v112, v113
  v_cvt_pk_bf16_f32 v145, v114, v115
  v_exp_f32 v116, v116
  v_exp_f32 v117, v117
  v_exp_f32 v118, v118
  v_exp_f32 v119, v119
  v_mfma_f32_32x32x16_bf16 v[96:111], v[184:187], v[152:155], v[96:111]
  v_cvt_pk_bf16_f32 v146, v116, v117
  v_cvt_pk_bf16_f32 v147, v118, v119
  v_exp_f32 v120, v120
  v_exp_f32 v121, v121
  v_exp_f32 v122, v122
  v_exp_f32 v123, v123
  v_mfma_f32_32x32x16_bf16 v[96:111], v[188:191], v[156:159], v[96:111]
  v_cvt_pk_bf16_f32 v148, v120, v121
  v_cvt_pk_bf16_f32 v149, v122, v123
  v_exp_f32 v124, v124
  v_exp_f32 v125, v125
  v_exp_f32 v126, v126
  v_exp_f32 v127, v127
  v_cvt_pk_bf16_f32 v150, v124, v125
  v_cvt_pk_bf16_f32 v151, v126, v127
  v_mfma_f32_32x32x16_bf16 v[112:127], v[192:195], v[32:35], 0
  buffer_load_dwordx4 v[212:215], v1, s[64:67], s11 offen offset:1024 sc1
  v_exp_f32 v128, v128
  v_exp_f32 v129, v129
  v_exp_f32 v130, v130
  v_exp_f32 v131, v131
  v_mfma_f32_32x32x16_bf16 v[112:127], v[196:199], v[36:39], v[112:127]
  v_cvt_pk_bf16_f32 v152, v128, v129
  v_cvt_pk_bf16_f32 v153, v130, v131
  v_exp_f32 v132, v132
  v_exp_f32 v133, v133
  v_exp_f32 v134, v134
  v_exp_f32 v135, v135
  v_mfma_f32_32x32x16_bf16 v[48:63], v[200:203], v[144:147], v[48:63]
  s_add_u32 s21, s18, 81920
  v_cvt_pk_bf16_f32 v154, v132, v133
  v_cvt_pk_bf16_f32 v155, v134, v135
  v_exp_f32 v136, v136
  v_exp_f32 v137, v137
  v_exp_f32 v138, v138
  v_exp_f32 v139, v139
  v_mfma_f32_32x32x16_bf16 v[48:63], v[204:207], v[148:151], v[48:63]
  s_mov_b64 exec, 0xc0
  buffer_load_dword v13, v232, s[64:67], s9 offen sc1
  s_mov_b64 exec, -1
  v_cvt_pk_bf16_f32 v156, v136, v137
  v_cvt_pk_bf16_f32 v157, v138, v139
  v_exp_f32 v140, v140
  v_exp_f32 v141, v141
  v_exp_f32 v142, v142
  v_exp_f32 v143, v143
  v_cvt_pk_bf16_f32 v158, v140, v141
  v_cvt_pk_bf16_f32 v159, v142, v143
  v_mfma_f32_32x32x16_bf16 v[128:143], v[192:195], v[40:43], 0
  buffer_load_dwordx4 v[216:219], v1, s[64:67], s11 offen offset:2048 sc1
  v_exp_f32 v112, v112
  v_exp_f32 v113, v113
  v_exp_f32 v114, v114
  v_exp_f32 v115, v115
  v_mfma_f32_32x32x16_bf16 v[128:143], v[196:199], v[44:47], v[128:143]
  s_and_b32 s21, s21, 245760
  v_cvt_pk_bf16_f32 v144, v112, v113
  v_cvt_pk_bf16_f32 v145, v114, v115
  v_exp_f32 v116, v116
  v_exp_f32 v117, v117
  v_exp_f32 v118, v118
  v_exp_f32 v119, v119
  v_mfma_f32_32x32x16_bf16 v[64:79], v[200:203], v[152:155], v[64:79]
  buffer_load_dwordx4 v[220:223], v1, s[64:67], s11 offen offset:3072 sc1
  s_add_u32 s21, s21, s10
  v_cvt_pk_bf16_f32 v146, v116, v117
  v_cvt_pk_bf16_f32 v147, v118, v119
  v_exp_f32 v120, v120
  v_exp_f32 v121, v121
  v_exp_f32 v122, v122
  v_exp_f32 v123, v123
  v_mfma_f32_32x32x16_bf16 v[64:79], v[204:207], v[156:159], v[64:79]
  s_waitcnt vmcnt(7)
  v_cvt_pk_bf16_f32 v148, v120, v121
  v_cvt_pk_bf16_f32 v149, v122, v123
  v_exp_f32 v124, v124
  v_exp_f32 v125, v125
  v_exp_f32 v126, v126
  v_exp_f32 v127, v127
  v_cvt_pk_bf16_f32 v150, v124, v125
  v_cvt_pk_bf16_f32 v151, v126, v127
  v_mfma_f32_32x32x16_bf16 v[112:127], v[160:163], v[16:19], 0
  buffer_load_dwordx4 v[176:179], v1, s[64:67], s21 offen offset:0 sc1
  v_exp_f32 v128, v128
  v_exp_f32 v129, v129
  v_exp_f32 v130, v130
  v_exp_f32 v131, v131
  v_mfma_f32_32x32x16_bf16 v[112:127], v[164:167], v[20:23], v[112:127]
  s_and_b32 s101, s68, 1
  v_cvt_pk_bf16_f32 v152, v128, v129
  v_cvt_pk_bf16_f32 v153, v130, v131
  v_exp_f32 v132, v132
  v_exp_f32 v133, v133
  v_exp_f32 v134, v134
  v_exp_f32 v135, v135
  v_mfma_f32_32x32x16_bf16 v[80:95], v[200:203], v[144:147], v[80:95]
  s_mul_i32 s100, s101, 50176
  v_cvt_pk_bf16_f32 v154, v132, v133
  v_cvt_pk_bf16_f32 v155, v134, v135
  v_exp_f32 v136, v136
  v_exp_f32 v137, v137
  v_exp_f32 v138, v138
  v_exp_f32 v139, v139
  v_mfma_f32_32x32x16_bf16 v[80:95], v[204:207], v[148:151], v[80:95]
  s_add_u32 s100, s100, s78
  v_cvt_pk_bf16_f32 v156, v136, v137
  v_cvt_pk_bf16_f32 v157, v138, v139
  v_exp_f32 v140, v140
  v_exp_f32 v141, v141
  v_exp_f32 v142, v142
  v_exp_f32 v143, v143
  v_cvt_pk_bf16_f32 v158, v140, v141
  v_cvt_pk_bf16_f32 v159, v142, v143
  v_mfma_f32_32x32x16_bf16 v[128:143], v[160:163], v[24:27], 0
  buffer_load_dwordx4 v[180:183], v1, s[64:67], s21 offen offset:1024 sc1
  v_exp_f32 v112, v112
  v_exp_f32 v113, v113
  v_exp_f32 v114, v114
  v_exp_f32 v115, v115
  v_mfma_f32_32x32x16_bf16 v[128:143], v[164:167], v[28:31], v[128:143]
  s_mul_i32 s101, s101, 7168
  v_cvt_pk_bf16_f32 v144, v112, v113
  v_cvt_pk_bf16_f32 v145, v114, v115
  v_exp_f32 v116, v116
  v_exp_f32 v117, v117
  v_exp_f32 v118, v118
  v_exp_f32 v119, v119
  v_mfma_f32_32x32x16_bf16 v[96:111], v[200:203], v[152:155], v[96:111]
  v_cvt_pk_bf16_f32 v146, v116, v117
  v_cvt_pk_bf16_f32 v147, v118, v119
  v_exp_f32 v120, v120
  v_exp_f32 v121, v121
  v_exp_f32 v122, v122
  v_exp_f32 v123, v123
  v_mfma_f32_32x32x16_bf16 v[96:111], v[204:207], v[156:159], v[96:111]
  s_add_u32 s101, s101, s76
  v_cvt_pk_bf16_f32 v148, v120, v121
  v_cvt_pk_bf16_f32 v149, v122, v123
  v_exp_f32 v124, v124
  v_exp_f32 v125, v125
  v_exp_f32 v126, v126
  v_exp_f32 v127, v127
  v_cvt_pk_bf16_f32 v150, v124, v125
  v_cvt_pk_bf16_f32 v151, v126, v127
  v_mfma_f32_32x32x16_bf16 v[112:127], v[160:163], v[32:35], 0
  buffer_load_dwordx4 v[184:187], v1, s[64:67], s21 offen offset:2048 sc1
  v_exp_f32 v128, v128
  v_exp_f32 v129, v129
  v_exp_f32 v130, v130
  v_exp_f32 v131, v131
  v_mfma_f32_32x32x16_bf16 v[112:127], v[164:167], v[36:39], v[112:127]
  s_waitcnt vmcnt(8)
  v_cvt_pk_bf16_f32 v152, v128, v129
  v_cvt_pk_bf16_f32 v153, v130, v131
  v_exp_f32 v132, v132
  v_exp_f32 v133, v133
  v_exp_f32 v134, v134
  v_exp_f32 v135, v135
  v_mfma_f32_32x32x16_bf16 v[48:63], v[168:171], v[144:147], v[48:63]
  buffer_load_dwordx4 v[188:191], v1, s[64:67], s21 offen offset:3072 sc1
  s_add_u32 s11, s22, 98304
  v_cvt_pk_bf16_f32 v154, v132, v133
  v_cvt_pk_bf16_f32 v155, v134, v135
  v_exp_f32 v136, v136
  v_exp_f32 v137, v137
  v_exp_f32 v138, v138
  v_exp_f32 v139, v139
  v_mfma_f32_32x32x16_bf16 v[48:63], v[172:175], v[148:151], v[48:63]
  s_add_u32 m0, s101, 0
  v_cvt_pk_bf16_f32 v156, v136, v137
  v_cvt_pk_bf16_f32 v157, v138, v139
  v_exp_f32 v140, v140
  v_exp_f32 v141, v141
  v_exp_f32 v142, v142
  v_exp_f32 v143, v143
  v_cvt_pk_bf16_f32 v158, v140, v141
  v_cvt_pk_bf16_f32 v159, v142, v143
  v_mfma_f32_32x32x16_bf16 v[128:143], v[160:163], v[40:43], 0
  s_add_u32 s12, s100, 0
  v_exp_f32 v112, v112
  v_exp_f32 v113, v113
  v_exp_f32 v114, v114
  v_exp_f32 v115, v115
  v_mfma_f32_32x32x16_bf16 v[128:143], v[164:167], v[44:47], v[128:143]
  s_and_b32 s11, s11, 245760
  s_waitcnt vmcnt(6)
  v_cmp_ne_u32 s[86:87], 0, v13
  v_cvt_pk_bf16_f32 v144, v112, v113
  v_cvt_pk_bf16_f32 v145, v114, v115
  v_exp_f32 v116, v116
  v_exp_f32 v117, v117
  v_exp_f32 v118, v118
  v_exp_f32 v119, v119
  v_mfma_f32_32x32x16_bf16 v[64:79], v[168:171], v[152:155], v[64:79]
  s_add_u32 s11, s11, s10
  v_cvt_pk_bf16_f32 v146, v116, v117
  v_cvt_pk_bf16_f32 v147, v118, v119
  v_exp_f32 v120, v120
  v_exp_f32 v121, v121
  v_exp_f32 v122, v122
  v_exp_f32 v123, v123
  v_mfma_f32_32x32x16_bf16 v[64:79], v[172:175], v[156:159], v[64:79]
  s_andn2_b32 s3, 0xc0, s86
  s_cbranch_scc1 L95
L96:
  v_cvt_pk_bf16_f32 v148, v120, v121
  v_cvt_pk_bf16_f32 v149, v122, v123
  v_exp_f32 v124, v124
  v_exp_f32 v125, v125
  v_exp_f32 v126, v126
  v_exp_f32 v127, v127
  v_cvt_pk_bf16_f32 v150, v124, v125
  v_cvt_pk_bf16_f32 v151, v126, v127
  v_mfma_f32_32x32x16_bf16 v[112:127], v[208:211], v[16:19], 0
  buffer_load_dwordx4 v[192:195], v1, s[64:67], s11 offen offset:0 sc1
  v_exp_f32 v128, v128
  v_exp_f32 v129, v129
  v_exp_f32 v130, v130
  v_exp_f32 v131, v131
  v_mfma_f32_32x32x16_bf16 v[112:127], v[212:215], v[20:23], v[112:127]
  v_cvt_pk_bf16_f32 v152, v128, v129
  v_cvt_pk_bf16_f32 v153, v130, v131
  v_exp_f32 v132, v132
  v_exp_f32 v133, v133
  v_exp_f32 v134, v134
  v_exp_f32 v135, v135
  v_mfma_f32_32x32x16_bf16 v[80:95], v[168:171], v[144:147], v[80:95]
  buffer_load_dwordx4 v236, s[36:39], s12 offen offset:0  lds
  v_cvt_pk_bf16_f32 v154, v132, v133
  v_cvt_pk_bf16_f32 v155, v134, v135
  v_exp_f32 v136, v136
  v_exp_f32 v137, v137
  v_exp_f32 v138, v138
  v_exp_f32 v139, v139
  v_mfma_f32_32x32x16_bf16 v[80:95], v[172:175], v[148:151], v[80:95]
  s_mov_b64 exec, 0xff00
  buffer_load_dword v13, v232, s[64:67], s9 offen sc1
  s_mov_b64 exec, -1
  v_cvt_pk_bf16_f32 v156, v136, v137
  v_cvt_pk_bf16_f32 v157, v138, v139
  v_exp_f32 v140, v140
  v_exp_f32 v141, v141
  v_exp_f32 v142, v142
  v_exp_f32 v143, v143
  v_cvt_pk_bf16_f32 v158, v140, v141
  v_cvt_pk_bf16_f32 v159, v142, v143
  v_mfma_f32_32x32x16_bf16 v[128:143], v[208:211], v[24:27], 0
  buffer_load_dwordx4 v[196:199], v1, s[64:67], s11 offen offset:1024 sc1
  v_exp_f32 v112, v112
  v_exp_f32 v113, v113
  v_exp_f32 v114, v114
  v_exp_f32 v115, v115
  v_mfma_f32_32x32x16_bf16 v[128:143], v[212:215], v[28:31], v[128:143]
  buffer_load_dwordx4 v237, s[36:39], s12 offen offset:1024  lds
  v_cvt_pk_bf16_f32 v144, v112, v113
  v_cvt_pk_bf16_f32 v145, v114, v115
  v_exp_f32 v116, v116
  v_exp_f32 v117, v117
  v_exp_f32 v118, v118
  v_exp_f32 v119, v119
  v_mfma_f32_32x32x16_bf16 v[96:111], v[168:171], v[152:155], v[96:111]
  buffer_load_dwordx4 v238, s[36:39], s12 offen offset:2048  lds
  v_cvt_pk_bf16_f32 v146, v116, v117
  v_cvt_pk_bf16_f32 v147, v118, v119
  v_exp_f32 v120, v120
  v_exp_f32 v121, v121
  v_exp_f32 v122, v122
  v_exp_f32 v123, v123
  v_mfma_f32_32x32x16_bf16 v[96:111], v[172:175], v[156:159], v[96:111]
  v_cvt_pk_bf16_f32 v148, v120, v121
  v_cvt_pk_bf16_f32 v149, v122, v123
  v_exp_f32 v124, v124
  v_exp_f32 v125, v125
  v_exp_f32 v126, v126
  v_exp_f32 v127, v127
  v_cvt_pk_bf16_f32 v150, v124, v125
  v_cvt_pk_bf16_f32 v151, v126, v127
  v_mfma_f32_32x32x16_bf16 v[112:127], v[208:211], v[32:35], 0
  buffer_load_dwordx4 v[200:203], v1, s[64:67], s11 offen offset:2048 sc1
  v_exp_f32 v128, v128
  v_exp_f32 v129, v129
  v_exp_f32 v130, v130
  v_exp_f32 v131, v131
  v_mfma_f32_32x32x16_bf16 v[112:127], v[212:215], v[36:39], v[112:127]
  s_waitcnt vmcnt(11)
  v_cvt_pk_bf16_f32 v152, v128, v129
  v_cvt_pk_bf16_f32 v153, v130, v131
  v_exp_f32 v132, v132
  v_exp_f32 v133, v133
  v_exp_f32 v134, v134
  v_exp_f32 v135, v135
  v_mfma_f32_32x32x16_bf16 v[48:63], v[216:219], v[144:147], v[48:63]
  s_add_u32 s21, s23, 114688
  v_cvt_pk_bf16_f32 v154, v132, v133
  v_cvt_pk_bf16_f32 v155, v134, v135
  v_exp_f32 v136, v136
  v_exp_f32 v137, v137
  v_exp_f32 v138, v138
  v_exp_f32 v139, v139
  v_mfma_f32_32x32x16_bf16 v[48:63], v[220:223], v[148:151], v[48:63]
  buffer_load_dwordx4 v239, s[36:39], s12 offen offset:3072  lds
  v_cvt_pk_bf16_f32 v156, v136, v137
  v_cvt_pk_bf16_f32 v157, v138, v139
  v_exp_f32 v140, v140
  v_exp_f32 v141, v141
  v_exp_f32 v142, v142
  v_exp_f32 v143, v143
  v_cvt_pk_bf16_f32 v158, v140, v141
  v_cvt_pk_bf16_f32 v159, v142, v143
  v_mfma_f32_32x32x16_bf16 v[128:143], v[208:211], v[40:43], 0
  buffer_load_dwordx4 v[204:207], v1, s[64:67], s11 offen offset:3072 sc1
  v_exp_f32 v112, v112
  v_exp_f32 v113, v113
  v_exp_f32 v114, v114
  v_exp_f32 v115, v115
  v_mfma_f32_32x32x16_bf16 v[128:143], v[212:215], v[44:47], v[128:143]
  s_and_b32 s21, s21, 245760
  v_cvt_pk_bf16_f32 v144, v112, v113
  v_cvt_pk_bf16_f32 v145, v114, v115
  v_exp_f32 v116, v116
  v_exp_f32 v117, v117
  v_exp_f32 v118, v118
  v_exp_f32 v119, v119
  v_mfma_f32_32x32x16_bf16 v[64:79], v[216:219], v[152:155], v[64:79]
  s_add_u32 s21, s21, s10
  v_cvt_pk_bf16_f32 v146, v116, v117
  v_cvt_pk_bf16_f32 v147, v118, v119
  v_exp_f32 v120, v120
  v_exp_f32 v121, v121
  v_exp_f32 v122, v122
  v_exp_f32 v123, v123
  v_mfma_f32_32x32x16_bf16 v[64:79], v[220:223], v[156:159], v[64:79]
  s_waitcnt vmcnt(11)
  v_cvt_pk_bf16_f32 v148, v120, v121
  v_cvt_pk_bf16_f32 v149, v122, v123
  v_exp_f32 v124, v124
  v_exp_f32 v125, v125
  v_exp_f32 v126, v126
  v_exp_f32 v127, v127
  v_cvt_pk_bf16_f32 v150, v124, v125
  v_cvt_pk_bf16_f32 v151, v126, v127
  v_mfma_f32_32x32x16_bf16 v[112:127], v[176:179], v[16:19], 0
  buffer_load_dwordx4 v[160:163], v1, s[64:67], s21 offen offset:0 sc1
  v_exp_f32 v128, v128
  v_exp_f32 v129, v129
  v_exp_f32 v130, v130
  v_exp_f32 v131, v131
  v_mfma_f32_32x32x16_bf16 v[112:127], v[180:183], v[20:23], v[112:127]
  s_add_u32 m0, s101, 4096
  v_cvt_pk_bf16_f32 v152, v128, v129
  v_cvt_pk_bf16_f32 v153, v130, v131
  v_exp_f32 v132, v132
  v_exp_f32 v133, v133
  v_exp_f32 v134, v134
  v_exp_f32 v135, v135
  v_mfma_f32_32x32x16_bf16 v[80:95], v[216:219], v[144:147], v[80:95]
  s_add_u32 s12, s100, 28672
  v_cvt_pk_bf16_f32 v154, v132, v133
  v_cvt_pk_bf16_f32 v155, v134, v135
  v_exp_f32 v136, v136
  v_exp_f32 v137, v137
  v_exp_f32 v138, v138
  v_exp_f32 v139, v139
  v_mfma_f32_32x32x16_bf16 v[80:95], v[220:223], v[148:151], v[80:95]
  buffer_load_dwordx4 v236, s[36:39], s12 offen offset:0  lds
  v_cvt_pk_bf16_f32 v156, v136, v137
  v_cvt_pk_bf16_f32 v157, v138, v139
  v_exp_f32 v140, v140
  v_exp_f32 v141, v141
  v_exp_f32 v142, v142
  v_exp_f32 v143, v143
  v_cvt_pk_bf16_f32 v158, v140, v141
  v_cvt_pk_bf16_f32 v159, v142, v143
  v_mfma_f32_32x32x16_bf16 v[128:143], v[176:179], v[24:27], 0
  buffer_load_dwordx4 v[164:167], v1, s[64:67], s21 offen offset:1024 sc1
  v_exp_f32 v112, v112
  v_exp_f32 v113, v113
  v_exp_f32 v114, v114
  v_exp_f32 v115, v115
  v_mfma_f32_32x32x16_bf16 v[128:143], v[180:183], v[28:31], v[128:143]
  v_cvt_pk_bf16_f32 v144, v112, v113
  v_cvt_pk_bf16_f32 v145, v114, v115
  v_exp_f32 v116, v116
  v_exp_f32 v117, v117
  v_exp_f32 v118, v118
  v_exp_f32 v119, v119
  v_mfma_f32_32x32x16_bf16 v[96:111], v[216:219], v[152:155], v[96:111]
  buffer_load_dwordx4 v237, s[36:39], s12 offen offset:1024  lds
  v_cvt_pk_bf16_f32 v146, v116, v117
  v_cvt_pk_bf16_f32 v147, v118, v119
  v_exp_f32 v120, v120
  v_exp_f32 v121, v121
  v_exp_f32 v122, v122
  v_exp_f32 v123, v123
  v_mfma_f32_32x32x16_bf16 v[96:111], v[220:223], v[156:159], v[96:111]
  buffer_load_dwordx4 v238, s[36:39], s12 offen offset:2048  lds
  v_cvt_pk_bf16_f32 v148, v120, v121
  v_cvt_pk_bf16_f32 v149, v122, v123
  v_exp_f32 v124, v124
  v_exp_f32 v125, v125
  v_exp_f32 v126, v126
  v_exp_f32 v127, v127
  v_cvt_pk_bf16_f32 v150, v124, v125
  v_cvt_pk_bf16_f32 v151, v126, v127
  v_mfma_f32_32x32x16_bf16 v[112:127], v[176:179], v[32:35], 0
  buffer_load_dwordx4 v[168:171], v1, s[64:67], s21 offen offset:2048 sc1
  v_exp_f32 v128, v128
  v_exp_f32 v129, v129
  v_exp_f32 v130, v130
  v_exp_f32 v131, v131
  v_mfma_f32_32x32x16_bf16 v[112:127], v[180:183], v[36:39], v[112:127]
  s_waitcnt vmcnt(12)
  v_cmp_ne_u32 s[86:87], 0, v13
  v_cvt_pk_bf16_f32 v152, v128, v129
  v_cvt_pk_bf16_f32 v153, v130, v131
  v_exp_f32 v132, v132
  v_exp_f32 v133, v133
  v_exp_f32 v134, v134
  v_exp_f32 v135, v135
  v_mfma_f32_32x32x16_bf16 v[48:63], v[184:187], v[144:147], v[48:63]
  s_add_u32 s11, s22, 131072
  v_cvt_pk_bf16_f32 v154, v132, v133
  v_cvt_pk_bf16_f32 v155, v134, v135
  v_exp_f32 v136, v136
  v_exp_f32 v137, v137
  v_exp_f32 v138, v138
  v_exp_f32 v139, v139
  v_mfma_f32_32x32x16_bf16 v[48:63], v[188:191], v[148:151], v[48:63]
  s_and_b32 s101, s68, 1
  v_cvt_pk_bf16_f32 v156, v136, v137
  v_cvt_pk_bf16_f32 v157, v138, v139
  v_exp_f32 v140, v140
  v_exp_f32 v141, v141
  v_exp_f32 v142, v142
  v_exp_f32 v143, v143
  v_cvt_pk_bf16_f32 v158, v140, v141
  v_cvt_pk_bf16_f32 v159, v142, v143
  v_mfma_f32_32x32x16_bf16 v[128:143], v[176:179], v[40:43], 0
  buffer_load_dwordx4 v[172:175], v1, s[64:67], s21 offen offset:3072 sc1
  v_exp_f32 v112, v112
  v_exp_f32 v113, v113
  v_exp_f32 v114, v114
  v_exp_f32 v115, v115
  v_mfma_f32_32x32x16_bf16 v[128:143], v[180:183], v[44:47], v[128:143]
  s_and_b32 s11, s11, 245760
  v_cvt_pk_bf16_f32 v144, v112, v113
  v_cvt_pk_bf16_f32 v145, v114, v115
  v_exp_f32 v116, v116
  v_exp_f32 v117, v117
  v_exp_f32 v118, v118
  v_exp_f32 v119, v119
  v_mfma_f32_32x32x16_bf16 v[64:79], v[184:187], v[152:155], v[64:79]
  s_add_u32 s11, s11, s10
  v_cvt_pk_bf16_f32 v146, v116, v117
  v_cvt_pk_bf16_f32 v147, v118, v119
  v_exp_f32 v120, v120
  v_exp_f32 v121, v121
  v_exp_f32 v122, v122
  v_exp_f32 v123, v123
  v_mfma_f32_32x32x16_bf16 v[64:79], v[188:191], v[156:159], v[64:79]
  s_andn2_b32 s3, 0xff00, s86
  s_cbranch_scc1 L97
L98:
  s_waitcnt vmcnt(12)
  v_cvt_pk_bf16_f32 v148, v120, v121
  v_cvt_pk_bf16_f32 v149, v122, v123
  v_exp_f32 v124, v124
  v_exp_f32 v125, v125
  v_exp_f32 v126, v126
  v_exp_f32 v127, v127
  v_cvt_pk_bf16_f32 v150, v124, v125
  v_cvt_pk_bf16_f32 v151, v126, v127
  v_mfma_f32_32x32x16_bf16 v[112:127], v[192:195], v[16:19], 0
  buffer_load_dwordx4 v[208:211], v1, s[64:67], s11 offen offset:0 sc1
  v_exp_f32 v128, v128
  v_exp_f32 v129, v129
  v_exp_f32 v130, v130
  v_exp_f32 v131, v131
  v_mfma_f32_32x32x16_bf16 v[112:127], v[196:199], v[20:23], v[112:127]
  v_cvt_pk_bf16_f32 v152, v128, v129
  v_cvt_pk_bf16_f32 v153, v130, v131
  v_exp_f32 v132, v132
  v_exp_f32 v133, v133
  v_exp_f32 v134, v134
  v_exp_f32 v135, v135
  v_mfma_f32_32x32x16_bf16 v[80:95], v[184:187], v[144:147], v[80:95]
  s_mul_i32 s100, s101, 50176
  v_cvt_pk_bf16_f32 v154, v132, v133
  v_cvt_pk_bf16_f32 v155, v134, v135
  v_exp_f32 v136, v136
  v_exp_f32 v137, v137
  v_exp_f32 v138, v138
  v_exp_f32 v139, v139
  v_mfma_f32_32x32x16_bf16 v[80:95], v[188:191], v[148:151], v[80:95]
  s_add_u32 s100, s100, s78
  v_cvt_pk_bf16_f32 v156, v136, v137
  v_cvt_pk_bf16_f32 v157, v138, v139
  v_exp_f32 v140, v140
  v_exp_f32 v141, v141
  v_exp_f32 v142, v142
  v_exp_f32 v143, v143
  v_cvt_pk_bf16_f32 v158, v140, v141
  v_cvt_pk_bf16_f32 v159, v142, v143
  v_mfma_f32_32x32x16_bf16 v[128:143], v[192:195], v[24:27], 0
  buffer_load_dwordx4 v[212:215], v1, s[64:67], s11 offen offset:1024 sc1
  v_exp_f32 v112, v112
  v_exp_f32 v113, v113
  v_exp_f32 v114, v114
  v_exp_f32 v115, v115
  v_mfma_f32_32x32x16_bf16 v[128:143], v[196:199], v[28:31], v[128:143]
  s_mul_i32 s101, s101, 7168
  v_cvt_pk_bf16_f32 v144, v112, v113
  v_cvt_pk_bf16_f32 v145, v114, v115
  v_exp_f32 v116, v116
  v_exp_f32 v117, v117
  v_exp_f32 v118, v118
  v_exp_f32 v119, v119
  v_mfma_f32_32x32x16_bf16 v[96:111], v[184:187], v[152:155], v[96:111]
  v_cvt_pk_bf16_f32 v146, v116, v117
  v_cvt_pk_bf16_f32 v147, v118, v119
  v_exp_f32 v120, v120
  v_exp_f32 v121, v121
  v_exp_f32 v122, v122
  v_exp_f32 v123, v123
  v_mfma_f32_32x32x16_bf16 v[96:111], v[188:191], v[156:159], v[96:111]
  s_add_u32 s101, s101, s77
  v_cvt_pk_bf16_f32 v148, v120, v121
  v_cvt_pk_bf16_f32 v149, v122, v123
  v_exp_f32 v124, v124
  v_exp_f32 v125, v125
  v_exp_f32 v126, v126
  v_exp_f32 v127, v127
  v_cvt_pk_bf16_f32 v150, v124, v125
  v_cvt_pk_bf16_f32 v151, v126, v127
  v_mfma_f32_32x32x16_bf16 v[112:127], v[192:195], v[32:35], 0
  buffer_load_dwordx4 v[216:219], v1, s[64:67], s11 offen offset:2048 sc1
  v_exp_f32 v128, v128
  v_exp_f32 v129, v129
  v_exp_f32 v130, v130
  v_exp_f32 v131, v131
  v_mfma_f32_32x32x16_bf16 v[112:127], v[196:199], v[36:39], v[112:127]
  s_waitcnt vmcnt(10)
  v_cvt_pk_bf16_f32 v152, v128, v129
  v_cvt_pk_bf16_f32 v153, v130, v131
  v_exp_f32 v132, v132
  v_exp_f32 v133, v133
  v_exp_f32 v134, v134
  v_exp_f32 v135, v135
  v_mfma_f32_32x32x16_bf16 v[48:63], v[200:203], v[144:147], v[48:63]
  s_add_u32 s21, s23, 147456
  v_cvt_pk_bf16_f32 v154, v132, v133
  v_cvt_pk_bf16_f32 v155, v134, v135
  v_exp_f32 v136, v136
  v_exp_f32 v137, v137
  v_exp_f32 v138, v138
  v_exp_f32 v139, v139
  v_mfma_f32_32x32x16_bf16 v[48:63], v[204:207], v[148:151], v[48:63]
  s_add_u32 m0, s101, 0
  v_cvt_pk_bf16_f32 v156, v136, v137
  v_cvt_pk_bf16_f32 v157, v138, v139
  v_exp_f32 v140, v140
  v_exp_f32 v141, v141
  v_exp_f32 v142, v142
  v_exp_f32 v143, v143
  v_cvt_pk_bf16_f32 v158, v140, v141
  v_cvt_pk_bf16_f32 v159, v142, v143
  v_mfma_f32_32x32x16_bf16 v[128:143], v[192:195], v[40:43], 0
  buffer_load_dwordx4 v[220:223], v1, s[64:67], s11 offen offset:3072 sc1
  v_exp_f32 v112, v112
  v_exp_f32 v113, v113
  v_exp_f32 v114, v114
  v_exp_f32 v115, v115
  v_mfma_f32_32x32x16_bf16 v[128:143], v[196:199], v[44:47], v[128:143]
  s_and_b32 s21, s21, 245760
  v_cvt_pk_bf16_f32 v144, v112, v113
  v_cvt_pk_bf16_f32 v145, v114, v115
  v_exp_f32 v116, v116
  v_exp_f32 v117, v117
  v_exp_f32 v118, v118
  v_exp_f32 v119, v119
  v_mfma_f32_32x32x16_bf16 v[64:79], v[200:203], v[152:155], v[64:79]
  s_add_u32 s21, s21, s10
  v_cvt_pk_bf16_f32 v146, v116, v117
  v_cvt_pk_bf16_f32 v147, v118, v119
  v_exp_f32 v120, v120
  v_exp_f32 v121, v121
  v_exp_f32 v122, v122
  v_exp_f32 v123, v123
  v_mfma_f32_32x32x16_bf16 v[64:79], v[204:207], v[156:159], v[64:79]
  s_waitcnt vmcnt(8)
  v_cvt_pk_bf16_f32 v148, v120, v121
  v_cvt_pk_bf16_f32 v149, v122, v123
  v_exp_f32 v124, v124
  v_exp_f32 v125, v125
  v_exp_f32 v126, v126
  v_exp_f32 v127, v127
  v_cvt_pk_bf16_f32 v150, v124, v125
  v_cvt_pk_bf16_f32 v151, v126, v127
  v_mfma_f32_32x32x16_bf16 v[112:127], v[160:163], v[16:19], 0
  buffer_load_dwordx4 v[176:179], v1, s[64:67], s21 offen offset:0 sc1
  v_exp_f32 v128, v128
  v_exp_f32 v129, v129
  v_exp_f32 v130, v130
  v_exp_f32 v131, v131
  v_mfma_f32_32x32x16_bf16 v[112:127], v[164:167], v[20:23], v[112:127]
  s_add_u32 s12, s100, 0
  v_cvt_pk_bf16_f32 v152, v128, v129
  v_cvt_pk_bf16_f32 v153, v130, v131
  v_exp_f32 v132, v132
  v_exp_f32 v133, v133
  v_exp_f32 v134, v134
  v_exp_f32 v135, v135
  v_mfma_f32_32x32x16_bf16 v[80:95], v[200:203], v[144:147], v[80:95]
  buffer_load_dwordx4 v236, s[40:43], s12 offen offset:0  lds
  v_cvt_pk_bf16_f32 v154, v132, v133
  v_cvt_pk_bf16_f32 v155, v134, v135
  v_exp_f32 v136, v136
  v_exp_f32 v137, v137
  v_exp_f32 v138, v138
  v_exp_f32 v139, v139
  v_mfma_f32_32x32x16_bf16 v[80:95], v[204:207], v[148:151], v[80:95]
  v_cvt_pk_bf16_f32 v156, v136, v137
  v_cvt_pk_bf16_f32 v157, v138, v139
  v_exp_f32 v140, v140
  v_exp_f32 v141, v141
  v_exp_f32 v142, v142
  v_exp_f32 v143, v143
  v_cvt_pk_bf16_f32 v158, v140, v141
  v_cvt_pk_bf16_f32 v159, v142, v143
  v_mfma_f32_32x32x16_bf16 v[128:143], v[160:163], v[24:27], 0
  buffer_load_dwordx4 v[180:183], v1, s[64:67], s21 offen offset:1024 sc1
  v_exp_f32 v112, v112
  v_exp_f32 v113, v113
  v_exp_f32 v114, v114
  v_exp_f32 v115, v115
  v_mfma_f32_32x32x16_bf16 v[128:143], v[164:167], v[28:31], v[128:143]
  buffer_load_dwordx4 v237, s[40:43], s12 offen offset:1024  lds
  v_cvt_pk_bf16_f32 v144, v112, v113
  v_cvt_pk_bf16_f32 v145, v114, v115
  v_exp_f32 v116, v116
  v_exp_f32 v117, v117
  v_exp_f32 v118, v118
  v_exp_f32 v119, v119
  v_mfma_f32_32x32x16_bf16 v[96:111], v[200:203], v[152:155], v[96:111]
  buffer_load_dwordx4 v238, s[40:43], s12 offen offset:2048  lds
  v_cvt_pk_bf16_f32 v146, v116, v117
  v_cvt_pk_bf16_f32 v147, v118, v119
  v_exp_f32 v120, v120
  v_exp_f32 v121, v121
  v_exp_f32 v122, v122
  v_exp_f32 v123, v123
  v_mfma_f32_32x32x16_bf16 v[96:111], v[204:207], v[156:159], v[96:111]
  buffer_load_dwordx4 v239, s[40:43], s12 offen offset:3072  lds
  v_cvt_pk_bf16_f32 v148, v120, v121
  v_cvt_pk_bf16_f32 v149, v122, v123
  v_exp_f32 v124, v124
  v_exp_f32 v125, v125
  v_exp_f32 v126, v126
  v_exp_f32 v127, v127
  v_cvt_pk_bf16_f32 v150, v124, v125
  v_cvt_pk_bf16_f32 v151, v126, v127
  v_mfma_f32_32x32x16_bf16 v[112:127], v[160:163], v[32:35], 0
  buffer_load_dwordx4 v[184:187], v1, s[64:67], s21 offen offset:2048 sc1
  v_exp_f32 v128, v128
  v_exp_f32 v129, v129
  v_exp_f32 v130, v130
  v_exp_f32 v131, v131
  v_mfma_f32_32x32x16_bf16 v[112:127], v[164:167], v[36:39], v[112:127]
  s_waitcnt vmcnt(11)
  v_cvt_pk_bf16_f32 v152, v128, v129
  v_cvt_pk_bf16_f32 v153, v130, v131
  v_exp_f32 v132, v132
  v_exp_f32 v133, v133
  v_exp_f32 v134, v134
  v_exp_f32 v135, v135
  v_mfma_f32_32x32x16_bf16 v[48:63], v[168:171], v[144:147], v[48:63]
  s_add_u32 s11, s22, 163840
  v_cvt_pk_bf16_f32 v154, v132, v133
  v_cvt_pk_bf16_f32 v155, v134, v135
  v_exp_f32 v136, v136
  v_exp_f32 v137, v137
  v_exp_f32 v138, v138
  v_exp_f32 v139, v139
  v_mfma_f32_32x32x16_bf16 v[48:63], v[172:175], v[148:151], v[48:63]
  v_cvt_pk_bf16_f32 v156, v136, v137
  v_cvt_pk_bf16_f32 v157, v138, v139
  v_exp_f32 v140, v140
  v_exp_f32 v141, v141
  v_exp_f32 v142, v142
  v_exp_f32 v143, v143
  v_cvt_pk_bf16_f32 v158, v140, v141
  v_cvt_pk_bf16_f32 v159, v142, v143
  v_mfma_f32_32x32x16_bf16 v[128:143], v[160:163], v[40:43], 0
  buffer_load_dwordx4 v[188:191], v1, s[64:67], s21 offen offset:3072 sc1
  v_exp_f32 v112, v112
  v_exp_f32 v113, v113
  v_exp_f32 v114, v114
  v_exp_f32 v115, v115
  v_mfma_f32_32x32x16_bf16 v[128:143], v[164:167], v[44:47], v[128:143]
  s_and_b32 s11, s11, 245760
  v_cvt_pk_bf16_f32 v144, v112, v113
  v_cvt_pk_bf16_f32 v145, v114, v115
  v_exp_f32 v116, v116
  v_exp_f32 v117, v117
  v_exp_f32 v118, v118
  v_exp_f32 v119, v119
  v_mfma_f32_32x32x16_bf16 v[64:79], v[168:171], v[152:155], v[64:79]
  s_add_u32 s11, s11, s10
  v_cvt_pk_bf16_f32 v146, v116, v117
  v_cvt_pk_bf16_f32 v147, v118, v119
  v_exp_f32 v120, v120
  v_exp_f32 v121, v121
  v_exp_f32 v122, v122
  v_exp_f32 v123, v123
  v_mfma_f32_32x32x16_bf16 v[64:79], v[172:175], v[156:159], v[64:79]
  s_waitcnt vmcnt(10)
  v_cvt_pk_bf16_f32 v148, v120, v121
  v_cvt_pk_bf16_f32 v149, v122, v123
  v_exp_f32 v124, v124
  v_exp_f32 v125, v125
  v_exp_f32 v126, v126
  v_exp_f32 v127, v127
  v_cvt_pk_bf16_f32 v150, v124, v125
  v_cvt_pk_bf16_f32 v151, v126, v127
  v_mfma_f32_32x32x16_bf16 v[112:127], v[208:211], v[16:19], 0
  buffer_load_dwordx4 v[192:195], v1, s[64:67], s11 offen offset:0 sc1
  v_exp_f32 v128, v128
  v_exp_f32 v129, v129
  v_exp_f32 v130, v130
  v_exp_f32 v131, v131
  v_mfma_f32_32x32x16_bf16 v[112:127], v[212:215], v[20:23], v[112:127]
  s_add_u32 m0, s101, 4096
  v_cvt_pk_bf16_f32 v152, v128, v129
  v_cvt_pk_bf16_f32 v153, v130, v131
  v_exp_f32 v132, v132
  v_exp_f32 v133, v133
  v_exp_f32 v134, v134
  v_exp_f32 v135, v135
  v_mfma_f32_32x32x16_bf16 v[80:95], v[168:171], v[144:147], v[80:95]
  s_add_u32 s12, s100, 28672
  v_cvt_pk_bf16_f32 v154, v132, v133
  v_cvt_pk_bf16_f32 v155, v134, v135
  v_exp_f32 v136, v136
  v_exp_f32 v137, v137
  v_exp_f32 v138, v138
  v_exp_f32 v139, v139
  v_mfma_f32_32x32x16_bf16 v[80:95], v[172:175], v[148:151], v[80:95]
  buffer_load_dwordx4 v236, s[40:43], s12 offen offset:0  lds
  v_cvt_pk_bf16_f32 v156, v136, v137
  v_cvt_pk_bf16_f32 v157, v138, v139
  v_exp_f32 v140, v140
  v_exp_f32 v141, v141
  v_exp_f32 v142, v142
  v_exp_f32 v143, v143
  v_cvt_pk_bf16_f32 v158, v140, v141
  v_cvt_pk_bf16_f32 v159, v142, v143
  v_mfma_f32_32x32x16_bf16 v[128:143], v[208:211], v[24:27], 0
  buffer_load_dwordx4 v[196:199], v1, s[64:67], s11 offen offset:1024 sc1
  v_exp_f32 v112, v112
  v_exp_f32 v113, v113
  v_exp_f32 v114, v114
  v_exp_f32 v115, v115
  v_mfma_f32_32x32x16_bf16 v[128:143], v[212:215], v[28:31], v[128:143]
  v_cvt_pk_bf16_f32 v144, v112, v113
  v_cvt_pk_bf16_f32 v145, v114, v115
  v_exp_f32 v116, v116
  v_exp_f32 v117, v117
  v_exp_f32 v118, v118
  v_exp_f32 v119, v119
  v_mfma_f32_32x32x16_bf16 v[96:111], v[168:171], v[152:155], v[96:111]
  buffer_load_dwordx4 v237, s[40:43], s12 offen offset:1024  lds
  v_cvt_pk_bf16_f32 v146, v116, v117
  v_cvt_pk_bf16_f32 v147, v118, v119
  v_exp_f32 v120, v120
  v_exp_f32 v121, v121
  v_exp_f32 v122, v122
  v_exp_f32 v123, v123
  v_mfma_f32_32x32x16_bf16 v[96:111], v[172:175], v[156:159], v[96:111]
  buffer_load_dwordx4 v238, s[40:43], s12 offen offset:2048  lds
  v_cvt_pk_bf16_f32 v148, v120, v121
  v_cvt_pk_bf16_f32 v149, v122, v123
  v_exp_f32 v124, v124
  v_exp_f32 v125, v125
  v_exp_f32 v126, v126
  v_exp_f32 v127, v127
  v_cvt_pk_bf16_f32 v150, v124, v125
  v_cvt_pk_bf16_f32 v151, v126, v127
  v_mfma_f32_32x32x16_bf16 v[112:127], v[208:211], v[32:35], 0
  buffer_load_dwordx4 v[200:203], v1, s[64:67], s11 offen offset:2048 sc1
  v_exp_f32 v128, v128
  v_exp_f32 v129, v129
  v_exp_f32 v130, v130
  v_exp_f32 v131, v131
  v_mfma_f32_32x32x16_bf16 v[112:127], v[212:215], v[36:39], v[112:127]
  s_waitcnt vmcnt(14)
  v_cvt_pk_bf16_f32 v152, v128, v129
  v_cvt_pk_bf16_f32 v153, v130, v131
  v_exp_f32 v132, v132
  v_exp_f32 v133, v133
  v_exp_f32 v134, v134
  v_exp_f32 v135, v135
  v_mfma_f32_32x32x16_bf16 v[48:63], v[216:219], v[144:147], v[48:63]
  s_add_u32 s21, s23, 180224
  v_cvt_pk_bf16_f32 v154, v132, v133
  v_cvt_pk_bf16_f32 v155, v134, v135
  v_exp_f32 v136, v136
  v_exp_f32 v137, v137
  v_exp_f32 v138, v138
  v_exp_f32 v139, v139
  v_mfma_f32_32x32x16_bf16 v[48:63], v[220:223], v[148:151], v[48:63]
  s_and_b32 s101, s68, 1
  v_cvt_pk_bf16_f32 v156, v136, v137
  v_cvt_pk_bf16_f32 v157, v138, v139
  v_exp_f32 v140, v140
  v_exp_f32 v141, v141
  v_exp_f32 v142, v142
  v_exp_f32 v143, v143
  v_cvt_pk_bf16_f32 v158, v140, v141
  v_cvt_pk_bf16_f32 v159, v142, v143
  v_mfma_f32_32x32x16_bf16 v[128:143], v[208:211], v[40:43], 0
  buffer_load_dwordx4 v[204:207], v1, s[64:67], s11 offen offset:3072 sc1
  v_exp_f32 v112, v112
  v_exp_f32 v113, v113
  v_exp_f32 v114, v114
  v_exp_f32 v115, v115
  v_mfma_f32_32x32x16_bf16 v[128:143], v[212:215], v[44:47], v[128:143]
  s_and_b32 s21, s21, 245760
  v_cvt_pk_bf16_f32 v144, v112, v113
  v_cvt_pk_bf16_f32 v145, v114, v115
  v_exp_f32 v116, v116
  v_exp_f32 v117, v117
  v_exp_f32 v118, v118
  v_exp_f32 v119, v119
  v_mfma_f32_32x32x16_bf16 v[64:79], v[216:219], v[152:155], v[64:79]
  s_add_u32 s21, s21, s10
  v_cvt_pk_bf16_f32 v146, v116, v117
  v_cvt_pk_bf16_f32 v147, v118, v119
  v_exp_f32 v120, v120
  v_exp_f32 v121, v121
  v_exp_f32 v122, v122
  v_exp_f32 v123, v123
  v_mfma_f32_32x32x16_bf16 v[64:79], v[220:223], v[156:159], v[64:79]
  s_waitcnt vmcnt(12)
  v_cvt_pk_bf16_f32 v148, v120, v121
  v_cvt_pk_bf16_f32 v149, v122, v123
  v_exp_f32 v124, v124
  v_exp_f32 v125, v125
  v_exp_f32 v126, v126
  v_exp_f32 v127, v127
  v_cvt_pk_bf16_f32 v150, v124, v125
  v_cvt_pk_bf16_f32 v151, v126, v127
  v_mfma_f32_32x32x16_bf16 v[112:127], v[176:179], v[16:19], 0
  buffer_load_dwordx4 v[160:163], v1, s[64:67], s21 offen offset:0 sc1
  v_exp_f32 v128, v128
  v_exp_f32 v129, v129
  v_exp_f32 v130, v130
  v_exp_f32 v131, v131
  v_mfma_f32_32x32x16_bf16 v[112:127], v[180:183], v[20:23], v[112:127]
  v_cvt_pk_bf16_f32 v152, v128, v129
  v_cvt_pk_bf16_f32 v153, v130, v131
  v_exp_f32 v132, v132
  v_exp_f32 v133, v133
  v_exp_f32 v134, v134
  v_exp_f32 v135, v135
  v_mfma_f32_32x32x16_bf16 v[80:95], v[216:219], v[144:147], v[80:95]
  s_xor_b32 s101, s101, 1
  v_cvt_pk_bf16_f32 v154, v132, v133
  v_cvt_pk_bf16_f32 v155, v134, v135
  v_exp_f32 v136, v136
  v_exp_f32 v137, v137
  v_exp_f32 v138, v138
  v_exp_f32 v139, v139
  v_mfma_f32_32x32x16_bf16 v[80:95], v[220:223], v[148:151], v[80:95]
  s_mul_i32 s100, s101, 50176
  v_cvt_pk_bf16_f32 v156, v136, v137
  v_cvt_pk_bf16_f32 v157, v138, v139
  v_exp_f32 v140, v140
  v_exp_f32 v141, v141
  v_exp_f32 v142, v142
  v_exp_f32 v143, v143
  v_cvt_pk_bf16_f32 v158, v140, v141
  v_cvt_pk_bf16_f32 v159, v142, v143
  v_mfma_f32_32x32x16_bf16 v[128:143], v[176:179], v[24:27], 0
  buffer_load_dwordx4 v[164:167], v1, s[64:67], s21 offen offset:1024 sc1
  v_exp_f32 v112, v112
  v_exp_f32 v113, v113
  v_exp_f32 v114, v114
  v_exp_f32 v115, v115
  v_mfma_f32_32x32x16_bf16 v[128:143], v[180:183], v[28:31], v[128:143]
  s_add_u32 s100, s100, s78
  v_cvt_pk_bf16_f32 v144, v112, v113
  v_cvt_pk_bf16_f32 v145, v114, v115
  v_exp_f32 v116, v116
  v_exp_f32 v117, v117
  v_exp_f32 v118, v118
  v_exp_f32 v119, v119
  v_mfma_f32_32x32x16_bf16 v[96:111], v[216:219], v[152:155], v[96:111]
  s_add_u32 s11, s22, 196608
  v_cvt_pk_bf16_f32 v146, v116, v117
  v_cvt_pk_bf16_f32 v147, v118, v119
  v_exp_f32 v120, v120
  v_exp_f32 v121, v121
  v_exp_f32 v122, v122
  v_exp_f32 v123, v123
  v_mfma_f32_32x32x16_bf16 v[96:111], v[220:223], v[156:159], v[96:111]
  s_mul_i32 s101, s101, 7168
  v_cvt_pk_bf16_f32 v148, v120, v121
  v_cvt_pk_bf16_f32 v149, v122, v123
  v_exp_f32 v124, v124
  v_exp_f32 v125, v125
  v_exp_f32 v126, v126
  v_exp_f32 v127, v127
  v_cvt_pk_bf16_f32 v150, v124, v125
  v_cvt_pk_bf16_f32 v151, v126, v127
  v_mfma_f32_32x32x16_bf16 v[112:127], v[176:179], v[32:35], 0
  buffer_load_dwordx4 v[168:171], v1, s[64:67], s21 offen offset:2048 sc1
  v_exp_f32 v128, v128
  v_exp_f32 v129, v129
  v_exp_f32 v130, v130
  v_exp_f32 v131, v131
  v_mfma_f32_32x32x16_bf16 v[112:127], v[180:183], v[36:39], v[112:127]
  s_and_b32 s11, s11, 245760
  s_waitcnt vmcnt(10)
  v_cvt_pk_bf16_f32 v152, v128, v129
  v_cvt_pk_bf16_f32 v153, v130, v131
  v_exp_f32 v132, v132
  v_exp_f32 v133, v133
  v_exp_f32 v134, v134
  v_exp_f32 v135, v135
  v_mfma_f32_32x32x16_bf16 v[48:63], v[184:187], v[144:147], v[48:63]
  buffer_load_dwordx4 v[172:175], v1, s[64:67], s21 offen offset:3072 sc1
  s_add_u32 s11, s11, s10
  v_cvt_pk_bf16_f32 v154, v132, v133
  v_cvt_pk_bf16_f32 v155, v134, v135
  v_exp_f32 v136, v136
  v_exp_f32 v137, v137
  v_exp_f32 v138, v138
  v_exp_f32 v139, v139
  v_mfma_f32_32x32x16_bf16 v[48:63], v[188:191], v[148:151], v[48:63]
  v_cvt_pk_bf16_f32 v156, v136, v137
  v_cvt_pk_bf16_f32 v157, v138, v139
  v_exp_f32 v140, v140
  v_exp_f32 v141, v141
  v_exp_f32 v142, v142
  v_exp_f32 v143, v143
  v_cvt_pk_bf16_f32 v158, v140, v141
  v_cvt_pk_bf16_f32 v159, v142, v143
  v_mfma_f32_32x32x16_bf16 v[128:143], v[176:179], v[40:43], 0
  buffer_load_dwordx4 v[208:211], v1, s[64:67], s11 offen offset:0 sc1
  v_exp_f32 v112, v112
  v_exp_f32 v113, v113
  v_exp_f32 v114, v114
  v_exp_f32 v115, v115
  v_mfma_f32_32x32x16_bf16 v[128:143], v[180:183], v[44:47], v[128:143]
  s_add_u32 s101, s101, s76
  v_cvt_pk_bf16_f32 v144, v112, v113
  v_cvt_pk_bf16_f32 v145, v114, v115
  v_exp_f32 v116, v116
  v_exp_f32 v117, v117
  v_exp_f32 v118, v118
  v_exp_f32 v119, v119
  v_mfma_f32_32x32x16_bf16 v[64:79], v[184:187], v[152:155], v[64:79]
  s_add_u32 m0, s101, 0
  v_cvt_pk_bf16_f32 v146, v116, v117
  v_cvt_pk_bf16_f32 v147, v118, v119
  v_exp_f32 v120, v120
  v_exp_f32 v121, v121
  v_exp_f32 v122, v122
  v_exp_f32 v123, v123
  v_mfma_f32_32x32x16_bf16 v[64:79], v[188:191], v[156:159], v[64:79]
  s_waitcnt vmcnt(9)
  v_cvt_pk_bf16_f32 v148, v120, v121
  v_cvt_pk_bf16_f32 v149, v122, v123
  v_exp_f32 v124, v124
  v_exp_f32 v125, v125
  v_exp_f32 v126, v126
  v_exp_f32 v127, v127
  v_cvt_pk_bf16_f32 v150, v124, v125
  v_cvt_pk_bf16_f32 v151, v126, v127
  v_mfma_f32_32x32x16_bf16 v[112:127], v[192:195], v[16:19], 0
  buffer_load_dwordx4 v[212:215], v1, s[64:67], s11 offen offset:1024 sc1
  v_exp_f32 v128, v128
  v_exp_f32 v129, v129
  v_exp_f32 v130, v130
  v_exp_f32 v131, v131
  v_mfma_f32_32x32x16_bf16 v[112:127], v[196:199], v[20:23], v[112:127]
  s_add_u32 s12, s100, 0
  v_cvt_pk_bf16_f32 v152, v128, v129
  v_cvt_pk_bf16_f32 v153, v130, v131
  v_exp_f32 v132, v132
  v_exp_f32 v133, v133
  v_exp_f32 v134, v134
  v_exp_f32 v135, v135
  v_mfma_f32_32x32x16_bf16 v[80:95], v[184:187], v[144:147], v[80:95]
  s_add_u32 s21, s23, 212992
  v_cvt_pk_bf16_f32 v154, v132, v133
  v_cvt_pk_bf16_f32 v155, v134, v135
  v_exp_f32 v136, v136
  v_exp_f32 v137, v137
  v_exp_f32 v138, v138
  v_exp_f32 v139, v139
  v_mfma_f32_32x32x16_bf16 v[80:95], v[188:191], v[148:151], v[80:95]
  v_cvt_pk_bf16_f32 v156, v136, v137
  v_cvt_pk_bf16_f32 v157, v138, v139
  v_exp_f32 v140, v140
  v_exp_f32 v141, v141
  v_exp_f32 v142, v142
  v_exp_f32 v143, v143
  v_cvt_pk_bf16_f32 v158, v140, v141
  v_cvt_pk_bf16_f32 v159, v142, v143
  v_mfma_f32_32x32x16_bf16 v[128:143], v[192:195], v[24:27], 0
  buffer_load_dwordx4 v[216:219], v1, s[64:67], s11 offen offset:2048 sc1
  v_exp_f32 v112, v112
  v_exp_f32 v113, v113
  v_exp_f32 v114, v114
  v_exp_f32 v115, v115
  v_mfma_f32_32x32x16_bf16 v[128:143], v[196:199], v[28:31], v[128:143]
  s_and_b32 s21, s21, 245760
  v_cvt_pk_bf16_f32 v144, v112, v113
  v_cvt_pk_bf16_f32 v145, v114, v115
  v_exp_f32 v116, v116
  v_exp_f32 v117, v117
  v_exp_f32 v118, v118
  v_exp_f32 v119, v119
  v_mfma_f32_32x32x16_bf16 v[96:111], v[184:187], v[152:155], v[96:111]
  buffer_load_dwordx4 v[220:223], v1, s[64:67], s11 offen offset:3072 sc1
  s_add_u32 s21, s21, s10
  v_cvt_pk_bf16_f32 v146, v116, v117
  v_cvt_pk_bf16_f32 v147, v118, v119
  v_exp_f32 v120, v120
  v_exp_f32 v121, v121
  v_exp_f32 v122, v122
  v_exp_f32 v123, v123
  v_mfma_f32_32x32x16_bf16 v[96:111], v[188:191], v[156:159], v[96:111]
  buffer_load_dwordx4 v236, s[36:39], s12 offen offset:0  lds
  v_cvt_pk_bf16_f32 v148, v120, v121
  v_cvt_pk_bf16_f32 v149, v122, v123
  v_exp_f32 v124, v124
  v_exp_f32 v125, v125
  v_exp_f32 v126, v126
  v_exp_f32 v127, v127
  v_cvt_pk_bf16_f32 v150, v124, v125
  v_cvt_pk_bf16_f32 v151, v126, v127
  v_mfma_f32_32x32x16_bf16 v[112:127], v[192:195], v[32:35], 0
  buffer_load_dwordx4 v[176:179], v1, s[64:67], s21 offen offset:0 sc1
  v_exp_f32 v128, v128
  v_exp_f32 v129, v129
  v_exp_f32 v130, v130
  v_exp_f32 v131, v131
  v_mfma_f32_32x32x16_bf16 v[112:127], v[196:199], v[36:39], v[112:127]
  s_waitcnt vmcnt(10)
  v_cvt_pk_bf16_f32 v152, v128, v129
  v_cvt_pk_bf16_f32 v153, v130, v131
  v_exp_f32 v132, v132
  v_exp_f32 v133, v133
  v_exp_f32 v134, v134
  v_exp_f32 v135, v135
  v_mfma_f32_32x32x16_bf16 v[48:63], v[200:203], v[144:147], v[48:63]
  buffer_load_dwordx4 v237, s[36:39], s12 offen offset:1024  lds
  v_cvt_pk_bf16_f32 v154, v132, v133
  v_cvt_pk_bf16_f32 v155, v134, v135
  v_exp_f32 v136, v136
  v_exp_f32 v137, v137
  v_exp_f32 v138, v138
  v_exp_f32 v139, v139
  v_mfma_f32_32x32x16_bf16 v[48:63], v[204:207], v[148:151], v[48:63]
  buffer_load_dwordx4 v238, s[36:39], s12 offen offset:2048  lds
  v_cvt_pk_bf16_f32 v156, v136, v137
  v_cvt_pk_bf16_f32 v157, v138, v139
  v_exp_f32 v140, v140
  v_exp_f32 v141, v141
  v_exp_f32 v142, v142
  v_exp_f32 v143, v143
  v_cvt_pk_bf16_f32 v158, v140, v141
  v_cvt_pk_bf16_f32 v159, v142, v143
  v_mfma_f32_32x32x16_bf16 v[128:143], v[192:195], v[40:43], 0
  buffer_load_dwordx4 v[180:183], v1, s[64:67], s21 offen offset:1024 sc1
  v_exp_f32 v112, v112
  v_exp_f32 v113, v113
  v_exp_f32 v114, v114
  v_exp_f32 v115, v115
  v_mfma_f32_32x32x16_bf16 v[128:143], v[196:199], v[44:47], v[128:143]
  v_cvt_pk_bf16_f32 v144, v112, v113
  v_cvt_pk_bf16_f32 v145, v114, v115
  v_exp_f32 v116, v116
  v_exp_f32 v117, v117
  v_exp_f32 v118, v118
  v_exp_f32 v119, v119
  v_mfma_f32_32x32x16_bf16 v[64:79], v[200:203], v[152:155], v[64:79]
  s_add_u32 s11, s22, 229376
  v_cvt_pk_bf16_f32 v146, v116, v117
  v_cvt_pk_bf16_f32 v147, v118, v119
  v_exp_f32 v120, v120
  v_exp_f32 v121, v121
  v_exp_f32 v122, v122
  v_exp_f32 v123, v123
  v_mfma_f32_32x32x16_bf16 v[64:79], v[204:207], v[156:159], v[64:79]
  s_waitcnt vmcnt(11)
  v_cvt_pk_bf16_f32 v148, v120, v121
  v_cvt_pk_bf16_f32 v149, v122, v123
  v_exp_f32 v124, v124
  v_exp_f32 v125, v125
  v_exp_f32 v126, v126
  v_exp_f32 v127, v127
  v_cvt_pk_bf16_f32 v150, v124, v125
  v_cvt_pk_bf16_f32 v151, v126, v127
  v_mfma_f32_32x32x16_bf16 v[112:127], v[160:163], v[16:19], 0
  buffer_load_dwordx4 v[184:187], v1, s[64:67], s21 offen offset:2048 sc1
  v_exp_f32 v128, v128
  v_exp_f32 v129, v129
  v_exp_f32 v130, v130
  v_exp_f32 v131, v131
  v_mfma_f32_32x32x16_bf16 v[112:127], v[164:167], v[20:23], v[112:127]
  s_and_b32 s11, s11, 245760
  v_cvt_pk_bf16_f32 v152, v128, v129
  v_cvt_pk_bf16_f32 v153, v130, v131
  v_exp_f32 v132, v132
  v_exp_f32 v133, v133
  v_exp_f32 v134, v134
  v_exp_f32 v135, v135
  v_mfma_f32_32x32x16_bf16 v[80:95], v[200:203], v[144:147], v[80:95]
  buffer_load_dwordx4 v[188:191], v1, s[64:67], s21 offen offset:3072 sc1
  s_add_u32 s11, s11, s10
  v_cvt_pk_bf16_f32 v154, v132, v133
  v_cvt_pk_bf16_f32 v155, v134, v135
  v_exp_f32 v136, v136
  v_exp_f32 v137, v137
  v_exp_f32 v138, v138
  v_exp_f32 v139, v139
  v_mfma_f32_32x32x16_bf16 v[80:95], v[204:207], v[148:151], v[80:95]
  buffer_load_dwordx4 v239, s[36:39], s12 offen offset:3072  lds
  v_cvt_pk_bf16_f32 v156, v136, v137
  v_cvt_pk_bf16_f32 v157, v138, v139
  v_exp_f32 v140, v140
  v_exp_f32 v141, v141
  v_exp_f32 v142, v142
  v_exp_f32 v143, v143
  v_cvt_pk_bf16_f32 v158, v140, v141
  v_cvt_pk_bf16_f32 v159, v142, v143
  v_mfma_f32_32x32x16_bf16 v[128:143], v[160:163], v[24:27], 0
  buffer_load_dwordx4 v[192:195], v1, s[64:67], s11 offen offset:0 sc1
  v_exp_f32 v112, v112
  v_exp_f32 v113, v113
  v_exp_f32 v114, v114
  v_exp_f32 v115, v115
  v_mfma_f32_32x32x16_bf16 v[128:143], v[164:167], v[28:31], v[128:143]
  s_add_u32 m0, s101, 4096
  v_cvt_pk_bf16_f32 v144, v112, v113
  v_cvt_pk_bf16_f32 v145, v114, v115
  v_exp_f32 v116, v116
  v_exp_f32 v117, v117
  v_exp_f32 v118, v118
  v_exp_f32 v119, v119
  v_mfma_f32_32x32x16_bf16 v[96:111], v[200:203], v[152:155], v[96:111]
  s_add_u32 s12, s100, 28672
  v_cvt_pk_bf16_f32 v146, v116, v117
  v_cvt_pk_bf16_f32 v147, v118, v119
  v_exp_f32 v120, v120
  v_exp_f32 v121, v121
  v_exp_f32 v122, v122
  v_exp_f32 v123, v123
  v_mfma_f32_32x32x16_bf16 v[96:111], v[204:207], v[156:159], v[96:111]
  buffer_load_dwordx4 v236, s[36:39], s12 offen offset:0  lds
  v_cvt_pk_bf16_f32 v148, v120, v121
  v_cvt_pk_bf16_f32 v149, v122, v123
  v_exp_f32 v124, v124
  v_exp_f32 v125, v125
  v_exp_f32 v126, v126
  v_exp_f32 v127, v127
  v_cvt_pk_bf16_f32 v150, v124, v125
  v_cvt_pk_bf16_f32 v151, v126, v127
  v_mfma_f32_32x32x16_bf16 v[112:127], v[160:163], v[32:35], 0
  buffer_load_dwordx4 v[196:199], v1, s[64:67], s11 offen offset:1024 sc1
  v_exp_f32 v128, v128
  v_exp_f32 v129, v129
  v_exp_f32 v130, v130
  v_exp_f32 v131, v131
  v_mfma_f32_32x32x16_bf16 v[112:127], v[164:167], v[36:39], v[112:127]
  s_waitcnt vmcnt(15)
  v_cvt_pk_bf16_f32 v152, v128, v129
  v_cvt_pk_bf16_f32 v153, v130, v131
  v_exp_f32 v132, v132
  v_exp_f32 v133, v133
  v_exp_f32 v134, v134
  v_exp_f32 v135, v135
  v_mfma_f32_32x32x16_bf16 v[48:63], v[168:171], v[144:147], v[48:63]
  s_add_u32 s21, s23, 245760
  v_cvt_pk_bf16_f32 v154, v132, v133
  v_cvt_pk_bf16_f32 v155, v134, v135
  v_exp_f32 v136, v136
  v_exp_f32 v137, v137
  v_exp_f32 v138, v138
  v_exp_f32 v139, v139
  v_mfma_f32_32x32x16_bf16 v[48:63], v[172:175], v[148:151], v[48:63]
  v_cvt_pk_bf16_f32 v156, v136, v137
  v_cvt_pk_bf16_f32 v157, v138, v139
  v_exp_f32 v140, v140
  v_exp_f32 v141, v141
  v_exp_f32 v142, v142
  v_exp_f32 v143, v143
  v_cvt_pk_bf16_f32 v158, v140, v141
  v_cvt_pk_bf16_f32 v159, v142, v143
  v_mfma_f32_32x32x16_bf16 v[128:143], v[160:163], v[40:43], 0
  buffer_load_dwordx4 v[200:203], v1, s[64:67], s11 offen offset:2048 sc1
  v_exp_f32 v112, v112
  v_exp_f32 v113, v113
  v_exp_f32 v114, v114
  v_exp_f32 v115, v115
  v_mfma_f32_32x32x16_bf16 v[128:143], v[164:167], v[44:47], v[128:143]
  s_and_b32 s21, s21, 245760
  v_cvt_pk_bf16_f32 v144, v112, v113
  v_cvt_pk_bf16_f32 v145, v114, v115
  v_exp_f32 v116, v116
  v_exp_f32 v117, v117
  v_exp_f32 v118, v118
  v_exp_f32 v119, v119
  v_mfma_f32_32x32x16_bf16 v[64:79], v[168:171], v[152:155], v[64:79]
  buffer_load_dwordx4 v[204:207], v1, s[64:67], s11 offen offset:3072 sc1
  s_add_u32 s21, s21, s10
  v_cvt_pk_bf16_f32 v146, v116, v117
  v_cvt_pk_bf16_f32 v147, v118, v119
  v_exp_f32 v120, v120
  v_exp_f32 v121, v121
  v_exp_f32 v122, v122
  v_exp_f32 v123, v123
  v_mfma_f32_32x32x16_bf16 v[64:79], v[172:175], v[156:159], v[64:79]
  s_waitcnt vmcnt(15)
  v_cvt_pk_bf16_f32 v148, v120, v121
  v_cvt_pk_bf16_f32 v149, v122, v123
  v_exp_f32 v124, v124
  v_exp_f32 v125, v125
  v_exp_f32 v126, v126
  v_exp_f32 v127, v127
  v_cvt_pk_bf16_f32 v150, v124, v125
  v_cvt_pk_bf16_f32 v151, v126, v127
  v_mfma_f32_32x32x16_bf16 v[112:127], v[208:211], v[16:19], 0
  buffer_load_dwordx4 v[160:163], v1, s[64:67], s21 offen offset:0 sc1
  v_exp_f32 v128, v128
  v_exp_f32 v129, v129
  v_exp_f32 v130, v130
  v_exp_f32 v131, v131
  v_mfma_f32_32x32x16_bf16 v[112:127], v[212:215], v[20:23], v[112:127]
  buffer_load_dwordx4 v237, s[36:39], s12 offen offset:1024  lds
  v_cvt_pk_bf16_f32 v152, v128, v129
  v_cvt_pk_bf16_f32 v153, v130, v131
  v_exp_f32 v132, v132
  v_exp_f32 v133, v133
  v_exp_f32 v134, v134
  v_exp_f32 v135, v135
  v_mfma_f32_32x32x16_bf16 v[80:95], v[168:171], v[144:147], v[80:95]
  buffer_load_dwordx4 v238, s[36:39], s12 offen offset:2048  lds
  v_cvt_pk_bf16_f32 v154, v132, v133
  v_cvt_pk_bf16_f32 v155, v134, v135
  v_exp_f32 v136, v136
  v_exp_f32 v137, v137
  v_exp_f32 v138, v138
  v_exp_f32 v139, v139
  v_mfma_f32_32x32x16_bf16 v[80:95], v[172:175], v[148:151], v[80:95]
  s_and_b32 s101, s68, 1
  v_cvt_pk_bf16_f32 v156, v136, v137
  v_cvt_pk_bf16_f32 v157, v138, v139
  v_exp_f32 v140, v140
  v_exp_f32 v141, v141
  v_exp_f32 v142, v142
  v_exp_f32 v143, v143
  v_cvt_pk_bf16_f32 v158, v140, v141
  v_cvt_pk_bf16_f32 v159, v142, v143
  v_mfma_f32_32x32x16_bf16 v[128:143], v[208:211], v[24:27], 0
  buffer_load_dwordx4 v[164:167], v1, s[64:67], s21 offen offset:1024 sc1
  v_exp_f32 v112, v112
  v_exp_f32 v113, v113
  v_exp_f32 v114, v114
  v_exp_f32 v115, v115
  v_mfma_f32_32x32x16_bf16 v[128:143], v[212:215], v[28:31], v[128:143]
  v_cvt_pk_bf16_f32 v144, v112, v113
  v_cvt_pk_bf16_f32 v145, v114, v115
  v_exp_f32 v116, v116
  v_exp_f32 v117, v117
  v_exp_f32 v118, v118
  v_exp_f32 v119, v119
  v_mfma_f32_32x32x16_bf16 v[96:111], v[168:171], v[152:155], v[96:111]
  s_xor_b32 s101, s101, 1
  v_cvt_pk_bf16_f32 v146, v116, v117
  v_cvt_pk_bf16_f32 v147, v118, v119
  v_exp_f32 v120, v120
  v_exp_f32 v121, v121
  v_exp_f32 v122, v122
  v_exp_f32 v123, v123
  v_mfma_f32_32x32x16_bf16 v[96:111], v[172:175], v[156:159], v[96:111]
  s_mul_i32 s100, s101, 50176
  v_cvt_pk_bf16_f32 v148, v120, v121
  v_cvt_pk_bf16_f32 v149, v122, v123
  v_exp_f32 v124, v124
  v_exp_f32 v125, v125
  v_exp_f32 v126, v126
  v_exp_f32 v127, v127
  v_cvt_pk_bf16_f32 v150, v124, v125
  v_cvt_pk_bf16_f32 v151, v126, v127
  v_mfma_f32_32x32x16_bf16 v[112:127], v[208:211], v[32:35], 0
  buffer_load_dwordx4 v[168:171], v1, s[64:67], s21 offen offset:2048 sc1
  v_exp_f32 v128, v128
  v_exp_f32 v129, v129
  v_exp_f32 v130, v130
  v_exp_f32 v131, v131
  v_mfma_f32_32x32x16_bf16 v[112:127], v[212:215], v[36:39], v[112:127]
  s_waitcnt vmcnt(18)
  v_cvt_pk_bf16_f32 v152, v128, v129
  v_cvt_pk_bf16_f32 v153, v130, v131
  v_exp_f32 v132, v132
  v_exp_f32 v133, v133
  v_exp_f32 v134, v134
  v_exp_f32 v135, v135
  v_mfma_f32_32x32x16_bf16 v[48:63], v[216:219], v[144:147], v[48:63]
  buffer_load_dwordx4 v[172:175], v1, s[64:67], s21 offen offset:3072 sc1
  v_cvt_pk_bf16_f32 v154, v132, v133
  v_cvt_pk_bf16_f32 v155, v134, v135
  v_exp_f32 v136, v136
  v_exp_f32 v137, v137
  v_exp_f32 v138, v138
  v_exp_f32 v139, v139
  v_mfma_f32_32x32x16_bf16 v[48:63], v[220:223], v[148:151], v[48:63]
  s_add_u32 s100, s100, s78
  v_cvt_pk_bf16_f32 v156, v136, v137
  v_cvt_pk_bf16_f32 v157, v138, v139
  v_exp_f32 v140, v140
  v_exp_f32 v141, v141
  v_exp_f32 v142, v142
  v_exp_f32 v143, v143
  v_cvt_pk_bf16_f32 v158, v140, v141
  v_cvt_pk_bf16_f32 v159, v142, v143
  v_mfma_f32_32x32x16_bf16 v[128:143], v[208:211], v[40:43], 0
  v_exp_f32 v112, v112
  v_exp_f32 v113, v113
  v_exp_f32 v114, v114
  v_exp_f32 v115, v115
  v_mfma_f32_32x32x16_bf16 v[128:143], v[212:215], v[44:47], v[128:143]
  s_mul_i32 s101, s101, 7168
  v_cvt_pk_bf16_f32 v144, v112, v113
  v_cvt_pk_bf16_f32 v145, v114, v115
  v_exp_f32 v116, v116
  v_exp_f32 v117, v117
  v_exp_f32 v118, v118
  v_exp_f32 v119, v119
  v_mfma_f32_32x32x16_bf16 v[64:79], v[216:219], v[152:155], v[64:79]
  s_add_u32 s101, s101, s77
  v_cvt_pk_bf16_f32 v146, v116, v117
  v_cvt_pk_bf16_f32 v147, v118, v119
  v_exp_f32 v120, v120
  v_exp_f32 v121, v121
  v_exp_f32 v122, v122
  v_exp_f32 v123, v123
  v_mfma_f32_32x32x16_bf16 v[64:79], v[220:223], v[156:159], v[64:79]
  s_waitcnt vmcnt(14)
  v_cvt_pk_bf16_f32 v148, v120, v121
  v_cvt_pk_bf16_f32 v149, v122, v123
  v_exp_f32 v124, v124
  v_exp_f32 v125, v125
  v_exp_f32 v126, v126
  v_exp_f32 v127, v127
  v_cvt_pk_bf16_f32 v150, v124, v125
  v_cvt_pk_bf16_f32 v151, v126, v127
  v_mfma_f32_32x32x16_bf16 v[112:127], v[176:179], v[16:19], 0
  s_add_u32 m0, s101, 0
  v_exp_f32 v128, v128
  v_exp_f32 v129, v129
  v_exp_f32 v130, v130
  v_exp_f32 v131, v131
  v_mfma_f32_32x32x16_bf16 v[112:127], v[180:183], v[20:23], v[112:127]
  s_add_u32 s12, s100, 0
  v_cvt_pk_bf16_f32 v152, v128, v129
  v_cvt_pk_bf16_f32 v153, v130, v131
  v_exp_f32 v132, v132
  v_exp_f32 v133, v133
  v_exp_f32 v134, v134
  v_exp_f32 v135, v135
  v_mfma_f32_32x32x16_bf16 v[80:95], v[216:219], v[144:147], v[80:95]
  v_cvt_pk_bf16_f32 v154, v132, v133
  v_cvt_pk_bf16_f32 v155, v134, v135
  v_exp_f32 v136, v136
  v_exp_f32 v137, v137
  v_exp_f32 v138, v138
  v_exp_f32 v139, v139
  v_mfma_f32_32x32x16_bf16 v[80:95], v[220:223], v[148:151], v[80:95]
  s_waitcnt vmcnt(8)
  v_cvt_pk_bf16_f32 v156, v136, v137
  v_cvt_pk_bf16_f32 v157, v138, v139
  v_exp_f32 v140, v140
  v_exp_f32 v141, v141
  v_exp_f32 v142, v142
  v_exp_f32 v143, v143
  v_cvt_pk_bf16_f32 v158, v140, v141
  v_cvt_pk_bf16_f32 v159, v142, v143
  v_mfma_f32_32x32x16_bf16 v[128:143], v[192:195], v[16:19], 0
  buffer_load_dwordx4 v236, s[40:43], s12 offen offset:0  lds
  v_exp_f32 v112, v112
  v_exp_f32 v113, v113
  v_exp_f32 v114, v114
  v_exp_f32 v115, v115
  v_mfma_f32_32x32x16_bf16 v[128:143], v[196:199], v[20:23], v[128:143]
  buffer_load_dwordx4 v237, s[40:43], s12 offen offset:1024  lds
  v_cvt_pk_bf16_f32 v144, v112, v113
  v_cvt_pk_bf16_f32 v145, v114, v115
  v_exp_f32 v116, v116
  v_exp_f32 v117, v117
  v_exp_f32 v118, v118
  v_exp_f32 v119, v119
  v_mfma_f32_32x32x16_bf16 v[96:111], v[216:219], v[152:155], v[96:111]
  buffer_load_dwordx4 v238, s[40:43], s12 offen offset:2048  lds
  v_cvt_pk_bf16_f32 v146, v116, v117
  v_cvt_pk_bf16_f32 v147, v118, v119
  v_exp_f32 v120, v120
  v_exp_f32 v121, v121
  v_exp_f32 v122, v122
  v_exp_f32 v123, v123
  v_mfma_f32_32x32x16_bf16 v[96:111], v[220:223], v[156:159], v[96:111]
  s_waitcnt vmcnt(5)
  v_cvt_pk_bf16_f32 v148, v120, v121
  v_cvt_pk_bf16_f32 v149, v122, v123
  v_exp_f32 v124, v124
  v_exp_f32 v125, v125
  v_exp_f32 v126, v126
  v_exp_f32 v127, v127
  v_cvt_pk_bf16_f32 v150, v124, v125
  v_cvt_pk_bf16_f32 v151, v126, v127
  v_mfma_f32_32x32x16_bf16 v[112:127], v[160:163], v[16:19], 0
  v_exp_f32 v128, v128
  v_exp_f32 v129, v129
  v_exp_f32 v130, v130
  v_exp_f32 v131, v131
  v_mfma_f32_32x32x16_bf16 v[112:127], v[164:167], v[20:23], v[112:127]
  v_cvt_pk_bf16_f32 v152, v128, v129
  v_cvt_pk_bf16_f32 v153, v130, v131
  v_exp_f32 v132, v132
  v_exp_f32 v133, v133
  v_exp_f32 v134, v134
  v_exp_f32 v135, v135
  v_mfma_f32_32x32x16_bf16 v[48:63], v[184:187], v[144:147], v[48:63]
  buffer_load_dwordx4 v239, s[40:43], s12 offen offset:3072  lds
  v_cvt_pk_bf16_f32 v154, v132, v133
  v_cvt_pk_bf16_f32 v155, v134, v135
  v_exp_f32 v136, v136
  v_exp_f32 v137, v137
  v_exp_f32 v138, v138
  v_exp_f32 v139, v139
  v_mfma_f32_32x32x16_bf16 v[48:63], v[188:191], v[148:151], v[48:63]
  s_add_u32 m0, s101, 4096
  v_cvt_pk_bf16_f32 v156, v136, v137
  v_cvt_pk_bf16_f32 v157, v138, v139
  v_exp_f32 v140, v140
  v_exp_f32 v141, v141
  v_exp_f32 v142, v142
  v_exp_f32 v143, v143
  v_cvt_pk_bf16_f32 v158, v140, v141
  v_cvt_pk_bf16_f32 v159, v142, v143
  v_mfma_f32_32x32x16_bf16 v[128:143], v[176:179], v[24:27], 0
  s_add_u32 s12, s100, 28672
  v_exp_f32 v112, v112
  v_exp_f32 v113, v113
  v_exp_f32 v114, v114
  v_exp_f32 v115, v115
  v_mfma_f32_32x32x16_bf16 v[128:143], v[180:183], v[28:31], v[128:143]
  v_cvt_pk_bf16_f32 v144, v112, v113
  v_cvt_pk_bf16_f32 v145, v114, v115
  v_exp_f32 v116, v116
  v_exp_f32 v117, v117
  v_exp_f32 v118, v118
  v_exp_f32 v119, v119
  v_mfma_f32_32x32x16_bf16 v[48:63], v[200:203], v[152:155], v[48:63]
  v_cvt_pk_bf16_f32 v146, v116, v117
  v_cvt_pk_bf16_f32 v147, v118, v119
  v_exp_f32 v120, v120
  v_exp_f32 v121, v121
  v_exp_f32 v122, v122
  v_exp_f32 v123, v123
  v_mfma_f32_32x32x16_bf16 v[48:63], v[204:207], v[156:159], v[48:63]
  buffer_load_dwordx4 v236, s[40:43], s12 offen offset:0  lds
  v_cvt_pk_bf16_f32 v148, v120, v121
  v_cvt_pk_bf16_f32 v149, v122, v123
  v_exp_f32 v124, v124
  v_exp_f32 v125, v125
  v_exp_f32 v126, v126
  v_exp_f32 v127, v127
  v_cvt_pk_bf16_f32 v150, v124, v125
  v_cvt_pk_bf16_f32 v151, v126, v127
  v_mfma_f32_32x32x16_bf16 v[112:127], v[192:195], v[24:27], 0
  buffer_load_dwordx4 v237, s[40:43], s12 offen offset:1024  lds
  v_exp_f32 v128, v128
  v_exp_f32 v129, v129
  v_exp_f32 v130, v130
  v_exp_f32 v131, v131
  v_mfma_f32_32x32x16_bf16 v[112:127], v[196:199], v[28:31], v[112:127]
  s_waitcnt vmcnt(6)
  v_cvt_pk_bf16_f32 v152, v128, v129
  v_cvt_pk_bf16_f32 v153, v130, v131
  v_exp_f32 v132, v132
  v_exp_f32 v133, v133
  v_exp_f32 v134, v134
  v_exp_f32 v135, v135
  v_mfma_f32_32x32x16_bf16 v[48:63], v[168:171], v[144:147], v[48:63]
  buffer_load_dwordx4 v238, s[40:43], s12 offen offset:2048  lds
  v_cvt_pk_bf16_f32 v154, v132, v133
  v_cvt_pk_bf16_f32 v155, v134, v135
  v_exp_f32 v136, v136
  v_exp_f32 v137, v137
  v_exp_f32 v138, v138
  v_exp_f32 v139, v139
  v_mfma_f32_32x32x16_bf16 v[48:63], v[172:175], v[148:151], v[48:63]
  v_cvt_pk_bf16_f32 v156, v136, v137
  v_cvt_pk_bf16_f32 v157, v138, v139
  v_exp_f32 v140, v140
  v_exp_f32 v141, v141
  v_exp_f32 v142, v142
  v_exp_f32 v143, v143
  v_cvt_pk_bf16_f32 v158, v140, v141
  v_cvt_pk_bf16_f32 v159, v142, v143
  v_mfma_f32_32x32x16_bf16 v[128:143], v[160:163], v[24:27], 0
  s_nop 2
  ds_write_b128 v224, v[48:51] offset:0
  v_exp_f32 v112, v112
  v_exp_f32 v113, v113
  v_exp_f32 v114, v114
  v_exp_f32 v115, v115
  v_mfma_f32_32x32x16_bf16 v[128:143], v[164:167], v[28:31], v[128:143]
  ds_write_b128 v224, v[52:55] offset:1024
  s_mov_b32 exec_hi, 0
  buffer_load_dword v15, v235, s[64:67], 0 offen sc1
  s_mov_b64 exec, -1
  v_cvt_pk_bf16_f32 v144, v112, v113
  v_cvt_pk_bf16_f32 v145, v114, v115
  v_exp_f32 v116, v116
  v_exp_f32 v117, v117
  v_exp_f32 v118, v118
  v_exp_f32 v119, v119
  v_mfma_f32_32x32x16_bf16 v[64:79], v[184:187], v[152:155], v[64:79]
  ds_write_b128 v224, v[56:59] offset:2048
  v_cvt_pk_bf16_f32 v146, v116, v117
  v_cvt_pk_bf16_f32 v147, v118, v119
  v_exp_f32 v120, v120
  v_exp_f32 v121, v121
  v_exp_f32 v122, v122
  v_exp_f32 v123, v123
  v_mfma_f32_32x32x16_bf16 v[64:79], v[188:191], v[156:159], v[64:79]
  ds_write_b128 v224, v[60:63] offset:3072
  v_cvt_pk_bf16_f32 v148, v120, v121
  v_cvt_pk_bf16_f32 v149, v122, v123
  v_exp_f32 v124, v124
  v_exp_f32 v125, v125
  v_exp_f32 v126, v126
  v_exp_f32 v127, v127
  v_cvt_pk_bf16_f32 v150, v124, v125
  v_cvt_pk_bf16_f32 v151, v126, v127
  v_mfma_f32_32x32x16_bf16 v[112:127], v[176:179], v[32:35], 0
  v_exp_f32 v128, v128
  v_exp_f32 v129, v129
  v_exp_f32 v130, v130
  v_exp_f32 v131, v131
  v_mfma_f32_32x32x16_bf16 v[112:127], v[180:183], v[36:39], v[112:127]
  s_lshr_b32 s4, s2, 3
  s_lshl_b32 s4, s4, 10
  s_lshl_b32 s3, s72, 15
  s_add_u32 s4, s4, s3
  v_and_b32 v230, 7, v0
  v_lshlrev_b32 v230, 7, v230
  v_add_u32 v230, s4, v230
  v_min_u32 v230, L_last-L_pc, v230
  global_load_dword v15, v230, s[26:27]
  v_cvt_pk_bf16_f32 v152, v128, v129
  v_cvt_pk_bf16_f32 v153, v130, v131
  v_exp_f32 v132, v132
  v_exp_f32 v133, v133
  v_exp_f32 v134, v134
  v_exp_f32 v135, v135
  v_mfma_f32_32x32x16_bf16 v[64:79], v[200:203], v[144:147], v[64:79]
  v_cvt_pk_bf16_f32 v154, v132, v133
  v_cvt_pk_bf16_f32 v155, v134, v135
  v_exp_f32 v136, v136
  v_exp_f32 v137, v137
  v_exp_f32 v138, v138
  v_exp_f32 v139, v139
  v_mfma_f32_32x32x16_bf16 v[64:79], v[204:207], v[148:151], v[64:79]
  v_cvt_pk_bf16_f32 v156, v136, v137
  v_cvt_pk_bf16_f32 v157, v138, v139
  v_exp_f32 v140, v140
  v_exp_f32 v141, v141
  v_exp_f32 v142, v142
  v_exp_f32 v143, v143
  v_cvt_pk_bf16_f32 v158, v140, v141
  v_cvt_pk_bf16_f32 v159, v142, v143
  v_mfma_f32_32x32x16_bf16 v[128:143], v[192:195], v[32:35], 0
  v_exp_f32 v112, v112
  v_exp_f32 v113, v113
  v_exp_f32 v114, v114
  v_exp_f32 v115, v115
  v_mfma_f32_32x32x16_bf16 v[128:143], v[196:199], v[36:39], v[128:143]
  v_cvt_pk_bf16_f32 v144, v112, v113
  v_cvt_pk_bf16_f32 v145, v114, v115
  v_exp_f32 v116, v116
  v_exp_f32 v117, v117
  v_exp_f32 v118, v118
  v_exp_f32 v119, v119
  v_mfma_f32_32x32x16_bf16 v[64:79], v[168:171], v[152:155], v[64:79]
  v_cvt_pk_bf16_f32 v146, v116, v117
  v_cvt_pk_bf16_f32 v147, v118, v119
  v_exp_f32 v120, v120
  v_exp_f32 v121, v121
  v_exp_f32 v122, v122
  v_exp_f32 v123, v123
  v_mfma_f32_32x32x16_bf16 v[64:79], v[172:175], v[156:159], v[64:79]
  s_mov_b32 exec_lo, 0
  buffer_load_dword v15, v235, s[64:67], 0 offen sc1
  s_mov_b64 exec, -1
  v_cvt_pk_bf16_f32 v148, v120, v121
  v_cvt_pk_bf16_f32 v149, v122, v123
  v_exp_f32 v124, v124
  v_exp_f32 v125, v125
  v_exp_f32 v126, v126
  v_exp_f32 v127, v127
  v_cvt_pk_bf16_f32 v150, v124, v125
  v_cvt_pk_bf16_f32 v151, v126, v127
  v_mfma_f32_32x32x16_bf16 v[112:127], v[160:163], v[32:35], 0
  ds_write_b128 v225, v[64:67] offset:0
  v_exp_f32 v128, v128
  v_exp_f32 v129, v129
  v_exp_f32 v130, v130
  v_exp_f32 v131, v131
  v_mfma_f32_32x32x16_bf16 v[112:127], v[164:167], v[36:39], v[112:127]
  ds_write_b128 v225, v[68:71] offset:1024
  v_cvt_pk_bf16_f32 v152, v128, v129
  v_cvt_pk_bf16_f32 v153, v130, v131
  v_exp_f32 v132, v132
  v_exp_f32 v133, v133
  v_exp_f32 v134, v134
  v_exp_f32 v135, v135
  v_mfma_f32_32x32x16_bf16 v[80:95], v[184:187], v[144:147], v[80:95]
  ds_write_b128 v225, v[72:75] offset:2048
  v_cvt_pk_bf16_f32 v154, v132, v133
  v_cvt_pk_bf16_f32 v155, v134, v135
  v_exp_f32 v136, v136
  v_exp_f32 v137, v137
  v_exp_f32 v138, v138
  v_exp_f32 v139, v139
  v_mfma_f32_32x32x16_bf16 v[80:95], v[188:191], v[148:151], v[80:95]
  ds_write_b128 v225, v[76:79] offset:3072
  v_cvt_pk_bf16_f32 v156, v136, v137
  v_cvt_pk_bf16_f32 v157, v138, v139
  v_exp_f32 v140, v140
  v_exp_f32 v141, v141
  v_exp_f32 v142, v142
  v_exp_f32 v143, v143
  v_cvt_pk_bf16_f32 v158, v140, v141
  v_cvt_pk_bf16_f32 v159, v142, v143
  v_mfma_f32_32x32x16_bf16 v[128:143], v[176:179], v[40:43], 0
  v_exp_f32 v112, v112
  v_exp_f32 v113, v113
  v_exp_f32 v114, v114
  v_exp_f32 v115, v115
  v_mfma_f32_32x32x16_bf16 v[128:143], v[180:183], v[44:47], v[128:143]
  v_cvt_pk_bf16_f32 v144, v112, v113
  v_cvt_pk_bf16_f32 v145, v114, v115
  v_exp_f32 v116, v116
  v_exp_f32 v117, v117
  v_exp_f32 v118, v118
  v_exp_f32 v119, v119
  v_mfma_f32_32x32x16_bf16 v[80:95], v[200:203], v[152:155], v[80:95]
  v_cvt_pk_bf16_f32 v146, v116, v117
  v_cvt_pk_bf16_f32 v147, v118, v119
  v_exp_f32 v120, v120
  v_exp_f32 v121, v121
  v_exp_f32 v122, v122
  v_exp_f32 v123, v123
  v_mfma_f32_32x32x16_bf16 v[80:95], v[204:207], v[156:159], v[80:95]
  v_cvt_pk_bf16_f32 v148, v120, v121
  v_cvt_pk_bf16_f32 v149, v122, v123
  v_exp_f32 v124, v124
  v_exp_f32 v125, v125
  v_exp_f32 v126, v126
  v_exp_f32 v127, v127
  v_cvt_pk_bf16_f32 v150, v124, v125
  v_cvt_pk_bf16_f32 v151, v126, v127
  v_mfma_f32_32x32x16_bf16 v[112:127], v[192:195], v[40:43], 0
  v_exp_f32 v128, v128
  v_exp_f32 v129, v129
  v_exp_f32 v130, v130
  v_exp_f32 v131, v131
  v_mfma_f32_32x32x16_bf16 v[112:127], v[196:199], v[44:47], v[112:127]
  v_cvt_pk_bf16_f32 v152, v128, v129
  v_cvt_pk_bf16_f32 v153, v130, v131
  v_exp_f32 v132, v132
  v_exp_f32 v133, v133
  v_exp_f32 v134, v134
  v_exp_f32 v135, v135
  v_mfma_f32_32x32x16_bf16 v[80:95], v[168:171], v[144:147], v[80:95]
  v_cvt_pk_bf16_f32 v154, v132, v133
  v_cvt_pk_bf16_f32 v155, v134, v135
  v_exp_f32 v136, v136
  v_exp_f32 v137, v137
  v_exp_f32 v138, v138
  v_exp_f32 v139, v139
  v_mfma_f32_32x32x16_bf16 v[80:95], v[172:175], v[148:151], v[80:95]
  v_cvt_pk_bf16_f32 v156, v136, v137
  v_cvt_pk_bf16_f32 v157, v138, v139
  v_exp_f32 v140, v140
  v_exp_f32 v141, v141
  v_exp_f32 v142, v142
  v_exp_f32 v143, v143
  v_cvt_pk_bf16_f32 v158, v140, v141
  v_cvt_pk_bf16_f32 v159, v142, v143
  v_mfma_f32_32x32x16_bf16 v[128:143], v[160:163], v[40:43], 0
  s_nop 2
  ds_write_b128 v226, v[80:83] offset:0
  v_exp_f32 v112, v112
  v_exp_f32 v113, v113
  v_exp_f32 v114, v114
  v_exp_f32 v115, v115
  v_mfma_f32_32x32x16_bf16 v[128:143], v[164:167], v[44:47], v[128:143]
  ds_write_b128 v226, v[84:87] offset:1024
  v_cvt_pk_bf16_f32 v144, v112, v113
  v_cvt_pk_bf16_f32 v145, v114, v115
  v_exp_f32 v116, v116
  v_exp_f32 v117, v117
  v_exp_f32 v118, v118
  v_exp_f32 v119, v119
  v_mfma_f32_32x32x16_bf16 v[96:111], v[184:187], v[152:155], v[96:111]
  ds_write_b128 v226, v[88:91] offset:2048
  v_cvt_pk_bf16_f32 v146, v116, v117
  v_cvt_pk_bf16_f32 v147, v118, v119
  v_exp_f32 v120, v120
  v_exp_f32 v121, v121
  v_exp_f32 v122, v122
  v_exp_f32 v123, v123
  v_mfma_f32_32x32x16_bf16 v[96:111], v[188:191], v[156:159], v[96:111]
  ds_write_b128 v226, v[92:95] offset:3072
  v_cvt_pk_bf16_f32 v148, v120, v121
  v_cvt_pk_bf16_f32 v149, v122, v123
  v_exp_f32 v124, v124
  v_exp_f32 v125, v125
  v_exp_f32 v126, v126
  v_exp_f32 v127, v127
  v_cvt_pk_bf16_f32 v150, v124, v125
  v_cvt_pk_bf16_f32 v151, v126, v127
  s_waitcnt lgkmcnt(0)
  s_barrier
  ds_read_b128 v[48:51], v227 offset:0
  ds_read_b128 v[52:55], v227 offset:1024
  ds_read_b128 v[56:59], v227 offset:2048
  v_exp_f32 v128, v128
  v_exp_f32 v129, v129
  v_exp_f32 v130, v130
  v_exp_f32 v131, v131
  ds_read_b128 v[60:63], v227 offset:3072
  ds_read_b128 v[64:67], v227 offset:4096
  ds_read_b128 v[68:71], v227 offset:5120
  v_cvt_pk_bf16_f32 v152, v128, v129
  v_cvt_pk_bf16_f32 v153, v130, v131
  v_exp_f32 v132, v132
  v_exp_f32 v133, v133
  v_exp_f32 v134, v134
  v_exp_f32 v135, v135
  v_mfma_f32_32x32x16_bf16 v[96:111], v[200:203], v[144:147], v[96:111]
  ds_read_b128 v[72:75], v227 offset:6144
  ds_read_b128 v[76:79], v227 offset:7168
  ds_read_b128 v[208:211], v227 offset:8192
  v_cvt_pk_bf16_f32 v154, v132, v133
  v_cvt_pk_bf16_f32 v155, v134, v135
  v_exp_f32 v136, v136
  v_exp_f32 v137, v137
  v_exp_f32 v138, v138
  v_exp_f32 v139, v139
  v_mfma_f32_32x32x16_bf16 v[96:111], v[204:207], v[148:151], v[96:111]
  ds_read_b128 v[212:215], v227 offset:9216
  ds_read_b128 v[216:219], v227 offset:10240
  ds_read_b128 v[220:223], v227 offset:11264
  v_cvt_pk_bf16_f32 v156, v136, v137
  v_cvt_pk_bf16_f32 v157, v138, v139
  v_exp_f32 v140, v140
  v_exp_f32 v141, v141
  v_exp_f32 v142, v142
  v_exp_f32 v143, v143
  v_cvt_pk_bf16_f32 v158, v140, v141
  v_cvt_pk_bf16_f32 v159, v142, v143
  v_mfma_f32_32x32x16_bf16 v[96:111], v[168:171], v[152:155], v[96:111]
  s_nop 0
  v_mfma_f32_32x32x16_bf16 v[96:111], v[172:175], v[156:159], v[96:111]
  s_waitcnt lgkmcnt(7)
  v_add_f32 v48, v48, v64
  v_add_f32 v49, v49, v65
  v_add_f32 v50, v50, v66
  v_add_f32 v51, v51, v67
  s_waitcnt lgkmcnt(6)
  v_add_f32 v52, v52, v68
  v_add_f32 v53, v53, v69
  v_add_f32 v54, v54, v70
  v_add_f32 v55, v55, v71
  s_waitcnt lgkmcnt(5)
  v_add_f32 v56, v56, v72
  v_add_f32 v57, v57, v73
  v_add_f32 v58, v58, v74
  v_add_f32 v59, v59, v75
  s_waitcnt lgkmcnt(4)
  v_add_f32 v60, v60, v76
  v_add_f32 v61, v61, v77
  v_add_f32 v62, v62, v78
  v_add_f32 v63, v63, v79
  s_lshl_b32 s4, s72, 15
  s_lshl_b32 s3, s69, 11
  s_add_u32 s4, s4, s3
  s_add_u32 s4, s4, s73
  s_waitcnt lgkmcnt(3)
  v_pk_add_f32 v[48:49], v[48:49], v[208:209]
  v_pk_add_f32 v[50:51], v[50:51], v[210:211]
  s_waitcnt lgkmcnt(2)
  v_pk_add_f32 v[52:53], v[52:53], v[212:213]
  v_pk_add_f32 v[54:55], v[54:55], v[214:215]
  s_waitcnt lgkmcnt(1)
  v_pk_add_f32 v[56:57], v[56:57], v[216:217]
  v_pk_add_f32 v[58:59], v[58:59], v[218:219]
  s_waitcnt lgkmcnt(0)
  v_pk_add_f32 v[60:61], v[60:61], v[220:221]
  v_pk_add_f32 v[62:63], v[62:63], v[222:223]
  v_pk_add_f32 v[108:109], v[108:109], v[60:61]
  v_pk_add_f32 v[96:97], v[96:97], v[48:49]
  v_pk_add_f32 v[98:99], v[98:99], v[50:51]
  v_pk_add_f32 v[100:101], v[100:101], v[52:53]
  v_pk_add_f32 v[102:103], v[102:103], v[54:55]
  v_pk_add_f32 v[104:105], v[104:105], v[56:57]
  v_pk_add_f32 v[106:107], v[106:107], v[58:59]
  v_pk_add_f32 v[110:111], v[110:111], v[62:63]
  v_mov_b32 v230, v108
  v_mov_b32 v232, v108
  s_nop 1
  v_permlane32_swap_b32 v230, v232
  v_subrev_u32 v230, 0x21800000, v232
  v_cmp_lt_u32 vcc, 0x3c000000, v230
  s_nop 0
  s_cbranch_vccnz L99
L100:
  v_rcp_f32 v232, v232
  v_mov_b32 v230, 0
  v_pk_mul_f32 v[96:97], v[96:97], v[232:233] op_sel_hi:[1,0]
  v_pk_mul_f32 v[98:99], v[98:99], v[232:233] op_sel_hi:[1,0]
  v_pk_mul_f32 v[100:101], v[100:101], v[232:233] op_sel_hi:[1,0]
  v_pk_mul_f32 v[102:103], v[102:103], v[232:233] op_sel_hi:[1,0]
  v_pk_mul_f32 v[104:105], v[104:105], v[232:233] op_sel_hi:[1,0]
  v_pk_mul_f32 v[106:107], v[106:107], v[232:233] op_sel_hi:[1,0]
  v_pk_mul_f32 v[108:109], v[108:109], v[232:233] op_sel_hi:[1,0]
  v_pk_mul_f32 v[110:111], v[110:111], v[232:233] op_sel_hi:[1,0]
  v_cvt_pk_bf16_f32 v144, v96, v97
  v_cvt_pk_bf16_f32 v145, v98, v99
  v_cvt_pk_bf16_f32 v146, v100, v101
  v_cvt_pk_bf16_f32 v147, v102, v103
  v_cvt_pk_bf16_f32 v148, v104, v105
  v_cvt_pk_bf16_f32 v149, v106, v107
  v_cvt_pk_bf16_f32 v150, v108, v109
  v_cvt_pk_bf16_f32 v151, v110, v111
  v_cndmask_b32 v150, v150, v230, s[90:91]
  v_cndmask_b32 v151, v151, v230, s[90:91]
  s_cmp_eq_u32 s74, 0
  s_cbranch_scc1 L101
  buffer_store_dwordx4 v[144:147], v1, s[64:67], s4 offen offset:0
  buffer_store_dwordx4 v[148:151], v1, s[64:67], s4 offen offset:1024
L102:
  v_accvgpr_read_b32 v228, a224
  v_xor_b32 v229, 64, v228
  s_mul_i32 s18, s81, 28672
  v_accvgpr_read_b32 v234, a239
  s_add_u32 s88, s73, 0xc0a00
  v_add_u32 v230, s18, v228
  v_add_u32 v231, s18, v229
  v_and_b32 v222, 0xfffffdff, v230
  v_and_b32 v223, 0xfffffdff, v231
  ds_read_b64_tr_b16 v[16:17], v230 offset:0
  ds_read_b64_tr_b16 v[18:19], v230 offset:1024
  ds_read_b64_tr_b16 v[20:21], v231 offset:0
  ds_read_b64_tr_b16 v[22:23], v231 offset:1024
  ds_read_b64_tr_b16 v[24:25], v230 offset:2048
  ds_read_b64_tr_b16 v[26:27], v222 offset:3072
  ds_read_b64_tr_b16 v[28:29], v231 offset:2048
  ds_read_b64_tr_b16 v[30:31], v223 offset:3072
  ds_read_b64_tr_b16 v[32:33], v230 offset:3584
  ds_read_b64_tr_b16 v[34:35], v230 offset:4608
  ds_read_b64_tr_b16 v[36:37], v231 offset:3584
  ds_read_b64_tr_b16 v[38:39], v231 offset:4608
  ds_read_b64_tr_b16 v[40:41], v230 offset:5632
  ds_read_b64_tr_b16 v[42:43], v222 offset:6656
  ds_read_b64_tr_b16 v[44:45], v231 offset:5632
  ds_read_b64_tr_b16 v[46:47], v223 offset:6656
  ds_read_b64_tr_b16 v[48:49], v230 offset:7168
  ds_read_b64_tr_b16 v[50:51], v230 offset:8192
  ds_read_b64_tr_b16 v[52:53], v231 offset:7168
  ds_read_b64_tr_b16 v[54:55], v231 offset:8192
  ds_read_b64_tr_b16 v[56:57], v230 offset:9216
  ds_read_b64_tr_b16 v[58:59], v222 offset:10240
  ds_read_b64_tr_b16 v[60:61], v231 offset:9216
  ds_read_b64_tr_b16 v[62:63], v223 offset:10240
  v_mov_b32 v233, 1
  s_mov_b64 exec, 1
  s_waitcnt vmcnt(0)
  s_barrier
  s_cmp_eq_u32 s74, 0
  s_cbranch_scc1 L105
  buffer_store_dword v233, off, s[64:67], s82 offset:2560
L106:
  s_mov_b64 exec, -1
  s_cmp_ge_u32 s0, 14
  s_cbranch_scc1 L103
  buffer_load_dword v235, v234, s[64:67], s88 offen sc1
  s_mov_b32 s95, 131072
  s_lshl_b32 s20, s81, 14
  s_add_u32 s20, s20, s79
  s_mov_b32 s24, s79
  s_add_u32 s24, s24, s84
  s_add_u32 s24, s24, 0x20000
  ds_read_b64_tr_b16 v[64:65], v230 offset:10752
  ds_read_b64_tr_b16 v[66:67], v230 offset:11776
  ds_read_b64_tr_b16 v[68:69], v231 offset:10752
  ds_read_b64_tr_b16 v[70:71], v231 offset:11776
  ds_read_b64_tr_b16 v[72:73], v230 offset:12800
  ds_read_b64_tr_b16 v[74:75], v222 offset:13824
  ds_read_b64_tr_b16 v[76:77], v231 offset:12800
  ds_read_b64_tr_b16 v[78:79], v223 offset:13824
  ds_read_b64_tr_b16 v[80:81], v230 offset:14336
  ds_read_b64_tr_b16 v[82:83], v230 offset:15360
  buffer_load_dword v13, v234, s[64:67], s88 offen sc1
L107:
  s_waitcnt vmcnt(1)
  v_cmp_eq_u32 vcc, 0, v235
  s_nop 0
  s_cbranch_vccz L108
  buffer_load_dword v235, v234, s[64:67], s88 offen sc1
  s_waitcnt vmcnt(1)
  v_cmp_eq_u32 vcc, 0, v13
  s_nop 0
  s_cbranch_vccz L108
  buffer_load_dword v13, v234, s[64:67], s88 offen sc1
  s_sub_u32 s95, s95, 1
  s_cbranch_scc0 L107
  s_branch L_abort
L108:
  s_add_u32 s23, s20, 0
  buffer_load_dwordx4 v[144:147], v1, s[64:67], s23 offen offset:0 sc1
  buffer_load_dwordx4 v[148:151], v1, s[64:67], s23 offen offset:1024 sc1
  buffer_load_dwordx4 v[152:155], v1, s[64:67], s23 offen offset:2048 sc1
  buffer_load_dwordx4 v[156:159], v1, s[64:67], s23 offen offset:3072 sc1
  s_add_u32 s23, s20, 4096
  buffer_load_dwordx4 v[160:163], v1, s[64:67], s23 offen offset:0 sc1
  buffer_load_dwordx4 v[164:167], v1, s[64:67], s23 offen offset:1024 sc1
  buffer_load_dwordx4 v[168:171], v1, s[64:67], s23 offen offset:2048 sc1
  ds_read_b64_tr_b16 v[84:85], v231 offset:14336
  ds_read_b64_tr_b16 v[86:87], v231 offset:15360
  ds_read_b64_tr_b16 v[88:89], v230 offset:16384
  ds_read_b64_tr_b16 v[90:91], v222 offset:17408
  ds_read_b64_tr_b16 v[92:93], v231 offset:16384
  ds_read_b64_tr_b16 v[94:95], v223 offset:17408
  ds_read_b64_tr_b16 v[96:97], v230 offset:17920
  ds_read_b64_tr_b16 v[98:99], v230 offset:18944
  ds_read_b64_tr_b16 v[100:101], v231 offset:17920
  ds_read_b64_tr_b16 v[102:103], v231 offset:18944
  ds_read_b64_tr_b16 v[104:105], v230 offset:19968
  ds_read_b64_tr_b16 v[106:107], v222 offset:20992
  ds_read_b64_tr_b16 v[108:109], v231 offset:19968
  ds_read_b64_tr_b16 v[110:111], v223 offset:20992
  ds_read_b64_tr_b16 v[112:113], v230 offset:21504
  ds_read_b64_tr_b16 v[114:115], v230 offset:22528
  ds_read_b64_tr_b16 v[116:117], v231 offset:21504
  ds_read_b64_tr_b16 v[118:119], v231 offset:22528
  ds_read_b64_tr_b16 v[120:121], v230 offset:23552
  ds_read_b64_tr_b16 v[122:123], v222 offset:24576
  s_waitcnt vmcnt(6) lgkmcnt(15)
  v_mfma_f32_32x32x16_bf16 v[192:207], v[20:23], v[144:147], 0
  buffer_load_dwordx4 v[172:175], v1, s[64:67], s23 offen offset:3072 sc1
  ds_read_b64_tr_b16 v[124:125], v231 offset:23552
  v_mfma_f32_32x32x16_bf16 v[240:255], v[16:19], v[144:147], v[240:255]
  ds_read_b64_tr_b16 v[126:127], v223 offset:24576
  s_waitcnt vmcnt(6)
  v_mfma_f32_32x32x16_bf16 v[192:207], v[28:31], v[148:151], v[192:207]
  s_add_u32 s23, s20, 8192
  buffer_load_dwordx4 v[144:147], v1, s[64:67], s23 offen offset:0 sc1
  v_mfma_f32_32x32x16_bf16 v[240:255], v[24:27], v[148:151], v[240:255]
  ds_read_b64_tr_b16 v[128:129], v230 offset:25088
  s_waitcnt vmcnt(6)
  v_mfma_f32_32x32x16_bf16 v[192:207], v[36:39], v[152:155], v[192:207]
  buffer_load_dwordx4 v[148:151], v1, s[64:67], s23 offen offset:1024 sc1
  ds_read_b64_tr_b16 v[130:131], v230 offset:26112
  v_mfma_f32_32x32x16_bf16 v[240:255], v[32:35], v[152:155], v[240:255]
  s_waitcnt vmcnt(6)
  v_mfma_f32_32x32x16_bf16 v[192:207], v[44:47], v[156:159], v[192:207]
  buffer_load_dwordx4 v[152:155], v1, s[64:67], s23 offen offset:2048 sc1
  ds_read_b64_tr_b16 v[132:133], v231 offset:25088
  v_mfma_f32_32x32x16_bf16 v[240:255], v[40:43], v[156:159], v[240:255]
  s_waitcnt vmcnt(6)
  v_mfma_f32_32x32x16_bf16 v[192:207], v[52:55], v[160:163], v[192:207]
  buffer_load_dwordx4 v[156:159], v1, s[64:67], s23 offen offset:3072 sc1
  ds_read_b64_tr_b16 v[134:135], v231 offset:26112
  v_mfma_f32_32x32x16_bf16 v[240:255], v[48:51], v[160:163], v[240:255]
  ds_read_b64_tr_b16 v[136:137], v230 offset:27136
  s_waitcnt vmcnt(6)
  v_mfma_f32_32x32x16_bf16 v[192:207], v[60:63], v[164:167], v[192:207]
  s_add_u32 s23, s20, 12288
  buffer_load_dwordx4 v[160:163], v1, s[64:67], s23 offen offset:0 sc1
  v_mfma_f32_32x32x16_bf16 v[240:255], v[56:59], v[164:167], v[240:255]
  ds_read_b64_tr_b16 v[138:139], v222 offset:28160
  s_waitcnt vmcnt(6)
  v_mfma_f32_32x32x16_bf16 v[192:207], v[68:71], v[168:171], v[192:207]
  buffer_load_dwordx4 v[164:167], v1, s[64:67], s23 offen offset:1024 sc1
  ds_read_b64_tr_b16 v[140:141], v231 offset:27136
  v_mfma_f32_32x32x16_bf16 v[240:255], v[64:67], v[168:171], v[240:255]
  s_waitcnt vmcnt(6)
  v_mfma_f32_32x32x16_bf16 v[192:207], v[76:79], v[172:175], v[192:207]
  buffer_load_dwordx4 v[168:171], v1, s[64:67], s23 offen offset:2048 sc1
  ds_read_b64_tr_b16 v[142:143], v223 offset:28160
  v_mfma_f32_32x32x16_bf16 v[240:255], v[72:75], v[172:175], v[240:255]
  s_waitcnt vmcnt(6)
  v_mfma_f32_32x32x16_bf16 v[192:207], v[84:87], v[144:147], v[192:207]
  buffer_load_dwordx4 v[172:175], v1, s[64:67], s23 offen offset:3072 sc1
  v_mfma_f32_32x32x16_bf16 v[240:255], v[80:83], v[144:147], v[240:255]
  s_waitcnt lgkmcnt(0)
  s_barrier
  s_waitcnt vmcnt(6)
  v_mfma_f32_32x32x16_bf16 v[192:207], v[92:95], v[148:151], v[192:207]
  s_and_b32 s101, s68, 1
  s_mul_i32 s100, s101, 50176
  s_add_u32 s100, s100, s78
  s_mul_i32 s101, s101, 7168
  s_add_u32 s101, s101, s76
  s_add_u32 m0, s101, 0
  s_add_u32 s22, s100, 0
  buffer_load_dwordx4 v236, s[44:47], s22 offen offset:0  lds
  v_mfma_f32_32x32x16_bf16 v[240:255], v[88:91], v[148:151], v[240:255]
  s_waitcnt vmcnt(6)
  v_mfma_f32_32x32x16_bf16 v[192:207], v[100:103], v[152:155], v[192:207]
  buffer_load_dwordx4 v237, s[44:47], s22 offen offset:1024  lds
  s_waitcnt vmcnt(6)
  v_mfma_f32_32x32x16_bf16 v[192:207], v[108:111], v[156:159], v[192:207]
  buffer_load_dwordx4 v238, s[44:47], s22 offen offset:2048  lds
  s_waitcnt vmcnt(6)
  v_mfma_f32_32x32x16_bf16 v[192:207], v[116:119], v[160:163], v[192:207]
  buffer_load_dwordx4 v239, s[44:47], s22 offen offset:3072  lds
  s_waitcnt vmcnt(6)
  v_mfma_f32_32x32x16_bf16 v[192:207], v[124:127], v[164:167], v[192:207]
  s_add_u32 m0, s101, 4096
  s_add_u32 s22, s100, 28672
  buffer_load_dwordx4 v236, s[44:47], s22 offen offset:0  lds
  s_waitcnt vmcnt(6)
  v_mfma_f32_32x32x16_bf16 v[192:207], v[132:135], v[168:171], v[192:207]
  buffer_load_dwordx4 v237, s[44:47], s22 offen offset:1024  lds
  s_waitcnt vmcnt(6)
  v_mfma_f32_32x32x16_bf16 v[192:207], v[140:143], v[172:175], v[192:207]
  buffer_load_dwordx4 v238, s[44:47], s22 offen offset:2048  lds
  v_mfma_f32_32x32x16_bf16 v[240:255], v[96:99], v[152:155], v[240:255]
  v_mfma_f32_32x32x16_bf16 v[240:255], v[104:107], v[156:159], v[240:255]
  s_nop 8
  ds_write_b128 v224, v[192:195] offset:0
  v_mfma_f32_32x32x16_bf16 v[240:255], v[112:115], v[160:163], v[240:255]
  ds_write_b128 v224, v[196:199] offset:1024
  v_mfma_f32_32x32x16_bf16 v[240:255], v[120:123], v[164:167], v[240:255]
  ds_write_b128 v224, v[200:203] offset:2048
  v_mfma_f32_32x32x16_bf16 v[240:255], v[128:131], v[168:171], v[240:255]
  ds_write_b128 v224, v[204:207] offset:3072
  v_mfma_f32_32x32x16_bf16 v[240:255], v[136:139], v[172:175], v[240:255]
  s_waitcnt lgkmcnt(0)
  s_barrier
  ds_read_b128 v[144:147], v227 offset:0
  ds_read_b128 v[148:151], v227 offset:1024
  ds_read_b128 v[152:155], v227 offset:2048
  ds_read_b128 v[156:159], v227 offset:3072
  s_waitcnt lgkmcnt(3)
  s_nop 4
  v_pk_add_f32 v[240:241], v[240:241], v[144:145]
  v_pk_add_f32 v[242:243], v[242:243], v[146:147]
  s_waitcnt lgkmcnt(2)
  v_pk_add_f32 v[244:245], v[244:245], v[148:149]
  v_pk_add_f32 v[246:247], v[246:247], v[150:151]
  s_waitcnt lgkmcnt(1)
  v_pk_add_f32 v[248:249], v[248:249], v[152:153]
  v_pk_add_f32 v[250:251], v[250:251], v[154:155]
  s_waitcnt lgkmcnt(0)
  v_pk_add_f32 v[252:253], v[252:253], v[156:157]
  v_pk_add_f32 v[254:255], v[254:255], v[158:159]
  v_cvt_pk_bf16_f32 v192, v240, v241
  v_cvt_pk_bf16_f32 v193, v242, v243
  v_cvt_pk_bf16_f32 v194, v244, v245
  v_cvt_pk_bf16_f32 v195, v246, v247
  v_cvt_pk_bf16_f32 v196, v248, v249
  v_cvt_pk_bf16_f32 v197, v250, v251
  v_cvt_pk_bf16_f32 v198, v252, v253
  v_cvt_pk_bf16_f32 v199, v254, v255
  s_cmp_eq_u32 s74, 0
  s_cbranch_scc1 L109
  buffer_store_dwordx4 v[192:195], v1, s[64:67], s24 offen offset:0
  buffer_store_dwordx4 v[196:199], v1, s[64:67], s24 offen offset:1024
L110:
  s_mul_i32 s18, s81, 28672
  s_add_u32 s18, s18, 0xe000
  v_accvgpr_read_b32 v234, a236
  s_add_u32 s88, s73, 0xc0b00
  s_and_b32 s101, s68, 1
  s_xor_b32 s101, s101, 1
  s_mul_i32 s100, s101, 50176
  s_add_u32 s100, s100, s78
  s_mul_i32 s101, s101, 7168
  s_add_u32 s101, s101, s76
  v_pk_add_f32 v[144:145], v[240:241], v[242:243]
  v_pk_mul_f32 v[146:147], v[240:241], v[240:241]
  v_pk_fma_f32 v[146:147], v[242:243], v[242:243], v[146:147]
  v_pk_add_f32 v[144:145], v[144:145], v[244:245]
  s_add_u32 m0, s101, 0
  s_add_u32 s22, s100, 0
  buffer_load_dwordx4 v236, s[44:47], s22 offen offset:0  lds
  v_pk_fma_f32 v[146:147], v[244:245], v[244:245], v[146:147]
  v_pk_add_f32 v[144:145], v[144:145], v[246:247]
  v_pk_fma_f32 v[146:147], v[246:247], v[246:247], v[146:147]
  v_pk_add_f32 v[144:145], v[144:145], v[248:249]
  buffer_load_dwordx4 v237, s[44:47], s22 offen offset:1024  lds
  v_pk_fma_f32 v[146:147], v[248:249], v[248:249], v[146:147]
  v_pk_add_f32 v[144:145], v[144:145], v[250:251]
  v_pk_fma_f32 v[146:147], v[250:251], v[250:251], v[146:147]
  v_pk_add_f32 v[144:145], v[144:145], v[252:253]
  buffer_load_dwordx4 v238, s[44:47], s22 offen offset:2048  lds
  v_pk_fma_f32 v[146:147], v[252:253], v[252:253], v[146:147]
  v_pk_add_f32 v[144:145], v[144:145], v[254:255]
  v_pk_fma_f32 v[146:147], v[254:255], v[254:255], v[146:147]
  v_add_f32 v144, v144, v145
  buffer_load_dwordx4 v239, s[44:47], s22 offen offset:3072  lds
  v_add_f32 v146, v146, v147
  v_add_u32 v145, s83, v2
  s_nop 0
  v_permlane32_swap_b32 v144, v146
  v_add_f32 v232, v144, v146
  s_add_u32 m0, s101, 4096
  s_add_u32 s22, s100, 28672
  buffer_load_dwordx4 v236, s[44:47], s22 offen offset:0  lds
  ds_write_b32 v145, v232
  v_add_u32 v230, s18, v228
  v_add_u32 v231, s18, v229
  ds_read_b64_tr_b16 v[16:17], v230 offset:0
  buffer_load_dwordx4 v237, s[44:47], s22 offen offset:1024  lds
  ds_read_b64_tr_b16 v[18:19], v230 offset:1024
  ds_read_b64_tr_b16 v[20:21], v231 offset:0
  ds_read_b64_tr_b16 v[22:23], v231 offset:1024
  ds_read_b64_tr_b16 v[24:25], v230 offset:2048
  buffer_load_dwordx4 v238, s[44:47], s22 offen offset:2048  lds
  ds_read_b64_tr_b16 v[26:27], v230 offset:3072
  ds_read_b64_tr_b16 v[28:29], v231 offset:2048
  ds_read_b64_tr_b16 v[30:31], v231 offset:3072
  v_mov_b32 v233, 1
  s_lshl_b32 s89, s70, 12
  s_lshl_b32 s3, s80, 11
  s_add_u32 s89, s89, s3
  s_lshl_b32 s3, s71, 8
  s_add_u32 s89, s89, s3
  s_add_u32 s89, s89, s73
  s_add_u32 s89, s89, 0xb6000
  s_cmp_eq_u32 s81, 1
  s_cselect_b32 s89, s89, 0x7f000000
  s_sub_u32 s4, s83, 12288
  v_add_u32 v14, s4, v2
  s_waitcnt lgkmcnt(8)
  s_mov_b64 exec, 1
  s_waitcnt vmcnt(7)
  s_barrier
  s_cmp_eq_u32 s74, 0
  s_cbranch_scc1 L111
  buffer_store_dword v233, off, s[64:67], s82 offset:2816
L112:
  s_mov_b64 exec, -1
  ds_read_b32 v14, v14
  buffer_load_dword v235, v234, s[64:67], s88 offen sc1
  s_mov_b32 s95, 131072
  s_waitcnt lgkmcnt(0)
  v_add_f32 v14, v14, v232
  s_cmp_eq_u32 s74, 0
  s_cbranch_scc1 L115
  buffer_store_dword v14, v2, s[64:67], s89 offen
L116:
  s_mul_i32 s20, s81, 14336
  s_add_u32 s20, s20, s79
  s_add_u32 s20, s20, 0x20000
  s_lshl_b32 s14, s70, 12
  s_lshl_b32 s3, s80, 11
  s_add_u32 s14, s14, s3
  s_add_u32 s14, s14, s73
  s_add_u32 s14, s14, 0xb6000
  s_lshl_b32 s16, s0, 7
  s_mul_i32 s3, s72, 401408
  s_add_u32 s16, s16, s3
  s_lshl_b32 s24, s70, 16
  s_add_u32 s24, s24, s73
  s_add_u32 s24, s24, s84
  s_mov_b32 s15, 131072
  v_accvgpr_read_b32 v236, a226
  v_accvgpr_read_b32 v216, a230
  v_accvgpr_read_b32 v237, a227
  v_accvgpr_read_b32 v217, a231
  v_accvgpr_read_b32 v238, a228
  v_accvgpr_read_b32 v218, a232
  v_accvgpr_read_b32 v239, a229
  v_accvgpr_read_b32 v219, a233
  ds_read_b64_tr_b16 v[32:33], v230 offset:4096
  ds_read_b64_tr_b16 v[34:35], v230 offset:5120
  ds_read_b64_tr_b16 v[36:37], v231 offset:4096
  ds_read_b64_tr_b16 v[38:39], v231 offset:5120
  ds_read_b64_tr_b16 v[40:41], v230 offset:6144
  ds_read_b64_tr_b16 v[42:43], v230 offset:7168
  ds_read_b64_tr_b16 v[44:45], v231 offset:6144
  ds_read_b64_tr_b16 v[46:47], v231 offset:7168
  ds_read_b64_tr_b16 v[48:49], v230 offset:8192
  ds_read_b64_tr_b16 v[50:51], v230 offset:9216
  buffer_load_dword v13, v234, s[64:67], s88 offen sc1
L113:
  s_waitcnt vmcnt(1)
  v_cmp_eq_u32 vcc, 0, v235
  s_nop 0
  s_cbranch_vccz L114
  buffer_load_dword v235, v234, s[64:67], s88 offen sc1
  s_waitcnt vmcnt(1)
  v_cmp_eq_u32 vcc, 0, v13
  s_nop 0
  s_cbranch_vccz L114
  buffer_load_dword v13, v234, s[64:67], s88 offen sc1
  s_sub_u32 s95, s95, 1
  s_cbranch_scc0 L113
  s_branch L_abort
L114:
  s_add_u32 s23, s20, 0
  buffer_load_dwordx4 v[144:147], v1, s[64:67], s23 offen offset:0 sc1
  buffer_load_dwordx4 v[148:151], v1, s[64:67], s23 offen offset:1024 sc1
  buffer_load_dwordx4 v[152:155], v1, s[64:67], s23 offen offset:2048 sc1
  buffer_load_dwordx4 v[156:159], v1, s[64:67], s23 offen offset:3072 sc1
  s_add_u32 s23, s20, 4096
  buffer_load_dwordx4 v[160:163], v1, s[64:67], s23 offen offset:0 sc1
  buffer_load_dwordx4 v[164:167], v1, s[64:67], s23 offen offset:1024 sc1
  buffer_load_dwordx4 v[168:171], v1, s[64:67], s23 offen offset:2048 sc1
  ds_read_b64_tr_b16 v[52:53], v231 offset:8192
  ds_read_b64_tr_b16 v[54:55], v231 offset:9216
  ds_read_b64_tr_b16 v[56:57], v230 offset:10240
  ds_read_b64_tr_b16 v[58:59], v230 offset:11264
  ds_read_b64_tr_b16 v[60:61], v231 offset:10240
  ds_read_b64_tr_b16 v[62:63], v231 offset:11264
  ds_read_b64_tr_b16 v[64:65], v230 offset:12288
  ds_read_b64_tr_b16 v[66:67], v230 offset:13312
  ds_read_b64_tr_b16 v[68:69], v231 offset:12288
  ds_read_b64_tr_b16 v[70:71], v231 offset:13312
  ds_read_b64_tr_b16 v[72:73], v230 offset:14336
  ds_read_b64_tr_b16 v[74:75], v230 offset:15360
  ds_read_b64_tr_b16 v[76:77], v231 offset:14336
  ds_read_b64_tr_b16 v[78:79], v231 offset:15360
  ds_read_b64_tr_b16 v[80:81], v230 offset:16384
  ds_read_b64_tr_b16 v[82:83], v230 offset:17408
  ds_read_b64_tr_b16 v[84:85], v231 offset:16384
  ds_read_b64_tr_b16 v[86:87], v231 offset:17408
  ds_read_b64_tr_b16 v[88:89], v230 offset:18432
  ds_read_b64_tr_b16 v[90:91], v230 offset:19456
  s_waitcnt vmcnt(6)
  v_mfma_f32_32x32x16_bf16 v[192:207], v[20:23], v[144:147], 0
  buffer_load_dwordx4 v[172:175], v1, s[64:67], s23 offen offset:3072 sc1
  ds_read_b64_tr_b16 v[92:93], v231 offset:18432
  ds_read_b64_tr_b16 v[94:95], v231 offset:19456
  v_mfma_f32_32x32x16_bf16 v[176:191], v[16:19], v[144:147], 0
  ds_read_b64_tr_b16 v[96:97], v230 offset:20480
  s_waitcnt vmcnt(6)
  v_mfma_f32_32x32x16_bf16 v[192:207], v[28:31], v[148:151], v[192:207]
  s_add_u32 s23, s20, 8192
  buffer_load_dwordx4 v[144:147], v1, s[64:67], s23 offen offset:0 sc1
  ds_read_b64_tr_b16 v[98:99], v230 offset:21504
  ds_read_b64_tr_b16 v[100:101], v231 offset:20480
  v_mfma_f32_32x32x16_bf16 v[176:191], v[24:27], v[148:151], v[176:191]
  ds_read_b64_tr_b16 v[102:103], v231 offset:21504
  s_waitcnt vmcnt(6) lgkmcnt(15)
  v_mfma_f32_32x32x16_bf16 v[192:207], v[36:39], v[152:155], v[192:207]
  buffer_load_dwordx4 v[148:151], v1, s[64:67], s23 offen offset:1024 sc1
  ds_read_b64_tr_b16 v[104:105], v230 offset:22528
  ds_read_b64_tr_b16 v[106:107], v230 offset:23552
  v_mfma_f32_32x32x16_bf16 v[176:191], v[32:35], v[152:155], v[176:191]
  ds_read_b64_tr_b16 v[108:109], v231 offset:22528
  s_waitcnt vmcnt(6)
  v_mfma_f32_32x32x16_bf16 v[192:207], v[44:47], v[156:159], v[192:207]
  buffer_load_dwordx4 v[152:155], v1, s[64:67], s23 offen offset:2048 sc1
  ds_read_b64_tr_b16 v[110:111], v231 offset:23552
  ds_read_b64_tr_b16 v[112:113], v230 offset:24576
  v_mfma_f32_32x32x16_bf16 v[176:191], v[40:43], v[156:159], v[176:191]
  ds_read_b64_tr_b16 v[114:115], v230 offset:25600
  s_waitcnt vmcnt(6)
  v_mfma_f32_32x32x16_bf16 v[192:207], v[52:55], v[160:163], v[192:207]
  buffer_load_dwordx4 v[156:159], v1, s[64:67], s23 offen offset:3072 sc1
  ds_read_b64_tr_b16 v[116:117], v231 offset:24576
  ds_read_b64_tr_b16 v[118:119], v231 offset:25600
  v_mfma_f32_32x32x16_bf16 v[176:191], v[48:51], v[160:163], v[176:191]
  ds_read_b64_tr_b16 v[120:121], v230 offset:26624
  s_waitcnt vmcnt(6)
  v_mfma_f32_32x32x16_bf16 v[192:207], v[60:63], v[164:167], v[192:207]
  s_add_u32 s23, s20, 12288
  buffer_load_dwordx4 v[160:163], v1, s[64:67], s23 offen offset:0 sc1
  ds_read_b64_tr_b16 v[122:123], v230 offset:27648
  ds_read_b64_tr_b16 v[124:125], v231 offset:26624
  v_mfma_f32_32x32x16_bf16 v[176:191], v[56:59], v[164:167], v[176:191]
  ds_read_b64_tr_b16 v[126:127], v231 offset:27648
  s_waitcnt vmcnt(6)
  v_mfma_f32_32x32x16_bf16 v[192:207], v[68:71], v[168:171], v[192:207]
  buffer_load_dwordx4 v[164:167], v1, s[64:67], s23 offen offset:1024 sc1
  buffer_load_dword v208, v2, s[64:67], s14 offen offset:0 sc1
  buffer_load_dword v209, v2, s[64:67], s14 offen offset:256 sc1
  buffer_load_dword v210, v2, s[64:67], s14 offen offset:512 sc1
  buffer_load_dword v211, v2, s[64:67], s14 offen offset:768 sc1
  v_mfma_f32_32x32x16_bf16 v[176:191], v[64:67], v[168:171], v[176:191]
  buffer_load_dword v212, v2, s[64:67], s14 offen offset:1024 sc1
  buffer_load_dword v213, v2, s[64:67], s14 offen offset:1280 sc1
  buffer_load_dword v214, v2, s[64:67], s14 offen offset:1536 sc1
  s_waitcnt lgkmcnt(0)
  s_barrier
  s_waitcnt vmcnt(13)
  v_mfma_f32_32x32x16_bf16 v[192:207], v[76:79], v[172:175], v[192:207]
  s_and_b32 s101, s68, 1
  s_mul_i32 s100, s101, 200704
  s_add_u32 s100, s100, s16
  s_mul_i32 s101, s101, 7168
  s_add_u32 s101, s101, s77
  s_add_u32 m0, s101, 0
  s_add_u32 s22, s100, 0
  buffer_load_dwordx4 v236, s[48:51], s22 offen offset:0  lds
  v_mfma_f32_32x32x16_bf16 v[176:191], v[72:75], v[172:175], v[176:191]
  s_waitcnt vmcnt(13)
  v_mfma_f32_32x32x16_bf16 v[192:207], v[84:87], v[144:147], v[192:207]
  buffer_load_dwordx4 v237, s[48:51], s22 offen offset:1024  lds
  v_mfma_f32_32x32x16_bf16 v[176:191], v[80:83], v[144:147], v[176:191]
  s_waitcnt vmcnt(13)
  v_mfma_f32_32x32x16_bf16 v[192:207], v[92:95], v[148:151], v[192:207]
  buffer_load_dwordx4 v238, s[48:51], s22 offen offset:2048  lds
  v_mfma_f32_32x32x16_bf16 v[176:191], v[88:91], v[148:151], v[176:191]
  s_waitcnt vmcnt(13)
  v_mfma_f32_32x32x16_bf16 v[192:207], v[100:103], v[152:155], v[192:207]
  buffer_load_dwordx4 v239, s[48:51], s22 offen offset:3072  lds
  v_mfma_f32_32x32x16_bf16 v[176:191], v[96:99], v[152:155], v[176:191]
  s_waitcnt vmcnt(13)
  v_mfma_f32_32x32x16_bf16 v[192:207], v[108:111], v[156:159], v[192:207]
  s_add_u32 m0, s101, 4096
  s_add_u32 s22, s100, 114688
  buffer_load_dwordx4 v236, s[48:51], s22 offen offset:0  lds
  v_mfma_f32_32x32x16_bf16 v[176:191], v[104:107], v[156:159], v[176:191]
  s_waitcnt vmcnt(13)
  v_mfma_f32_32x32x16_bf16 v[192:207], v[116:119], v[160:163], v[192:207]
  buffer_load_dwordx4 v237, s[48:51], s22 offen offset:1024  lds
  s_waitcnt vmcnt(13)
  v_mfma_f32_32x32x16_bf16 v[192:207], v[124:127], v[164:167], v[192:207]
  buffer_load_dwordx4 v238, s[48:51], s22 offen offset:2048  lds
  v_mfma_f32_32x32x16_bf16 v[176:191], v[112:115], v[160:163], v[176:191]
  s_waitcnt vmcnt(11)
  v_max3_u32 v141, v208, v209, v210
  s_waitcnt vmcnt(8)
  v_max3_u32 v140, v211, v212, v213
  s_waitcnt vmcnt(7)
  v_max3_u32 v141, v141, v140, v214
  v_cmp_eq_u32 vcc, -1, v141
  s_nop 0
  s_cbranch_vccnz L117
L118:
  v_add_f32 v140, v208, v209
  v_add_f32 v141, v210, v211
  v_add_f32 v140, v140, v212
  v_add_f32 v141, v141, v213
  ds_write_b128 v224, v[192:195] offset:0
  v_add_f32 v140, v140, v214
  v_add_f32 v140, v140, v141
  v_mov_b32 v141, v140
  s_nop 1
  v_permlane32_swap_b32 v140, v141
  v_mul_f32 v10, 0x3b124925, v140
  v_mul_f32 v141, 0x3b124925, v141
  v_fma_f32 v140, -v10, v10, v141
  ds_write_b128 v224, v[196:199] offset:1024
  v_mfma_f32_32x32x16_bf16 v[176:191], v[120:123], v[164:167], v[176:191]
  v_max_f32 v140, 0, v140
  v_add_f32 v141, 0x3727c5ac, v140
  v_rsq_f32 v12, v141
  v_cvt_pk_bf16_f32 v130, -v10, -v10
  v_mov_b32 v128, 0
  v_mov_b32 v129, 0
  v_lshlrev_b32 v142, 16, v130
  v_mov_b32 v132, 0
  ds_write_b128 v224, v[200:203] offset:2048
  v_add_f32 v142, v10, v142
  v_mov_b32 v133, 0
  v_cvt_pk_bf16_f32 v131, -v142, 0
  v_mul_f32 v140, v140, v12
  v_mul_f32 v140, v140, v12
  v_mfma_f32_32x32x16_bf16 v[176:191], a[240:243], v[130:133], v[176:191]
  v_add_f32 v140, 0x3727c5ac, v140
  ds_write_b128 v224, v[204:207] offset:3072
  v_rsq_f32 v140, v140
  s_nop 0
  v_mul_f32 v140, v140, v12
  v_rcp_f32 v138, v140
  v_mul_f32 v134, 0xc0135761, v140
  v_mul_f32 v136, v140, v140
  v_mul_f32 v136, v136, v134
  v_mul_f32 v136, 0x3d372713, v136
  s_waitcnt lgkmcnt(0)
  s_barrier
  ds_read_b128 v[144:147], v227 offset:0
  ds_read_b128 v[148:151], v227 offset:1024
  ds_read_b128 v[152:155], v227 offset:2048
  ds_read_b128 v[156:159], v227 offset:3072
  s_waitcnt lgkmcnt(3)
  v_pk_add_f32 v[176:177], v[176:177], v[144:145]
  v_pk_add_f32 v[178:179], v[178:179], v[146:147]
  s_waitcnt lgkmcnt(2)
  v_pk_add_f32 v[180:181], v[180:181], v[148:149]
  v_pk_add_f32 v[182:183], v[182:183], v[150:151]
  s_waitcnt lgkmcnt(1)
  v_pk_add_f32 v[184:185], v[184:185], v[152:153]
  v_pk_add_f32 v[186:187], v[186:187], v[154:155]
  s_waitcnt lgkmcnt(0)
  v_pk_add_f32 v[188:189], v[188:189], v[156:157]
  v_pk_add_f32 v[190:191], v[190:191], v[158:159]
  v_pk_mul_f32 v[144:145], v[176:177], v[176:177]
  v_pk_mul_f32 v[146:147], v[178:179], v[178:179]
  v_pk_mul_f32 v[148:149], v[180:181], v[180:181]
  v_pk_mul_f32 v[150:151], v[182:183], v[182:183]
  v_pk_fma_f32 v[144:145], v[144:145], v[136:137], v[134:135] op_sel_hi:[1,0,0]
  v_pk_fma_f32 v[146:147], v[146:147], v[136:137], v[134:135] op_sel_hi:[1,0,0]
  v_pk_fma_f32 v[148:149], v[148:149], v[136:137], v[134:135] op_sel_hi:[1,0,0]
  v_pk_fma_f32 v[150:151], v[150:151], v[136:137], v[134:135] op_sel_hi:[1,0,0]
  v_pk_mul_f32 v[144:145], v[144:145], v[176:177]
  v_pk_mul_f32 v[146:147], v[146:147], v[178:179]
  v_pk_mul_f32 v[148:149], v[148:149], v[180:181]
  v_pk_mul_f32 v[150:151], v[150:151], v[182:183]
  v_exp_f32 v144, v144
  v_exp_f32 v145, v145
  v_exp_f32 v146, v146
  v_exp_f32 v147, v147
  v_exp_f32 v148, v148
  v_exp_f32 v149, v149
  v_exp_f32 v150, v150
  v_exp_f32 v151, v151
  v_pk_fma_f32 v[144:145], v[144:145], v[138:139], v[138:139] op_sel_hi:[1,0,0]
  v_pk_fma_f32 v[146:147], v[146:147], v[138:139], v[138:139] op_sel_hi:[1,0,0]
  v_pk_fma_f32 v[148:149], v[148:149], v[138:139], v[138:139] op_sel_hi:[1,0,0]
  v_pk_fma_f32 v[150:151], v[150:151], v[138:139], v[138:139] op_sel_hi:[1,0,0]
  v_rcp_f32 v144, v144
  v_rcp_f32 v145, v145
  v_rcp_f32 v146, v146
  v_rcp_f32 v147, v147
  v_rcp_f32 v148, v148
  v_rcp_f32 v149, v149
  v_rcp_f32 v150, v150
  v_rcp_f32 v151, v151
  v_pk_mul_f32 v[144:145], v[176:177], v[144:145]
  v_pk_mul_f32 v[146:147], v[178:179], v[146:147]
  v_pk_mul_f32 v[148:149], v[180:181], v[148:149]
  v_pk_mul_f32 v[150:151], v[182:183], v[150:151]
  v_cvt_pk_bf16_f32 v192, v144, v145
  v_cvt_pk_bf16_f32 v193, v146, v147
  v_cvt_pk_bf16_f32 v194, v148, v149
  v_cvt_pk_bf16_f32 v195, v150, v151
  s_cmp_eq_u32 s74, 0
  s_cbranch_scc1 L119
  buffer_store_dwordx4 v[192:195], v216, s[64:67], s24 offen offset:0 nt
L120:
  v_pk_mul_f32 v[144:145], v[184:185], v[184:185]
  v_pk_mul_f32 v[146:147], v[186:187], v[186:187]
  v_pk_mul_f32 v[148:149], v[188:189], v[188:189]
  v_pk_mul_f32 v[150:151], v[190:191], v[190:191]
  v_pk_fma_f32 v[144:145], v[144:145], v[136:137], v[134:135] op_sel_hi:[1,0,0]
  v_pk_fma_f32 v[146:147], v[146:147], v[136:137], v[134:135] op_sel_hi:[1,0,0]
  v_pk_fma_f32 v[148:149], v[148:149], v[136:137], v[134:135] op_sel_hi:[1,0,0]
  v_pk_fma_f32 v[150:151], v[150:151], v[136:137], v[134:135] op_sel_hi:[1,0,0]
  v_pk_mul_f32 v[144:145], v[144:145], v[184:185]
  v_pk_mul_f32 v[146:147], v[146:147], v[186:187]
  v_pk_mul_f32 v[148:149], v[148:149], v[188:189]
  v_pk_mul_f32 v[150:151], v[150:151], v[190:191]
  v_exp_f32 v144, v144
  v_exp_f32 v145, v145
  v_exp_f32 v146, v146
  v_exp_f32 v147, v147
  v_exp_f32 v148, v148
  v_exp_f32 v149, v149
  v_exp_f32 v150, v150
  v_exp_f32 v151, v151
  v_pk_fma_f32 v[144:145], v[144:145], v[138:139], v[138:139] op_sel_hi:[1,0,0]
  v_pk_fma_f32 v[146:147], v[146:147], v[138:139], v[138:139] op_sel_hi:[1,0,0]
  v_pk_fma_f32 v[148:149], v[148:149], v[138:139], v[138:139] op_sel_hi:[1,0,0]
  v_pk_fma_f32 v[150:151], v[150:151], v[138:139], v[138:139] op_sel_hi:[1,0,0]
  v_rcp_f32 v144, v144
  v_rcp_f32 v145, v145
  v_rcp_f32 v146, v146
  v_rcp_f32 v147, v147
  v_rcp_f32 v148, v148
  v_rcp_f32 v149, v149
  v_rcp_f32 v150, v150
  v_rcp_f32 v151, v151
  v_pk_mul_f32 v[144:145], v[184:185], v[144:145]
  v_pk_mul_f32 v[146:147], v[186:187], v[146:147]
  v_pk_mul_f32 v[148:149], v[188:189], v[148:149]
  v_pk_mul_f32 v[150:151], v[190:191], v[150:151]
  v_cvt_pk_bf16_f32 v196, v144, v145
  v_cvt_pk_bf16_f32 v197, v146, v147
  v_cvt_pk_bf16_f32 v198, v148, v149
  v_cvt_pk_bf16_f32 v199, v150, v151
  s_cmp_eq_u32 s74, 0
  s_cbranch_scc1 L121
  buffer_store_dwordx4 v[196:199], v217, s[64:67], s24 offen offset:1024 nt
L122:
  buffer_store_dwordx4 v[192:195], v218, s[64:67], s15 offen sc1
  buffer_store_dwordx4 v[196:199], v219, s[64:67], s15 offen sc1
  s_lshl_b32 s6, s81, 1
  s_add_u32 s6, s6, s80
  s_xor_b32 s7, s6, 1
  s_mul_i32 s18, s7, 14336
  s_mul_i32 s19, s6, 14336
  s_mul_i32 s20, s7, 7168
  s_add_u32 s20, s20, s79
  s_mul_i32 s21, s6, 7168
  s_add_u32 s21, s21, s79
  v_accvgpr_read_b32 v234, a236
  s_add_u32 s88, s73, 0xc0c00
  s_and_b32 s101, s68, 1
  s_xor_b32 s101, s101, 1
  s_mul_i32 s100, s101, 200704
  s_add_u32 s100, s100, s16
  s_mul_i32 s101, s101, 7168
  s_add_u32 s101, s101, s77
  v_add_u32 v230, s18, v228
  v_add_u32 v231, s18, v229
  ds_read_b64_tr_b16 v[16:17], v230 offset:0
  s_add_u32 m0, s101, 0
  s_add_u32 s22, s100, 0
  buffer_load_dwordx4 v236, s[48:51], s22 offen offset:0  lds
  ds_read_b64_tr_b16 v[18:19], v230 offset:1024
  ds_read_b64_tr_b16 v[20:21], v231 offset:0
  ds_read_b64_tr_b16 v[22:23], v231 offset:1024
  buffer_load_dwordx4 v237, s[48:51], s22 offen offset:1024  lds
  ds_read_b64_tr_b16 v[24:25], v230 offset:2048
  ds_read_b64_tr_b16 v[26:27], v230 offset:3072
  ds_read_b64_tr_b16 v[28:29], v231 offset:2048
  buffer_load_dwordx4 v238, s[48:51], s22 offen offset:2048  lds
  ds_read_b64_tr_b16 v[30:31], v231 offset:3072
  ds_read_b64_tr_b16 v[32:33], v230 offset:4096
  buffer_load_dwordx4 v239, s[48:51], s22 offen offset:3072  lds
  ds_read_b64_tr_b16 v[34:35], v230 offset:5120
  ds_read_b64_tr_b16 v[36:37], v231 offset:4096
  ds_read_b64_tr_b16 v[38:39], v231 offset:5120
  s_add_u32 m0, s101, 4096
  s_add_u32 s22, s100, 114688
  buffer_load_dwordx4 v236, s[48:51], s22 offen offset:0  lds
  ds_read_b64_tr_b16 v[40:41], v230 offset:6144
  ds_read_b64_tr_b16 v[42:43], v230 offset:7168
  ds_read_b64_tr_b16 v[44:45], v231 offset:6144
  buffer_load_dwordx4 v237, s[48:51], s22 offen offset:1024  lds
  ds_read_b64_tr_b16 v[46:47], v231 offset:7168
  ds_read_b64_tr_b16 v[48:49], v230 offset:8192
  ds_read_b64_tr_b16 v[50:51], v230 offset:9216
  buffer_load_dwordx4 v238, s[48:51], s22 offen offset:2048  lds
  ds_read_b64_tr_b16 v[52:53], v231 offset:8192
  ds_read_b64_tr_b16 v[54:55], v231 offset:9216
  v_mov_b32 v233, 1
  s_mov_b64 exec, 1
  s_waitcnt vmcnt(9)
  s_barrier
  s_cmp_eq_u32 s74, 0
  s_cbranch_scc1 L123
  buffer_store_dword v233, off, s[64:67], s82 offset:3072
L124:
  s_mov_b64 exec, -1
  buffer_load_dword v235, v234, s[64:67], s88 offen sc1
  s_mov_b32 s95, 131072
  s_mov_b32 s24, s79
  s_add_u32 s24, s24, s84
  s_add_u32 s24, s24, 0x20000
  v_accvgpr_read_b32 v216, a235
  v_pk_add_f32 v[128:129], v[240:241], v[10:11] op_sel_hi:[1,0] neg_lo:[0,1] neg_hi:[0,1]
  v_pk_add_f32 v[130:131], v[242:243], v[10:11] op_sel_hi:[1,0] neg_lo:[0,1] neg_hi:[0,1]
  v_pk_add_f32 v[132:133], v[244:245], v[10:11] op_sel_hi:[1,0] neg_lo:[0,1] neg_hi:[0,1]
  v_pk_add_f32 v[134:135], v[246:247], v[10:11] op_sel_hi:[1,0] neg_lo:[0,1] neg_hi:[0,1]
  v_pk_add_f32 v[136:137], v[248:249], v[10:11] op_sel_hi:[1,0] neg_lo:[0,1] neg_hi:[0,1]
  v_pk_add_f32 v[138:139], v[250:251], v[10:11] op_sel_hi:[1,0] neg_lo:[0,1] neg_hi:[0,1]
  v_pk_add_f32 v[140:141], v[252:253], v[10:11] op_sel_hi:[1,0] neg_lo:[0,1] neg_hi:[0,1]
  v_pk_add_f32 v[142:143], v[254:255], v[10:11] op_sel_hi:[1,0] neg_lo:[0,1] neg_hi:[0,1]
  v_pk_mul_f32 v[128:129], v[128:129], v[12:13] op_sel_hi:[1,0]
  v_pk_mul_f32 v[130:131], v[130:131], v[12:13] op_sel_hi:[1,0]
  v_pk_mul_f32 v[132:133], v[132:133], v[12:13] op_sel_hi:[1,0]
  v_pk_mul_f32 v[134:135], v[134:135], v[12:13] op_sel_hi:[1,0]
  v_pk_mul_f32 v[136:137], v[136:137], v[12:13] op_sel_hi:[1,0]
  v_pk_mul_f32 v[138:139], v[138:139], v[12:13] op_sel_hi:[1,0]
  v_pk_mul_f32 v[140:141], v[140:141], v[12:13] op_sel_hi:[1,0]
  v_pk_mul_f32 v[142:143], v[142:143], v[12:13] op_sel_hi:[1,0]
  ds_read_b64_tr_b16 v[56:57], v230 offset:10240
  ds_read_b64_tr_b16 v[58:59], v230 offset:11264
  ds_read_b64_tr_b16 v[60:61], v231 offset:10240
  ds_read_b64_tr_b16 v[62:63], v231 offset:11264
  ds_read_b64_tr_b16 v[64:65], v230 offset:12288
  ds_read_b64_tr_b16 v[66:67], v230 offset:13312
  ds_read_b64_tr_b16 v[68:69], v231 offset:12288
  ds_read_b64_tr_b16 v[70:71], v231 offset:13312
  v_add_u32 v230, s19, v228
  v_add_u32 v231, s19, v229
  buffer_load_dword v13, v234, s[64:67], s88 offen sc1
L125:
  s_waitcnt vmcnt(1)
  v_cmp_eq_u32 vcc, 0, v235
  s_nop 0
  s_cbranch_vccz L126
  buffer_load_dword v235, v234, s[64:67], s88 offen sc1
  s_waitcnt vmcnt(1)
  v_cmp_eq_u32 vcc, 0, v13
  s_nop 0
  s_cbranch_vccz L126
  buffer_load_dword v13, v234, s[64:67], s88 offen sc1
  s_sub_u32 s95, s95, 1
  s_cbranch_scc0 L125
  s_branch L_abort
L126:
  s_add_u32 s23, s20, 0
  buffer_load_dwordx4 v[144:147], v1, s[64:67], s23 offen offset:0 sc1
  buffer_load_dwordx4 v[148:151], v1, s[64:67], s23 offen offset:1024 sc1
  buffer_load_dwordx4 v[152:155], v1, s[64:67], s23 offen offset:2048 sc1
  buffer_load_dwordx4 v[156:159], v1, s[64:67], s23 offen offset:3072 sc1
  s_add_u32 s23, s20, 4096
  buffer_load_dwordx4 v[160:163], v1, s[64:67], s23 offen offset:0 sc1
  buffer_load_dwordx4 v[164:167], v1, s[64:67], s23 offen offset:1024 sc1
  buffer_load_dwordx4 v[168:171], v1, s[64:67], s23 offen offset:2048 sc1
  ds_read_b64_tr_b16 v[72:73], v230 offset:0
  ds_read_b64_tr_b16 v[74:75], v230 offset:1024
  ds_read_b64_tr_b16 v[76:77], v231 offset:0
  ds_read_b64_tr_b16 v[78:79], v231 offset:1024
  ds_read_b64_tr_b16 v[80:81], v230 offset:2048
  ds_read_b64_tr_b16 v[82:83], v230 offset:3072
  ds_read_b64_tr_b16 v[84:85], v231 offset:2048
  ds_read_b64_tr_b16 v[86:87], v231 offset:3072
  ds_read_b64_tr_b16 v[88:89], v230 offset:4096
  ds_read_b64_tr_b16 v[90:91], v230 offset:5120
  ds_read_b64_tr_b16 v[92:93], v231 offset:4096
  ds_read_b64_tr_b16 v[94:95], v231 offset:5120
  ds_read_b64_tr_b16 v[96:97], v230 offset:6144
  ds_read_b64_tr_b16 v[98:99], v230 offset:7168
  ds_read_b64_tr_b16 v[100:101], v231 offset:6144
  ds_read_b64_tr_b16 v[102:103], v231 offset:7168
  ds_read_b64_tr_b16 v[104:105], v230 offset:8192
  ds_read_b64_tr_b16 v[106:107], v230 offset:9216
  ds_read_b64_tr_b16 v[108:109], v231 offset:8192
  ds_read_b64_tr_b16 v[110:111], v231 offset:9216
  s_waitcnt vmcnt(6) lgkmcnt(15)
  v_mfma_f32_32x32x16_bf16 v[192:207], v[20:23], v[144:147], 0
  s_add_u32 s23, s21, 0
  buffer_load_dwordx4 v[172:175], v216, s[64:67], s23 offen offset:0 sc1
  ds_read_b64_tr_b16 v[112:113], v230 offset:10240
  v_mfma_f32_32x32x16_bf16 v[176:191], v[16:19], v[144:147], v[128:143]
  ds_read_b64_tr_b16 v[114:115], v230 offset:11264
  s_waitcnt vmcnt(6)
  v_mfma_f32_32x32x16_bf16 v[192:207], v[28:31], v[148:151], v[192:207]
  buffer_load_dwordx4 v[144:147], v216, s[64:67], s23 offen offset:1024 sc1
  v_mfma_f32_32x32x16_bf16 v[176:191], v[24:27], v[148:151], v[176:191]
  ds_read_b64_tr_b16 v[116:117], v231 offset:10240
  s_waitcnt vmcnt(6)
  v_mfma_f32_32x32x16_bf16 v[192:207], v[36:39], v[152:155], v[192:207]
  buffer_load_dwordx4 v[148:151], v216, s[64:67], s23 offen offset:2048 sc1
  ds_read_b64_tr_b16 v[118:119], v231 offset:11264
  v_mfma_f32_32x32x16_bf16 v[176:191], v[32:35], v[152:155], v[176:191]
  s_waitcnt vmcnt(6)
  v_mfma_f32_32x32x16_bf16 v[192:207], v[44:47], v[156:159], v[192:207]
  buffer_load_dwordx4 v[152:155], v216, s[64:67], s23 offen offset:3072 sc1
  ds_read_b64_tr_b16 v[120:121], v230 offset:12288
  v_mfma_f32_32x32x16_bf16 v[176:191], v[40:43], v[156:159], v[176:191]
  ds_read_b64_tr_b16 v[122:123], v230 offset:13312
  s_waitcnt vmcnt(6)
  v_mfma_f32_32x32x16_bf16 v[192:207], v[52:55], v[160:163], v[192:207]
  s_add_u32 s23, s21, 4096
  buffer_load_dwordx4 v[156:159], v216, s[64:67], s23 offen offset:0 sc1
  v_mfma_f32_32x32x16_bf16 v[176:191], v[48:51], v[160:163], v[176:191]
  ds_read_b64_tr_b16 v[124:125], v231 offset:12288
  s_waitcnt vmcnt(6)
  v_mfma_f32_32x32x16_bf16 v[192:207], v[60:63], v[164:167], v[192:207]
  buffer_load_dwordx4 v[160:163], v216, s[64:67], s23 offen offset:1024 sc1
  ds_read_b64_tr_b16 v[126:127], v231 offset:13312
  v_mfma_f32_32x32x16_bf16 v[176:191], v[56:59], v[164:167], v[176:191]
  s_waitcnt vmcnt(6)
  v_mfma_f32_32x32x16_bf16 v[192:207], v[68:71], v[168:171], v[192:207]
  buffer_load_dwordx4 v[164:167], v216, s[64:67], s23 offen offset:2048 sc1
  v_mfma_f32_32x32x16_bf16 v[176:191], v[64:67], v[168:171], v[176:191]
  s_waitcnt vmcnt(6)
  v_max_u32 v217, v172, v173
  v_max3_u32 v217, v217, v174, v175
  v_cmp_eq_u32 vcc, -1, v217
  s_nop 0
  s_cbranch_vccnz L127
L128:
  s_waitcnt lgkmcnt(0)
  s_barrier
  v_mfma_f32_32x32x16_bf16 v[192:207], v[76:79], v[172:175], v[192:207]
  s_and_b32 s101, s68, 1
  s_mul_i32 s100, s101, 200704
  s_add_u32 s100, s100, s16
  s_mul_i32 s101, s101, 7168
  s_add_u32 s101, s101, s76
  s_add_u32 m0, s101, 0
  s_add_u32 s22, s100, 1792
  buffer_load_dwordx4 v236, s[48:51], s22 offen offset:0  lds
  v_mfma_f32_32x32x16_bf16 v[176:191], v[72:75], v[172:175], v[176:191]
  s_waitcnt vmcnt(6)
  v_mfma_f32_32x32x16_bf16 v[192:207], v[84:87], v[144:147], v[192:207]
  buffer_load_dwordx4 v237, s[48:51], s22 offen offset:1024  lds
  v_max3_u32 v217, v217, v144, v145
  v_max3_u32 v217, v217, v146, v147
  s_waitcnt vmcnt(6)
  v_mfma_f32_32x32x16_bf16 v[192:207], v[92:95], v[148:151], v[192:207]
  buffer_load_dwordx4 v238, s[48:51], s22 offen offset:2048  lds
  v_max3_u32 v217, v217, v148, v149
  v_max3_u32 v217, v217, v150, v151
  s_waitcnt vmcnt(6)
  v_mfma_f32_32x32x16_bf16 v[192:207], v[100:103], v[152:155], v[192:207]
  buffer_load_dwordx4 v239, s[48:51], s22 offen offset:3072  lds
  v_max3_u32 v217, v217, v152, v153
  v_max3_u32 v217, v217, v154, v155
  s_waitcnt vmcnt(6)
  v_mfma_f32_32x32x16_bf16 v[192:207], v[108:111], v[156:159], v[192:207]
  s_add_u32 m0, s101, 4096
  s_add_u32 s22, s100, 116480
  buffer_load_dwordx4 v236, s[48:51], s22 offen offset:0  lds
  v_max3_u32 v217, v217, v156, v157
  v_max3_u32 v217, v217, v158, v159
  s_waitcnt vmcnt(6)
  v_mfma_f32_32x32x16_bf16 v[192:207], v[116:119], v[160:163], v[192:207]
  buffer_load_dwordx4 v237, s[48:51], s22 offen offset:1024  lds
  v_max3_u32 v217, v217, v160, v161
  v_max3_u32 v217, v217, v162, v163
  s_waitcnt vmcnt(6)
  v_mfma_f32_32x32x16_bf16 v[192:207], v[124:127], v[164:167], v[192:207]
  buffer_load_dwordx4 v238, s[48:51], s22 offen offset:2048  lds
  v_max3_u32 v217, v217, v164, v165
  v_max3_u32 v217, v217, v166, v167
  v_cmp_eq_u32 vcc, -1, v217
  s_nop 0
  s_cbranch_vccnz L129
L130:
  v_mfma_f32_32x32x16_bf16 v[176:191], v[80:83], v[144:147], v[176:191]
  v_mfma_f32_32x32x16_bf16 v[176:191], v[88:91], v[148:151], v[176:191]
  s_nop 3
  ds_write_b128 v224, v[192:195] offset:0
  v_mfma_f32_32x32x16_bf16 v[176:191], v[96:99], v[152:155], v[176:191]
  ds_write_b128 v224, v[196:199] offset:1024
  v_mfma_f32_32x32x16_bf16 v[176:191], v[104:107], v[156:159], v[176:191]
  ds_write_b128 v224, v[200:203] offset:2048
  v_mfma_f32_32x32x16_bf16 v[176:191], v[112:115], v[160:163], v[176:191]
  ds_write_b128 v224, v[204:207] offset:3072
  v_mfma_f32_32x32x16_bf16 v[176:191], v[120:123], v[164:167], v[176:191]
  s_waitcnt lgkmcnt(0)
  s_barrier
  ds_read_b128 v[144:147], v227 offset:0
  ds_read_b128 v[148:151], v227 offset:1024
  ds_read_b128 v[152:155], v227 offset:2048
  ds_read_b128 v[156:159], v227 offset:3072
  s_waitcnt lgkmcnt(3)
  s_nop 4
  v_pk_add_f32 v[176:177], v[176:177], v[144:145]
  v_pk_add_f32 v[178:179], v[178:179], v[146:147]
  s_waitcnt lgkmcnt(2)
  v_pk_add_f32 v[180:181], v[180:181], v[148:149]
  v_pk_add_f32 v[182:183], v[182:183], v[150:151]
  s_waitcnt lgkmcnt(1)
  v_pk_add_f32 v[184:185], v[184:185], v[152:153]
  v_pk_add_f32 v[186:187], v[186:187], v[154:155]
  s_waitcnt lgkmcnt(0)
  v_pk_add_f32 v[188:189], v[188:189], v[156:157]
  v_pk_add_f32 v[190:191], v[190:191], v[158:159]
  v_cvt_pk_bf16_f32 v192, v176, v177
  v_cvt_pk_bf16_f32 v193, v178, v179
  v_cvt_pk_bf16_f32 v194, v180, v181
  v_cvt_pk_bf16_f32 v195, v182, v183
  v_cvt_pk_bf16_f32 v196, v184, v185
  v_cvt_pk_bf16_f32 v197, v186, v187
  v_cvt_pk_bf16_f32 v198, v188, v189
  v_cvt_pk_bf16_f32 v199, v190, v191
  s_cmp_eq_u32 s74, 0
  s_cbranch_scc1 L131
  buffer_store_dwordx4 v[192:195], v1, s[64:67], s24 offen offset:0 nt
  buffer_store_dwordx4 v[196:199], v1, s[64:67], s24 offen offset:1024 nt
L132:
  v_accvgpr_read_b32 v234, a237
  s_add_u32 s88, s73, 0xc0d00
  s_and_b32 s101, s68, 1
  s_xor_b32 s101, s101, 1
  s_mul_i32 s100, s101, 200704
  s_add_u32 s100, s100, s16
  s_mul_i32 s101, s101, 7168
  s_add_u32 s101, s101, s76
  v_pk_add_f32 v[144:145], v[176:177], v[178:179]
  v_pk_mul_f32 v[146:147], v[176:177], v[176:177]
  v_pk_fma_f32 v[146:147], v[178:179], v[178:179], v[146:147]
  v_pk_add_f32 v[144:145], v[144:145], v[180:181]
  s_add_u32 m0, s101, 0
  s_add_u32 s22, s100, 1792
  buffer_load_dwordx4 v236, s[48:51], s22 offen offset:0  lds
  v_pk_fma_f32 v[146:147], v[180:181], v[180:181], v[146:147]
  v_pk_add_f32 v[144:145], v[144:145], v[182:183]
  v_pk_fma_f32 v[146:147], v[182:183], v[182:183], v[146:147]
  v_pk_add_f32 v[144:145], v[144:145], v[184:185]
  buffer_load_dwordx4 v237, s[48:51], s22 offen offset:1024  lds
  v_pk_fma_f32 v[146:147], v[184:185], v[184:185], v[146:147]
  v_pk_add_f32 v[144:145], v[144:145], v[186:187]
  v_pk_fma_f32 v[146:147], v[186:187], v[186:187], v[146:147]
  buffer_load_dwordx4 v238, s[48:51], s22 offen offset:2048  lds
  v_pk_add_f32 v[144:145], v[144:145], v[188:189]
  v_pk_fma_f32 v[146:147], v[188:189], v[188:189], v[146:147]
  v_pk_add_f32 v[144:145], v[144:145], v[190:191]
  v_pk_fma_f32 v[146:147], v[190:191], v[190:191], v[146:147]
  buffer_load_dwordx4 v239, s[48:51], s22 offen offset:3072  lds
  v_add_f32 v144, v144, v145
  v_add_f32 v146, v146, v147
  v_add_u32 v145, s83, v2
  s_nop 0
  v_permlane32_swap_b32 v144, v146
  s_add_u32 m0, s101, 4096
  s_add_u32 s22, s100, 116480
  buffer_load_dwordx4 v236, s[48:51], s22 offen offset:0  lds
  v_add_f32 v232, v144, v146
  ds_write_b32 v145, v232
  v_pk_add_f32 v[240:241], v[240:241], v[176:177]
  buffer_load_dwordx4 v237, s[48:51], s22 offen offset:1024  lds
  v_pk_add_f32 v[242:243], v[242:243], v[178:179]
  v_pk_add_f32 v[244:245], v[244:245], v[180:181]
  v_pk_add_f32 v[246:247], v[246:247], v[182:183]
  v_pk_add_f32 v[248:249], v[248:249], v[184:185]
  buffer_load_dwordx4 v238, s[48:51], s22 offen offset:2048  lds
  v_pk_add_f32 v[250:251], v[250:251], v[186:187]
  v_pk_add_f32 v[252:253], v[252:253], v[188:189]
  v_pk_add_f32 v[254:255], v[254:255], v[190:191]
  v_mov_b32 v233, 1
  s_lshl_b32 s89, s70, 12
  s_lshl_b32 s3, s80, 11
  s_add_u32 s89, s89, s3
  s_lshl_b32 s3, s71, 8
  s_add_u32 s89, s89, s3
  s_add_u32 s89, s89, s73
  s_add_u32 s89, s89, 0xb8000
  s_cmp_eq_u32 s81, 1
  s_cselect_b32 s89, s89, 0x7f000000
  s_sub_u32 s4, s83, 12288
  v_add_u32 v14, s4, v2
  s_waitcnt lgkmcnt(0)
  s_mov_b64 exec, 1
  s_waitcnt vmcnt(7)
  s_barrier
  s_cmp_eq_u32 s74, 0
  s_cbranch_scc1 L133
  buffer_store_dword v233, off, s[64:67], s82 offset:3328
L134:
  s_mov_b64 exec, -1
  ds_read_b32 v14, v14
  buffer_load_dword v235, v234, s[64:67], s88 offen sc1
  s_mov_b32 s95, 131072
  s_waitcnt lgkmcnt(0)
  v_add_f32 v14, v14, v232
  s_cmp_eq_u32 s74, 0
  s_cbranch_scc1 L137
  buffer_store_dword v14, v2, s[64:67], s89 offen
L138:
  v_accvgpr_read_b32 v230, a225
  v_xor_b32 v231, 64, v230
  v_add_u32 v228, 57344, v230
  v_add_u32 v229, 57344, v231
  ds_read_b64_tr_b16 v[192:193], v228 offset:0
  ds_read_b64_tr_b16 v[194:195], v228 offset:1024
  ds_read_b64_tr_b16 v[196:197], v229 offset:0
  ds_read_b64_tr_b16 v[198:199], v229 offset:1024
  ds_read_b64_tr_b16 v[200:201], v228 offset:2048
  ds_read_b64_tr_b16 v[202:203], v228 offset:3072
  ds_read_b64_tr_b16 v[204:205], v229 offset:2048
  ds_read_b64_tr_b16 v[206:207], v229 offset:3072
  ds_read_b64_tr_b16 v[208:209], v228 offset:4096
  ds_read_b64_tr_b16 v[210:211], v228 offset:5120
  s_lshl_b32 s7, s72, 15
  s_add_u32 s7, s7, s73
  s_add_u32 s7, s7, 0x20000
  s_lshl_b32 s8, s72, 11
  s_add_u32 s8, s8, s73
  s_add_u32 s8, s8, 0xb8000
  s_mul_i32 s10, s72, 114688
  s_lshl_b32 s3, s0, 12
  s_add_u32 s10, s10, s3
  s_add_u32 s10, s10, s73
  s_add_u32 s10, s10, 0x40000
  s_add_u32 s11, s10, 0xe000
  buffer_load_dword v13, v234, s[64:67], s88 offen sc1
L135:
  s_waitcnt vmcnt(1)
  v_cmp_eq_u32 vcc, 0, v235
  s_nop 0
  s_cbranch_vccz L136
  buffer_load_dword v235, v234, s[64:67], s88 offen sc1
  s_waitcnt vmcnt(1)
  v_cmp_eq_u32 vcc, 0, v13
  s_nop 0
  s_cbranch_vccz L136
  buffer_load_dword v13, v234, s[64:67], s88 offen sc1
  s_sub_u32 s95, s95, 1
  s_cbranch_scc0 L135
  s_branch L_abort
L136:
  buffer_load_dwordx4 v[16:19], v1, s[64:67], s7 offen offset:0 sc1
  buffer_load_dwordx4 v[20:23], v1, s[64:67], s7 offen offset:1024 sc1
  buffer_load_dwordx4 v[24:27], v1, s[64:67], s7 offen offset:2048 sc1
  buffer_load_dwordx4 v[28:31], v1, s[64:67], s7 offen offset:3072 sc1
  s_add_u32 s7, s7, 4096
  buffer_load_dwordx4 v[32:35], v1, s[64:67], s7 offen offset:0 sc1
  buffer_load_dwordx4 v[36:39], v1, s[64:67], s7 offen offset:1024 sc1
  buffer_load_dwordx4 v[40:43], v1, s[64:67], s7 offen offset:2048 sc1
  s_waitcnt lgkmcnt(0)
  s_barrier
  s_waitcnt vmcnt(6)
  v_mfma_f32_32x32x16_bf16 v[128:143], v[192:195], v[16:19], 0
  ds_read_b64_tr_b16 v[212:213], v229 offset:4096
  ds_read_b64_tr_b16 v[214:215], v229 offset:5120
  buffer_load_dwordx4 v[44:47], v1, s[64:67], s7 offen offset:3072 sc1
  v_mfma_f32_32x32x16_bf16 v[144:159], v[196:199], v[16:19], 0
  ds_read_b64_tr_b16 v[192:193], v228 offset:6144
  ds_read_b64_tr_b16 v[194:195], v228 offset:7168
  s_waitcnt vmcnt(6)
  v_mfma_f32_32x32x16_bf16 v[128:143], v[200:203], v[20:23], v[128:143]
  ds_read_b64_tr_b16 v[196:197], v229 offset:6144
  ds_read_b64_tr_b16 v[198:199], v229 offset:7168
  s_add_u32 s7, s7, 4096
  buffer_load_dwordx4 v[48:51], v1, s[64:67], s7 offen offset:0 sc1
  v_mfma_f32_32x32x16_bf16 v[144:159], v[204:207], v[20:23], v[144:159]
  ds_read_b64_tr_b16 v[200:201], v230 offset:0
  ds_read_b64_tr_b16 v[202:203], v230 offset:1024
  s_waitcnt vmcnt(6)
  v_mfma_f32_32x32x16_bf16 v[128:143], v[208:211], v[24:27], v[128:143]
  ds_read_b64_tr_b16 v[204:205], v228 offset:8192
  ds_read_b64_tr_b16 v[206:207], v228 offset:9216
  buffer_load_dwordx4 v[52:55], v1, s[64:67], s7 offen offset:1024 sc1
  s_waitcnt lgkmcnt(8)
  v_mfma_f32_32x32x16_bf16 v[144:159], v[212:215], v[24:27], v[144:159]
  ds_read_b64_tr_b16 v[208:209], v229 offset:8192
  ds_read_b64_tr_b16 v[210:211], v229 offset:9216
  s_waitcnt vmcnt(6) lgkmcnt(8)
  v_mfma_f32_32x32x16_bf16 v[128:143], v[192:195], v[28:31], v[128:143]
  ds_read_b64_tr_b16 v[212:213], v228 offset:10240
  ds_read_b64_tr_b16 v[214:215], v228 offset:11264
  buffer_load_dwordx4 v[56:59], v1, s[64:67], s7 offen offset:2048 sc1
  s_waitcnt lgkmcnt(8)
  v_mfma_f32_32x32x16_bf16 v[144:159], v[196:199], v[28:31], v[144:159]
  ds_read_b64_tr_b16 v[192:193], v229 offset:10240
  ds_read_b64_tr_b16 v[194:195], v229 offset:11264
  s_waitcnt lgkmcnt(8)
  v_mfma_f32_32x32x16_bf16 v[160:175], v[200:203], v[16:19], 0
  ds_read_b64_tr_b16 v[196:197], v228 offset:12288
  ds_read_b64_tr_b16 v[198:199], v228 offset:13312
  s_waitcnt vmcnt(6) lgkmcnt(8)
  v_mfma_f32_32x32x16_bf16 v[128:143], v[204:207], v[32:35], v[128:143]
  ds_read_b64_tr_b16 v[200:201], v229 offset:12288
  ds_read_b64_tr_b16 v[202:203], v229 offset:13312
  buffer_load_dwordx4 v[60:63], v1, s[64:67], s7 offen offset:3072 sc1
  s_waitcnt lgkmcnt(8)
  v_mfma_f32_32x32x16_bf16 v[144:159], v[208:211], v[32:35], v[144:159]
  ds_read_b64_tr_b16 v[204:205], v230 offset:2048
  ds_read_b64_tr_b16 v[206:207], v230 offset:3072
  s_waitcnt vmcnt(6) lgkmcnt(8)
  v_mfma_f32_32x32x16_bf16 v[128:143], v[212:215], v[36:39], v[128:143]
  ds_read_b64_tr_b16 v[208:209], v228 offset:14336
  ds_read_b64_tr_b16 v[210:211], v228 offset:15360
  s_add_u32 s7, s7, 4096
  buffer_load_dwordx4 v[64:67], v1, s[64:67], s7 offen offset:0 sc1
  s_waitcnt lgkmcnt(8)
  v_mfma_f32_32x32x16_bf16 v[144:159], v[192:195], v[36:39], v[144:159]
  ds_read_b64_tr_b16 v[212:213], v229 offset:14336
  ds_read_b64_tr_b16 v[214:215], v229 offset:15360
  buffer_load_dword v176, v2, s[64:67], s8 offen offset:0 sc1
  buffer_load_dword v177, v2, s[64:67], s8 offen offset:256 sc1
  s_waitcnt vmcnt(8) lgkmcnt(8)
  v_mfma_f32_32x32x16_bf16 v[128:143], v[196:199], v[40:43], v[128:143]
  ds_read_b64_tr_b16 v[192:193], v228 offset:16384
  ds_read_b64_tr_b16 v[194:195], v228 offset:17408
  buffer_load_dwordx4 v[68:71], v1, s[64:67], s7 offen offset:1024 sc1
  s_waitcnt lgkmcnt(8)
  v_mfma_f32_32x32x16_bf16 v[144:159], v[200:203], v[40:43], v[144:159]
  ds_read_b64_tr_b16 v[196:197], v229 offset:16384
  ds_read_b64_tr_b16 v[198:199], v229 offset:17408
  buffer_load_dword v178, v2, s[64:67], s8 offen offset:512 sc1
  buffer_load_dword v179, v2, s[64:67], s8 offen offset:768 sc1
  s_waitcnt lgkmcnt(8)
  v_mfma_f32_32x32x16_bf16 v[160:175], v[204:207], v[20:23], v[160:175]
  ds_read_b64_tr_b16 v[200:201], v230 offset:4096
  ds_read_b64_tr_b16 v[202:203], v230 offset:5120
  s_waitcnt vmcnt(10) lgkmcnt(8)
  v_mfma_f32_32x32x16_bf16 v[128:143], v[208:211], v[44:47], v[128:143]
  ds_read_b64_tr_b16 v[204:205], v228 offset:18432
  ds_read_b64_tr_b16 v[206:207], v228 offset:19456
  buffer_load_dwordx4 v[72:75], v1, s[64:67], s7 offen offset:2048 sc1
  s_waitcnt lgkmcnt(8)
  v_mfma_f32_32x32x16_bf16 v[144:159], v[212:215], v[44:47], v[144:159]
  ds_read_b64_tr_b16 v[208:209], v229 offset:18432
  ds_read_b64_tr_b16 v[210:211], v229 offset:19456
  buffer_load_dword v180, v2, s[64:67], s8 offen offset:1024 sc1
  buffer_load_dword v181, v2, s[64:67], s8 offen offset:1280 sc1
  s_waitcnt vmcnt(12) lgkmcnt(8)
  v_mfma_f32_32x32x16_bf16 v[128:143], v[192:195], v[48:51], v[128:143]
  ds_read_b64_tr_b16 v[212:213], v228 offset:20480
  ds_read_b64_tr_b16 v[214:215], v228 offset:21504
  buffer_load_dwordx4 v[76:79], v1, s[64:67], s7 offen offset:3072 sc1
  s_waitcnt lgkmcnt(8)
  v_mfma_f32_32x32x16_bf16 v[144:159], v[196:199], v[48:51], v[144:159]
  ds_read_b64_tr_b16 v[192:193], v229 offset:20480
  ds_read_b64_tr_b16 v[194:195], v229 offset:21504
  buffer_load_dword v182, v2, s[64:67], s8 offen offset:1536 sc1
  s_waitcnt lgkmcnt(8)
  v_mfma_f32_32x32x16_bf16 v[160:175], v[200:203], v[24:27], v[160:175]
  ds_read_b64_tr_b16 v[196:197], v228 offset:22528
  ds_read_b64_tr_b16 v[198:199], v228 offset:23552
  s_waitcnt vmcnt(13) lgkmcnt(8)
  v_mfma_f32_32x32x16_bf16 v[128:143], v[204:207], v[52:55], v[128:143]
  ds_read_b64_tr_b16 v[200:201], v229 offset:22528
  ds_read_b64_tr_b16 v[202:203], v229 offset:23552
  s_add_u32 s7, s7, 4096
  buffer_load_dwordx4 v[80:83], v1, s[64:67], s7 offen offset:0 sc1
  s_waitcnt lgkmcnt(8)
  v_mfma_f32_32x32x16_bf16 v[144:159], v[208:211], v[52:55], v[144:159]
  ds_read_b64_tr_b16 v[204:205], v230 offset:6144
  ds_read_b64_tr_b16 v[206:207], v230 offset:7168
  s_mul_i32 s21, s70, 229376
  s_mul_i32 s3, s80, 114688
  s_add_u32 s21, s21, s3
  s_mul_i32 s3, s72, 14336
  s_add_u32 s21, s21, s3
  s_add_u32 s21, s21, s73
  s_add_u32 s21, s21, 0x40000
  s_waitcnt vmcnt(13) lgkmcnt(8)
  v_mfma_f32_32x32x16_bf16 v[128:143], v[212:215], v[56:59], v[128:143]
  ds_read_b64_tr_b16 v[208:209], v228 offset:24576
  ds_read_b64_tr_b16 v[210:211], v228 offset:25600
  buffer_load_dwordx4 v[84:87], v1, s[64:67], s7 offen offset:1024 sc1
  s_waitcnt lgkmcnt(8)
  v_mfma_f32_32x32x16_bf16 v[144:159], v[192:195], v[56:59], v[144:159]
  ds_read_b64_tr_b16 v[212:213], v229 offset:24576
  ds_read_b64_tr_b16 v[214:215], v229 offset:25600
  s_xor_b32 s4, s80, 1
  s_mul_i32 s20, s70, 229376
  s_mul_i32 s3, s4, 114688
  s_add_u32 s20, s20, s3
  s_mul_i32 s3, s72, 14336
  s_add_u32 s20, s20, s3
  s_add_u32 s20, s20, s73
  s_add_u32 s20, s20, 0x40000
  s_waitcnt vmcnt(13) lgkmcnt(8)
  v_mfma_f32_32x32x16_bf16 v[128:143], v[196:199], v[60:63], v[128:143]
  ds_read_b64_tr_b16 v[192:193], v228 offset:26624
  ds_read_b64_tr_b16 v[194:195], v228 offset:27648
  buffer_load_dwordx4 v[88:91], v1, s[64:67], s7 offen offset:2048 sc1
  s_waitcnt lgkmcnt(8)
  v_mfma_f32_32x32x16_bf16 v[144:159], v[200:203], v[60:63], v[144:159]
  ds_read_b64_tr_b16 v[196:197], v229 offset:26624
  ds_read_b64_tr_b16 v[198:199], v229 offset:27648
  s_and_b32 s4, s71, 0
  s_mul_i32 s4, s4, 7168
  s_sub_u32 s18, s20, s4
  s_add_u32 s20, s20, s4
  s_sub_u32 s19, s21, s4
  s_add_u32 s21, s21, s4
  s_waitcnt lgkmcnt(8)
  v_mfma_f32_32x32x16_bf16 v[160:175], v[204:207], v[28:31], v[160:175]
  ds_read_b64_tr_b16 v[200:201], v230 offset:8192
  ds_read_b64_tr_b16 v[202:203], v230 offset:9216
  s_waitcnt vmcnt(13) lgkmcnt(8)
  v_mfma_f32_32x32x16_bf16 v[128:143], v[208:211], v[64:67], v[128:143]
  ds_read_b64_tr_b16 v[204:205], v228 offset:28672
  ds_read_b64_tr_b16 v[206:207], v228 offset:29696
  buffer_load_dwordx4 v[92:95], v1, s[64:67], s7 offen offset:3072 sc1
  s_waitcnt lgkmcnt(8)
  v_mfma_f32_32x32x16_bf16 v[144:159], v[212:215], v[64:67], v[144:159]
  ds_read_b64_tr_b16 v[208:209], v229 offset:28672
  ds_read_b64_tr_b16 v[210:211], v229 offset:29696
  s_waitcnt vmcnt(11) lgkmcnt(8)
  v_mfma_f32_32x32x16_bf16 v[128:143], v[192:195], v[68:71], v[128:143]
  ds_read_b64_tr_b16 v[212:213], v228 offset:30720
  ds_read_b64_tr_b16 v[214:215], v228 offset:31744
  s_add_u32 s7, s7, 4096
  buffer_load_dwordx4 v[96:99], v1, s[64:67], s7 offen offset:0 sc1
  s_waitcnt lgkmcnt(8)
  v_mfma_f32_32x32x16_bf16 v[144:159], v[196:199], v[68:71], v[144:159]
  ds_read_b64_tr_b16 v[192:193], v229 offset:30720
  ds_read_b64_tr_b16 v[194:195], v229 offset:31744
  v_accvgpr_read_b32 v13, a238
  s_waitcnt lgkmcnt(8)
  v_mfma_f32_32x32x16_bf16 v[160:175], v[200:203], v[32:35], v[160:175]
  ds_read_b64_tr_b16 v[196:197], v228 offset:32768
  ds_read_b64_tr_b16 v[198:199], v228 offset:33792
  s_waitcnt vmcnt(9) lgkmcnt(8)
  v_mfma_f32_32x32x16_bf16 v[128:143], v[204:207], v[72:75], v[128:143]
  ds_read_b64_tr_b16 v[200:201], v229 offset:32768
  ds_read_b64_tr_b16 v[202:203], v229 offset:33792
  buffer_load_dwordx4 v[100:103], v1, s[64:67], s7 offen offset:1024 sc1
  s_waitcnt lgkmcnt(8)
  v_mfma_f32_32x32x16_bf16 v[144:159], v[208:211], v[72:75], v[144:159]
  ds_read_b64_tr_b16 v[204:205], v230 offset:10240
  ds_read_b64_tr_b16 v[206:207], v230 offset:11264
  s_add_u32 s88, s73, 0xc0e00
  s_waitcnt vmcnt(7) lgkmcnt(8)
  v_mfma_f32_32x32x16_bf16 v[128:143], v[212:215], v[76:79], v[128:143]
  ds_read_b64_tr_b16 v[208:209], v228 offset:34816
  ds_read_b64_tr_b16 v[210:211], v228 offset:35840
  buffer_load_dwordx4 v[104:107], v1, s[64:67], s7 offen offset:2048 sc1
  s_waitcnt lgkmcnt(8)
  v_mfma_f32_32x32x16_bf16 v[144:159], v[192:195], v[76:79], v[144:159]
  ds_read_b64_tr_b16 v[212:213], v229 offset:34816
  ds_read_b64_tr_b16 v[214:215], v229 offset:35840
  s_add_u32 s89, s73, 0xc0900
  s_waitcnt vmcnt(6) lgkmcnt(8)
  v_mfma_f32_32x32x16_bf16 v[128:143], v[196:199], v[80:83], v[128:143]
  ds_read_b64_tr_b16 v[192:193], v228 offset:36864
  ds_read_b64_tr_b16 v[194:195], v228 offset:37888
  buffer_load_dwordx4 v[108:111], v1, s[64:67], s7 offen offset:3072 sc1
  s_waitcnt lgkmcnt(8)
  v_mfma_f32_32x32x16_bf16 v[144:159], v[200:203], v[80:83], v[144:159]
  ds_read_b64_tr_b16 v[196:197], v229 offset:36864
  ds_read_b64_tr_b16 v[198:199], v229 offset:37888
  s_waitcnt lgkmcnt(8)
  v_mfma_f32_32x32x16_bf16 v[160:175], v[204:207], v[36:39], v[160:175]
  ds_read_b64_tr_b16 v[200:201], v230 offset:12288
  ds_read_b64_tr_b16 v[202:203], v230 offset:13312
  s_waitcnt vmcnt(6) lgkmcnt(8)
  v_mfma_f32_32x32x16_bf16 v[128:143], v[208:211], v[84:87], v[128:143]
  ds_read_b64_tr_b16 v[204:205], v228 offset:38912
  ds_read_b64_tr_b16 v[206:207], v228 offset:39936
  s_add_u32 s7, s7, 4096
  buffer_load_dwordx4 v[112:115], v1, s[64:67], s7 offen offset:0 sc1
  v_max3_u32 v239, v176, v177, v178
  v_max3_u32 v238, v179, v180, v181
  s_waitcnt lgkmcnt(8)
  v_mfma_f32_32x32x16_bf16 v[144:159], v[212:215], v[84:87], v[144:159]
  ds_read_b64_tr_b16 v[208:209], v229 offset:38912
  ds_read_b64_tr_b16 v[210:211], v229 offset:39936
  v_max3_u32 v239, v239, v238, v182
  v_cmp_eq_u32 vcc, -1, v239
  s_nop 0
  s_cbranch_vccnz L139
L140:
  s_waitcnt vmcnt(6) lgkmcnt(8)
  v_mfma_f32_32x32x16_bf16 v[128:143], v[192:195], v[88:91], v[128:143]
  ds_read_b64_tr_b16 v[212:213], v228 offset:40960
  ds_read_b64_tr_b16 v[214:215], v228 offset:41984
  buffer_load_dwordx4 v[116:119], v1, s[64:67], s7 offen offset:1024 sc1
  v_add_f32 v238, v176, v177
  s_waitcnt lgkmcnt(8)
  v_mfma_f32_32x32x16_bf16 v[144:159], v[196:199], v[88:91], v[144:159]
  ds_read_b64_tr_b16 v[192:193], v229 offset:40960
  ds_read_b64_tr_b16 v[194:195], v229 offset:41984
  v_add_f32 v239, v178, v179
  v_add_f32 v238, v238, v180
  s_waitcnt lgkmcnt(8)
  v_mfma_f32_32x32x16_bf16 v[160:175], v[200:203], v[40:43], v[160:175]
  ds_read_b64_tr_b16 v[196:197], v228 offset:43008
  ds_read_b64_tr_b16 v[198:199], v228 offset:44032
  s_waitcnt vmcnt(6) lgkmcnt(8)
  v_mfma_f32_32x32x16_bf16 v[128:143], v[204:207], v[92:95], v[128:143]
  ds_read_b64_tr_b16 v[200:201], v229 offset:43008
  ds_read_b64_tr_b16 v[202:203], v229 offset:44032
  buffer_load_dwordx4 v[120:123], v1, s[64:67], s7 offen offset:2048 sc1
  v_add_f32 v239, v239, v181
  v_add_f32 v238, v238, v182
  s_waitcnt lgkmcnt(8)
  v_mfma_f32_32x32x16_bf16 v[144:159], v[208:211], v[92:95], v[144:159]
  ds_read_b64_tr_b16 v[204:205], v230 offset:14336
  ds_read_b64_tr_b16 v[206:207], v230 offset:15360
  v_add_f32 v238, v238, v239
  s_waitcnt vmcnt(6) lgkmcnt(8)
  v_mfma_f32_32x32x16_bf16 v[128:143], v[212:215], v[96:99], v[128:143]
  ds_read_b64_tr_b16 v[208:209], v228 offset:45056
  ds_read_b64_tr_b16 v[210:211], v228 offset:46080
  buffer_load_dwordx4 v[124:127], v1, s[64:67], s7 offen offset:3072 sc1
  v_mov_b32 v239, v238
  s_nop 1
  v_permlane32_swap_b32 v238, v239
  s_waitcnt lgkmcnt(8)
  v_mfma_f32_32x32x16_bf16 v[144:159], v[192:195], v[96:99], v[144:159]
  ds_read_b64_tr_b16 v[212:213], v229 offset:45056
  ds_read_b64_tr_b16 v[214:215], v229 offset:46080
  v_mul_f32 v232, 0x3b124925, v238
  v_mul_f32 v239, 0x3b124925, v239
  s_waitcnt vmcnt(6) lgkmcnt(8)
  v_mfma_f32_32x32x16_bf16 v[128:143], v[196:199], v[100:103], v[128:143]
  ds_read_b64_tr_b16 v[192:193], v228 offset:47104
  ds_read_b64_tr_b16 v[194:195], v228 offset:48128
  v_fma_f32 v238, -v232, v232, v239
  s_waitcnt lgkmcnt(8)
  v_mfma_f32_32x32x16_bf16 v[144:159], v[200:203], v[100:103], v[144:159]
  ds_read_b64_tr_b16 v[196:197], v229 offset:47104
  ds_read_b64_tr_b16 v[198:199], v229 offset:48128
  v_max_f32 v238, 0, v238
  v_add_f32 v238, 0x3727c5ac, v238
  s_waitcnt lgkmcnt(8)
  v_mfma_f32_32x32x16_bf16 v[160:175], v[204:207], v[44:47], v[160:175]
  ds_read_b64_tr_b16 v[200:201], v230 offset:16384
  ds_read_b64_tr_b16 v[202:203], v230 offset:17408
  s_waitcnt vmcnt(5) lgkmcnt(8)
  v_mfma_f32_32x32x16_bf16 v[128:143], v[208:211], v[104:107], v[128:143]
  ds_read_b64_tr_b16 v[204:205], v228 offset:49152
  ds_read_b64_tr_b16 v[206:207], v228 offset:50176
  v_rsq_f32 v238, v238
  v_cvt_pk_bf16_f32 v218, -v232, -v232
  s_waitcnt lgkmcnt(8)
  v_mfma_f32_32x32x16_bf16 v[144:159], v[212:215], v[104:107], v[144:159]
  ds_read_b64_tr_b16 v[208:209], v229 offset:49152
  ds_read_b64_tr_b16 v[210:211], v229 offset:50176
  v_mov_b32 v216, 0
  s_waitcnt vmcnt(4) lgkmcnt(8)
  v_mfma_f32_32x32x16_bf16 v[128:143], v[192:195], v[108:111], v[128:143]
  ds_read_b64_tr_b16 v[212:213], v228 offset:51200
  ds_read_b64_tr_b16 v[214:215], v228 offset:52224
  v_mov_b32 v217, 0
  v_lshlrev_b32 v239, 16, v218
  s_waitcnt lgkmcnt(8)
  v_mfma_f32_32x32x16_bf16 v[144:159], v[196:199], v[108:111], v[144:159]
  ds_read_b64_tr_b16 v[192:193], v229 offset:51200
  ds_read_b64_tr_b16 v[194:195], v229 offset:52224
  v_mov_b32 v220, 0
  v_add_f32 v239, v232, v239
  s_waitcnt lgkmcnt(8)
  v_mfma_f32_32x32x16_bf16 v[160:175], v[200:203], v[48:51], v[160:175]
  ds_read_b64_tr_b16 v[196:197], v228 offset:53248
  ds_read_b64_tr_b16 v[198:199], v228 offset:54272
  s_waitcnt vmcnt(3) lgkmcnt(8)
  v_mfma_f32_32x32x16_bf16 v[128:143], v[204:207], v[112:115], v[128:143]
  ds_read_b64_tr_b16 v[200:201], v229 offset:53248
  ds_read_b64_tr_b16 v[202:203], v229 offset:54272
  v_mov_b32 v221, 0
  s_waitcnt lgkmcnt(8)
  v_mfma_f32_32x32x16_bf16 v[144:159], v[208:211], v[112:115], v[144:159]
  ds_read_b64_tr_b16 v[204:205], v230 offset:18432
  ds_read_b64_tr_b16 v[206:207], v230 offset:19456
  v_cvt_pk_bf16_f32 v219, -v239, 0
  v_rcp_f32 v222, v238
  s_waitcnt vmcnt(2) lgkmcnt(8)
  v_mfma_f32_32x32x16_bf16 v[128:143], v[212:215], v[116:119], v[128:143]
  ds_read_b64_tr_b16 v[208:209], v228 offset:55296
  ds_read_b64_tr_b16 v[210:211], v228 offset:56320
  v_mul_f32 v10, 0xc0135761, v238
  v_mul_f32 v12, v238, v238
  s_waitcnt lgkmcnt(8)
  v_mfma_f32_32x32x16_bf16 v[144:159], v[192:195], v[116:119], v[144:159]
  ds_read_b64_tr_b16 v[212:213], v229 offset:55296
  ds_read_b64_tr_b16 v[214:215], v229 offset:56320
  v_mul_f32 v12, v12, v10
  s_waitcnt vmcnt(1) lgkmcnt(8)
  v_mfma_f32_32x32x16_bf16 v[128:143], v[196:199], v[120:123], v[128:143]
  ds_read_b64_tr_b16 v[192:193], v230 offset:20480
  ds_read_b64_tr_b16 v[194:195], v230 offset:21504
  v_mul_f32 v12, 0x3d372713, v12
  v_mfma_f32_32x32x16_bf16 v[128:143], a[248:251], v[218:221], v[128:143]
  s_waitcnt lgkmcnt(8)
  v_mfma_f32_32x32x16_bf16 v[144:159], v[200:203], v[120:123], v[144:159]
  ds_read_b64_tr_b16 v[196:197], v230 offset:22528
  ds_read_b64_tr_b16 v[198:199], v230 offset:23552
  v_mfma_f32_32x32x16_bf16 v[144:159], a[248:251], v[216:219], v[144:159]
  s_waitcnt lgkmcnt(8)
  v_mfma_f32_32x32x16_bf16 v[160:175], v[204:207], v[52:55], v[160:175]
  ds_read_b64_tr_b16 v[200:201], v230 offset:24576
  ds_read_b64_tr_b16 v[202:203], v230 offset:25600
  s_waitcnt vmcnt(0) lgkmcnt(8)
  v_mfma_f32_32x32x16_bf16 v[128:143], v[208:211], v[124:127], v[128:143]
  ds_read_b64_tr_b16 v[204:205], v230 offset:26624
  ds_read_b64_tr_b16 v[206:207], v230 offset:27648
  s_waitcnt lgkmcnt(8)
  v_mfma_f32_32x32x16_bf16 v[144:159], v[212:215], v[124:127], v[144:159]
  ds_read_b64_tr_b16 v[208:209], v230 offset:28672
  ds_read_b64_tr_b16 v[210:211], v230 offset:29696
  s_nop 5
  v_pk_mul_f32 v[232:233], v[128:129], v[128:129]
  v_pk_mul_f32 v[234:235], v[130:131], v[130:131]
  v_pk_mul_f32 v[236:237], v[132:133], v[132:133]
  v_pk_mul_f32 v[238:239], v[134:135], v[134:135]
  v_pk_fma_f32 v[232:233], v[232:233], v[12:13], v[10:11] op_sel_hi:[1,0,0]
  v_pk_fma_f32 v[234:235], v[234:235], v[12:13], v[10:11] op_sel_hi:[1,0,0]
  v_pk_fma_f32 v[236:237], v[236:237], v[12:13], v[10:11] op_sel_hi:[1,0,0]
  v_pk_fma_f32 v[238:239], v[238:239], v[12:13], v[10:11] op_sel_hi:[1,0,0]
  v_pk_mul_f32 v[232:233], v[232:233], v[128:129]
  v_pk_mul_f32 v[234:235], v[234:235], v[130:131]
  v_pk_mul_f32 v[236:237], v[236:237], v[132:133]
  v_pk_mul_f32 v[238:239], v[238:239], v[134:135]
  v_exp_f32 v232, v232
  v_exp_f32 v233, v233
  v_exp_f32 v234, v234
  v_exp_f32 v235, v235
  v_exp_f32 v236, v236
  v_exp_f32 v237, v237
  v_exp_f32 v238, v238
  v_exp_f32 v239, v239
  v_pk_fma_f32 v[232:233], v[232:233], v[222:223], v[222:223] op_sel_hi:[1,0,0]
  v_pk_fma_f32 v[234:235], v[234:235], v[222:223], v[222:223] op_sel_hi:[1,0,0]
  v_pk_fma_f32 v[236:237], v[236:237], v[222:223], v[222:223] op_sel_hi:[1,0,0]
  v_pk_fma_f32 v[238:239], v[238:239], v[222:223], v[222:223] op_sel_hi:[1,0,0]
  v_rcp_f32 v232, v232
  v_rcp_f32 v233, v233
  v_rcp_f32 v234, v234
  v_rcp_f32 v235, v235
  v_rcp_f32 v236, v236
  v_rcp_f32 v237, v237
  v_rcp_f32 v238, v238
  v_rcp_f32 v239, v239
  v_pk_mul_f32 v[232:233], v[128:129], v[232:233]
  v_pk_mul_f32 v[234:235], v[130:131], v[234:235]
  v_pk_mul_f32 v[236:237], v[132:133], v[236:237]
  v_pk_mul_f32 v[238:239], v[134:135], v[238:239]
  v_cvt_pk_bf16_f32 v128, v232, v233
  v_cvt_pk_bf16_f32 v129, v234, v235
  v_cvt_pk_bf16_f32 v130, v236, v237
  v_cvt_pk_bf16_f32 v131, v238, v239
  buffer_store_dwordx4 v[128:131], v1, s[64:67], s10 offen offset:0 sc1
  v_pk_mul_f32 v[232:233], v[136:137], v[136:137]
  v_pk_mul_f32 v[234:235], v[138:139], v[138:139]
  v_pk_mul_f32 v[236:237], v[140:141], v[140:141]
  v_pk_mul_f32 v[238:239], v[142:143], v[142:143]
  v_pk_fma_f32 v[232:233], v[232:233], v[12:13], v[10:11] op_sel_hi:[1,0,0]
  v_pk_fma_f32 v[234:235], v[234:235], v[12:13], v[10:11] op_sel_hi:[1,0,0]
  v_pk_fma_f32 v[236:237], v[236:237], v[12:13], v[10:11] op_sel_hi:[1,0,0]
  v_pk_fma_f32 v[238:239], v[238:239], v[12:13], v[10:11] op_sel_hi:[1,0,0]
  v_pk_mul_f32 v[232:233], v[232:233], v[136:137]
  v_pk_mul_f32 v[234:235], v[234:235], v[138:139]
  v_pk_mul_f32 v[236:237], v[236:237], v[140:141]
  v_pk_mul_f32 v[238:239], v[238:239], v[142:143]
  v_exp_f32 v232, v232
  v_exp_f32 v233, v233
  v_exp_f32 v234, v234
  v_exp_f32 v235, v235
  v_exp_f32 v236, v236
  v_exp_f32 v237, v237
  v_exp_f32 v238, v238
  v_exp_f32 v239, v239
  v_pk_fma_f32 v[232:233], v[232:233], v[222:223], v[222:223] op_sel_hi:[1,0,0]
  v_pk_fma_f32 v[234:235], v[234:235], v[222:223], v[222:223] op_sel_hi:[1,0,0]
  v_pk_fma_f32 v[236:237], v[236:237], v[222:223], v[222:223] op_sel_hi:[1,0,0]
  v_pk_fma_f32 v[238:239], v[238:239], v[222:223], v[222:223] op_sel_hi:[1,0,0]
  v_rcp_f32 v232, v232
  v_rcp_f32 v233, v233
  v_rcp_f32 v234, v234
  v_rcp_f32 v235, v235
  v_rcp_f32 v236, v236
  v_rcp_f32 v237, v237
  v_rcp_f32 v238, v238
  v_rcp_f32 v239, v239
  v_pk_mul_f32 v[232:233], v[136:137], v[232:233]
  v_pk_mul_f32 v[234:235], v[138:139], v[234:235]
  v_pk_mul_f32 v[236:237], v[140:141], v[236:237]
  v_pk_mul_f32 v[238:239], v[142:143], v[238:239]
  v_cvt_pk_bf16_f32 v136, v232, v233
  v_cvt_pk_bf16_f32 v137, v234, v235
  v_cvt_pk_bf16_f32 v138, v236, v237
  v_cvt_pk_bf16_f32 v139, v238, v239
  buffer_store_dwordx4 v[136:139], v1, s[64:67], s10 offen offset:1024 sc1
  s_waitcnt lgkmcnt(8)
  v_mfma_f32_32x32x16_bf16 v[160:175], v[192:195], v[56:59], v[160:175]
  s_waitcnt lgkmcnt(4)
  ds_read_b64_tr_b16 v[212:213], v230 offset:30720
  ds_read_b64_tr_b16 v[214:215], v230 offset:31744
  v_mul_f32 v232, v144, v144
  v_mul_f32 v233, v145, v145
  v_mul_f32 v234, v146, v146
  v_mul_f32 v235, v147, v147
  v_fma_f32 v232, v232, v12, v10
  v_fma_f32 v233, v233, v12, v10
  v_fma_f32 v234, v234, v12, v10
  v_fma_f32 v235, v235, v12, v10
  v_mul_f32 v232, v232, v144
  v_mfma_f32_32x32x16_bf16 v[160:175], v[196:199], v[60:63], v[160:175]
  ds_read_b64_tr_b16 v[192:193], v230 offset:32768
  ds_read_b64_tr_b16 v[194:195], v230 offset:33792
  v_mul_f32 v233, v233, v145
  v_mul_f32 v234, v234, v146
  v_mul_f32 v235, v235, v147
  v_exp_f32 v232, v232
  v_exp_f32 v233, v233
  v_mfma_f32_32x32x16_bf16 v[160:175], v[200:203], v[64:67], v[160:175]
  s_waitcnt lgkmcnt(4)
  ds_read_b64_tr_b16 v[196:197], v230 offset:34816
  ds_read_b64_tr_b16 v[198:199], v230 offset:35840
  v_exp_f32 v234, v234
  v_exp_f32 v235, v235
  v_fma_f32 v232, v232, v222, v222
  v_fma_f32 v233, v233, v222, v222
  v_fma_f32 v234, v234, v222, v222
  v_fma_f32 v235, v235, v222, v222
  v_rcp_f32 v232, v232
  v_mfma_f32_32x32x16_bf16 v[160:175], v[204:207], v[68:71], v[160:175]
  ds_read_b64_tr_b16 v[200:201], v230 offset:36864
  ds_read_b64_tr_b16 v[202:203], v230 offset:37888
  v_rcp_f32 v233, v233
  v_rcp_f32 v234, v234
  v_rcp_f32 v235, v235
  v_mul_f32 v232, v144, v232
  v_mul_f32 v233, v145, v233
  v_mfma_f32_32x32x16_bf16 v[160:175], v[208:211], v[72:75], v[160:175]
  s_waitcnt lgkmcnt(4)
  ds_read_b64_tr_b16 v[204:205], v230 offset:38912
  ds_read_b64_tr_b16 v[206:207], v230 offset:39936
  v_mul_f32 v234, v146, v234
  v_mul_f32 v235, v147, v235
  v_cvt_pk_bf16_f32 v144, v232, v233
  v_cvt_pk_bf16_f32 v145, v234, v235
  v_mul_f32 v236, v148, v148
  v_mul_f32 v237, v149, v149
  v_mul_f32 v238, v150, v150
  v_mul_f32 v239, v151, v151
  v_fma_f32 v236, v236, v12, v10
  v_mfma_f32_32x32x16_bf16 v[160:175], v[212:215], v[76:79], v[160:175]
  ds_read_b64_tr_b16 v[208:209], v230 offset:40960
  ds_read_b64_tr_b16 v[210:211], v230 offset:41984
  v_fma_f32 v237, v237, v12, v10
  v_fma_f32 v238, v238, v12, v10
  v_fma_f32 v239, v239, v12, v10
  v_mul_f32 v236, v236, v148
  v_mul_f32 v237, v237, v149
  v_mul_f32 v238, v238, v150
  v_mul_f32 v239, v239, v151
  v_mfma_f32_32x32x16_bf16 v[160:175], v[192:195], v[80:83], v[160:175]
  s_waitcnt lgkmcnt(4)
  ds_read_b64_tr_b16 v[212:213], v230 offset:43008
  ds_read_b64_tr_b16 v[214:215], v230 offset:44032
  v_exp_f32 v236, v236
  v_exp_f32 v237, v237
  v_exp_f32 v238, v238
  v_exp_f32 v239, v239
  v_fma_f32 v236, v236, v222, v222
  v_fma_f32 v237, v237, v222, v222
  v_mfma_f32_32x32x16_bf16 v[160:175], v[196:199], v[84:87], v[160:175]
  ds_read_b64_tr_b16 v[192:193], v230 offset:45056
  ds_read_b64_tr_b16 v[194:195], v230 offset:46080
  v_fma_f32 v238, v238, v222, v222
  v_fma_f32 v239, v239, v222, v222
  v_rcp_f32 v236, v236
  v_rcp_f32 v237, v237
  v_rcp_f32 v238, v238
  v_mfma_f32_32x32x16_bf16 v[160:175], v[200:203], v[88:91], v[160:175]
  s_waitcnt lgkmcnt(4)
  ds_read_b64_tr_b16 v[196:197], v230 offset:47104
  ds_read_b64_tr_b16 v[198:199], v230 offset:48128
  v_rcp_f32 v239, v239
  v_mul_f32 v236, v148, v236
  v_mul_f32 v237, v149, v237
  v_mul_f32 v238, v150, v238
  v_mul_f32 v239, v151, v239
  v_cvt_pk_bf16_f32 v146, v236, v237
  v_cvt_pk_bf16_f32 v147, v238, v239
  buffer_store_dwordx4 v[144:147], v1, s[64:67], s10 offen offset:2048 sc1
  v_mfma_f32_32x32x16_bf16 v[160:175], v[204:207], v[92:95], v[160:175]
  ds_read_b64_tr_b16 v[200:201], v230 offset:49152
  ds_read_b64_tr_b16 v[202:203], v230 offset:50176
  v_mul_f32 v232, v152, v152
  v_mul_f32 v233, v153, v153
  v_mul_f32 v234, v154, v154
  v_mul_f32 v235, v155, v155
  v_fma_f32 v232, v232, v12, v10
  v_fma_f32 v233, v233, v12, v10
  v_fma_f32 v234, v234, v12, v10
  v_fma_f32 v235, v235, v12, v10
  v_mfma_f32_32x32x16_bf16 v[160:175], v[208:211], v[96:99], v[160:175]
  s_waitcnt lgkmcnt(4)
  ds_read_b64_tr_b16 v[204:205], v230 offset:51200
  ds_read_b64_tr_b16 v[206:207], v230 offset:52224
  v_mul_f32 v232, v232, v152
  v_mul_f32 v233, v233, v153
  v_mul_f32 v234, v234, v154
  v_mul_f32 v235, v235, v155
  v_exp_f32 v232, v232
  v_exp_f32 v233, v233
  v_mfma_f32_32x32x16_bf16 v[160:175], v[212:215], v[100:103], v[160:175]
  ds_read_b64_tr_b16 v[208:209], v230 offset:53248
  ds_read_b64_tr_b16 v[210:211], v230 offset:54272
  v_exp_f32 v234, v234
  v_exp_f32 v235, v235
  v_fma_f32 v232, v232, v222, v222
  v_fma_f32 v233, v233, v222, v222
  v_fma_f32 v234, v234, v222, v222
  v_fma_f32 v235, v235, v222, v222
  v_mfma_f32_32x32x16_bf16 v[160:175], v[192:195], v[104:107], v[160:175]
  s_waitcnt lgkmcnt(4)
  ds_read_b64_tr_b16 v[212:213], v230 offset:55296
  ds_read_b64_tr_b16 v[214:215], v230 offset:56320
  v_rcp_f32 v232, v232
  v_rcp_f32 v233, v233
  v_rcp_f32 v234, v234
  v_rcp_f32 v235, v235
  v_mul_f32 v232, v152, v232
  v_mul_f32 v233, v153, v233
  v_mfma_f32_32x32x16_bf16 v[160:175], v[196:199], v[108:111], v[160:175]
  ds_read_b64_tr_b16 v[192:193], v231 offset:0
  ds_read_b64_tr_b16 v[194:195], v231 offset:1024
  v_mul_f32 v234, v154, v234
  v_mul_f32 v235, v155, v235
  v_cvt_pk_bf16_f32 v152, v232, v233
  v_cvt_pk_bf16_f32 v153, v234, v235
  v_mul_f32 v236, v156, v156
  v_mul_f32 v237, v157, v157
  v_mul_f32 v238, v158, v158
  v_mul_f32 v239, v159, v159
  v_mfma_f32_32x32x16_bf16 v[160:175], v[200:203], v[112:115], v[160:175]
  s_waitcnt lgkmcnt(4)
  ds_read_b64_tr_b16 v[196:197], v231 offset:2048
  ds_read_b64_tr_b16 v[198:199], v231 offset:3072
  v_fma_f32 v236, v236, v12, v10
  v_fma_f32 v237, v237, v12, v10
  v_fma_f32 v238, v238, v12, v10
  v_fma_f32 v239, v239, v12, v10
  v_mul_f32 v236, v236, v156
  v_mul_f32 v237, v237, v157
  v_mul_f32 v238, v238, v158
  v_mul_f32 v239, v239, v159
  v_mfma_f32_32x32x16_bf16 v[160:175], a[252:255], v[218:221], v[160:175]
  v_mfma_f32_32x32x16_bf16 v[160:175], v[204:207], v[116:119], v[160:175]
  ds_read_b64_tr_b16 v[200:201], v231 offset:4096
  ds_read_b64_tr_b16 v[202:203], v231 offset:5120
  v_exp_f32 v236, v236
  v_exp_f32 v237, v237
  v_exp_f32 v238, v238
  v_exp_f32 v239, v239
  v_fma_f32 v236, v236, v222, v222
  v_mfma_f32_32x32x16_bf16 v[160:175], v[208:211], v[120:123], v[160:175]
  s_waitcnt lgkmcnt(4)
  ds_read_b64_tr_b16 v[204:205], v231 offset:6144
  ds_read_b64_tr_b16 v[206:207], v231 offset:7168
  v_fma_f32 v237, v237, v222, v222
  v_fma_f32 v238, v238, v222, v222
  v_fma_f32 v239, v239, v222, v222
  v_rcp_f32 v236, v236
  v_rcp_f32 v237, v237
  v_rcp_f32 v238, v238
  v_mfma_f32_32x32x16_bf16 v[160:175], v[212:215], v[124:127], v[160:175]
  ds_read_b64_tr_b16 v[208:209], v231 offset:8192
  ds_read_b64_tr_b16 v[210:211], v231 offset:9216
  v_rcp_f32 v239, v239
  v_mul_f32 v236, v156, v236
  v_mul_f32 v237, v157, v237
  v_mul_f32 v238, v158, v238
  v_mul_f32 v239, v159, v239
  v_cvt_pk_bf16_f32 v154, v236, v237
  v_cvt_pk_bf16_f32 v155, v238, v239
  v_mfma_f32_32x32x16_bf16 v[176:191], v[192:195], v[16:19], 0
  s_waitcnt lgkmcnt(4)
  ds_read_b64_tr_b16 v[212:213], v231 offset:10240
  ds_read_b64_tr_b16 v[214:215], v231 offset:11264
  buffer_store_dwordx4 v[152:155], v1, s[64:67], s10 offen offset:3072 sc1
  v_mfma_f32_32x32x16_bf16 v[176:191], v[196:199], v[20:23], v[176:191]
  ds_read_b64_tr_b16 v[192:193], v231 offset:12288
  ds_read_b64_tr_b16 v[194:195], v231 offset:13312
  v_mfma_f32_32x32x16_bf16 v[176:191], v[200:203], v[24:27], v[176:191]
  s_waitcnt lgkmcnt(4)
  ds_read_b64_tr_b16 v[196:197], v231 offset:14336
  ds_read_b64_tr_b16 v[198:199], v231 offset:15360
  v_mul_f32 v232, v160, v160
  v_mul_f32 v233, v161, v161
  v_mul_f32 v234, v162, v162
  v_mul_f32 v235, v163, v163
  v_fma_f32 v232, v232, v12, v10
  v_fma_f32 v233, v233, v12, v10
  v_mfma_f32_32x32x16_bf16 v[176:191], v[204:207], v[28:31], v[176:191]
  ds_read_b64_tr_b16 v[200:201], v231 offset:16384
  ds_read_b64_tr_b16 v[202:203], v231 offset:17408
  v_fma_f32 v234, v234, v12, v10
  v_fma_f32 v235, v235, v12, v10
  v_mul_f32 v232, v232, v160
  v_mul_f32 v233, v233, v161
  v_mul_f32 v234, v234, v162
  v_mul_f32 v235, v235, v163
  v_mfma_f32_32x32x16_bf16 v[176:191], v[208:211], v[32:35], v[176:191]
  s_waitcnt lgkmcnt(4)
  ds_read_b64_tr_b16 v[204:205], v231 offset:18432
  ds_read_b64_tr_b16 v[206:207], v231 offset:19456
  v_exp_f32 v232, v232
  v_exp_f32 v233, v233
  v_exp_f32 v234, v234
  v_mfma_f32_32x32x16_bf16 v[176:191], v[212:215], v[36:39], v[176:191]
  ds_read_b64_tr_b16 v[208:209], v231 offset:20480
  ds_read_b64_tr_b16 v[210:211], v231 offset:21504
  v_exp_f32 v235, v235
  v_fma_f32 v232, v232, v222, v222
  v_fma_f32 v233, v233, v222, v222
  v_fma_f32 v234, v234, v222, v222
  v_mfma_f32_32x32x16_bf16 v[176:191], v[192:195], v[40:43], v[176:191]
  s_waitcnt lgkmcnt(4)
  ds_read_b64_tr_b16 v[212:213], v231 offset:22528
  ds_read_b64_tr_b16 v[214:215], v231 offset:23552
  v_fma_f32 v235, v235, v222, v222
  v_rcp_f32 v232, v232
  v_rcp_f32 v233, v233
  v_mfma_f32_32x32x16_bf16 v[176:191], v[196:199], v[44:47], v[176:191]
  ds_read_b64_tr_b16 v[192:193], v231 offset:24576
  ds_read_b64_tr_b16 v[194:195], v231 offset:25600
  v_rcp_f32 v234, v234
  v_rcp_f32 v235, v235
  v_mul_f32 v232, v160, v232
  v_mul_f32 v233, v161, v233
  v_mul_f32 v234, v162, v234
  v_mfma_f32_32x32x16_bf16 v[176:191], v[200:203], v[48:51], v[176:191]
  s_waitcnt lgkmcnt(4)
  ds_read_b64_tr_b16 v[196:197], v231 offset:26624
  ds_read_b64_tr_b16 v[198:199], v231 offset:27648
  v_mul_f32 v235, v163, v235
  v_cvt_pk_bf16_f32 v160, v232, v233
  v_cvt_pk_bf16_f32 v161, v234, v235
  v_mul_f32 v236, v164, v164
  v_mul_f32 v237, v165, v165
  v_mul_f32 v238, v166, v166
  v_mfma_f32_32x32x16_bf16 v[176:191], v[204:207], v[52:55], v[176:191]
  ds_read_b64_tr_b16 v[200:201], v231 offset:28672
  ds_read_b64_tr_b16 v[202:203], v231 offset:29696
  v_mul_f32 v239, v167, v167
  v_fma_f32 v236, v236, v12, v10
  v_fma_f32 v237, v237, v12, v10
  v_fma_f32 v238, v238, v12, v10
  v_fma_f32 v239, v239, v12, v10
  v_mul_f32 v236, v236, v164
  v_mfma_f32_32x32x16_bf16 v[176:191], v[208:211], v[56:59], v[176:191]
  s_waitcnt lgkmcnt(4)
  ds_read_b64_tr_b16 v[204:205], v231 offset:30720
  ds_read_b64_tr_b16 v[206:207], v231 offset:31744
  v_mul_f32 v237, v237, v165
  v_mul_f32 v238, v238, v166
  v_mul_f32 v239, v239, v167
  v_exp_f32 v236, v236
  v_mfma_f32_32x32x16_bf16 v[176:191], v[212:215], v[60:63], v[176:191]
  ds_read_b64_tr_b16 v[208:209], v231 offset:32768
  ds_read_b64_tr_b16 v[210:211], v231 offset:33792
  v_exp_f32 v237, v237
  v_exp_f32 v238, v238
  v_exp_f32 v239, v239
  v_mfma_f32_32x32x16_bf16 v[176:191], v[192:195], v[64:67], v[176:191]
  s_waitcnt lgkmcnt(4)
  ds_read_b64_tr_b16 v[212:213], v231 offset:34816
  ds_read_b64_tr_b16 v[214:215], v231 offset:35840
  v_fma_f32 v236, v236, v222, v222
  v_fma_f32 v237, v237, v222, v222
  v_fma_f32 v238, v238, v222, v222
  v_fma_f32 v239, v239, v222, v222
  v_rcp_f32 v236, v236
  v_mfma_f32_32x32x16_bf16 v[176:191], v[196:199], v[68:71], v[176:191]
  ds_read_b64_tr_b16 v[192:193], v231 offset:36864
  ds_read_b64_tr_b16 v[194:195], v231 offset:37888
  v_rcp_f32 v237, v237
  v_rcp_f32 v238, v238
  v_rcp_f32 v239, v239
  v_mfma_f32_32x32x16_bf16 v[176:191], v[200:203], v[72:75], v[176:191]
  s_waitcnt lgkmcnt(4)
  ds_read_b64_tr_b16 v[196:197], v231 offset:38912
  ds_read_b64_tr_b16 v[198:199], v231 offset:39936
  v_mul_f32 v236, v164, v236
  v_mul_f32 v237, v165, v237
  v_mul_f32 v238, v166, v238
  v_mul_f32 v239, v167, v239
  v_cvt_pk_bf16_f32 v162, v236, v237
  v_cvt_pk_bf16_f32 v163, v238, v239
  v_mfma_f32_32x32x16_bf16 v[176:191], a[252:255], v[216:219], v[176:191]
  v_mfma_f32_32x32x16_bf16 v[176:191], v[204:207], v[76:79], v[176:191]
  ds_read_b64_tr_b16 v[200:201], v231 offset:40960
  ds_read_b64_tr_b16 v[202:203], v231 offset:41984
  v_mul_f32 v232, v168, v168
  v_mul_f32 v233, v169, v169
  v_mul_f32 v234, v170, v170
  v_mul_f32 v235, v171, v171
  v_fma_f32 v232, v232, v12, v10
  v_fma_f32 v233, v233, v12, v10
  v_mfma_f32_32x32x16_bf16 v[176:191], v[208:211], v[80:83], v[176:191]
  s_waitcnt lgkmcnt(4)
  ds_read_b64_tr_b16 v[204:205], v231 offset:43008
  ds_read_b64_tr_b16 v[206:207], v231 offset:44032
  v_fma_f32 v234, v234, v12, v10
  v_fma_f32 v235, v235, v12, v10
  v_mul_f32 v232, v232, v168
  v_mul_f32 v233, v233, v169
  v_mul_f32 v234, v234, v170
  v_mul_f32 v235, v235, v171
  v_mfma_f32_32x32x16_bf16 v[176:191], v[212:215], v[84:87], v[176:191]
  ds_read_b64_tr_b16 v[208:209], v231 offset:45056
  ds_read_b64_tr_b16 v[210:211], v231 offset:46080
  v_exp_f32 v232, v232
  v_exp_f32 v233, v233
  v_exp_f32 v234, v234
  v_mfma_f32_32x32x16_bf16 v[176:191], v[192:195], v[88:91], v[176:191]
  s_waitcnt lgkmcnt(4)
  ds_read_b64_tr_b16 v[212:213], v231 offset:47104
  ds_read_b64_tr_b16 v[214:215], v231 offset:48128
  v_exp_f32 v235, v235
  v_fma_f32 v232, v232, v222, v222
  v_fma_f32 v233, v233, v222, v222
  v_fma_f32 v234, v234, v222, v222
  v_mfma_f32_32x32x16_bf16 v[176:191], v[196:199], v[92:95], v[176:191]
  ds_read_b64_tr_b16 v[192:193], v231 offset:49152
  ds_read_b64_tr_b16 v[194:195], v231 offset:50176
  v_fma_f32 v235, v235, v222, v222
  v_rcp_f32 v232, v232
  v_rcp_f32 v233, v233
  v_mfma_f32_32x32x16_bf16 v[176:191], v[200:203], v[96:99], v[176:191]
  s_waitcnt lgkmcnt(4)
  ds_read_b64_tr_b16 v[196:197], v231 offset:51200
  ds_read_b64_tr_b16 v[198:199], v231 offset:52224
  v_rcp_f32 v234, v234
  v_rcp_f32 v235, v235
  v_mul_f32 v232, v168, v232
  v_mul_f32 v233, v169, v233
  v_mul_f32 v234, v170, v234
  v_mfma_f32_32x32x16_bf16 v[176:191], v[204:207], v[100:103], v[176:191]
  ds_read_b64_tr_b16 v[200:201], v231 offset:53248
  ds_read_b64_tr_b16 v[202:203], v231 offset:54272
  v_mul_f32 v235, v171, v235
  v_cvt_pk_bf16_f32 v168, v232, v233
  v_cvt_pk_bf16_f32 v169, v234, v235
  v_mul_f32 v236, v172, v172
  v_mul_f32 v237, v173, v173
  v_mul_f32 v238, v174, v174
  v_mfma_f32_32x32x16_bf16 v[176:191], v[208:211], v[104:107], v[176:191]
  s_waitcnt lgkmcnt(4)
  ds_read_b64_tr_b16 v[204:205], v231 offset:55296
  ds_read_b64_tr_b16 v[206:207], v231 offset:56320
  v_mul_f32 v239, v175, v175
  v_fma_f32 v236, v236, v12, v10
  v_fma_f32 v237, v237, v12, v10
  v_fma_f32 v238, v238, v12, v10
  v_fma_f32 v239, v239, v12, v10
  v_mul_f32 v236, v236, v172
  v_mov_b32 v11, 1
  s_mov_b64 exec, 1
  s_waitcnt vmcnt(0)
  s_barrier
  s_cmp_eq_u32 s74, 0
  s_cbranch_scc1 L141
  buffer_store_dword v11, off, s[64:67], s82 offset:3584
L142:
  s_mov_b64 exec, -1
  v_mfma_f32_32x32x16_bf16 v[176:191], v[212:215], v[108:111], v[176:191]
  v_mul_f32 v237, v237, v173
  v_mul_f32 v238, v238, v174
  v_mul_f32 v239, v239, v175
  v_exp_f32 v236, v236
  v_mfma_f32_32x32x16_bf16 v[176:191], v[192:195], v[112:115], v[176:191]
  s_waitcnt lgkmcnt(2)
  v_exp_f32 v237, v237
  v_exp_f32 v238, v238
  v_exp_f32 v239, v239
  v_mfma_f32_32x32x16_bf16 v[176:191], v[196:199], v[116:119], v[176:191]
  v_fma_f32 v236, v236, v222, v222
  v_fma_f32 v237, v237, v222, v222
  v_fma_f32 v238, v238, v222, v222
  v_fma_f32 v239, v239, v222, v222
  v_rcp_f32 v236, v236
  v_mfma_f32_32x32x16_bf16 v[176:191], v[200:203], v[120:123], v[176:191]
  v_rcp_f32 v237, v237
  v_rcp_f32 v238, v238
  v_rcp_f32 v239, v239
  s_waitcnt lgkmcnt(0)
  v_mfma_f32_32x32x16_bf16 v[176:191], v[204:207], v[124:127], v[176:191]
  v_mul_f32 v236, v172, v236
  v_mul_f32 v237, v173, v237
  v_mul_f32 v238, v174, v238
  v_mul_f32 v239, v175, v239
  v_cvt_pk_bf16_f32 v170, v236, v237
  v_cvt_pk_bf16_f32 v171, v238, v239
  buffer_load_dword v14, v13, s[64:67], s88 offen sc1
  buffer_store_dwordx4 v[160:163], v1, s[64:67], s11 offen offset:0 sc1
  buffer_store_dwordx4 v[168:171], v1, s[64:67], s11 offen offset:1024 sc1
  s_nop 2
  v_pk_mul_f32 v[232:233], v[176:177], v[176:177]
  v_pk_mul_f32 v[234:235], v[178:179], v[178:179]
  v_pk_mul_f32 v[236:237], v[180:181], v[180:181]
  v_pk_mul_f32 v[238:239], v[182:183], v[182:183]
  v_pk_fma_f32 v[232:233], v[232:233], v[12:13], v[10:11] op_sel_hi:[1,0,0]
  v_pk_fma_f32 v[234:235], v[234:235], v[12:13], v[10:11] op_sel_hi:[1,0,0]
  v_pk_fma_f32 v[236:237], v[236:237], v[12:13], v[10:11] op_sel_hi:[1,0,0]
  v_pk_fma_f32 v[238:239], v[238:239], v[12:13], v[10:11] op_sel_hi:[1,0,0]
  v_pk_mul_f32 v[232:233], v[232:233], v[176:177]
  v_pk_mul_f32 v[234:235], v[234:235], v[178:179]
  v_pk_mul_f32 v[236:237], v[236:237], v[180:181]
  v_pk_mul_f32 v[238:239], v[238:239], v[182:183]
  v_exp_f32 v232, v232
  v_exp_f32 v233, v233
  v_exp_f32 v234, v234
  v_exp_f32 v235, v235
  v_exp_f32 v236, v236
  v_exp_f32 v237, v237
  v_exp_f32 v238, v238
  v_exp_f32 v239, v239
  v_pk_fma_f32 v[232:233], v[232:233], v[222:223], v[222:223] op_sel_hi:[1,0,0]
  v_pk_fma_f32 v[234:235], v[234:235], v[222:223], v[222:223] op_sel_hi:[1,0,0]
  v_pk_fma_f32 v[236:237], v[236:237], v[222:223], v[222:223] op_sel_hi:[1,0,0]
  v_pk_fma_f32 v[238:239], v[238:239], v[222:223], v[222:223] op_sel_hi:[1,0,0]
  v_rcp_f32 v232, v232
  v_rcp_f32 v233, v233
  v_rcp_f32 v234, v234
  v_rcp_f32 v235, v235
  v_rcp_f32 v236, v236
  v_rcp_f32 v237, v237
  v_rcp_f32 v238, v238
  v_rcp_f32 v239, v239
  v_pk_mul_f32 v[232:233], v[176:177], v[232:233]
  v_pk_mul_f32 v[234:235], v[178:179], v[234:235]
  v_pk_mul_f32 v[236:237], v[180:181], v[236:237]
  v_pk_mul_f32 v[238:239], v[182:183], v[238:239]
  v_cvt_pk_bf16_f32 v176, v232, v233
  v_cvt_pk_bf16_f32 v177, v234, v235
  v_cvt_pk_bf16_f32 v178, v236, v237
  v_cvt_pk_bf16_f32 v179, v238, v239
  buffer_store_dwordx4 v[176:179], v1, s[64:67], s11 offen offset:2048 sc1
  s_waitcnt vmcnt(3)
  v_cmp_eq_u32 vcc, 0, v14
  s_nop 0
  s_cbranch_vccnz L143
L144:
  s_add_u32 s23, s20, 0
  buffer_load_dwordx4 v[64:67], v1, s[64:67], s23 offen sc1
  s_add_u32 s23, s21, 0
  buffer_load_dwordx4 v[68:71], v1, s[64:67], s23 offen sc1
  s_add_u32 s23, s20, 1024
  buffer_load_dwordx4 v[72:75], v1, s[64:67], s23 offen sc1
  s_add_u32 s23, s21, 1024
  buffer_load_dwordx4 v[76:79], v1, s[64:67], s23 offen sc1
  s_add_u32 s23, s20, 2048
  buffer_load_dwordx4 v[80:83], v1, s[64:67], s23 offen sc1
  v_pk_mul_f32 v[232:233], v[184:185], v[184:185]
  v_pk_mul_f32 v[234:235], v[186:187], v[186:187]
  v_pk_mul_f32 v[236:237], v[188:189], v[188:189]
  v_pk_mul_f32 v[238:239], v[190:191], v[190:191]
  v_pk_fma_f32 v[232:233], v[232:233], v[12:13], v[10:11] op_sel_hi:[1,0,0]
  v_pk_fma_f32 v[234:235], v[234:235], v[12:13], v[10:11] op_sel_hi:[1,0,0]
  v_pk_fma_f32 v[236:237], v[236:237], v[12:13], v[10:11] op_sel_hi:[1,0,0]
  v_pk_fma_f32 v[238:239], v[238:239], v[12:13], v[10:11] op_sel_hi:[1,0,0]
  v_pk_mul_f32 v[232:233], v[232:233], v[184:185]
  v_pk_mul_f32 v[234:235], v[234:235], v[186:187]
  v_pk_mul_f32 v[236:237], v[236:237], v[188:189]
  v_pk_mul_f32 v[238:239], v[238:239], v[190:191]
  v_exp_f32 v232, v232
  v_exp_f32 v233, v233
  v_exp_f32 v234, v234
  v_exp_f32 v235, v235
  v_exp_f32 v236, v236
  v_exp_f32 v237, v237
  v_exp_f32 v238, v238
  v_exp_f32 v239, v239
  v_pk_fma_f32 v[232:233], v[232:233], v[222:223], v[222:223] op_sel_hi:[1,0,0]
  v_pk_fma_f32 v[234:235], v[234:235], v[222:223], v[222:223] op_sel_hi:[1,0,0]
  v_pk_fma_f32 v[236:237], v[236:237], v[222:223], v[222:223] op_sel_hi:[1,0,0]
  v_pk_fma_f32 v[238:239], v[238:239], v[222:223], v[222:223] op_sel_hi:[1,0,0]
  v_rcp_f32 v232, v232
  v_rcp_f32 v233, v233
  v_rcp_f32 v234, v234
  v_rcp_f32 v235, v235
  v_rcp_f32 v236, v236
  v_rcp_f32 v237, v237
  v_rcp_f32 v238, v238
  v_rcp_f32 v239, v239
  v_pk_mul_f32 v[232:233], v[184:185], v[232:233]
  v_pk_mul_f32 v[234:235], v[186:187], v[234:235]
  v_pk_mul_f32 v[236:237], v[188:189], v[236:237]
  v_pk_mul_f32 v[238:239], v[190:191], v[238:239]
  v_cvt_pk_bf16_f32 v184, v232, v233
  v_cvt_pk_bf16_f32 v185, v234, v235
  v_cvt_pk_bf16_f32 v186, v236, v237
  v_cvt_pk_bf16_f32 v187, v238, v239
  buffer_store_dwordx4 v[184:187], v1, s[64:67], s11 offen offset:3072 sc1
  s_add_u32 s23, s21, 2048
  buffer_load_dwordx4 v[84:87], v1, s[64:67], s23 offen sc1
  s_add_u32 s23, s20, 3072
  buffer_load_dwordx4 v[88:91], v1, s[64:67], s23 offen sc1
  s_add_u32 s23, s21, 3072
  buffer_load_dwordx4 v[92:95], v1, s[64:67], s23 offen sc1
  s_add_u32 s23, s20, 4096
  buffer_load_dwordx4 v[96:99], v1, s[64:67], s23 offen sc1
  s_add_u32 s23, s21, 4096
  buffer_load_dwordx4 v[100:103], v1, s[64:67], s23 offen sc1
  s_add_u32 s23, s20, 5120
  buffer_load_dwordx4 v[104:107], v1, s[64:67], s23 offen sc1
  v_and_b32 v233, 31, v0
  v_lshrrev_b32 v234, 5, v0
  s_lshl_b32 s4, s81, 2
  v_add_u32 v234, s4, v234
  v_and_b32 v235, 7, v233
  v_xor_b32 v234, v234, v235
  v_lshlrev_b32 v234, 4, v234
  v_lshl_add_u32 v234, v233, 7, v234
  s_lshl_b32 s4, s80, 12
  v_add_u32 v234, s4, v234
  v_xor_b32 v235, 32, v234
  v_lshrrev_b32 v233, 3, v0
  v_and_b32 v236, 7, v0
  v_xor_b32 v236, v236, v233
  v_mul_u32_u24 v232, 896, v233
  v_lshl_add_u32 v232, v236, 4, v232
  s_lshl_b32 s4, s72, 11
  v_add_u32 v236, s4, v1
  s_mul_i32 s24, s85, 57344
  s_mul_i32 s3, s72, 14336
  s_add_u32 s24, s24, s3
  s_lshl_b32 s3, s71, 7
  s_add_u32 s24, s24, s3
  s_add_u32 s25, s24, 0x1c00
  s_waitcnt vmcnt(11)
  v_mfma_f32_32x32x16_bf16 v[32:47], a[4:7], v[64:67], 0
  s_add_u32 s23, s21, 5120
  buffer_load_dwordx4 v[108:111], v1, s[64:67], s23 offen sc1
  v_mfma_f32_32x32x16_bf16 v[16:31], a[0:3], v[64:67], 0
  s_waitcnt vmcnt(11)
  v_mfma_f32_32x32x16_bf16 v[48:63], a[4:7], v[68:71], 0
  s_add_u32 s23, s20, 6144
  buffer_load_dwordx4 v[112:115], v1, s[64:67], s23 offen sc1
  v_mfma_f32_32x32x16_bf16 v[240:255], a[0:3], v[68:71], v[240:255]
  s_waitcnt vmcnt(11)
  v_mfma_f32_32x32x16_bf16 v[32:47], a[12:15], v[72:75], v[32:47]
  s_add_u32 s23, s21, 6144
  buffer_load_dwordx4 v[116:119], v1, s[64:67], s23 offen sc1
  v_mfma_f32_32x32x16_bf16 v[16:31], a[8:11], v[72:75], v[16:31]
  s_waitcnt vmcnt(11)
  v_mfma_f32_32x32x16_bf16 v[48:63], a[12:15], v[76:79], v[48:63]
  s_add_u32 s23, s18, 7168
  buffer_load_dwordx4 v[120:123], v1, s[64:67], s23 offen sc1
  v_mfma_f32_32x32x16_bf16 v[240:255], a[8:11], v[76:79], v[240:255]
  s_waitcnt vmcnt(11)
  v_mfma_f32_32x32x16_bf16 v[32:47], a[20:23], v[80:83], v[32:47]
  s_add_u32 s23, s19, 7168
  buffer_load_dwordx4 v[124:127], v1, s[64:67], s23 offen sc1
  v_mfma_f32_32x32x16_bf16 v[16:31], a[16:19], v[80:83], v[16:31]
  v_mov_b32 v11, 1
  s_mov_b64 exec, 1
  s_waitcnt vmcnt(11)
  s_barrier
  s_cmp_eq_u32 s74, 0
  s_cbranch_scc1 L145
  buffer_store_dword v11, off, s[64:67], s82 offset:2304
L146:
  s_mov_b64 exec, -1
  s_waitcnt vmcnt(11)
  v_mfma_f32_32x32x16_bf16 v[48:63], a[20:23], v[84:87], v[48:63]
  s_add_u32 s23, s18, 8192
  buffer_load_dwordx4 v[64:67], v1, s[64:67], s23 offen sc1
  v_mfma_f32_32x32x16_bf16 v[240:255], a[16:19], v[84:87], v[240:255]
  s_waitcnt vmcnt(11)
  v_mfma_f32_32x32x16_bf16 v[32:47], a[28:31], v[88:91], v[32:47]
  s_add_u32 s23, s19, 8192
  buffer_load_dwordx4 v[68:71], v1, s[64:67], s23 offen sc1
  v_mfma_f32_32x32x16_bf16 v[16:31], a[24:27], v[88:91], v[16:31]
  s_waitcnt vmcnt(11)
  v_mfma_f32_32x32x16_bf16 v[48:63], a[28:31], v[92:95], v[48:63]
  s_add_u32 s23, s18, 9216
  buffer_load_dwordx4 v[72:75], v1, s[64:67], s23 offen sc1
  v_mfma_f32_32x32x16_bf16 v[240:255], a[24:27], v[92:95], v[240:255]
  s_waitcnt vmcnt(11)
  v_mfma_f32_32x32x16_bf16 v[32:47], a[36:39], v[96:99], v[32:47]
  s_add_u32 s23, s19, 9216
  buffer_load_dwordx4 v[76:79], v1, s[64:67], s23 offen sc1
  v_mfma_f32_32x32x16_bf16 v[16:31], a[32:35], v[96:99], v[16:31]
  s_waitcnt vmcnt(11)
  v_mfma_f32_32x32x16_bf16 v[48:63], a[36:39], v[100:103], v[48:63]
  s_add_u32 s23, s18, 10240
  buffer_load_dwordx4 v[80:83], v1, s[64:67], s23 offen sc1
  v_mfma_f32_32x32x16_bf16 v[240:255], a[32:35], v[100:103], v[240:255]
  s_waitcnt vmcnt(11)
  v_mfma_f32_32x32x16_bf16 v[32:47], a[44:47], v[104:107], v[32:47]
  s_add_u32 s23, s19, 10240
  buffer_load_dwordx4 v[84:87], v1, s[64:67], s23 offen sc1
  v_mfma_f32_32x32x16_bf16 v[16:31], a[40:43], v[104:107], v[16:31]
  s_waitcnt vmcnt(11)
  v_mfma_f32_32x32x16_bf16 v[48:63], a[44:47], v[108:111], v[48:63]
  s_add_u32 s23, s18, 11264
  buffer_load_dwordx4 v[88:91], v1, s[64:67], s23 offen sc1
  buffer_load_dword v14, v13, s[64:67], s89 offen sc1
  v_mfma_f32_32x32x16_bf16 v[240:255], a[40:43], v[108:111], v[240:255]
  s_waitcnt vmcnt(12)
  v_mfma_f32_32x32x16_bf16 v[32:47], a[52:55], v[112:115], v[32:47]
  s_add_u32 s23, s19, 11264
  buffer_load_dwordx4 v[92:95], v1, s[64:67], s23 offen sc1
  v_mfma_f32_32x32x16_bf16 v[16:31], a[48:51], v[112:115], v[16:31]
  s_waitcnt vmcnt(12)
  v_mfma_f32_32x32x16_bf16 v[48:63], a[52:55], v[116:119], v[48:63]
  s_add_u32 s23, s18, 12288
  buffer_load_dwordx4 v[96:99], v1, s[64:67], s23 offen sc1
  v_mfma_f32_32x32x16_bf16 v[240:255], a[48:51], v[116:119], v[240:255]
  s_waitcnt vmcnt(12)
  v_mfma_f32_32x32x16_bf16 v[32:47], a[60:63], v[120:123], v[32:47]
  s_add_u32 s23, s19, 12288
  buffer_load_dwordx4 v[100:103], v1, s[64:67], s23 offen sc1
  v_mfma_f32_32x32x16_bf16 v[16:31], a[56:59], v[120:123], v[16:31]
  s_waitcnt vmcnt(12)
  v_mfma_f32_32x32x16_bf16 v[48:63], a[60:63], v[124:127], v[48:63]
  s_add_u32 s23, s18, 13312
  buffer_load_dwordx4 v[104:107], v1, s[64:67], s23 offen sc1
  v_mfma_f32_32x32x16_bf16 v[240:255], a[56:59], v[124:127], v[240:255]
  s_waitcnt vmcnt(11)
  v_mfma_f32_32x32x16_bf16 v[32:47], a[68:71], v[64:67], v[32:47]
  s_add_u32 s23, s19, 13312
  buffer_load_dwordx4 v[108:111], v1, s[64:67], s23 offen sc1
  v_mfma_f32_32x32x16_bf16 v[16:31], a[64:67], v[64:67], v[16:31]
  s_waitcnt vmcnt(11)
  v_mfma_f32_32x32x16_bf16 v[48:63], a[68:71], v[68:71], v[48:63]
  v_mfma_f32_32x32x16_bf16 v[240:255], a[64:67], v[68:71], v[240:255]
  s_waitcnt vmcnt(10)
  v_mfma_f32_32x32x16_bf16 v[32:47], a[76:79], v[72:75], v[32:47]
  v_mfma_f32_32x32x16_bf16 v[16:31], a[72:75], v[72:75], v[16:31]
  s_waitcnt vmcnt(5)
  v_cmp_eq_u32 vcc, 0, v14
  s_nop 0
  s_cbranch_vccnz L147
L148:
  v_mfma_f32_32x32x16_bf16 v[48:63], a[76:79], v[76:79], v[48:63]
  s_add_u32 s23, s20, 57344
  buffer_load_dwordx4 v[112:115], v1, s[64:67], s23 offen sc1
  v_mfma_f32_32x32x16_bf16 v[240:255], a[72:75], v[76:79], v[240:255]
  s_add_u32 s23, s21, 57344
  buffer_load_dwordx4 v[116:119], v1, s[64:67], s23 offen sc1
  v_mfma_f32_32x32x16_bf16 v[32:47], a[84:87], v[80:83], v[32:47]
  s_add_u32 s23, s20, 58368
  buffer_load_dwordx4 v[120:123], v1, s[64:67], s23 offen sc1
  v_mfma_f32_32x32x16_bf16 v[16:31], a[80:83], v[80:83], v[16:31]
  s_add_u32 s23, s21, 58368
  buffer_load_dwordx4 v[124:127], v1, s[64:67], s23 offen sc1
  v_mfma_f32_32x32x16_bf16 v[48:63], a[84:87], v[84:87], v[48:63]
  s_add_u32 s23, s20, 59392
  buffer_load_dwordx4 v[64:67], v1, s[64:67], s23 offen sc1
  v_mfma_f32_32x32x16_bf16 v[240:255], a[80:83], v[84:87], v[240:255]
  v_mfma_f32_32x32x16_bf16 v[32:47], a[92:95], v[88:91], v[32:47]
  s_add_u32 s23, s20, 60416
  buffer_load_dwordx4 v[68:71], v1, s[64:67], s23 offen sc1
  v_mfma_f32_32x32x16_bf16 v[16:31], a[88:91], v[88:91], v[16:31]
  s_waitcnt vmcnt(10)
  v_mfma_f32_32x32x16_bf16 v[48:63], a[92:95], v[92:95], v[48:63]
  s_add_u32 s23, s20, 61440
  buffer_load_dwordx4 v[72:75], v1, s[64:67], s23 offen sc1
  v_mfma_f32_32x32x16_bf16 v[240:255], a[88:91], v[92:95], v[240:255]
  s_waitcnt vmcnt(10)
  v_mfma_f32_32x32x16_bf16 v[32:47], a[100:103], v[96:99], v[32:47]
  s_add_u32 s23, s20, 62464
  buffer_load_dwordx4 v[76:79], v1, s[64:67], s23 offen sc1
  v_mfma_f32_32x32x16_bf16 v[16:31], a[96:99], v[96:99], v[16:31]
  s_waitcnt vmcnt(10)
  v_mfma_f32_32x32x16_bf16 v[48:63], a[100:103], v[100:103], v[48:63]
  s_add_u32 s23, s20, 63488
  buffer_load_dwordx4 v[80:83], v1, s[64:67], s23 offen sc1
  v_mfma_f32_32x32x16_bf16 v[240:255], a[96:99], v[100:103], v[240:255]
  s_waitcnt vmcnt(10)
  v_mfma_f32_32x32x16_bf16 v[32:47], a[108:111], v[104:107], v[32:47]
  s_add_u32 s23, s18, 64512
  buffer_load_dwordx4 v[84:87], v1, s[64:67], s23 offen sc1
  v_mfma_f32_32x32x16_bf16 v[16:31], a[104:107], v[104:107], v[16:31]
  s_waitcnt vmcnt(10)
  v_mfma_f32_32x32x16_bf16 v[48:63], a[108:111], v[108:111], v[48:63]
  s_add_u32 s23, s18, 65536
  buffer_load_dwordx4 v[88:91], v1, s[64:67], s23 offen sc1
  v_mfma_f32_32x32x16_bf16 v[240:255], a[104:107], v[108:111], v[240:255]
  s_waitcnt vmcnt(10)
  v_mfma_f32_32x32x16_bf16 v[32:47], a[116:119], v[112:115], v[32:47]
  s_add_u32 s23, s18, 66560
  buffer_load_dwordx4 v[92:95], v1, s[64:67], s23 offen sc1
  v_mfma_f32_32x32x16_bf16 v[16:31], a[112:115], v[112:115], v[16:31]
  s_waitcnt vmcnt(10)
  v_mfma_f32_32x32x16_bf16 v[48:63], a[116:119], v[116:119], v[48:63]
  s_add_u32 s23, s18, 67584
  buffer_load_dwordx4 v[96:99], v1, s[64:67], s23 offen sc1
  v_mfma_f32_32x32x16_bf16 v[240:255], a[112:115], v[116:119], v[240:255]
  s_waitcnt vmcnt(10)
  v_mfma_f32_32x32x16_bf16 v[32:47], a[124:127], v[120:123], v[32:47]
  s_add_u32 s23, s18, 68608
  buffer_load_dwordx4 v[100:103], v1, s[64:67], s23 offen sc1
  v_mfma_f32_32x32x16_bf16 v[16:31], a[120:123], v[120:123], v[16:31]
  s_waitcnt vmcnt(10)
  v_mfma_f32_32x32x16_bf16 v[48:63], a[124:127], v[124:127], v[48:63]
  s_add_u32 s23, s18, 69632
  buffer_load_dwordx4 v[104:107], v1, s[64:67], s23 offen sc1
  v_mfma_f32_32x32x16_bf16 v[240:255], a[120:123], v[124:127], v[240:255]
  s_waitcnt vmcnt(10)
  v_mfma_f32_32x32x16_bf16 v[32:47], a[132:135], v[64:67], v[32:47]
  s_add_u32 s23, s18, 70656
  buffer_load_dwordx4 v[108:111], v1, s[64:67], s23 offen sc1
  v_mfma_f32_32x32x16_bf16 v[16:31], a[128:131], v[64:67], v[16:31]
  s_waitcnt vmcnt(10)
  v_mfma_f32_32x32x16_bf16 v[32:47], a[140:143], v[68:71], v[32:47]
  s_add_u32 s23, s21, 59392
  buffer_load_dwordx4 v[112:115], v1, s[64:67], s23 offen sc1
  v_mfma_f32_32x32x16_bf16 v[16:31], a[136:139], v[68:71], v[16:31]
  s_waitcnt vmcnt(10)
  v_mfma_f32_32x32x16_bf16 v[32:47], a[148:151], v[72:75], v[32:47]
  s_add_u32 s23, s21, 60416
  buffer_load_dwordx4 v[116:119], v1, s[64:67], s23 offen sc1
  v_mfma_f32_32x32x16_bf16 v[16:31], a[144:147], v[72:75], v[16:31]
  s_waitcnt vmcnt(10)
  v_mfma_f32_32x32x16_bf16 v[32:47], a[156:159], v[76:79], v[32:47]
  s_add_u32 s23, s21, 61440
  buffer_load_dwordx4 v[120:123], v1, s[64:67], s23 offen sc1
  v_mfma_f32_32x32x16_bf16 v[16:31], a[152:155], v[76:79], v[16:31]
  s_waitcnt vmcnt(10)
  v_mfma_f32_32x32x16_bf16 v[32:47], a[164:167], v[80:83], v[32:47]
  s_add_u32 s23, s21, 62464
  buffer_load_dwordx4 v[124:127], v1, s[64:67], s23 offen sc1
  v_mfma_f32_32x32x16_bf16 v[16:31], a[160:163], v[80:83], v[16:31]
  s_waitcnt vmcnt(10)
  v_mfma_f32_32x32x16_bf16 v[32:47], a[172:175], v[84:87], v[32:47]
  s_add_u32 s23, s21, 63488
  buffer_load_dwordx4 v[64:67], v1, s[64:67], s23 offen sc1
  v_mfma_f32_32x32x16_bf16 v[16:31], a[168:171], v[84:87], v[16:31]
  s_waitcnt vmcnt(10)
  v_mfma_f32_32x32x16_bf16 v[32:47], a[180:183], v[88:91], v[32:47]
  s_add_u32 s23, s19, 64512
  buffer_load_dwordx4 v[68:71], v1, s[64:67], s23 offen sc1
  v_mfma_f32_32x32x16_bf16 v[16:31], a[176:179], v[88:91], v[16:31]
  s_waitcnt vmcnt(10)
  v_mfma_f32_32x32x16_bf16 v[32:47], a[188:191], v[92:95], v[32:47]
  s_add_u32 s23, s19, 65536
  buffer_load_dwordx4 v[72:75], v1, s[64:67], s23 offen sc1
  v_mfma_f32_32x32x16_bf16 v[16:31], a[184:187], v[92:95], v[16:31]
  s_waitcnt vmcnt(10)
  v_mfma_f32_32x32x16_bf16 v[32:47], a[196:199], v[96:99], v[32:47]
  s_add_u32 s23, s19, 66560
  buffer_load_dwordx4 v[76:79], v1, s[64:67], s23 offen sc1
  v_mfma_f32_32x32x16_bf16 v[16:31], a[192:195], v[96:99], v[16:31]
  s_waitcnt vmcnt(10)
  v_mfma_f32_32x32x16_bf16 v[32:47], a[204:207], v[100:103], v[32:47]
  s_add_u32 s23, s19, 67584
  buffer_load_dwordx4 v[80:83], v1, s[64:67], s23 offen sc1
  v_mfma_f32_32x32x16_bf16 v[16:31], a[200:203], v[100:103], v[16:31]
  s_waitcnt vmcnt(10)
  v_mfma_f32_32x32x16_bf16 v[32:47], a[212:215], v[104:107], v[32:47]
  s_add_u32 s23, s19, 68608
  buffer_load_dwordx4 v[84:87], v1, s[64:67], s23 offen sc1
  v_mfma_f32_32x32x16_bf16 v[16:31], a[208:211], v[104:107], v[16:31]
  s_waitcnt vmcnt(10)
  v_mfma_f32_32x32x16_bf16 v[32:47], a[220:223], v[108:111], v[32:47]
  s_add_u32 s23, s19, 69632
  buffer_load_dwordx4 v[88:91], v1, s[64:67], s23 offen sc1
  v_mfma_f32_32x32x16_bf16 v[16:31], a[216:219], v[108:111], v[16:31]
  s_waitcnt vmcnt(10)
  v_mfma_f32_32x32x16_bf16 v[48:63], a[132:135], v[112:115], v[48:63]
  s_add_u32 s23, s19, 70656
  buffer_load_dwordx4 v[92:95], v1, s[64:67], s23 offen sc1
  v_mfma_f32_32x32x16_bf16 v[240:255], a[128:131], v[112:115], v[240:255]
  s_waitcnt vmcnt(10)
  v_mfma_f32_32x32x16_bf16 v[48:63], a[140:143], v[116:119], v[48:63]
  v_mfma_f32_32x32x16_bf16 v[240:255], a[136:139], v[116:119], v[240:255]
  s_waitcnt vmcnt(9)
  v_mfma_f32_32x32x16_bf16 v[48:63], a[148:151], v[120:123], v[48:63]
  ds_write_b128 v226, v[32:35] offset:0
  v_mfma_f32_32x32x16_bf16 v[240:255], a[144:147], v[120:123], v[240:255]
  ds_write_b128 v226, v[36:39] offset:1024
  s_waitcnt vmcnt(8)
  v_mfma_f32_32x32x16_bf16 v[48:63], a[156:159], v[124:127], v[48:63]
  ds_write_b128 v226, v[40:43] offset:2048
  v_mfma_f32_32x32x16_bf16 v[240:255], a[152:155], v[124:127], v[240:255]
  ds_write_b128 v226, v[44:47] offset:3072
  s_waitcnt vmcnt(7)
  v_mfma_f32_32x32x16_bf16 v[48:63], a[164:167], v[64:67], v[48:63]
  ds_write_b128 v225, v[16:19] offset:0
  v_mfma_f32_32x32x16_bf16 v[240:255], a[160:163], v[64:67], v[240:255]
  ds_write_b128 v225, v[20:23] offset:1024
  s_waitcnt vmcnt(6)
  v_mfma_f32_32x32x16_bf16 v[48:63], a[172:175], v[68:71], v[48:63]
  ds_write_b128 v225, v[24:27] offset:2048
  v_mfma_f32_32x32x16_bf16 v[240:255], a[168:171], v[68:71], v[240:255]
  ds_write_b128 v225, v[28:31] offset:3072
  s_waitcnt vmcnt(5)
  v_mfma_f32_32x32x16_bf16 v[48:63], a[180:183], v[72:75], v[48:63]
  s_waitcnt lgkmcnt(0)
  s_barrier
  ds_read_b128 v[144:147], v227 offset:4096
  ds_read_b128 v[148:151], v227 offset:5120
  v_mfma_f32_32x32x16_bf16 v[240:255], a[176:179], v[72:75], v[240:255]
  ds_read_b128 v[152:155], v227 offset:6144
  ds_read_b128 v[156:159], v227 offset:7168
  s_waitcnt vmcnt(4)
  v_mfma_f32_32x32x16_bf16 v[48:63], a[188:191], v[76:79], v[48:63]
  ds_read_b128 v[160:163], v227 offset:8192
  ds_read_b128 v[164:167], v227 offset:9216
  v_mfma_f32_32x32x16_bf16 v[240:255], a[184:187], v[76:79], v[240:255]
  ds_read_b128 v[168:171], v227 offset:10240
  ds_read_b128 v[172:175], v227 offset:11264
  s_waitcnt vmcnt(3)
  v_mfma_f32_32x32x16_bf16 v[48:63], a[196:199], v[80:83], v[48:63]
  s_waitcnt lgkmcnt(3)
  v_add_f32 v144, v144, v160
  v_add_f32 v145, v145, v161
  v_add_f32 v146, v146, v162
  v_add_f32 v147, v147, v163
  s_waitcnt vmcnt(2)
  v_mfma_f32_32x32x16_bf16 v[48:63], a[204:207], v[84:87], v[48:63]
  s_waitcnt lgkmcnt(2)
  v_add_f32 v148, v148, v164
  v_add_f32 v149, v149, v165
  v_add_f32 v150, v150, v166
  v_add_f32 v151, v151, v167
  s_waitcnt vmcnt(1)
  v_mfma_f32_32x32x16_bf16 v[48:63], a[212:215], v[88:91], v[48:63]
  s_waitcnt lgkmcnt(1)
  v_add_f32 v152, v152, v168
  v_add_f32 v153, v153, v169
  v_add_f32 v154, v154, v170
  v_add_f32 v155, v155, v171
  s_waitcnt vmcnt(0)
  v_mfma_f32_32x32x16_bf16 v[48:63], a[220:223], v[92:95], v[48:63]
  s_waitcnt lgkmcnt(0)
  v_add_f32 v156, v156, v172
  v_add_f32 v157, v157, v173
  v_add_f32 v158, v158, v174
  v_add_f32 v159, v159, v175
  v_mfma_f32_32x32x16_bf16 v[240:255], a[192:195], v[80:83], v[240:255]
  v_mfma_f32_32x32x16_bf16 v[240:255], a[200:203], v[84:87], v[240:255]
  s_nop 4
  ds_write_b128 v224, v[48:51] offset:0
  v_mfma_f32_32x32x16_bf16 v[240:255], a[208:211], v[88:91], v[240:255]
  ds_write_b128 v224, v[52:55] offset:1024
  v_mfma_f32_32x32x16_bf16 v[240:255], a[216:219], v[92:95], v[240:255]
  ds_write_b128 v224, v[56:59] offset:2048
  ds_write_b128 v224, v[60:63] offset:3072
  s_nop 9
  v_pk_add_f32 v[240:241], v[240:241], v[144:145]
  v_pk_add_f32 v[242:243], v[242:243], v[146:147]
  v_pk_add_f32 v[244:245], v[244:245], v[148:149]
  v_pk_add_f32 v[246:247], v[246:247], v[150:151]
  v_pk_add_f32 v[248:249], v[248:249], v[152:153]
  v_pk_add_f32 v[250:251], v[250:251], v[154:155]
  v_pk_add_f32 v[252:253], v[252:253], v[156:157]
  v_pk_add_f32 v[254:255], v[254:255], v[158:159]
  s_waitcnt lgkmcnt(0)
  s_barrier
  ds_read_b128 v[128:131], v227 offset:0
  ds_read_b128 v[132:135], v227 offset:1024
  ds_read_b128 v[136:139], v227 offset:2048
  ds_read_b128 v[140:143], v227 offset:3072
  s_waitcnt lgkmcnt(3)
  v_pk_add_f32 v[240:241], v[240:241], v[128:129]
  v_pk_add_f32 v[242:243], v[242:243], v[130:131]
  s_waitcnt lgkmcnt(2)
  v_pk_add_f32 v[244:245], v[244:245], v[132:133]
  v_pk_add_f32 v[246:247], v[246:247], v[134:135]
  s_waitcnt lgkmcnt(1)
  v_pk_add_f32 v[248:249], v[248:249], v[136:137]
  v_pk_add_f32 v[250:251], v[250:251], v[138:139]
  s_waitcnt lgkmcnt(0)
  v_pk_add_f32 v[252:253], v[252:253], v[140:141]
  v_pk_add_f32 v[254:255], v[254:255], v[142:143]
  v_cvt_pk_bf16_f32 v16, v240, v241
  v_cvt_pk_bf16_f32 v17, v242, v243
  v_cvt_pk_bf16_f32 v18, v244, v245
  v_cvt_pk_bf16_f32 v19, v246, v247
  v_cvt_pk_bf16_f32 v20, v248, v249
  v_cvt_pk_bf16_f32 v21, v250, v251
  v_cvt_pk_bf16_f32 v22, v252, v253
  v_cvt_pk_bf16_f32 v23, v254, v255
  v_permlane32_swap_b32 v16, v18
  v_permlane32_swap_b32 v17, v19
  v_permlane32_swap_b32 v20, v22
  v_permlane32_swap_b32 v21, v23
  ds_write_b128 v234, v[16:19]
  ds_write_b128 v235, v[20:23]
  s_waitcnt lgkmcnt(0)
  s_barrier
  ds_read_b128 v[24:27], v236 offset:0
  ds_read_b128 v[28:31], v236 offset:1024
  s_waitcnt lgkmcnt(1)
  buffer_store_dwordx4 v[24:27], v232, s[56:59], s24 offen nt
  s_waitcnt lgkmcnt(0)
  buffer_store_dwordx4 v[28:31], v232, s[56:59], s25 offen nt
L104:
L_end:
L_abort:
L_exit:
  s_endpgm
L2:
  s_mov_b32 s95, 131072
L149:
  buffer_load_dword v12, v13, s[60:63], 0 offen sc1
  s_sub_u32 s95, s95, 1
  s_cbranch_scc1 L_abort
  s_waitcnt vmcnt(0)
  v_cmp_eq_u32 vcc, 0, v12
  s_nop 0
  s_cbranch_vccnz L149
  s_branch L3
L4:
  s_mov_b32 s95, 131072
L150:
  buffer_load_dword v12, off, s[64:67], s16 sc1
  s_waitcnt vmcnt(0)
  v_cmp_eq_u32 vcc, 0, v12
  s_nop 0
  s_cbranch_vccz L5
  buffer_load_dword v12, off, s[64:67], s16 sc1
  s_waitcnt vmcnt(0)
  v_cmp_eq_u32 vcc, 0, v12
  s_nop 0
  s_cbranch_vccz L5
  buffer_load_dword v12, off, s[64:67], s16 sc1
  s_waitcnt vmcnt(0)
  v_cmp_eq_u32 vcc, 0, v12
  s_nop 0
  s_cbranch_vccz L5
  s_mov_b64 exec, 0x3
  buffer_load_dword v13, v232, s[64:67], s9 offen sc1
  s_mov_b64 exec, -1
  s_sub_u32 s95, s95, 1
  s_cbranch_scc1 L_abort
  s_waitcnt vmcnt(0)
  v_cmp_ne_u32 s[86:87], 0, v13
  s_nop 2
  s_andn2_b32 s87, 3, s86
  s_cbranch_scc1 L150
  s_branch L5
L6:
  s_mov_b32 s95, 131072
L151:
  s_mov_b64 exec, 0xc
  buffer_load_dword v13, v232, s[64:67], s9 offen sc1
  s_mov_b64 exec, -1
  s_sub_u32 s95, s95, 1
  s_cbranch_scc1 L_abort
  s_waitcnt vmcnt(0)
  v_cmp_ne_u32 s[86:87], 0, v13
  s_nop 2
  s_andn2_b32 s3, 0xc, s86
  s_cbranch_scc1 L151
  s_branch L7
L9:
  v_mov_b32 v240, -1
  v_mov_b32 v244, 0
  v_mov_b32 v241, -1
  v_mov_b32 v245, 0
  v_mov_b32 v242, -1
  v_mov_b32 v246, 0
  v_mov_b32 v243, -1
  v_mov_b32 v247, 0
  s_lshl_b32 s4, s71, 2
  s_lshl_b32 s3, s68, 3
  s_add_u32 s4, s4, s3
  s_add_u32 s4, s4, s72
  s_add_u32 s4, s4, 0xfffffff0
  s_lshl_b32 s5, s4, 11
  s_add_u32 s5, s5, 0x1840000
  buffer_store_dwordx4 v[240:243], v1, s[64:67], s5 offen offset:0 sc1
  buffer_store_dwordx4 v[240:243], v1, s[64:67], s5 offen offset:1024 sc1
  s_lshl_b32 s5, s4, 10
  s_add_u32 s5, s5, 0x1820000
  buffer_store_dwordx4 v[244:247], v1, s[64:67], s5 offen offset:0 sc1
  s_add_u32 s5, s5, 0x180000
  buffer_store_dwordx4 v[244:247], v1, s[64:67], s5 offen offset:0 sc1
  s_lshl_b32 s5, s68, 8
  s_lshl_b32 s3, s71, 7
  s_add_u32 s5, s5, s3
  s_add_u32 s5, s5, 0x18bfe00
  s_mov_b64 exec, 0xff
  buffer_store_dwordx4 v[244:247], v1, s[64:67], s5 offen offset:0 sc1
  s_mov_b64 exec, -1
  s_nop 1
  s_branch L10
L11:
  s_mov_b32 s95, 131072
L152:
  s_mov_b64 exec, 0x30
  buffer_load_dword v13, v232, s[64:67], s9 offen sc1
  s_mov_b64 exec, -1
  s_sub_u32 s95, s95, 1
  s_cbranch_scc1 L_abort
  s_waitcnt vmcnt(0)
  v_cmp_ne_u32 s[86:87], 0, v13
  s_nop 2
  s_andn2_b32 s3, 0x30, s86
  s_cbranch_scc1 L152
  s_branch L12
L13:
  s_mov_b32 s95, 131072
L153:
  s_mov_b64 exec, 0xc0
  buffer_load_dword v13, v232, s[64:67], s9 offen sc1
  s_mov_b64 exec, -1
  s_sub_u32 s95, s95, 1
  s_cbranch_scc1 L_abort
  s_waitcnt vmcnt(0)
  v_cmp_ne_u32 s[86:87], 0, v13
  s_nop 2
  s_andn2_b32 s3, 0xc0, s86
  s_cbranch_scc1 L153
  s_branch L14
L15:
  s_mov_b32 s95, 131072
L154:
  s_mov_b64 exec, 0xff00
  buffer_load_dword v13, v232, s[64:67], s9 offen sc1
  s_mov_b64 exec, -1
  s_sub_u32 s95, s95, 1
  s_cbranch_scc1 L_abort
  s_waitcnt vmcnt(0)
  v_cmp_ne_u32 s[86:87], 0, v13
  s_nop 2
  s_andn2_b32 s3, 0xff00, s86
  s_cbranch_scc1 L154
  s_branch L16
L17:
  s_mov_b32 s95, 131072
L155:
  buffer_load_dword v229, v228, s[64:67], s14 offen sc1
  s_sub_u32 s95, s95, 1
  s_cbranch_scc1 L_abort
  s_waitcnt vmcnt(0)
  v_cmp_eq_u32 vcc, 0, v229
  s_nop 0
  s_cbranch_vccnz L155
  s_branch L18
L19:
  s_mov_b32 s95, 131072
L156:
  buffer_load_dword v12, v10, s[64:67], s73 offen sc1
  s_sub_u32 s95, s95, 1
  s_cbranch_scc1 L_abort
  s_waitcnt vmcnt(0)
  v_cmp_eq_u32 vcc, 0, v12
  s_nop 0
  s_cbranch_vccnz L156
  s_branch L20
L21:
  v_mov_b32 v240, -1
  v_mov_b32 v241, -1
  v_mov_b32 v242, -1
  v_mov_b32 v243, -1
  s_mul_i32 s5, s71, 20480
  s_mul_i32 s3, s72, 5120
  s_add_u32 s5, s5, s3
  s_add_u32 s5, s5, s73
  s_add_u32 s5, s5, 0xb0000
  buffer_store_dwordx4 v[240:243], v1, s[64:67], s5 offen offset:0 sc1
  buffer_store_dwordx4 v[240:243], v1, s[64:67], s5 offen offset:1024 sc1
  buffer_store_dwordx4 v[240:243], v1, s[64:67], s5 offen offset:2048 sc1
  buffer_store_dwordx4 v[240:243], v1, s[64:67], s5 offen offset:3072 sc1
  s_add_u32 s5, s5, 0x1000
  buffer_store_dwordx4 v[240:243], v1, s[64:67], s5 offen offset:0 sc1
  s_nop 1
  s_branch L22
L23:
  s_waitcnt vmcnt(0) lgkmcnt(0)
  s_and_b32 s6, s10, 0xffffc000
  s_add_u32 s5, s6, 262144
  v_mov_b32 v230, 0xff7fffff
  v_mov_b32 v96, 0
  v_mov_b32 v97, 0
  v_mov_b32 v98, 0
  v_mov_b32 v99, 0
  v_mov_b32 v100, 0
  v_mov_b32 v101, 0
  v_mov_b32 v102, 0
  v_mov_b32 v103, 0
  v_mov_b32 v104, 0
  v_mov_b32 v105, 0
  v_mov_b32 v106, 0
  v_mov_b32 v107, 0
  v_mov_b32 v108, 0
  v_mov_b32 v109, 0
  v_mov_b32 v110, 0
  v_mov_b32 v111, 0
L157:
  buffer_load_dwordx4 v[176:179], v1, s[64:67], s6 offen offset:0 sc1
  buffer_load_dwordx4 v[180:183], v1, s[64:67], s6 offen offset:1024 sc1
  buffer_load_dwordx4 v[184:187], v1, s[64:67], s6 offen offset:2048 sc1
  buffer_load_dwordx4 v[188:191], v1, s[64:67], s6 offen offset:3072 sc1
  s_waitcnt vmcnt(3)
  v_mfma_f32_32x32x16_bf16 v[112:127], v[176:179], v[40:43], 0
  s_waitcnt vmcnt(2)
  v_mfma_f32_32x32x16_bf16 v[112:127], v[180:183], v[44:47], v[112:127]
  s_nop 11
  v_max3_f32 v231, v230, v112, v113
  v_max3_f32 v231, v231, v114, v115
  v_max3_f32 v231, v231, v116, v117
  v_max3_f32 v231, v231, v118, v119
  v_max3_f32 v231, v231, v120, v121
  v_max3_f32 v231, v231, v122, v123
  v_max3_f32 v231, v231, v124, v125
  v_max3_f32 v231, v231, v126, v127
  v_mov_b32 v233, v231
  s_nop 1
  v_permlane32_swap_b32 v233, v231
  v_max_f32 v231, v231, v233
  v_sub_f32 v233, v230, v231
  v_exp_f32 v233, v233
  v_mov_b32 v230, v231
  v_sub_f32 v112, v112, v231
  v_sub_f32 v113, v113, v231
  v_sub_f32 v114, v114, v231
  v_sub_f32 v115, v115, v231
  v_sub_f32 v116, v116, v231
  v_sub_f32 v117, v117, v231
  v_sub_f32 v118, v118, v231
  v_sub_f32 v119, v119, v231
  v_sub_f32 v120, v120, v231
  v_sub_f32 v121, v121, v231
  v_sub_f32 v122, v122, v231
  v_sub_f32 v123, v123, v231
  v_sub_f32 v124, v124, v231
  v_sub_f32 v125, v125, v231
  v_sub_f32 v126, v126, v231
  v_sub_f32 v127, v127, v231
  v_exp_f32 v112, v112
  v_exp_f32 v113, v113
  v_exp_f32 v114, v114
  v_exp_f32 v115, v115
  v_exp_f32 v116, v116
  v_exp_f32 v117, v117
  v_exp_f32 v118, v118
  v_exp_f32 v119, v119
  v_exp_f32 v120, v120
  v_exp_f32 v121, v121
  v_exp_f32 v122, v122
  v_exp_f32 v123, v123
  v_exp_f32 v124, v124
  v_exp_f32 v125, v125
  v_exp_f32 v126, v126
  v_exp_f32 v127, v127
  v_mul_f32 v96, v96, v233
  v_mul_f32 v97, v97, v233
  v_mul_f32 v98, v98, v233
  v_mul_f32 v99, v99, v233
  v_mul_f32 v100, v100, v233
  v_mul_f32 v101, v101, v233
  v_mul_f32 v102, v102, v233
  v_mul_f32 v103, v103, v233
  v_mul_f32 v104, v104, v233
  v_mul_f32 v105, v105, v233
  v_mul_f32 v106, v106, v233
  v_mul_f32 v107, v107, v233
  v_mul_f32 v108, v108, v233
  v_mul_f32 v109, v109, v233
  v_mul_f32 v110, v110, v233
  v_mul_f32 v111, v111, v233
  v_cvt_pk_bf16_f32 v144, v112, v113
  v_cvt_pk_bf16_f32 v145, v114, v115
  v_cvt_pk_bf16_f32 v146, v116, v117
  v_cvt_pk_bf16_f32 v147, v118, v119
  v_cvt_pk_bf16_f32 v148, v120, v121
  v_cvt_pk_bf16_f32 v149, v122, v123
  v_cvt_pk_bf16_f32 v150, v124, v125
  v_cvt_pk_bf16_f32 v151, v126, v127
  s_waitcnt vmcnt(1)
  v_mfma_f32_32x32x16_bf16 v[96:111], v[184:187], v[144:147], v[96:111]
  s_waitcnt vmcnt(0)
  v_mfma_f32_32x32x16_bf16 v[96:111], v[188:191], v[148:151], v[96:111]
  s_add_u32 s6, s6, 4096
  s_cmp_lt_u32 s6, s5
  s_nop 15
  s_cbranch_scc1 L157
  v_mov_b32 v230, v108
  v_mov_b32 v232, v108
  s_nop 1
  v_permlane32_swap_b32 v230, v232
  s_branch L24
L25:
  buffer_store_dwordx4 v[144:147], v1, s[64:67], s4 offen offset:0 sc1
  buffer_store_dwordx4 v[148:151], v1, s[64:67], s4 offen offset:1024 sc1
  s_nop 0
  s_branch L26
L29:
  buffer_store_dword v233, off, s[64:67], s82 offset:512 sc1
  s_nop 0
  s_branch L30
L33:
  buffer_store_dwordx4 v[192:195], v1, s[64:67], s24 offen offset:0 sc1
  buffer_store_dwordx4 v[196:199], v1, s[64:67], s24 offen offset:1024 sc1
  s_nop 0
  s_branch L34
L35:
  buffer_store_dword v233, off, s[64:67], s82 offset:768 sc1
  s_nop 0
  s_branch L36
L39:
  buffer_store_dword v14, v2, s[64:67], s89 offen sc1
  s_nop 0
  s_branch L40
L41:
  s_mov_b32 s3, 131072
L158:
  buffer_load_dword v208, v11, s[64:67], s25 offen sc1
  s_sub_u32 s3, s3, 1
  s_cbranch_scc1 L_abort
  s_waitcnt vmcnt(0)
  v_cmp_eq_u32 vcc, -1, v208
  s_nop 0
  s_cbranch_vccnz L158
  s_branch L42
L43:
  s_mov_b32 s95, 131072
L159:
  buffer_load_dword v208, v2, s[64:67], s14 offen offset:0 sc1
  buffer_load_dword v209, v2, s[64:67], s14 offen offset:256 sc1
  buffer_load_dword v210, v2, s[64:67], s14 offen offset:512 sc1
  buffer_load_dword v211, v2, s[64:67], s14 offen offset:768 sc1
  buffer_load_dword v212, v2, s[64:67], s14 offen offset:1024 sc1
  buffer_load_dword v213, v2, s[64:67], s14 offen offset:1280 sc1
  buffer_load_dword v214, v2, s[64:67], s14 offen offset:1536 sc1
  s_sub_u32 s95, s95, 1
  s_cbranch_scc1 L_abort
  s_waitcnt vmcnt(0)
  v_max3_u32 v141, v208, v209, v210
  v_max3_u32 v140, v211, v212, v213
  v_max3_u32 v141, v141, v140, v214
  v_cmp_eq_u32 vcc, -1, v141
  s_nop 0
  s_cbranch_vccnz L159
  s_branch L44
L45:
  buffer_store_dwordx4 v[192:195], v216, s[64:67], s24 offen offset:0 sc1
  s_nop 0
  s_branch L46
L47:
  buffer_store_dwordx4 v[196:199], v217, s[64:67], s24 offen offset:1024 sc1
  s_nop 0
  s_branch L48
L49:
  buffer_store_dword v233, off, s[64:67], s82 offset:1024 sc1
  s_nop 0
  s_branch L50
L53:
  s_mov_b32 s3, 131072
L160:
  buffer_load_dword v220, v11, s[64:67], s25 offen offset:0 sc1
  buffer_load_dword v221, v11, s[64:67], s25 offen offset:128 sc1
  buffer_load_dword v222, v11, s[64:67], s9 offen offset:0 sc1
  buffer_load_dword v223, v11, s[64:67], s9 offen offset:128 sc1
  s_sub_u32 s3, s3, 1
  s_cbranch_scc1 L_abort
  s_waitcnt vmcnt(0)
  v_max3_u32 v217, v220, v221, v222
  v_max_u32 v217, v217, v223
  v_cmp_eq_u32 vcc, -1, v217
  s_nop 0
  s_cbranch_vccnz L160
  s_branch L54
L55:
  s_mov_b32 s95, 131072
L161:
  s_sub_u32 s95, s95, 1
  s_cbranch_scc1 L_abort
  s_add_u32 s23, s21, 0
  buffer_load_dwordx4 v[172:175], v216, s[64:67], s23 offen offset:0 sc1
  buffer_load_dwordx4 v[144:147], v216, s[64:67], s23 offen offset:1024 sc1
  buffer_load_dwordx4 v[148:151], v216, s[64:67], s23 offen offset:2048 sc1
  buffer_load_dwordx4 v[152:155], v216, s[64:67], s23 offen offset:3072 sc1
  s_add_u32 s23, s21, 4096
  buffer_load_dwordx4 v[156:159], v216, s[64:67], s23 offen offset:0 sc1
  buffer_load_dwordx4 v[160:163], v216, s[64:67], s23 offen offset:1024 sc1
  buffer_load_dwordx4 v[164:167], v216, s[64:67], s23 offen offset:2048 sc1
  s_waitcnt vmcnt(0)
  v_max_u32 v217, v172, v173
  v_max3_u32 v217, v217, v174, v175
  v_max3_u32 v217, v217, v144, v145
  v_max3_u32 v217, v217, v146, v147
  v_max3_u32 v217, v217, v148, v149
  v_max3_u32 v217, v217, v150, v151
  v_max3_u32 v217, v217, v152, v153
  v_max3_u32 v217, v217, v154, v155
  v_max3_u32 v217, v217, v156, v157
  v_max3_u32 v217, v217, v158, v159
  v_max3_u32 v217, v217, v160, v161
  v_max3_u32 v217, v217, v162, v163
  v_max3_u32 v217, v217, v164, v165
  v_max3_u32 v217, v217, v166, v167
  v_cmp_eq_u32 vcc, -1, v217
  s_nop 0
  s_cbranch_vccnz L161
  s_branch L56
L57:
  s_mov_b32 s95, 131072
L162:
  s_sub_u32 s95, s95, 1
  s_cbranch_scc1 L_abort
  s_add_u32 s23, s21, 0
  buffer_load_dwordx4 v[172:175], v216, s[64:67], s23 offen offset:0 sc1
  buffer_load_dwordx4 v[144:147], v216, s[64:67], s23 offen offset:1024 sc1
  buffer_load_dwordx4 v[148:151], v216, s[64:67], s23 offen offset:2048 sc1
  buffer_load_dwordx4 v[152:155], v216, s[64:67], s23 offen offset:3072 sc1
  s_add_u32 s23, s21, 4096
  buffer_load_dwordx4 v[156:159], v216, s[64:67], s23 offen offset:0 sc1
  buffer_load_dwordx4 v[160:163], v216, s[64:67], s23 offen offset:1024 sc1
  buffer_load_dwordx4 v[164:167], v216, s[64:67], s23 offen offset:2048 sc1
  s_waitcnt vmcnt(0)
  v_max_u32 v217, v172, v173
  v_max3_u32 v217, v217, v174, v175
  v_max3_u32 v217, v217, v144, v145
  v_max3_u32 v217, v217, v146, v147
  v_max3_u32 v217, v217, v148, v149
  v_max3_u32 v217, v217, v150, v151
  v_max3_u32 v217, v217, v152, v153
  v_max3_u32 v217, v217, v154, v155
  v_max3_u32 v217, v217, v156, v157
  v_max3_u32 v217, v217, v158, v159
  v_max3_u32 v217, v217, v160, v161
  v_max3_u32 v217, v217, v162, v163
  v_max3_u32 v217, v217, v164, v165
  v_max3_u32 v217, v217, v166, v167
  v_cmp_eq_u32 vcc, -1, v217
  s_nop 0
  s_cbranch_vccnz L162
  s_add_u32 s23, s20, 0
  buffer_load_dwordx4 v[144:147], v1, s[64:67], s23 offen offset:0 sc1
  buffer_load_dwordx4 v[148:151], v1, s[64:67], s23 offen offset:1024 sc1
  buffer_load_dwordx4 v[152:155], v1, s[64:67], s23 offen offset:2048 sc1
  buffer_load_dwordx4 v[156:159], v1, s[64:67], s23 offen offset:3072 sc1
  s_add_u32 s23, s20, 4096
  buffer_load_dwordx4 v[160:163], v1, s[64:67], s23 offen offset:0 sc1
  buffer_load_dwordx4 v[164:167], v1, s[64:67], s23 offen offset:1024 sc1
  buffer_load_dwordx4 v[168:171], v1, s[64:67], s23 offen offset:2048 sc1
  s_waitcnt vmcnt(6)
  v_mfma_f32_32x32x16_bf16 v[192:207], v[20:23], v[144:147], 0
  v_mfma_f32_32x32x16_bf16 v[176:191], v[16:19], v[144:147], v[128:143]
  s_waitcnt vmcnt(5)
  v_mfma_f32_32x32x16_bf16 v[192:207], v[28:31], v[148:151], v[192:207]
  v_mfma_f32_32x32x16_bf16 v[176:191], v[24:27], v[148:151], v[176:191]
  s_waitcnt vmcnt(4)
  v_mfma_f32_32x32x16_bf16 v[192:207], v[36:39], v[152:155], v[192:207]
  v_mfma_f32_32x32x16_bf16 v[176:191], v[32:35], v[152:155], v[176:191]
  s_waitcnt vmcnt(3)
  v_mfma_f32_32x32x16_bf16 v[192:207], v[44:47], v[156:159], v[192:207]
  v_mfma_f32_32x32x16_bf16 v[176:191], v[40:43], v[156:159], v[176:191]
  s_waitcnt vmcnt(2)
  v_mfma_f32_32x32x16_bf16 v[192:207], v[52:55], v[160:163], v[192:207]
  v_mfma_f32_32x32x16_bf16 v[176:191], v[48:51], v[160:163], v[176:191]
  s_waitcnt vmcnt(1)
  v_mfma_f32_32x32x16_bf16 v[192:207], v[60:63], v[164:167], v[192:207]
  v_mfma_f32_32x32x16_bf16 v[176:191], v[56:59], v[164:167], v[176:191]
  s_waitcnt vmcnt(0)
  v_mfma_f32_32x32x16_bf16 v[192:207], v[68:71], v[168:171], v[192:207]
  v_mfma_f32_32x32x16_bf16 v[176:191], v[64:67], v[168:171], v[176:191]
  s_add_u32 s23, s21, 0
  buffer_load_dwordx4 v[172:175], v216, s[64:67], s23 offen offset:0 sc1
  buffer_load_dwordx4 v[144:147], v216, s[64:67], s23 offen offset:1024 sc1
  buffer_load_dwordx4 v[148:151], v216, s[64:67], s23 offen offset:2048 sc1
  buffer_load_dwordx4 v[152:155], v216, s[64:67], s23 offen offset:3072 sc1
  s_add_u32 s23, s21, 4096
  buffer_load_dwordx4 v[156:159], v216, s[64:67], s23 offen offset:0 sc1
  buffer_load_dwordx4 v[160:163], v216, s[64:67], s23 offen offset:1024 sc1
  buffer_load_dwordx4 v[164:167], v216, s[64:67], s23 offen offset:2048 sc1
  s_waitcnt vmcnt(6)
  v_mfma_f32_32x32x16_bf16 v[192:207], v[76:79], v[172:175], v[192:207]
  v_mfma_f32_32x32x16_bf16 v[176:191], v[72:75], v[172:175], v[176:191]
  s_waitcnt vmcnt(5)
  v_mfma_f32_32x32x16_bf16 v[192:207], v[84:87], v[144:147], v[192:207]
  s_waitcnt vmcnt(4)
  v_mfma_f32_32x32x16_bf16 v[192:207], v[92:95], v[148:151], v[192:207]
  s_waitcnt vmcnt(3)
  v_mfma_f32_32x32x16_bf16 v[192:207], v[100:103], v[152:155], v[192:207]
  s_waitcnt vmcnt(2)
  v_mfma_f32_32x32x16_bf16 v[192:207], v[108:111], v[156:159], v[192:207]
  s_waitcnt vmcnt(1)
  v_mfma_f32_32x32x16_bf16 v[192:207], v[116:119], v[160:163], v[192:207]
  s_waitcnt vmcnt(0)
  v_mfma_f32_32x32x16_bf16 v[192:207], v[124:127], v[164:167], v[192:207]
  s_nop 15
  s_branch L58
L59:
  buffer_store_dwordx4 v[192:195], v1, s[64:67], s24 offen offset:0 sc1
  buffer_store_dwordx4 v[196:199], v1, s[64:67], s24 offen offset:1024 sc1
  s_nop 0
  s_branch L60
L61:
  buffer_store_dword v233, off, s[64:67], s82 offset:1280 sc1
  s_nop 0
  s_branch L62
L65:
  buffer_store_dword v14, v2, s[64:67], s89 offen sc1
  s_nop 0
  s_branch L66
L67:
  s_mov_b32 s95, 131072
L163:
  buffer_load_dword v176, v2, s[64:67], s8 offen offset:0 sc1
  buffer_load_dword v177, v2, s[64:67], s8 offen offset:256 sc1
  buffer_load_dword v178, v2, s[64:67], s8 offen offset:512 sc1
  buffer_load_dword v179, v2, s[64:67], s8 offen offset:768 sc1
  buffer_load_dword v180, v2, s[64:67], s8 offen offset:1024 sc1
  buffer_load_dword v181, v2, s[64:67], s8 offen offset:1280 sc1
  buffer_load_dword v182, v2, s[64:67], s8 offen offset:1536 sc1
  s_sub_u32 s95, s95, 1
  s_cbranch_scc1 L_abort
  s_waitcnt vmcnt(0)
  v_max3_u32 v239, v176, v177, v178
  v_max3_u32 v238, v179, v180, v181
  v_max3_u32 v239, v239, v238, v182
  v_cmp_eq_u32 vcc, -1, v239
  s_nop 0
  s_cbranch_vccnz L163
  s_branch L68
L69:
  buffer_store_dword v11, off, s[64:67], s82 offset:1536 sc1
  s_nop 0
  s_branch L70
L71:
  buffer_load_dword v14, v13, s[64:67], s88 offen sc1
  s_mov_b32 s95, 131072
L164:
  s_waitcnt vmcnt(0)
  v_cmp_eq_u32 vcc, 0, v14
  s_nop 0
  s_cbranch_vccz L165
  buffer_load_dword v14, v13, s[64:67], s88 offen sc1
  s_sub_u32 s95, s95, 1
  s_cbranch_scc0 L164
  s_branch L_abort
L165:
  s_branch L72
L73:
  buffer_store_dword v11, off, s[64:67], s82 offset:256 sc1
  s_nop 0
  s_branch L74
L75:
  buffer_load_dword v14, v13, s[64:67], s89 offen sc1
  s_mov_b32 s95, 131072
L166:
  s_waitcnt vmcnt(0)
  v_cmp_eq_u32 vcc, 0, v14
  s_nop 0
  s_cbranch_vccz L167
  buffer_load_dword v14, v13, s[64:67], s89 offen sc1
  s_sub_u32 s95, s95, 1
  s_cbranch_scc0 L166
  s_branch L_abort
L167:
  s_branch L76
L77:
  buffer_load_dword v231, v230, s[64:67], s14 offen sc1
  s_mov_b32 s95, 131072
L168:
  s_waitcnt vmcnt(0)
  v_cmp_eq_u32 vcc, 0, v231
  s_nop 0
  s_cbranch_vccz L169
  buffer_load_dword v231, v230, s[64:67], s14 offen sc1
  s_sub_u32 s95, s95, 1
  s_cbranch_scc0 L168
  s_branch L_abort
L169:
  s_branch L78
L79:
  buffer_store_dwordx4 v[16:19], v1, s[64:67], s24 offen offset:0 sc1
  buffer_store_dwordx4 v[20:23], v1, s[64:67], s24 offen offset:1024 sc1
  s_nop 0
  s_branch L80
L81:
  buffer_store_dword v233, off, s[64:67], s82 offset:1792 sc1
  s_nop 0
  s_branch L82
L83:
  buffer_store_dword v14, v2, s[64:67], s89 offen sc1
  s_nop 0
  s_branch L84
L27:
  s_waitcnt vmcnt(0) lgkmcnt(0)
  s_lshl_b32 s6, s68, 1
  s_add_u32 s6, s6, s71
  s_sub_u32 s7, s6, 4
  s_cmp_ge_u32 s6, 18
  s_cselect_b32 s8, 29184, 0
  s_lshl_b32 s10, s7, 8
  s_add_u32 s10, s10, s8
  s_add_u32 s10, s10, 0x1847000
  s_lshl_b32 s8, s7, 7
  s_mul_i32 s3, s72, 401408
  s_add_u32 s8, s8, s3
  s_cmp_ge_u32 s6, 4
  s_cselect_b32 s8, s8, 0x7f000000
  s_cselect_b32 s10, s10, 0x7f000000
  s_lshl_b32 s11, s6, 8
  s_add_u32 s11, s11, 0x1857000
  s_cmp_lt_u32 s6, 7
  s_cselect_b32 s11, s11, 0x7f000000
  v_bfe_u32 v16, v0, 3, 1
  v_bfe_u32 v230, v0, 4, 1
  v_lshl_add_u32 v230, v16, 1, v230
  v_and_b32 v16, 3, v0
  v_lshl_add_u32 v230, v230, 2, v16
  v_bfe_u32 v16, v0, 2, 2
  v_lshl_add_u32 v230, v16, 4, v230
  v_lshrrev_b32 v16, 5, v0
  v_lshl_add_u32 v230, v16, 6, v230
  v_lshlrev_b32 v230, 3, v230
  v_add_u32 v230, s77, v230
  v_xor_b32 v231, 64, v230
  ds_read_b64_tr_b16 v[16:17], v230 offset:0
  ds_read_b64_tr_b16 v[18:19], v230 offset:1024
  ds_read_b64_tr_b16 v[20:21], v231 offset:0
  ds_read_b64_tr_b16 v[22:23], v231 offset:1024
  ds_read_b64_tr_b16 v[24:25], v230 offset:2048
  ds_read_b64_tr_b16 v[26:27], v230 offset:3072
  ds_read_b64_tr_b16 v[28:29], v231 offset:2048
  ds_read_b64_tr_b16 v[30:31], v231 offset:3072
  ds_read_b64_tr_b16 v[32:33], v230 offset:4096
  ds_read_b64_tr_b16 v[34:35], v230 offset:5120
  ds_read_b64_tr_b16 v[36:37], v231 offset:4096
  ds_read_b64_tr_b16 v[38:39], v231 offset:5120
  ds_read_b64_tr_b16 v[40:41], v230 offset:6144
  ds_read_b64_tr_b16 v[42:43], v230 offset:7168
  ds_read_b64_tr_b16 v[44:45], v231 offset:6144
  ds_read_b64_tr_b16 v[46:47], v231 offset:7168
  ds_read_b64_tr_b16 v[48:49], v230 offset:8192
  ds_read_b64_tr_b16 v[50:51], v230 offset:9216
  ds_read_b64_tr_b16 v[52:53], v231 offset:8192
  ds_read_b64_tr_b16 v[54:55], v231 offset:9216
  ds_read_b64_tr_b16 v[56:57], v230 offset:10240
  ds_read_b64_tr_b16 v[58:59], v230 offset:11264
  ds_read_b64_tr_b16 v[60:61], v231 offset:10240
  ds_read_b64_tr_b16 v[62:63], v231 offset:11264
  ds_read_b64_tr_b16 v[64:65], v230 offset:12288
  ds_read_b64_tr_b16 v[66:67], v230 offset:13312
  ds_read_b64_tr_b16 v[68:69], v231 offset:12288
  ds_read_b64_tr_b16 v[70:71], v231 offset:13312
  v_mov_b32 v232, 0
  v_mov_b32 v233, 0
  s_waitcnt lgkmcnt(15)
  v_dot2c_f32_bf16 v232, s94, v16
  v_dot2c_f32_bf16 v233, s94, v20
  v_dot2c_f32_bf16 v232, s94, v17
  v_dot2c_f32_bf16 v233, s94, v21
  v_dot2c_f32_bf16 v232, s94, v18
  v_dot2c_f32_bf16 v233, s94, v22
  v_dot2c_f32_bf16 v232, s94, v19
  v_dot2c_f32_bf16 v233, s94, v23
  v_dot2c_f32_bf16 v232, s94, v24
  v_dot2c_f32_bf16 v233, s94, v28
  v_dot2c_f32_bf16 v232, s94, v25
  v_dot2c_f32_bf16 v233, s94, v29
  v_dot2c_f32_bf16 v232, s94, v26
  v_dot2c_f32_bf16 v233, s94, v30
  v_dot2c_f32_bf16 v232, s94, v27
  v_dot2c_f32_bf16 v233, s94, v31
  v_dot2c_f32_bf16 v232, s94, v32
  v_dot2c_f32_bf16 v233, s94, v36
  v_dot2c_f32_bf16 v232, s94, v33
  v_dot2c_f32_bf16 v233, s94, v37
  v_dot2c_f32_bf16 v232, s94, v34
  v_dot2c_f32_bf16 v233, s94, v38
  v_dot2c_f32_bf16 v232, s94, v35
  v_dot2c_f32_bf16 v233, s94, v39
  v_dot2c_f32_bf16 v232, s94, v40
  s_waitcnt lgkmcnt(13)
  v_dot2c_f32_bf16 v233, s94, v44
  v_dot2c_f32_bf16 v232, s94, v41
  v_dot2c_f32_bf16 v233, s94, v45
  v_dot2c_f32_bf16 v232, s94, v42
  s_waitcnt lgkmcnt(12)
  v_dot2c_f32_bf16 v233, s94, v46
  v_dot2c_f32_bf16 v232, s94, v43
  v_dot2c_f32_bf16 v233, s94, v47
  s_waitcnt lgkmcnt(11)
  v_dot2c_f32_bf16 v232, s94, v48
  s_waitcnt lgkmcnt(9)
  v_dot2c_f32_bf16 v233, s94, v52
  v_dot2c_f32_bf16 v232, s94, v49
  v_dot2c_f32_bf16 v233, s94, v53
  v_dot2c_f32_bf16 v232, s94, v50
  s_waitcnt lgkmcnt(8)
  v_dot2c_f32_bf16 v233, s94, v54
  v_dot2c_f32_bf16 v232, s94, v51
  v_dot2c_f32_bf16 v233, s94, v55
  s_waitcnt lgkmcnt(7)
  v_dot2c_f32_bf16 v232, s94, v56
  s_waitcnt lgkmcnt(5)
  v_dot2c_f32_bf16 v233, s94, v60
  v_dot2c_f32_bf16 v232, s94, v57
  v_dot2c_f32_bf16 v233, s94, v61
  v_dot2c_f32_bf16 v232, s94, v58
  s_waitcnt lgkmcnt(4)
  v_dot2c_f32_bf16 v233, s94, v62
  v_dot2c_f32_bf16 v232, s94, v59
  v_dot2c_f32_bf16 v233, s94, v63
  s_waitcnt lgkmcnt(3)
  v_dot2c_f32_bf16 v232, s94, v64
  s_waitcnt lgkmcnt(1)
  v_dot2c_f32_bf16 v233, s94, v68
  v_dot2c_f32_bf16 v232, s94, v65
  v_dot2c_f32_bf16 v233, s94, v69
  v_dot2c_f32_bf16 v232, s94, v66
  s_waitcnt lgkmcnt(0)
  v_dot2c_f32_bf16 v233, s94, v70
  v_dot2c_f32_bf16 v232, s94, v67
  v_dot2c_f32_bf16 v233, s94, v71
  s_nop 2
  v_permlane32_swap_b32 v232, v233
  v_add_f32 v232, v232, v233
  v_add_u32 v233, s83, v2
  ds_write_b32 v233, v232
  s_waitcnt lgkmcnt(0)
  s_barrier
  v_add_u32 v233, 114688, v2
  ds_read2st64_b32 v[16:17], v233 offset0:0 offset1:48
  ds_read2st64_b32 v[18:19], v233 offset0:96 offset1:144
  s_waitcnt lgkmcnt(1)
  v_add_f32 v16, v16, v17
  s_waitcnt lgkmcnt(0)
  v_add_f32 v18, v18, v19
  v_add_f32 v16, v16, v18
  s_cmp_eq_u32 s72, 0
  s_cselect_b32 s11, s11, 0x7f000000
  buffer_load_dword v235, v234, s[64:67], s88 offen sc1
  s_mov_b32 s95, 131072
L170:
  s_waitcnt vmcnt(0)
  v_cmp_eq_u32 vcc, 0, v235
  s_nop 0
  s_cbranch_vccz L171
  buffer_load_dword v235, v234, s[64:67], s88 offen sc1
  s_sub_u32 s95, s95, 1
  s_cbranch_scc0 L170
  s_branch L_abort
L171:
  buffer_store_dword v16, v2, s[64:67], s11 offen sc1
  s_barrier
  v_accvgpr_read_b32 v236, a226
  v_accvgpr_read_b32 v237, a227
  v_accvgpr_read_b32 v238, a228
  v_accvgpr_read_b32 v239, a229
  s_add_u32 m0, s76, 0
  s_add_u32 s22, s8, 0
  buffer_load_dwordx4 v236, s[48:51], s22 offen offset:0  lds
  buffer_load_dwordx4 v237, s[48:51], s22 offen offset:1024  lds
  buffer_load_dwordx4 v238, s[48:51], s22 offen offset:2048  lds
  buffer_load_dwordx4 v239, s[48:51], s22 offen offset:3072  lds
  s_add_u32 m0, s76, 4096
  s_add_u32 s22, s8, 114688
  buffer_load_dwordx4 v236, s[48:51], s22 offen offset:0  lds
  buffer_load_dwordx4 v237, s[48:51], s22 offen offset:1024  lds
  buffer_load_dwordx4 v238, s[48:51], s22 offen offset:2048  lds
  buffer_load_dwordx4 v239, s[48:51], s22 offen offset:3072  lds
  s_add_u32 m0, s76, 8192
  s_add_u32 s22, s8, 229376
  buffer_load_dwordx4 v236, s[48:51], s22 offen offset:0  lds
  buffer_load_dwordx4 v237, s[48:51], s22 offen offset:1024  lds
  buffer_load_dwordx4 v238, s[48:51], s22 offen offset:2048  lds
  buffer_load_dwordx4 v239, s[48:51], s22 offen offset:3072  lds
  s_add_u32 m0, s76, 12288
  s_add_u32 s22, s8, 344064
  buffer_load_dwordx4 v236, s[48:51], s22 offen offset:0  lds
  buffer_load_dwordx4 v237, s[48:51], s22 offen offset:1024  lds
  s_waitcnt vmcnt(0)
  v_bfe_u32 v16, v0, 3, 1
  v_bfe_u32 v230, v0, 4, 1
  v_lshl_add_u32 v230, v16, 1, v230
  v_and_b32 v16, 3, v0
  v_lshl_add_u32 v230, v230, 2, v16
  v_bfe_u32 v16, v0, 2, 2
  v_lshl_add_u32 v230, v16, 4, v230
  v_lshrrev_b32 v16, 5, v0
  v_lshl_add_u32 v230, v16, 6, v230
  v_lshlrev_b32 v230, 3, v230
  v_add_u32 v230, s76, v230
  v_xor_b32 v231, 64, v230
  ds_read_b64_tr_b16 v[16:17], v230 offset:0
  ds_read_b64_tr_b16 v[18:19], v230 offset:1024
  ds_read_b64_tr_b16 v[20:21], v231 offset:0
  ds_read_b64_tr_b16 v[22:23], v231 offset:1024
  ds_read_b64_tr_b16 v[24:25], v230 offset:2048
  ds_read_b64_tr_b16 v[26:27], v230 offset:3072
  ds_read_b64_tr_b16 v[28:29], v231 offset:2048
  ds_read_b64_tr_b16 v[30:31], v231 offset:3072
  ds_read_b64_tr_b16 v[32:33], v230 offset:4096
  ds_read_b64_tr_b16 v[34:35], v230 offset:5120
  ds_read_b64_tr_b16 v[36:37], v231 offset:4096
  ds_read_b64_tr_b16 v[38:39], v231 offset:5120
  ds_read_b64_tr_b16 v[40:41], v230 offset:6144
  ds_read_b64_tr_b16 v[42:43], v230 offset:7168
  ds_read_b64_tr_b16 v[44:45], v231 offset:6144
  ds_read_b64_tr_b16 v[46:47], v231 offset:7168
  ds_read_b64_tr_b16 v[48:49], v230 offset:8192
  ds_read_b64_tr_b16 v[50:51], v230 offset:9216
  ds_read_b64_tr_b16 v[52:53], v231 offset:8192
  ds_read_b64_tr_b16 v[54:55], v231 offset:9216
  ds_read_b64_tr_b16 v[56:57], v230 offset:10240
  ds_read_b64_tr_b16 v[58:59], v230 offset:11264
  ds_read_b64_tr_b16 v[60:61], v231 offset:10240
  ds_read_b64_tr_b16 v[62:63], v231 offset:11264
  ds_read_b64_tr_b16 v[64:65], v230 offset:12288
  ds_read_b64_tr_b16 v[66:67], v230 offset:13312
  ds_read_b64_tr_b16 v[68:69], v231 offset:12288
  ds_read_b64_tr_b16 v[70:71], v231 offset:13312
  v_mov_b32 v232, 0
  v_mov_b32 v233, 0
  s_waitcnt lgkmcnt(15)
  v_dot2c_f32_bf16 v232, s94, v16
  v_dot2c_f32_bf16 v233, s94, v20
  v_dot2c_f32_bf16 v232, s94, v17
  v_dot2c_f32_bf16 v233, s94, v21
  v_dot2c_f32_bf16 v232, s94, v18
  v_dot2c_f32_bf16 v233, s94, v22
  v_dot2c_f32_bf16 v232, s94, v19
  v_dot2c_f32_bf16 v233, s94, v23
  v_dot2c_f32_bf16 v232, s94, v24
  v_dot2c_f32_bf16 v233, s94, v28
  v_dot2c_f32_bf16 v232, s94, v25
  v_dot2c_f32_bf16 v233, s94, v29
  v_dot2c_f32_bf16 v232, s94, v26
  v_dot2c_f32_bf16 v233, s94, v30
  v_dot2c_f32_bf16 v232, s94, v27
  v_dot2c_f32_bf16 v233, s94, v31
  v_dot2c_f32_bf16 v232, s94, v32
  v_dot2c_f32_bf16 v233, s94, v36
  v_dot2c_f32_bf16 v232, s94, v33
  v_dot2c_f32_bf16 v233, s94, v37
  v_dot2c_f32_bf16 v232, s94, v34
  v_dot2c_f32_bf16 v233, s94, v38
  v_dot2c_f32_bf16 v232, s94, v35
  v_dot2c_f32_bf16 v233, s94, v39
  v_dot2c_f32_bf16 v232, s94, v40
  s_waitcnt lgkmcnt(13)
  v_dot2c_f32_bf16 v233, s94, v44
  v_dot2c_f32_bf16 v232, s94, v41
  v_dot2c_f32_bf16 v233, s94, v45
  v_dot2c_f32_bf16 v232, s94, v42
  s_waitcnt lgkmcnt(12)
  v_dot2c_f32_bf16 v233, s94, v46
  v_dot2c_f32_bf16 v232, s94, v43
  v_dot2c_f32_bf16 v233, s94, v47
  s_waitcnt lgkmcnt(11)
  v_dot2c_f32_bf16 v232, s94, v48
  s_waitcnt lgkmcnt(9)
  v_dot2c_f32_bf16 v233, s94, v52
  v_dot2c_f32_bf16 v232, s94, v49
  v_dot2c_f32_bf16 v233, s94, v53
  v_dot2c_f32_bf16 v232, s94, v50
  s_waitcnt lgkmcnt(8)
  v_dot2c_f32_bf16 v233, s94, v54
  v_dot2c_f32_bf16 v232, s94, v51
  v_dot2c_f32_bf16 v233, s94, v55
  s_waitcnt lgkmcnt(7)
  v_dot2c_f32_bf16 v232, s94, v56
  s_waitcnt lgkmcnt(5)
  v_dot2c_f32_bf16 v233, s94, v60
  v_dot2c_f32_bf16 v232, s94, v57
  v_dot2c_f32_bf16 v233, s94, v61
  v_dot2c_f32_bf16 v232, s94, v58
  s_waitcnt lgkmcnt(4)
  v_dot2c_f32_bf16 v233, s94, v62
  v_dot2c_f32_bf16 v232, s94, v59
  v_dot2c_f32_bf16 v233, s94, v63
  s_waitcnt lgkmcnt(3)
  v_dot2c_f32_bf16 v232, s94, v64
  s_waitcnt lgkmcnt(1)
  v_dot2c_f32_bf16 v233, s94, v68
  v_dot2c_f32_bf16 v232, s94, v65
  v_dot2c_f32_bf16 v233, s94, v69
  v_dot2c_f32_bf16 v232, s94, v66
  s_waitcnt lgkmcnt(0)
  v_dot2c_f32_bf16 v233, s94, v70
  v_dot2c_f32_bf16 v232, s94, v67
  v_dot2c_f32_bf16 v233, s94, v71
  s_nop 2
  v_permlane32_swap_b32 v232, v233
  v_add_f32 v232, v232, v233
  v_add_u32 v233, s83, v2
  ds_write_b32 v233, v232
  s_waitcnt lgkmcnt(0)
  s_barrier
  v_add_u32 v233, 114688, v2
  ds_read2st64_b32 v[16:17], v233 offset0:0 offset1:48
  ds_read2st64_b32 v[18:19], v233 offset0:96 offset1:144
  s_waitcnt lgkmcnt(1)
  v_add_f32 v16, v16, v17
  s_waitcnt lgkmcnt(0)
  v_add_f32 v18, v18, v19
  v_add_f32 v16, v16, v18
  s_cmp_eq_u32 s72, 0
  s_cselect_b32 s10, s10, 0x7f000000
  buffer_store_dword v16, v2, s[64:67], s10 offen sc1
  s_barrier
  s_lshr_b32 s7, s2, 7
  s_lshl_b32 s7, s7, 3
  s_lshl_b32 s3, s71, 2
  s_add_u32 s7, s7, s3
  s_add_u32 s7, s7, s72
  v_min_u32 v230, 55, v0
  v_mul_u32_u24 v231, 37, v230
  v_lshrrev_b32 v231, 9, v231
  v_mul_u32_u24 v231, 1792, v231
  v_lshl_add_u32 v230, v230, 7, v231
  s_mul_i32 s8, s7, 100352
  s_add_u32 s8, s8, 0x700
  buffer_load_dword v15, v230, s[48:51], s8 offen sc1
  s_add_u32 s8, s8, 14336
  buffer_load_dword v15, v230, s[48:51], s8 offen sc1
  s_add_u32 s8, s8, 14336
  buffer_load_dword v15, v230, s[48:51], s8 offen sc1
  s_add_u32 s8, s8, 14336
  buffer_load_dword v15, v230, s[48:51], s8 offen sc1
  s_add_u32 s8, s8, 14336
  buffer_load_dword v15, v230, s[48:51], s8 offen sc1
  s_add_u32 s8, s8, 14336
  buffer_load_dword v15, v230, s[48:51], s8 offen sc1
  s_add_u32 s8, s8, 14336
  buffer_load_dword v15, v230, s[48:51], s8 offen sc1
  s_add_u32 s8, s8, 14336
  s_lshr_b32 s4, s2, 7
  s_lshl_b32 s4, s4, 16
  s_lshl_b32 s3, s71, 15
  s_add_u32 s4, s4, s3
  s_lshl_b32 s3, s72, 13
  s_add_u32 s4, s4, s3
  v_lshlrev_b32 v230, 7, v0
  v_add_u32 v230, s4, v230
  v_min_u32 v230, L_last-L_pc, v230
  global_load_dword v15, v230, s[26:27] sc1
  v_lshrrev_b32 v16, 2, v0
  v_mul_u32_u24 v16, 2688, v16
  v_and_b32 v230, 3, v0
  v_lshl_add_u32 v230, v230, 4, v16
  s_mul_i32 s5, s68, 56
  s_and_b32 s5, s5, 0xfffffff0
  s_add_u32 s6, s72, 1
  s_cmp_eq_u32 s72, 2
  s_cselect_b32 s6, 0, s6
  s_mul_i32 s6, s6, 896
  s_mul_i32 s3, s71, 602112
  s_add_u32 s6, s6, s3
  s_add_u32 s6, s6, s5
  s_lshl_b32 s7, s68, 17
  s_mul_i32 s3, s72, 28672
  s_add_u32 s7, s7, s3
  s_mul_i32 s3, s71, 14336
  s_add_u32 s7, s7, s3
  s_add_u32 s7, s7, 0x1a00000
  s_cmp_lt_u32 s72, 3
  s_cselect_b32 s6, s6, 0x7f000000
  s_cselect_b32 s7, s7, 0x7f000000
  s_add_u32 m0, s77, 0
  s_nop 0
  buffer_load_dwordx4 v230, s[32:35], s6 offen lds
  s_add_u32 m0, s77, 1024
  s_add_u32 s6, s6, 43008
  buffer_load_dwordx4 v230, s[32:35], s6 offen lds
  s_add_u32 m0, s77, 2048
  s_add_u32 s6, s6, 43008
  buffer_load_dwordx4 v230, s[32:35], s6 offen lds
  s_add_u32 m0, s77, 3072
  s_add_u32 s6, s6, 43008
  buffer_load_dwordx4 v230, s[32:35], s6 offen lds
  s_add_u32 m0, s77, 4096
  s_add_u32 s6, s6, 43008
  buffer_load_dwordx4 v230, s[32:35], s6 offen lds
  s_add_u32 m0, s77, 5120
  s_add_u32 s6, s6, 43008
  buffer_load_dwordx4 v230, s[32:35], s6 offen lds
  s_add_u32 m0, s77, 6144
  s_add_u32 s6, s6, 43008
  buffer_load_dwordx4 v230, s[32:35], s6 offen lds
  s_add_u32 m0, s77, 7168
  s_add_u32 s6, s6, 43008
  buffer_load_dwordx4 v230, s[32:35], s6 offen lds
  s_add_u32 m0, s77, 8192
  s_add_u32 s6, s6, 43008
  buffer_load_dwordx4 v230, s[32:35], s6 offen lds
  s_add_u32 m0, s77, 9216
  s_add_u32 s6, s6, 43008
  buffer_load_dwordx4 v230, s[32:35], s6 offen lds
  s_add_u32 m0, s77, 10240
  s_add_u32 s6, s6, 43008
  buffer_load_dwordx4 v230, s[32:35], s6 offen lds
  s_add_u32 m0, s77, 11264
  s_add_u32 s6, s6, 43008
  buffer_load_dwordx4 v230, s[32:35], s6 offen lds
  s_add_u32 m0, s77, 12288
  s_add_u32 s6, s6, 43008
  buffer_load_dwordx4 v230, s[32:35], s6 offen lds
  s_add_u32 m0, s77, 13312
  s_add_u32 s6, s6, 43008
  buffer_load_dwordx4 v230, s[32:35], s6 offen lds
  v_bfe_u32 v230, v0, 4, 1
  v_lshlrev_b32 v230, 5, v230
  v_and_b32 v16, 3, v0
  v_lshl_add_u32 v230, v16, 3, v230
  v_bfe_u32 v16, v0, 2, 2
  v_lshl_add_u32 v230, v16, 6, v230
  v_lshrrev_b32 v16, 5, v0
  v_lshl_add_u32 v230, v16, 8, v230
  s_and_b32 s4, s68, 1
  s_lshl_b32 s4, s4, 3
  v_add_u32 v230, s4, v230
  v_add_u32 v230, s77, v230
  s_waitcnt vmcnt(0)
  ds_read_b64_tr_b16 v[16:17], v230 offset:0
  ds_read_b64_tr_b16 v[18:19], v230 offset:512
  ds_read_b64_tr_b16 v[20:21], v230 offset:1024
  ds_read_b64_tr_b16 v[22:23], v230 offset:1536
  ds_read_b64_tr_b16 v[24:25], v230 offset:2048
  ds_read_b64_tr_b16 v[26:27], v230 offset:2560
  ds_read_b64_tr_b16 v[28:29], v230 offset:3072
  ds_read_b64_tr_b16 v[30:31], v230 offset:3584
  ds_read_b64_tr_b16 v[32:33], v230 offset:4096
  ds_read_b64_tr_b16 v[34:35], v230 offset:4608
  ds_read_b64_tr_b16 v[36:37], v230 offset:5120
  ds_read_b64_tr_b16 v[38:39], v230 offset:5632
  ds_read_b64_tr_b16 v[40:41], v230 offset:6144
  ds_read_b64_tr_b16 v[42:43], v230 offset:6656
  ds_read_b64_tr_b16 v[44:45], v230 offset:7168
  ds_read_b64_tr_b16 v[46:47], v230 offset:7680
  ds_read_b64_tr_b16 v[48:49], v230 offset:8192
  ds_read_b64_tr_b16 v[50:51], v230 offset:8704
  ds_read_b64_tr_b16 v[52:53], v230 offset:9216
  ds_read_b64_tr_b16 v[54:55], v230 offset:9728
  ds_read_b64_tr_b16 v[56:57], v230 offset:10240
  ds_read_b64_tr_b16 v[58:59], v230 offset:10752
  ds_read_b64_tr_b16 v[60:61], v230 offset:11264
  ds_read_b64_tr_b16 v[62:63], v230 offset:11776
  ds_read_b64_tr_b16 v[64:65], v230 offset:12288
  ds_read_b64_tr_b16 v[66:67], v230 offset:12800
  ds_read_b64_tr_b16 v[68:69], v230 offset:13312
  ds_read_b64_tr_b16 v[70:71], v230 offset:13824
  v_mov_b32 v231, 0
  s_waitcnt lgkmcnt(15)
  v_cndmask_b32 v16, v16, v231, s[92:93]
  v_cndmask_b32 v17, v17, v231, s[92:93]
  v_cndmask_b32 v18, v18, v231, s[92:93]
  v_cndmask_b32 v19, v19, v231, s[92:93]
  buffer_store_dwordx4 v[16:19], v1, s[64:67], s7 offen offset:0 sc1
  v_cndmask_b32 v20, v20, v231, s[92:93]
  v_cndmask_b32 v21, v21, v231, s[92:93]
  v_cndmask_b32 v22, v22, v231, s[92:93]
  v_cndmask_b32 v23, v23, v231, s[92:93]
  buffer_store_dwordx4 v[20:23], v1, s[64:67], s7 offen offset:1024 sc1
  v_cndmask_b32 v24, v24, v231, s[92:93]
  v_cndmask_b32 v25, v25, v231, s[92:93]
  v_cndmask_b32 v26, v26, v231, s[92:93]
  v_cndmask_b32 v27, v27, v231, s[92:93]
  buffer_store_dwordx4 v[24:27], v1, s[64:67], s7 offen offset:2048 sc1
  v_cndmask_b32 v28, v28, v231, s[92:93]
  v_cndmask_b32 v29, v29, v231, s[92:93]
  v_cndmask_b32 v30, v30, v231, s[92:93]
  v_cndmask_b32 v31, v31, v231, s[92:93]
  buffer_store_dwordx4 v[28:31], v1, s[64:67], s7 offen offset:3072 sc1
  s_add_u32 s7, s7, 4096
  v_cndmask_b32 v32, v32, v231, s[92:93]
  v_cndmask_b32 v33, v33, v231, s[92:93]
  v_cndmask_b32 v34, v34, v231, s[92:93]
  v_cndmask_b32 v35, v35, v231, s[92:93]
  buffer_store_dwordx4 v[32:35], v1, s[64:67], s7 offen offset:0 sc1
  v_cndmask_b32 v36, v36, v231, s[92:93]
  v_cndmask_b32 v37, v37, v231, s[92:93]
  v_cndmask_b32 v38, v38, v231, s[92:93]
  v_cndmask_b32 v39, v39, v231, s[92:93]
  buffer_store_dwordx4 v[36:39], v1, s[64:67], s7 offen offset:1024 sc1
  v_cndmask_b32 v40, v40, v231, s[92:93]
  v_cndmask_b32 v41, v41, v231, s[92:93]
  s_waitcnt lgkmcnt(14)
  v_cndmask_b32 v42, v42, v231, s[92:93]
  v_cndmask_b32 v43, v43, v231, s[92:93]
  buffer_store_dwordx4 v[40:43], v1, s[64:67], s7 offen offset:2048 sc1
  s_waitcnt lgkmcnt(13)
  v_cndmask_b32 v44, v44, v231, s[92:93]
  v_cndmask_b32 v45, v45, v231, s[92:93]
  s_waitcnt lgkmcnt(12)
  v_cndmask_b32 v46, v46, v231, s[92:93]
  v_cndmask_b32 v47, v47, v231, s[92:93]
  buffer_store_dwordx4 v[44:47], v1, s[64:67], s7 offen offset:3072 sc1
  s_add_u32 s7, s7, 4096
  s_waitcnt lgkmcnt(11)
  v_cndmask_b32 v48, v48, v231, s[92:93]
  v_cndmask_b32 v49, v49, v231, s[92:93]
  s_waitcnt lgkmcnt(10)
  v_cndmask_b32 v50, v50, v231, s[92:93]
  v_cndmask_b32 v51, v51, v231, s[92:93]
  buffer_store_dwordx4 v[48:51], v1, s[64:67], s7 offen offset:0 sc1
  s_waitcnt lgkmcnt(9)
  v_cndmask_b32 v52, v52, v231, s[92:93]
  v_cndmask_b32 v53, v53, v231, s[92:93]
  s_waitcnt lgkmcnt(8)
  v_cndmask_b32 v54, v54, v231, s[92:93]
  v_cndmask_b32 v55, v55, v231, s[92:93]
  buffer_store_dwordx4 v[52:55], v1, s[64:67], s7 offen offset:1024 sc1
  s_waitcnt lgkmcnt(7)
  v_cndmask_b32 v56, v56, v231, s[92:93]
  v_cndmask_b32 v57, v57, v231, s[92:93]
  s_waitcnt lgkmcnt(6)
  v_cndmask_b32 v58, v58, v231, s[92:93]
  v_cndmask_b32 v59, v59, v231, s[92:93]
  buffer_store_dwordx4 v[56:59], v1, s[64:67], s7 offen offset:2048 sc1
  s_waitcnt lgkmcnt(5)
  v_cndmask_b32 v60, v60, v231, s[92:93]
  v_cndmask_b32 v61, v61, v231, s[92:93]
  s_waitcnt lgkmcnt(4)
  v_cndmask_b32 v62, v62, v231, s[92:93]
  v_cndmask_b32 v63, v63, v231, s[92:93]
  buffer_store_dwordx4 v[60:63], v1, s[64:67], s7 offen offset:3072 sc1
  s_add_u32 s7, s7, 4096
  s_waitcnt lgkmcnt(3)
  v_cndmask_b32 v64, v64, v231, s[92:93]
  v_cndmask_b32 v65, v65, v231, s[92:93]
  s_waitcnt lgkmcnt(2)
  v_cndmask_b32 v66, v66, v231, s[92:93]
  v_cndmask_b32 v67, v67, v231, s[92:93]
  buffer_store_dwordx4 v[64:67], v1, s[64:67], s7 offen offset:0 sc1
  s_waitcnt lgkmcnt(1)
  v_cndmask_b32 v68, v68, v231, s[92:93]
  v_cndmask_b32 v69, v69, v231, s[92:93]
  s_waitcnt lgkmcnt(0)
  v_cndmask_b32 v70, v70, v231, s[92:93]
  v_cndmask_b32 v71, v71, v231, s[92:93]
  buffer_store_dwordx4 v[68:71], v1, s[64:67], s7 offen offset:1024 sc1
  s_lshl_b32 s5, s68, 8
  s_lshl_b32 s3, s71, 7
  s_add_u32 s5, s5, s3
  s_add_u32 s5, s5, 0x18c0000
  s_cmp_eq_u32 s72, 0
  s_cselect_b32 s5, s5, 0x7f000000
  v_mov_b32 v230, 1
  s_waitcnt vmcnt(0)
  s_barrier
  s_mov_b64 exec, 1
  buffer_store_dword v230, off, s[64:67], s5 sc1
  s_mov_b64 exec, -1
  s_lshr_b32 s7, s2, 7
  s_lshl_b32 s7, s7, 3
  s_lshl_b32 s3, s71, 2
  s_add_u32 s7, s7, s3
  s_add_u32 s7, s7, s72
  s_min_u32 s7, s7, 13
  s_mov_b32 s10, 0
  s_lshl_b32 s8, s7, 17
  s_add_u32 s8, s8, 0x1c07000
  s_mul_i32 s4, s10, 28672
  s_add_u32 s4, s4, s8
  v_lshlrev_b32 v230, 7, v0
  buffer_load_dword v15, v230, s[64:67], s4 offen sc1
  s_mul_i32 s4, s10, 28672
  s_add_u32 s4, s4, s8
  s_add_u32 s4, s4, 0x2000
  v_lshlrev_b32 v230, 7, v0
  buffer_load_dword v15, v230, s[64:67], s4 offen sc1
  s_mul_i32 s4, s10, 28672
  s_add_u32 s4, s4, s8
  s_add_u32 s4, s4, 0x4000
  v_lshlrev_b32 v230, 7, v0
  buffer_load_dword v15, v230, s[64:67], s4 offen sc1
  s_mul_i32 s4, s10, 28672
  s_add_u32 s4, s4, s8
  s_add_u32 s4, s4, 0x6000
  v_min_u32 v230, 31, v0
  v_lshlrev_b32 v230, 7, v230
  buffer_load_dword v15, v230, s[64:67], s4 offen sc1
  s_lshl_b32 s8, s7, 17
  s_add_u32 s8, s8, 0x1c17000
  s_mul_i32 s4, s10, 28672
  s_add_u32 s4, s4, s8
  v_lshlrev_b32 v230, 7, v0
  buffer_load_dword v15, v230, s[64:67], s4 offen sc1
  s_mul_i32 s4, s10, 28672
  s_add_u32 s4, s4, s8
  s_add_u32 s4, s4, 0x2000
  v_lshlrev_b32 v230, 7, v0
  buffer_load_dword v15, v230, s[64:67], s4 offen sc1
  s_mul_i32 s4, s10, 28672
  s_add_u32 s4, s4, s8
  s_add_u32 s4, s4, 0x4000
  v_lshlrev_b32 v230, 7, v0
  buffer_load_dword v15, v230, s[64:67], s4 offen sc1
  s_mul_i32 s4, s10, 28672
  s_add_u32 s4, s4, s8
  s_add_u32 s4, s4, 0x6000
  v_min_u32 v230, 31, v0
  v_lshlrev_b32 v230, 7, v230
  buffer_load_dword v15, v230, s[64:67], s4 offen sc1
  v_and_b32 v230, 1, v0
  v_lshlrev_b32 v230, 7, v230
  s_lshl_b32 s14, s69, 8
  s_add_u32 s14, s14, 0x18c0000
  buffer_load_dword v231, v230, s[64:67], s14 offen sc1
  s_mov_b32 s95, 131072
L172:
  s_waitcnt vmcnt(0)
  v_cmp_eq_u32 vcc, 0, v231
  s_nop 0
  s_cbranch_vccz L173
  s_sleep 4
  buffer_load_dword v231, v230, s[64:67], s14 offen sc1
  s_sub_u32 s95, s95, 1
  s_cbranch_scc0 L172
  s_branch L_abort
L173:
  s_lshl_b32 s15, s69, 17
  s_mul_i32 s3, s72, 14336
  s_add_u32 s15, s15, s3
  s_add_u32 s15, s15, 0x1a00000
  s_mul_i32 s16, s72, 14336
  s_and_b32 s101, s68, 1
  s_mul_i32 s100, s101, 7168
  s_add_u32 s100, s100, s15
  s_mul_i32 s101, s101, 7168
  s_add_u32 s101, s101, s16
  s_add_u32 m0, s101, 0
  s_add_u32 s22, s100, 0
  buffer_load_dwordx4 v1, s[64:67], s22 offen offset:0 sc1 lds
  buffer_load_dwordx4 v1, s[64:67], s22 offen offset:1024 sc1 lds
  buffer_load_dwordx4 v1, s[64:67], s22 offen offset:2048 sc1 lds
  buffer_load_dwordx4 v1, s[64:67], s22 offen offset:3072 sc1 lds
  s_add_u32 m0, s101, 4096
  s_add_u32 s22, s100, 4096
  buffer_load_dwordx4 v1, s[64:67], s22 offen offset:0 sc1 lds
  buffer_load_dwordx4 v1, s[64:67], s22 offen offset:1024 sc1 lds
  buffer_load_dwordx4 v1, s[64:67], s22 offen offset:2048 sc1 lds
  s_and_b32 s101, s68, 1
  s_xor_b32 s101, s101, 1
  s_mul_i32 s100, s101, 7168
  s_add_u32 s100, s100, s15
  s_mul_i32 s101, s101, 7168
  s_add_u32 s101, s101, s16
  s_add_u32 m0, s101, 0
  s_add_u32 s22, s100, 0
  buffer_load_dwordx4 v1, s[64:67], s22 offen offset:0 sc1 lds
  buffer_load_dwordx4 v1, s[64:67], s22 offen offset:1024 sc1 lds
  buffer_load_dwordx4 v1, s[64:67], s22 offen offset:2048 sc1 lds
  buffer_load_dwordx4 v1, s[64:67], s22 offen offset:3072 sc1 lds
  s_add_u32 m0, s101, 4096
  s_add_u32 s22, s100, 4096
  buffer_load_dwordx4 v1, s[64:67], s22 offen offset:0 sc1 lds
  buffer_load_dwordx4 v1, s[64:67], s22 offen offset:1024 sc1 lds
  buffer_load_dwordx4 v1, s[64:67], s22 offen offset:2048 sc1 lds
  v_accvgpr_read_b32 v238, a238
  s_add_u32 s5, s73, 0xc0500
  buffer_load_dword v239, v238, s[64:67], s5 offen sc1
  s_mov_b32 s95, 131072
L174:
  s_waitcnt vmcnt(0)
  v_cmp_eq_u32 vcc, 0, v239
  s_nop 0
  s_cbranch_vccz L175
  s_sleep 8
  buffer_load_dword v239, v238, s[64:67], s5 offen sc1
  s_sub_u32 s95, s95, 1
  s_cbranch_scc0 L174
  s_branch L_abort
L175:
  s_lshr_b32 s7, s2, 7
  s_lshl_b32 s7, s7, 3
  s_lshl_b32 s3, s71, 2
  s_add_u32 s7, s7, s3
  s_add_u32 s7, s7, s72
  s_lshl_b32 s8, s7, 17
  s_add_u32 s8, s8, 0x1a0e000
  s_mov_b32 s7, 0
  s_mul_i32 s4, s7, 28672
  s_add_u32 s4, s4, s8
  v_lshlrev_b32 v230, 7, v0
  buffer_load_dword v15, v230, s[64:67], s4 offen sc1
  s_mul_i32 s4, s7, 28672
  s_add_u32 s4, s4, s8
  s_add_u32 s4, s4, 0x2000
  v_lshlrev_b32 v230, 7, v0
  buffer_load_dword v15, v230, s[64:67], s4 offen sc1
  s_mul_i32 s4, s7, 28672
  s_add_u32 s4, s4, s8
  s_add_u32 s4, s4, 0x4000
  v_lshlrev_b32 v230, 7, v0
  buffer_load_dword v15, v230, s[64:67], s4 offen sc1
  s_mul_i32 s4, s7, 28672
  s_add_u32 s4, s4, s8
  s_add_u32 s4, s4, 0x6000
  v_min_u32 v230, 31, v0
  v_lshlrev_b32 v230, 7, v230
  buffer_load_dword v15, v230, s[64:67], s4 offen sc1
  s_add_u32 s5, s73, 0xc0100
  buffer_load_dword v239, v238, s[64:67], s5 offen sc1
  s_mov_b32 s95, 131072
L176:
  s_waitcnt vmcnt(0)
  v_cmp_eq_u32 vcc, 0, v239
  s_nop 0
  s_cbranch_vccz L177
  s_sleep 8
  buffer_load_dword v239, v238, s[64:67], s5 offen sc1
  s_sub_u32 s95, s95, 1
  s_cbranch_scc0 L176
  s_branch L_abort
L177:
  s_lshr_b32 s4, s2, 7
  s_lshl_b32 s4, s4, 16
  s_lshl_b32 s3, s71, 15
  s_add_u32 s4, s4, s3
  s_lshl_b32 s3, s72, 13
  s_add_u32 s4, s4, s3
  v_lshlrev_b32 v230, 7, v0
  v_add_u32 v230, s4, v230
  v_min_u32 v230, L_last-L_pc, v230
  global_load_dword v15, v230, s[26:27] sc1
  s_branch L28
L87:
  s_mov_b32 s95, 131072
L178:
  buffer_load_dword v208, v2, s[64:67], s8 offen offset:0 sc1
  buffer_load_dword v209, v2, s[64:67], s8 offen offset:256 sc1
  buffer_load_dword v210, v2, s[64:67], s8 offen offset:512 sc1
  buffer_load_dword v211, v2, s[64:67], s8 offen offset:768 sc1
  buffer_load_dword v212, v2, s[64:67], s8 offen offset:1024 sc1
  buffer_load_dword v213, v2, s[64:67], s8 offen offset:1280 sc1
  buffer_load_dword v214, v2, s[64:67], s8 offen offset:1536 sc1
  s_sub_u32 s95, s95, 1
  s_cbranch_scc1 L_abort
  s_waitcnt vmcnt(0)
  v_max3_u32 v235, v208, v209, v210
  v_max3_u32 v234, v211, v212, v213
  v_max3_u32 v235, v235, v234, v214
  v_cmp_eq_u32 vcc, -1, v235
  s_nop 0
  s_cbranch_vccnz L178
  s_branch L88
L89:
  s_mov_b32 s95, 131072
L179:
  buffer_load_dword v12, off, s[64:67], s16 sc1
  s_waitcnt vmcnt(0)
  v_cmp_eq_u32 vcc, 0, v12
  s_nop 0
  s_cbranch_vccz L90
  buffer_load_dword v12, off, s[64:67], s16 sc1
  s_waitcnt vmcnt(0)
  v_cmp_eq_u32 vcc, 0, v12
  s_nop 0
  s_cbranch_vccz L90
  buffer_load_dword v12, off, s[64:67], s16 sc1
  s_waitcnt vmcnt(0)
  v_cmp_eq_u32 vcc, 0, v12
  s_nop 0
  s_cbranch_vccz L90
  s_mov_b64 exec, 0x3
  buffer_load_dword v13, v232, s[64:67], s9 offen sc1
  s_mov_b64 exec, -1
  s_sub_u32 s95, s95, 1
  s_cbranch_scc1 L_abort
  s_waitcnt vmcnt(0)
  v_cmp_ne_u32 s[86:87], 0, v13
  s_nop 2
  s_andn2_b32 s87, 3, s86
  s_cbranch_scc1 L179
  s_branch L90
L91:
  s_mov_b32 s95, 131072
L180:
  s_mov_b64 exec, 0xc
  buffer_load_dword v13, v232, s[64:67], s9 offen sc1
  s_mov_b64 exec, -1
  s_sub_u32 s95, s95, 1
  s_cbranch_scc1 L_abort
  s_waitcnt vmcnt(0)
  v_cmp_ne_u32 s[86:87], 0, v13
  s_nop 2
  s_andn2_b32 s3, 0xc, s86
  s_cbranch_scc1 L180
  s_branch L92
L93:
  s_mov_b32 s95, 131072
L181:
  s_mov_b64 exec, 0x30
  buffer_load_dword v13, v232, s[64:67], s9 offen sc1
  s_mov_b64 exec, -1
  s_sub_u32 s95, s95, 1
  s_cbranch_scc1 L_abort
  s_waitcnt vmcnt(0)
  v_cmp_ne_u32 s[86:87], 0, v13
  s_nop 2
  s_andn2_b32 s3, 0x30, s86
  s_cbranch_scc1 L181
  s_branch L94
L95:
  s_mov_b32 s95, 131072
L182:
  s_mov_b64 exec, 0xc0
  buffer_load_dword v13, v232, s[64:67], s9 offen sc1
  s_mov_b64 exec, -1
  s_sub_u32 s95, s95, 1
  s_cbranch_scc1 L_abort
  s_waitcnt vmcnt(0)
  v_cmp_ne_u32 s[86:87], 0, v13
  s_nop 2
  s_andn2_b32 s3, 0xc0, s86
  s_cbranch_scc1 L182
  s_branch L96
L97:
  s_mov_b32 s95, 131072
L183:
  s_mov_b64 exec, 0xff00
  buffer_load_dword v13, v232, s[64:67], s9 offen sc1
  s_mov_b64 exec, -1
  s_sub_u32 s95, s95, 1
  s_cbranch_scc1 L_abort
  s_waitcnt vmcnt(0)
  v_cmp_ne_u32 s[86:87], 0, v13
  s_nop 2
  s_andn2_b32 s3, 0xff00, s86
  s_cbranch_scc1 L183
  s_branch L98
L99:
  s_waitcnt vmcnt(0) lgkmcnt(0)
  s_and_b32 s6, s10, 0xffffc000
  s_add_u32 s5, s6, 262144
  v_mov_b32 v230, 0xff7fffff
  v_mov_b32 v96, 0
  v_mov_b32 v97, 0
  v_mov_b32 v98, 0
  v_mov_b32 v99, 0
  v_mov_b32 v100, 0
  v_mov_b32 v101, 0
  v_mov_b32 v102, 0
  v_mov_b32 v103, 0
  v_mov_b32 v104, 0
  v_mov_b32 v105, 0
  v_mov_b32 v106, 0
  v_mov_b32 v107, 0
  v_mov_b32 v108, 0
  v_mov_b32 v109, 0
  v_mov_b32 v110, 0
  v_mov_b32 v111, 0
L184:
  buffer_load_dwordx4 v[176:179], v1, s[64:67], s6 offen offset:0 sc1
  buffer_load_dwordx4 v[180:183], v1, s[64:67], s6 offen offset:1024 sc1
  buffer_load_dwordx4 v[184:187], v1, s[64:67], s6 offen offset:2048 sc1
  buffer_load_dwordx4 v[188:191], v1, s[64:67], s6 offen offset:3072 sc1
  s_waitcnt vmcnt(3)
  v_mfma_f32_32x32x16_bf16 v[112:127], v[176:179], v[40:43], 0
  s_waitcnt vmcnt(2)
  v_mfma_f32_32x32x16_bf16 v[112:127], v[180:183], v[44:47], v[112:127]
  s_nop 11
  v_max3_f32 v231, v230, v112, v113
  v_max3_f32 v231, v231, v114, v115
  v_max3_f32 v231, v231, v116, v117
  v_max3_f32 v231, v231, v118, v119
  v_max3_f32 v231, v231, v120, v121
  v_max3_f32 v231, v231, v122, v123
  v_max3_f32 v231, v231, v124, v125
  v_max3_f32 v231, v231, v126, v127
  v_mov_b32 v233, v231
  s_nop 1
  v_permlane32_swap_b32 v233, v231
  v_max_f32 v231, v231, v233
  v_sub_f32 v233, v230, v231
  v_exp_f32 v233, v233
  v_mov_b32 v230, v231
  v_sub_f32 v112, v112, v231
  v_sub_f32 v113, v113, v231
  v_sub_f32 v114, v114, v231
  v_sub_f32 v115, v115, v231
  v_sub_f32 v116, v116, v231
  v_sub_f32 v117, v117, v231
  v_sub_f32 v118, v118, v231
  v_sub_f32 v119, v119, v231
  v_sub_f32 v120, v120, v231
  v_sub_f32 v121, v121, v231
  v_sub_f32 v122, v122, v231
  v_sub_f32 v123, v123, v231
  v_sub_f32 v124, v124, v231
  v_sub_f32 v125, v125, v231
  v_sub_f32 v126, v126, v231
  v_sub_f32 v127, v127, v231
  v_exp_f32 v112, v112
  v_exp_f32 v113, v113
  v_exp_f32 v114, v114
  v_exp_f32 v115, v115
  v_exp_f32 v116, v116
  v_exp_f32 v117, v117
  v_exp_f32 v118, v118
  v_exp_f32 v119, v119
  v_exp_f32 v120, v120
  v_exp_f32 v121, v121
  v_exp_f32 v122, v122
  v_exp_f32 v123, v123
  v_exp_f32 v124, v124
  v_exp_f32 v125, v125
  v_exp_f32 v126, v126
  v_exp_f32 v127, v127
  v_mul_f32 v96, v96, v233
  v_mul_f32 v97, v97, v233
  v_mul_f32 v98, v98, v233
  v_mul_f32 v99, v99, v233
  v_mul_f32 v100, v100, v233
  v_mul_f32 v101, v101, v233
  v_mul_f32 v102, v102, v233
  v_mul_f32 v103, v103, v233
  v_mul_f32 v104, v104, v233
  v_mul_f32 v105, v105, v233
  v_mul_f32 v106, v106, v233
  v_mul_f32 v107, v107, v233
  v_mul_f32 v108, v108, v233
  v_mul_f32 v109, v109, v233
  v_mul_f32 v110, v110, v233
  v_mul_f32 v111, v111, v233
  v_cvt_pk_bf16_f32 v144, v112, v113
  v_cvt_pk_bf16_f32 v145, v114, v115
  v_cvt_pk_bf16_f32 v146, v116, v117
  v_cvt_pk_bf16_f32 v147, v118, v119
  v_cvt_pk_bf16_f32 v148, v120, v121
  v_cvt_pk_bf16_f32 v149, v122, v123
  v_cvt_pk_bf16_f32 v150, v124, v125
  v_cvt_pk_bf16_f32 v151, v126, v127
  s_waitcnt vmcnt(1)
  v_mfma_f32_32x32x16_bf16 v[96:111], v[184:187], v[144:147], v[96:111]
  s_waitcnt vmcnt(0)
  v_mfma_f32_32x32x16_bf16 v[96:111], v[188:191], v[148:151], v[96:111]
  s_add_u32 s6, s6, 4096
  s_cmp_lt_u32 s6, s5
  s_nop 15
  s_cbranch_scc1 L184
  v_mov_b32 v230, v108
  v_mov_b32 v232, v108
  s_nop 1
  v_permlane32_swap_b32 v230, v232
  s_branch L100
L101:
  buffer_store_dwordx4 v[144:147], v1, s[64:67], s4 offen offset:0 sc1
  buffer_store_dwordx4 v[148:151], v1, s[64:67], s4 offen offset:1024 sc1
  s_nop 0
  s_branch L102
L105:
  buffer_store_dword v233, off, s[64:67], s82 offset:2560 sc1
  s_nop 0
  s_branch L106
L109:
  buffer_store_dwordx4 v[192:195], v1, s[64:67], s24 offen offset:0 sc1
  buffer_store_dwordx4 v[196:199], v1, s[64:67], s24 offen offset:1024 sc1
  s_nop 0
  s_branch L110
L111:
  buffer_store_dword v233, off, s[64:67], s82 offset:2816 sc1
  s_nop 0
  s_branch L112
L115:
  buffer_store_dword v14, v2, s[64:67], s89 offen sc1
  s_nop 0
  s_branch L116
L117:
  s_mov_b32 s95, 131072
L185:
  buffer_load_dword v208, v2, s[64:67], s14 offen offset:0 sc1
  buffer_load_dword v209, v2, s[64:67], s14 offen offset:256 sc1
  buffer_load_dword v210, v2, s[64:67], s14 offen offset:512 sc1
  buffer_load_dword v211, v2, s[64:67], s14 offen offset:768 sc1
  buffer_load_dword v212, v2, s[64:67], s14 offen offset:1024 sc1
  buffer_load_dword v213, v2, s[64:67], s14 offen offset:1280 sc1
  buffer_load_dword v214, v2, s[64:67], s14 offen offset:1536 sc1
  s_sub_u32 s95, s95, 1
  s_cbranch_scc1 L_abort
  s_waitcnt vmcnt(0)
  v_max3_u32 v141, v208, v209, v210
  v_max3_u32 v140, v211, v212, v213
  v_max3_u32 v141, v141, v140, v214
  v_cmp_eq_u32 vcc, -1, v141
  s_nop 0
  s_cbranch_vccnz L185
  s_branch L118
L119:
  buffer_store_dwordx4 v[192:195], v216, s[64:67], s24 offen offset:0 sc1
  s_nop 0
  s_branch L120
L121:
  buffer_store_dwordx4 v[196:199], v217, s[64:67], s24 offen offset:1024 sc1
  s_nop 0
  s_branch L122
L123:
  buffer_store_dword v233, off, s[64:67], s82 offset:3072 sc1
  s_nop 0
  s_branch L124
L127:
  s_mov_b32 s95, 131072
L186:
  s_sub_u32 s95, s95, 1
  s_cbranch_scc1 L_abort
  s_add_u32 s23, s21, 0
  buffer_load_dwordx4 v[172:175], v216, s[64:67], s23 offen offset:0 sc1
  buffer_load_dwordx4 v[144:147], v216, s[64:67], s23 offen offset:1024 sc1
  buffer_load_dwordx4 v[148:151], v216, s[64:67], s23 offen offset:2048 sc1
  buffer_load_dwordx4 v[152:155], v216, s[64:67], s23 offen offset:3072 sc1
  s_add_u32 s23, s21, 4096
  buffer_load_dwordx4 v[156:159], v216, s[64:67], s23 offen offset:0 sc1
  buffer_load_dwordx4 v[160:163], v216, s[64:67], s23 offen offset:1024 sc1
  buffer_load_dwordx4 v[164:167], v216, s[64:67], s23 offen offset:2048 sc1
  s_waitcnt vmcnt(0)
  v_max_u32 v217, v172, v173
  v_max3_u32 v217, v217, v174, v175
  v_max3_u32 v217, v217, v144, v145
  v_max3_u32 v217, v217, v146, v147
  v_max3_u32 v217, v217, v148, v149
  v_max3_u32 v217, v217, v150, v151
  v_max3_u32 v217, v217, v152, v153
  v_max3_u32 v217, v217, v154, v155
  v_max3_u32 v217, v217, v156, v157
  v_max3_u32 v217, v217, v158, v159
  v_max3_u32 v217, v217, v160, v161
  v_max3_u32 v217, v217, v162, v163
  v_max3_u32 v217, v217, v164, v165
  v_max3_u32 v217, v217, v166, v167
  v_cmp_eq_u32 vcc, -1, v217
  s_nop 0
  s_cbranch_vccnz L186
  s_branch L128
L129:
  s_mov_b32 s95, 131072
L187:
  s_sub_u32 s95, s95, 1
  s_cbranch_scc1 L_abort
  s_add_u32 s23, s21, 0
  buffer_load_dwordx4 v[172:175], v216, s[64:67], s23 offen offset:0 sc1
  buffer_load_dwordx4 v[144:147], v216, s[64:67], s23 offen offset:1024 sc1
  buffer_load_dwordx4 v[148:151], v216, s[64:67], s23 offen offset:2048 sc1
  buffer_load_dwordx4 v[152:155], v216, s[64:67], s23 offen offset:3072 sc1
  s_add_u32 s23, s21, 4096
  buffer_load_dwordx4 v[156:159], v216, s[64:67], s23 offen offset:0 sc1
  buffer_load_dwordx4 v[160:163], v216, s[64:67], s23 offen offset:1024 sc1
  buffer_load_dwordx4 v[164:167], v216, s[64:67], s23 offen offset:2048 sc1
  s_waitcnt vmcnt(0)
  v_max_u32 v217, v172, v173
  v_max3_u32 v217, v217, v174, v175
  v_max3_u32 v217, v217, v144, v145
  v_max3_u32 v217, v217, v146, v147
  v_max3_u32 v217, v217, v148, v149
  v_max3_u32 v217, v217, v150, v151
  v_max3_u32 v217, v217, v152, v153
  v_max3_u32 v217, v217, v154, v155
  v_max3_u32 v217, v217, v156, v157
  v_max3_u32 v217, v217, v158, v159
  v_max3_u32 v217, v217, v160, v161
  v_max3_u32 v217, v217, v162, v163
  v_max3_u32 v217, v217, v164, v165
  v_max3_u32 v217, v217, v166, v167
  v_cmp_eq_u32 vcc, -1, v217
  s_nop 0
  s_cbranch_vccnz L187
  s_add_u32 s23, s20, 0
  buffer_load_dwordx4 v[144:147], v1, s[64:67], s23 offen offset:0 sc1
  buffer_load_dwordx4 v[148:151], v1, s[64:67], s23 offen offset:1024 sc1
  buffer_load_dwordx4 v[152:155], v1, s[64:67], s23 offen offset:2048 sc1
  buffer_load_dwordx4 v[156:159], v1, s[64:67], s23 offen offset:3072 sc1
  s_add_u32 s23, s20, 4096
  buffer_load_dwordx4 v[160:163], v1, s[64:67], s23 offen offset:0 sc1
  buffer_load_dwordx4 v[164:167], v1, s[64:67], s23 offen offset:1024 sc1
  buffer_load_dwordx4 v[168:171], v1, s[64:67], s23 offen offset:2048 sc1
  s_waitcnt vmcnt(6)
  v_mfma_f32_32x32x16_bf16 v[192:207], v[20:23], v[144:147], 0
  v_mfma_f32_32x32x16_bf16 v[176:191], v[16:19], v[144:147], v[128:143]
  s_waitcnt vmcnt(5)
  v_mfma_f32_32x32x16_bf16 v[192:207], v[28:31], v[148:151], v[192:207]
  v_mfma_f32_32x32x16_bf16 v[176:191], v[24:27], v[148:151], v[176:191]
  s_waitcnt vmcnt(4)
  v_mfma_f32_32x32x16_bf16 v[192:207], v[36:39], v[152:155], v[192:207]
  v_mfma_f32_32x32x16_bf16 v[176:191], v[32:35], v[152:155], v[176:191]
  s_waitcnt vmcnt(3)
  v_mfma_f32_32x32x16_bf16 v[192:207], v[44:47], v[156:159], v[192:207]
  v_mfma_f32_32x32x16_bf16 v[176:191], v[40:43], v[156:159], v[176:191]
  s_waitcnt vmcnt(2)
  v_mfma_f32_32x32x16_bf16 v[192:207], v[52:55], v[160:163], v[192:207]
  v_mfma_f32_32x32x16_bf16 v[176:191], v[48:51], v[160:163], v[176:191]
  s_waitcnt vmcnt(1)
  v_mfma_f32_32x32x16_bf16 v[192:207], v[60:63], v[164:167], v[192:207]
  v_mfma_f32_32x32x16_bf16 v[176:191], v[56:59], v[164:167], v[176:191]
  s_waitcnt vmcnt(0)
  v_mfma_f32_32x32x16_bf16 v[192:207], v[68:71], v[168:171], v[192:207]
  v_mfma_f32_32x32x16_bf16 v[176:191], v[64:67], v[168:171], v[176:191]
  s_add_u32 s23, s21, 0
  buffer_load_dwordx4 v[172:175], v216, s[64:67], s23 offen offset:0 sc1
  buffer_load_dwordx4 v[144:147], v216, s[64:67], s23 offen offset:1024 sc1
  buffer_load_dwordx4 v[148:151], v216, s[64:67], s23 offen offset:2048 sc1
  buffer_load_dwordx4 v[152:155], v216, s[64:67], s23 offen offset:3072 sc1
  s_add_u32 s23, s21, 4096
  buffer_load_dwordx4 v[156:159], v216, s[64:67], s23 offen offset:0 sc1
  buffer_load_dwordx4 v[160:163], v216, s[64:67], s23 offen offset:1024 sc1
  buffer_load_dwordx4 v[164:167], v216, s[64:67], s23 offen offset:2048 sc1
  s_waitcnt vmcnt(6)
  v_mfma_f32_32x32x16_bf16 v[192:207], v[76:79], v[172:175], v[192:207]
  v_mfma_f32_32x32x16_bf16 v[176:191], v[72:75], v[172:175], v[176:191]
  s_waitcnt vmcnt(5)
  v_mfma_f32_32x32x16_bf16 v[192:207], v[84:87], v[144:147], v[192:207]
  s_waitcnt vmcnt(4)
  v_mfma_f32_32x32x16_bf16 v[192:207], v[92:95], v[148:151], v[192:207]
  s_waitcnt vmcnt(3)
  v_mfma_f32_32x32x16_bf16 v[192:207], v[100:103], v[152:155], v[192:207]
  s_waitcnt vmcnt(2)
  v_mfma_f32_32x32x16_bf16 v[192:207], v[108:111], v[156:159], v[192:207]
  s_waitcnt vmcnt(1)
  v_mfma_f32_32x32x16_bf16 v[192:207], v[116:119], v[160:163], v[192:207]
  s_waitcnt vmcnt(0)
  v_mfma_f32_32x32x16_bf16 v[192:207], v[124:127], v[164:167], v[192:207]
  s_nop 15
  s_branch L130
L131:
  buffer_store_dwordx4 v[192:195], v1, s[64:67], s24 offen offset:0 sc1
  buffer_store_dwordx4 v[196:199], v1, s[64:67], s24 offen offset:1024 sc1
  s_nop 0
  s_branch L132
L133:
  buffer_store_dword v233, off, s[64:67], s82 offset:3328 sc1
  s_nop 0
  s_branch L134
L137:
  buffer_store_dword v14, v2, s[64:67], s89 offen sc1
  s_nop 0
  s_branch L138
L139:
  s_mov_b32 s95, 131072
L188:
  buffer_load_dword v176, v2, s[64:67], s8 offen offset:0 sc1
  buffer_load_dword v177, v2, s[64:67], s8 offen offset:256 sc1
  buffer_load_dword v178, v2, s[64:67], s8 offen offset:512 sc1
  buffer_load_dword v179, v2, s[64:67], s8 offen offset:768 sc1
  buffer_load_dword v180, v2, s[64:67], s8 offen offset:1024 sc1
  buffer_load_dword v181, v2, s[64:67], s8 offen offset:1280 sc1
  buffer_load_dword v182, v2, s[64:67], s8 offen offset:1536 sc1
  s_sub_u32 s95, s95, 1
  s_cbranch_scc1 L_abort
  s_waitcnt vmcnt(0)
  v_max3_u32 v239, v176, v177, v178
  v_max3_u32 v238, v179, v180, v181
  v_max3_u32 v239, v239, v238, v182
  v_cmp_eq_u32 vcc, -1, v239
  s_nop 0
  s_cbranch_vccnz L188
  s_branch L140
L141:
  buffer_store_dword v11, off, s[64:67], s82 offset:3584 sc1
  s_nop 0
  s_branch L142
L143:
  buffer_load_dword v14, v13, s[64:67], s88 offen sc1
  s_mov_b32 s95, 131072
L189:
  s_waitcnt vmcnt(0)
  v_cmp_eq_u32 vcc, 0, v14
  s_nop 0
  s_cbranch_vccz L190
  buffer_load_dword v14, v13, s[64:67], s88 offen sc1
  s_sub_u32 s95, s95, 1
  s_cbranch_scc0 L189
  s_branch L_abort
L190:
  s_branch L144
L145:
  buffer_store_dword v11, off, s[64:67], s82 offset:2304 sc1
  s_nop 0
  s_branch L146
L147:
  buffer_load_dword v14, v13, s[64:67], s89 offen sc1
  s_mov_b32 s95, 131072
L191:
  s_waitcnt vmcnt(0)
  v_cmp_eq_u32 vcc, 0, v14
  s_nop 0
  s_cbranch_vccz L192
  buffer_load_dword v14, v13, s[64:67], s89 offen sc1
  s_sub_u32 s95, s95, 1
  s_cbranch_scc0 L191
  s_branch L_abort
L192:
  s_branch L148
L103:
  s_waitcnt vmcnt(0) lgkmcnt(0)
  s_lshr_b32 s7, s2, 7
  s_lshl_b32 s7, s7, 3
  s_lshl_b32 s3, s71, 2
  s_add_u32 s7, s7, s3
  s_add_u32 s7, s7, s72
  v_min_u32 v230, 55, v0
  v_mul_u32_u24 v231, 37, v230
  v_lshrrev_b32 v231, 9, v231
  v_mul_u32_u24 v231, 1792, v231
  v_lshl_add_u32 v230, v230, 7, v231
  s_mul_i32 s8, s7, 100352
  s_add_u32 s8, s8, 0x700
  buffer_load_dword v15, v230, s[48:51], s8 offen sc1
  s_add_u32 s8, s8, 14336
  buffer_load_dword v15, v230, s[48:51], s8 offen sc1
  s_add_u32 s8, s8, 14336
  buffer_load_dword v15, v230, s[48:51], s8 offen sc1
  s_add_u32 s8, s8, 14336
  buffer_load_dword v15, v230, s[48:51], s8 offen sc1
  s_add_u32 s8, s8, 14336
  buffer_load_dword v15, v230, s[48:51], s8 offen sc1
  s_add_u32 s8, s8, 14336
  buffer_load_dword v15, v230, s[48:51], s8 offen sc1
  s_add_u32 s8, s8, 14336
  buffer_load_dword v15, v230, s[48:51], s8 offen sc1
  s_add_u32 s8, s8, 14336
  s_lshr_b32 s4, s2, 7
  s_lshl_b32 s4, s4, 16
  s_lshl_b32 s3, s71, 15
  s_add_u32 s4, s4, s3
  s_lshl_b32 s3, s72, 13
  s_add_u32 s4, s4, s3
  v_lshlrev_b32 v230, 7, v0
  v_add_u32 v230, s4, v230
  v_min_u32 v230, L_last-L_pc, v230
  global_load_dword v15, v230, s[26:27] sc1
  s_branch L_end
L_last:
  s_endpgm
.section .rodata,"a"
.p2align 6
.amdhsa_kernel interleave_layers__mha_block__mixer_s_mlp__prompt_kernel
  .amdhsa_next_free_vgpr 512
  .amdhsa_next_free_sgpr 102
  .amdhsa_accum_offset 256
  .amdhsa_group_segment_fixed_size 0
  .amdhsa_kernarg_size 88
  .amdhsa_user_sgpr_count 2
  .amdhsa_user_sgpr_kernarg_segment_ptr 1
  .amdhsa_system_sgpr_workgroup_id_x 1
.end_amdhsa_kernel
```
